```python
import torch

def _softmax(x, axis=-1):
    return torch.softmax(x, dim=axis)
def _gelu(x):
    return torch.nn.functional.gelu(x, approximate="tanh")
def _silu(x):
    return torch.nn.functional.silu(x)
def _sigmoid(x):
    return torch.sigmoid(x)
def _layernorm(x, axis=-1, eps=1e-5):
    m = x.mean(dim=axis, keepdim=True)
    v = x.var(dim=axis, keepdim=True, unbiased=False)
    return (x - m) / torch.sqrt(v + eps)
def _scatter_add(tgt, idx, src, axis=0):
    return tgt.clone().index_add_(axis, idx, src)
def _segment_sum(src, seg, n):
    out = torch.zeros((n,) + src.shape[1:], dtype=src.dtype)
    return out.index_add_(0, seg, src)
def _pad(x, pw):
    flat = tuple(v for pair in reversed(pw) for v in pair)
    return torch.nn.functional.pad(x, flat)

kernel_name = 'gated_mix__spectral_gfnet__dense_activation_gelu__prompt'

def setup_inputs():

    _w = (lambda a: (lambda t: t.to(torch.bfloat16) if t.is_floating_point() else t)(torch.as_tensor(a)))
    def _A_setup():
        B, S, D = 1, 2048, 1024
        Df = D // 2 + 1
        return {
            "x": _w((lambda *s: torch.randn(*s, dtype=torch.bfloat16) * 0.05)(B, S, D)),
            "w_r": _w((lambda *s: torch.randn(*s, dtype=torch.bfloat16) * 3.2)(S, Df) * 0.02),
            "w_i": _w((lambda *s: torch.randn(*s, dtype=torch.bfloat16) * 3.2)(S, Df) * 0.02),
        }
    _A_in = _A_setup()

    def _B_setup():
        B, S, D, F = 1, 2048, 1024, 3584
        return {
            "x": _w((lambda *s: torch.randn(*s, dtype=torch.bfloat16) * 0.05)(B, S, D)),
            "w1": _w((lambda *s: torch.randn(*s, dtype=torch.bfloat16) * 3.2)(D, F) * (D ** -0.5)),
            "b1": _w((lambda *s: torch.randn(*s, dtype=torch.bfloat16) * 3.2)(F) * 0.01),
            "w2": _w((lambda *s: torch.randn(*s, dtype=torch.bfloat16) * 0.2)(F, D) * (F ** -0.5)),
            "b2": _w((lambda *s: torch.randn(*s, dtype=torch.bfloat16) * 0.4)(D) * 0.01),
        }
    _B_in = _B_setup()

    return {
        "A_x": _A_in["x"],
        "A_w_r": _A_in["w_r"],
        "A_w_i": _A_in["w_i"],
        "B_x": _B_in["x"],
        "B_w1": _B_in["w1"],
        "B_b1": _B_in["b1"],
        "B_w2": _B_in["w2"],
        "B_b2": _B_in["b2"],
        "gate_w": _w((lambda *s: torch.randn(*s, dtype=torch.bfloat16) * 0.05)(1024) * 16.0),
    }

def reference(A_x, A_w_r, A_w_i, B_x, B_w1, B_b1, B_w2, B_b2, gate_w):
    def _A_ref(x, w_r, w_i):
        B, S, D = x.shape
        X = (lambda x, axes=(-2,-1): torch.fft.rfft2(x.float(), dim=axes))(x, axes=(-2, -1))
        W = w_r + 1j * w_i
        X = X * W
        y = (lambda x, s, axes=(-2,-1): torch.fft.irfft2(x, s=s, dim=axes).to(torch.bfloat16))(X, (S, D), axes=(-2, -1))
        return y

    def _B_ref(x, w1, b1, w2, b2):
        h = torch.einsum("bsd,df->bsf", x, w1) + b1
        h = _gelu(h)
        return torch.einsum("bsf,fd->bsd", h, w2) + b2

    x = A_x
    g = _sigmoid((x * gate_w).sum(-1, keepdims=True))
    a = _A_ref(x, A_w_r, A_w_i)
    b = _B_ref(x, B_w1, B_b1, B_w2, B_b2)
    return g * a + (1 - g) * b
```

```asm
; @launch kernel=gated_mix__spectral_gfnet__dense_activation_gelu__prompt_kernel grid=(256,1,1) block=(512,1,1) lds=163840
.amdgcn_target "amdgcn-amd-amdhsa--gfx950"
.text
.globl gated_mix__spectral_gfnet__dense_activation_gelu__prompt_kernel
.p2align 8
.type gated_mix__spectral_gfnet__dense_activation_gelu__prompt_kernel,@function
gated_mix__spectral_gfnet__dense_activation_gelu__prompt_kernel:
    s_cmp_ge_u32 s2, 256
    s_cbranch_scc1 gated__end
    s_load_dwordx16 s[64:79], s[0:1], 0
    s_load_dwordx8 s[80:87], s[0:1], 64
    v_lshrrev_b32 v1, 6, v0
    v_and_b32 v0, 63, v0
    v_readfirstlane_b32 s30, v1
    s_and_b32 s34, s2, 3
    s_bfe_u32 s31, s2, 0x10002
    s_bfe_u32 s35, s2, 0x20003
    s_lshr_b32 s32, s2, 5
    s_lshl_b32 s28, s34, 2
    s_add_u32 s28, s28, s35
    s_lshl_b32 s29, s31, 3
    s_add_u32 s29, s29, s32
    s_lshl_b32 s33, s28, 4
    s_add_u32 s33, s33, s29
    v_and_b32 v14, 15, v0
    v_lshrrev_b32 v15, 4, v0
    v_lshlrev_b32 v13, 4, v0
    v_mov_b32 v1, 0
    s_cmp_ge_u32 s30, 4
    s_cbranch_scc1 gated__L
    s_getpc_b64 s[44:45]
    s_add_u32 s44, s44, fft_tab@rel32@lo+4
    s_addc_u32 s45, s45, fft_tab@rel32@hi+12
    s_mov_b32 s16, s44
    s_and_b32 s17, s45, 0xffff
    s_mov_b32 s18, 108544
    s_mov_b32 s19, 0x00020000
    s_mov_b32 s34, 0
    buffer_load_dwordx4 v[104:107], v13, s[16:19], s34 offen offset:0
    buffer_load_dwordx4 v[108:111], v13, s[16:19], s34 offen offset:1024
    buffer_load_dwordx4 v[112:115], v13, s[16:19], s34 offen offset:2048
    buffer_load_dwordx4 v[116:119], v13, s[16:19], s34 offen offset:3072
    s_mov_b32 s34, 4096
    buffer_load_dwordx4 v[120:123], v13, s[16:19], s34 offen offset:0
    buffer_load_dwordx4 v[124:127], v13, s[16:19], s34 offen offset:1024
    buffer_load_dwordx4 v[128:131], v13, s[16:19], s34 offen offset:2048
    buffer_load_dwordx4 v[132:135], v13, s[16:19], s34 offen offset:3072
    s_mov_b32 s34, 8192
    buffer_load_dwordx4 v[136:139], v13, s[16:19], s34 offen offset:0
    buffer_load_dwordx4 v[140:143], v13, s[16:19], s34 offen offset:1024
    buffer_load_dwordx4 v[144:147], v13, s[16:19], s34 offen offset:2048
    buffer_load_dwordx4 v[148:151], v13, s[16:19], s34 offen offset:3072
    s_mov_b32 s34, 12288
    buffer_load_dwordx4 v[152:155], v13, s[16:19], s34 offen offset:0
    buffer_load_dwordx4 v[156:159], v13, s[16:19], s34 offen offset:1024
    buffer_load_dwordx4 v[160:163], v13, s[16:19], s34 offen offset:2048
    buffer_load_dwordx4 v[164:167], v13, s[16:19], s34 offen offset:3072
    s_mov_b32 s34, 16384
    buffer_load_dwordx4 v[168:171], v13, s[16:19], s34 offen offset:0
    buffer_load_dwordx4 v[172:175], v13, s[16:19], s34 offen offset:1024
    s_branch gated__Mc
gated__L:
    s_sub_u32 s30, s30, 4
    s_and_b32 s3, s2, 7
    s_lshl_b32 s3, s3, 1
    s_bfe_u32 s34, s2, 0x10003
    s_or_b32 s3, s3, s34
    s_and_b32 s34, s2, 0xf0
    s_or_b32 s3, s3, s34
    s_lshl_b32 s52, s30, 12
    s_getpc_b64 s[38:39]
    s_add_u32 s38, s38, fft_tab@rel32@lo+4
    s_addc_u32 s39, s39, fft_tab@rel32@hi+12
    s_mov_b32 s16, s38
    s_and_b32 s17, s39, 0xffff
    s_mov_b32 s18, 108544
    s_mov_b32 s19, 0x00020000
    v_lshlrev_b32 v59, 2, v0
    s_cmp_ge_u32 s30, 2
    s_cbranch_scc1 gated__X
    v_lshrrev_b32 v30, 3, v0
    v_and_b32 v31, 7, v0
    v_lshlrev_b32 v30, 11, v30
    v_xor_b32 v32, v31, v15
    v_lshl_add_u32 v2, v32, 4, v30
    v_xor_b32 v3, 64, v2
    v_add_u32 v3, 15360, v3
    s_lshl_b32 s57, s28, 18
    s_lshl_b32 s34, s30, 17
    s_add_u32 s57, s57, s34
    s_mul_i32 s58, s29, 448
    s_mul_i32 s34, s30, 229376
    s_add_u32 s58, s58, s34
    s_movk_i32 s36, 2341
    s_movk_i32 s37, 7168
    v_add_u32 v32, 0, v0
    v_add_u32 v35, 64, v0
    v_add_u32 v38, 128, v0
    v_add_u32 v41, 192, v0
    v_add_u32 v44, 256, v0
    v_add_u32 v47, 320, v0
    v_add_u32 v50, 384, v0
    v_mul_u32_u24 v33, s36, v32
    v_mul_u32_u24 v36, s36, v35
    v_mul_u32_u24 v39, s36, v38
    v_mul_u32_u24 v42, s36, v41
    v_mul_u32_u24 v45, s36, v44
    v_mul_u32_u24 v48, s36, v47
    v_mul_u32_u24 v51, s36, v50
    v_lshrrev_b32 v33, 16, v33
    v_lshrrev_b32 v36, 16, v36
    v_lshrrev_b32 v39, 16, v39
    v_lshrrev_b32 v42, 16, v42
    v_lshrrev_b32 v45, 16, v45
    v_lshrrev_b32 v48, 16, v48
    v_lshrrev_b32 v51, 16, v51
    v_mul_u32_u24 v34, 28, v33
    v_mul_u32_u24 v37, 28, v36
    v_mul_u32_u24 v40, 28, v39
    v_mul_u32_u24 v43, 28, v42
    v_mul_u32_u24 v46, 28, v45
    v_mul_u32_u24 v49, 28, v48
    v_mul_u32_u24 v52, 28, v51
    v_sub_u32 v34, v32, v34
    v_sub_u32 v37, v35, v37
    v_sub_u32 v40, v38, v40
    v_sub_u32 v43, v41, v43
    v_sub_u32 v46, v44, v46
    v_sub_u32 v49, v47, v49
    v_sub_u32 v52, v50, v52
    v_lshrrev_b32 v32, 2, v33
    v_lshrrev_b32 v35, 2, v36
    v_lshrrev_b32 v38, 2, v39
    v_lshrrev_b32 v41, 2, v42
    v_lshrrev_b32 v44, 2, v45
    v_lshrrev_b32 v47, 2, v48
    v_lshrrev_b32 v50, 2, v51
    v_and_b32 v32, 2, v32
    v_and_b32 v35, 2, v35
    v_and_b32 v38, 2, v38
    v_and_b32 v41, 2, v41
    v_and_b32 v44, 2, v44
    v_and_b32 v47, 2, v47
    v_and_b32 v50, 2, v50
    v_xor_b32 v34, v34, v32
    v_xor_b32 v37, v37, v35
    v_xor_b32 v40, v40, v38
    v_xor_b32 v43, v43, v41
    v_xor_b32 v46, v46, v44
    v_xor_b32 v49, v49, v47
    v_xor_b32 v52, v52, v50
    v_mul_u32_u24 v32, s37, v33
    v_mul_u32_u24 v35, s37, v36
    v_mul_u32_u24 v38, s37, v39
    v_mul_u32_u24 v41, s37, v42
    v_mul_u32_u24 v44, s37, v45
    v_mul_u32_u24 v47, s37, v48
    v_mul_u32_u24 v50, s37, v51
    v_lshl_add_u32 v16, v34, 4, v32
    v_lshl_add_u32 v17, v37, 4, v35
    v_lshl_add_u32 v18, v40, 4, v38
    v_lshl_add_u32 v19, v43, 4, v41
    v_lshl_add_u32 v20, v46, 4, v44
    v_lshl_add_u32 v21, v49, 4, v47
    v_lshl_add_u32 v22, v52, 4, v50
    v_subrev_u32 v17, 1024, v17
    v_subrev_u32 v18, 2048, v18
    v_subrev_u32 v19, 3072, v19
    v_subrev_u32 v21, 1024, v21
    v_subrev_u32 v22, 2048, v22
    s_lshl_b32 s53, s30, 13
    s_mul_i32 s56, s30, 14336
    s_add_u32 s56, s56, 16384
    s_waitcnt lgkmcnt(0)
    s_mov_b32 s4, s64
    s_and_b32 s5, s65, 0xffff
    s_mov_b32 s6, 4194304
    s_mov_b32 s7, 0x00020000
    s_mov_b32 s8, s72
    s_and_b32 s9, s73, 0xffff
    s_mov_b32 s10, 7340032
    s_mov_b32 s11, 0x00020000
    s_and_b32 s59, s2, 3
    s_lshl_b32 s59, s59, 2
    s_add_u32 s59, s59, 0
    s_and_b32 s59, s59, 15
    s_lshl_b32 s60, s59, 7
    s_add_u32 s60, s60, s57
    s_mul_i32 s59, s59, 458752
    s_add_u32 s59, s59, s58
    s_add_u32 m0, s53, 0
    s_add_u32 s54, s60, 0
    buffer_load_dwordx4 v2, s[4:7], s54 offen lds
    buffer_load_dwordx4 v3, s[4:7], s54 offen offset:1024 lds
    s_add_u32 m0, s53, 2048
    s_add_u32 s54, s60, 32768
    buffer_load_dwordx4 v2, s[4:7], s54 offen lds
    buffer_load_dwordx4 v3, s[4:7], s54 offen offset:1024 lds
    s_add_u32 m0, s53, 4096
    s_add_u32 s54, s60, 65536
    buffer_load_dwordx4 v2, s[4:7], s54 offen lds
    buffer_load_dwordx4 v3, s[4:7], s54 offen offset:1024 lds
    s_add_u32 m0, s53, 6144
    s_add_u32 s54, s60, 98304
    buffer_load_dwordx4 v2, s[4:7], s54 offen lds
    buffer_load_dwordx4 v3, s[4:7], s54 offen offset:1024 lds
    s_add_u32 s54, s59, 0
    s_add_u32 m0, s56, 0
    s_nop 0
    buffer_load_dwordx4 v16, s[8:11], s54 offen offset:0 lds
    buffer_load_dwordx4 v17, s[8:11], s54 offen offset:1024 lds
    buffer_load_dwordx4 v18, s[8:11], s54 offen offset:2048 lds
    buffer_load_dwordx4 v19, s[8:11], s54 offen offset:3072 lds
    s_add_u32 m0, s56, 4096
    s_nop 0
    buffer_load_dwordx4 v20, s[8:11], s54 offen offset:0 lds
    buffer_load_dwordx4 v21, s[8:11], s54 offen offset:1024 lds
    buffer_load_dwordx4 v22, s[8:11], s54 offen offset:2048 lds
    s_add_u32 s54, s59, 114688
    s_add_u32 m0, s56, 7168
    s_nop 0
    buffer_load_dwordx4 v16, s[8:11], s54 offen offset:0 lds
    buffer_load_dwordx4 v17, s[8:11], s54 offen offset:1024 lds
    buffer_load_dwordx4 v18, s[8:11], s54 offen offset:2048 lds
    buffer_load_dwordx4 v19, s[8:11], s54 offen offset:3072 lds
    s_add_u32 m0, s56, 11264
    s_nop 0
    buffer_load_dwordx4 v20, s[8:11], s54 offen offset:0 lds
    buffer_load_dwordx4 v21, s[8:11], s54 offen offset:1024 lds
    buffer_load_dwordx4 v22, s[8:11], s54 offen offset:2048 lds
    s_branch gated__Dc
gated__X:
    s_sub_u32 s57, s30, 2
    s_and_b32 s56, s2, 31
    s_and_b32 s58, s2, 63
    s_lshr_b32 s59, s2, 6
    s_lshl_b32 s34, s32, 3
    s_lshl_b32 s35, s57, 2
    s_add_u32 s34, s34, s35
    s_lshl_b32 s34, s34, 5
    s_add_u32 s60, s34, s56
    v_lshrrev_b32 v2, 4, v0
    v_and_b32 v2, 2, v2
    v_xor_b32 v2, v0, v2
    v_lshlrev_b32 v2, 4, v2
    s_lshl_b32 s53, s57, 13
    s_add_u32 s53, s53, 135168
    s_lshl_b32 s34, s60, 11
    s_waitcnt lgkmcnt(0)
    s_mov_b32 s4, s64
    s_and_b32 s5, s65, 0xffff
    s_mov_b32 s6, 4194304
    s_mov_b32 s7, 0x00020000
    s_add_u32 m0, s53, 0
    s_nop 0
    buffer_load_dwordx4 v2, s[4:7], s34 offen lds
    buffer_load_dwordx4 v2, s[4:7], s34 offen offset:1024 lds
    s_add_u32 s34, s34, 65536
    s_add_u32 m0, s53, 2048
    s_nop 0
    buffer_load_dwordx4 v2, s[4:7], s34 offen lds
    buffer_load_dwordx4 v2, s[4:7], s34 offen offset:1024 lds
    s_add_u32 s34, s34, 65536
    s_add_u32 m0, s53, 4096
    s_nop 0
    buffer_load_dwordx4 v2, s[4:7], s34 offen lds
    buffer_load_dwordx4 v2, s[4:7], s34 offen offset:1024 lds
    s_add_u32 s34, s34, 65536
    s_add_u32 m0, s53, 6144
    s_nop 0
    buffer_load_dwordx4 v2, s[4:7], s34 offen lds
    buffer_load_dwordx4 v2, s[4:7], s34 offen offset:1024 lds
    s_add_u32 s34, s34, 65536
    s_mov_b32 s40, s74
    s_and_b32 s41, s75, 0xffff
    s_mov_b32 s42, 7168
    s_mov_b32 s43, 0x00020000
    s_mul_i32 s34, s29, 448
    s_mov_b32 m0, 151552
    s_mov_b32 exec_lo, 0x0fffffff
    s_mov_b32 exec_hi, 0
    buffer_load_dwordx4 v13, s[40:43], s34 offen lds
    s_mov_b64 exec, -1
    s_branch gated__Xc
gated__Xc:
    s_mov_b32 s12, s86
    s_and_b32 s13, s87, 0xffff
    s_mov_b32 s14, 42467328
    s_mov_b32 s15, 0x00020000
    s_mov_b32 s20, s76
    s_and_b32 s21, s77, 0xffff
    s_mov_b32 s22, 7340032
    s_mov_b32 s23, 0x00020000
    s_mov_b32 s24, s84
    s_and_b32 s25, s85, 0xffff
    s_mov_b32 s26, 256
    s_mov_b32 s27, 0x00020000
    s_mov_b32 s44, s66
    s_and_b32 s45, s67, 0xffff
    s_mov_b32 s46, 2101248
    s_mov_b32 s47, 0x00020000
    s_mov_b32 s48, s68
    s_and_b32 s49, s69, 0xffff
    s_mov_b32 s50, 2101248
    s_mov_b32 s51, 0x00020000
    v_lshlrev_b32 v4, 2, v0
    v_add_u32 v5, 163712, v4
    s_mov_b64 exec, 0xffff
    ds_write_b32 v5, v1
    s_mov_b64 exec, -1
    v_lshrrev_b32 v16, 2, v0
    v_and_b32 v17, 3, v0
    v_lshl_add_u32 v19, v17, 8, v16
    v_sub_u32 v20, 1055, v19
    v_cmp_gt_u32 vcc, 2, v17
    v_add_u32 v21, 16, v16
    v_cmp_eq_u32 s[34:35], 2, v17
    v_add_u32 v40, 0, v19
    v_add_u32 v41, 32, v19
    v_add_u32 v42, 64, v19
    v_add_u32 v43, 96, v19
    v_add_u32 v44, 128, v19
    v_add_u32 v45, 160, v19
    v_add_u32 v46, 192, v19
    v_add_u32 v47, 224, v19
    v_subrev_u32 v24, 0, v20
    v_subrev_u32 v25, 32, v20
    v_subrev_u32 v26, 64, v20
    v_subrev_u32 v27, 96, v20
    v_subrev_u32 v28, 128, v20
    v_subrev_u32 v29, 160, v20
    v_subrev_u32 v30, 192, v20
    v_subrev_u32 v31, 224, v20
    v_cndmask_b32 v40, v24, v40, vcc
    v_cndmask_b32 v41, v25, v41, vcc
    v_cndmask_b32 v42, v26, v42, vcc
    v_cndmask_b32 v43, v27, v43, vcc
    v_cndmask_b32 v44, v28, v44, vcc
    v_cndmask_b32 v45, v29, v45, vcc
    v_cndmask_b32 v46, v30, v46, vcc
    v_cndmask_b32 v47, v31, v47, vcc
    v_cndmask_b32 v40, v40, v21, s[34:35]
    v_lshrrev_b32 v24, 6, v40
    v_lshrrev_b32 v25, 6, v41
    v_lshrrev_b32 v26, 6, v42
    v_lshrrev_b32 v27, 6, v43
    v_lshrrev_b32 v28, 6, v44
    v_lshrrev_b32 v29, 6, v45
    v_lshrrev_b32 v30, 6, v46
    v_lshrrev_b32 v31, 6, v47
    v_and_b32 v24, 4, v24
    v_and_b32 v25, 4, v25
    v_and_b32 v26, 4, v26
    v_and_b32 v27, 4, v27
    v_and_b32 v28, 4, v28
    v_and_b32 v29, 4, v29
    v_and_b32 v30, 4, v30
    v_and_b32 v31, 4, v31
    v_xor_b32 v40, v40, v24
    v_xor_b32 v41, v41, v25
    v_xor_b32 v42, v42, v26
    v_xor_b32 v43, v43, v27
    v_xor_b32 v44, v44, v28
    v_xor_b32 v45, v45, v29
    v_xor_b32 v46, v46, v30
    v_xor_b32 v47, v47, v31
    v_lshl_add_u32 v40, v40, 4, s53
    v_lshl_add_u32 v41, v41, 4, s53
    v_lshl_add_u32 v42, v42, 4, s53
    v_lshl_add_u32 v43, v43, 4, s53
    v_lshl_add_u32 v44, v44, 4, s53
    v_lshl_add_u32 v45, v45, 4, s53
    v_lshl_add_u32 v46, v46, 4, s53
    v_lshl_add_u32 v47, v47, 4, s53
    s_and_b32 s34, s56, 3
    v_xor_b32 v16, s34, v0
    v_lshrrev_b32 v17, 2, v0
    v_lshlrev_b32 v17, 1, v17
    v_and_b32 v18, 1, v16
    v_add_u32 v18, v17, v18
    s_lshl_b32 s35, s57, 3
    v_xor_b32 v18, s35, v18
    v_lshlrev_b32 v18, 3, v18
    v_bfe_u32 v19, v16, 1, 1
    v_lshl_add_u32 v18, v19, 13, v18
    s_lshl_b32 s35, s57, 11
    s_add_u32 s35, s35, 135168
    v_add_u32 v6, s35, v18
    v_and_b32 v18, 1, v0
    v_add_u32 v18, v17, v18
    s_lshl_b32 s35, s57, 2
    v_xor_b32 v18, s35, v18
    v_lshlrev_b32 v18, 4, v18
    v_bfe_u32 v19, v0, 1, 1
    v_lshl_add_u32 v18, v19, 13, v18
    s_lshl_b32 s35, s57, 12
    s_add_u32 s35, s35, 135168
    v_add_u32 v7, s35, v18
    v_lshrrev_b32 v16, 3, v0
    v_lshlrev_b32 v8, 15, v16
    v_and_b32 v9, 7, v0
    v_lshl_add_u32 v8, v9, 4, v8
    s_lshl_b32 s36, s57, 21
    s_bfe_u32 s34, s56, 0x20002
    s_xor_b32 s34, s34, s32
    v_mov_b32 v17, s34
    s_lshl_b32 s34, s58, 2
    s_add_u32 s34, s34, s59
    s_and_b32 s35, s34, 7
    v_mov_b32 v18, s35
    v_lshl_add_u32 v10, v18, 7, v8
    v_lshl_add_u32 v8, v17, 7, v8
    s_lshl_b32 s35, s56, 10
    s_add_u32 s35, s35, s36
    s_add_u32 s40, s35, 15728640
    s_lshl_b32 s35, s34, 7
    s_add_u32 s42, s35, 24117248
    s_andn2_b32 s35, s35, 0x380
    s_add_u32 s35, s35, s36
    s_add_u32 s41, s35, 19922944
    s_mov_b32 s61, 0x05040100
    s_mov_b32 s62, 0x07060302
    s_mov_b32 s8, s72
    s_and_b32 s9, s73, 0xffff
    s_mov_b32 s10, 7340032
    s_mov_b32 s11, 0x00020000
    v_mul_u32_u24 v50, 4682, v0
    v_lshrrev_b32 v50, 16, v50
    v_mul_u32_u24 v51, 14, v50
    v_sub_u32 v51, v0, v51
    s_mul_i32 s34, s2, 14
    v_add_u32 v51, s34, v51
    v_lshlrev_b32 v51, 7, v51
    s_mov_b32 s34, 458752
    v_mul_lo_u32 v50, v50, s34
    v_add_u32 v50, v50, v51
    s_mul_i32 s43, s57, 1835008
    s_cmp_eq_u32 s57, 0
    s_cselect_b32 s34, s33, s2
    s_lshl_b32 s34, s34, 7
    s_mul_i32 s35, s57, 32768
    s_add_u32 s34, s34, s35
    s_add_u32 s34, s34, 42008576
    s_mov_b32 exec_lo, -1
    s_mov_b32 exec_hi, 0
    buffer_store_dword v1, v4, s[12:15], s34 offen sc1
    s_mov_b64 exec, -1
    s_lshl_b32 s34, s59, 3
    s_lshl_b32 s35, s57, 2
    s_add_u32 s34, s34, s35
    s_add_u32 s34, s34, 0
    s_lshl_b32 s34, s34, 6
    s_add_u32 s34, s34, s58
    s_mul_i32 s34, s34, 1026
    s_mov_b32 s35, 65664
    v_mul_lo_u32 v61, v0, s35
    s_mov_b64 exec, 0xf
    buffer_load_ushort v56, v61, s[44:47], s34 offen offset:1024
    buffer_load_ushort v57, v61, s[48:51], s34 offen offset:1024
    s_mov_b64 exec, -1
    buffer_load_dwordx4 v[224:227], v13, s[44:47], s34 offen
    buffer_load_dwordx4 v[228:231], v13, s[48:51], s34 offen
    s_add_u32 s34, s34, s35
    buffer_load_dwordx4 v[232:235], v13, s[44:47], s34 offen
    buffer_load_dwordx4 v[236:239], v13, s[48:51], s34 offen
    s_add_u32 s34, s34, s35
    s_lshl_b32 s34, s59, 3
    s_lshl_b32 s35, s57, 2
    s_add_u32 s34, s34, s35
    s_add_u32 s34, s34, 2
    s_lshl_b32 s34, s34, 6
    s_add_u32 s34, s34, s58
    s_mul_i32 s34, s34, 1026
    s_mov_b32 s35, 65664
    buffer_load_dwordx4 v[240:243], v13, s[44:47], s34 offen
    buffer_load_dwordx4 v[244:247], v13, s[48:51], s34 offen
    s_add_u32 s34, s34, s35
    buffer_load_dwordx4 v[248:251], v13, s[44:47], s34 offen
    buffer_load_dwordx4 v[252:255], v13, s[48:51], s34 offen
    s_add_u32 s34, s34, s35
    v_lshrrev_b32 v61, 3, v0
    v_lshlrev_b32 v61, 11, v61
    v_lshl_add_u32 v61, v9, 4, v61
    s_lshl_b32 s63, s2, 2
    s_lshl_b32 s34, s57, 1
    s_add_u32 s63, s63, s34
    s_add_u32 s34, s63, 0
    s_cmp_ge_u32 s34, 448
    s_cselect_b32 s35, 448, 0
    s_cselect_b32 s36, 1024, 0
    s_sub_u32 s34, s34, s35
    s_lshl_b32 s34, s34, 14
    s_add_u32 s34, s34, s36
    buffer_load_dwordx4 v[168:171], v61, s[20:23], s34 offen offset:384
    s_add_u32 s34, s63, 1
    s_cmp_ge_u32 s34, 448
    s_cselect_b32 s35, 448, 0
    s_cselect_b32 s36, 1024, 0
    s_sub_u32 s34, s34, s35
    s_lshl_b32 s34, s34, 14
    s_add_u32 s34, s34, s36
    buffer_load_dwordx4 v[172:175], v61, s[20:23], s34 offen offset:384
    s_waitcnt vmcnt(13)
    s_waitcnt lgkmcnt(0)
    s_barrier
    s_and_b32 s34, s3, 7
    s_lshl_b32 s34, s34, 3
    s_lshl_b32 s35, s57, 2
    s_add_u32 s34, s34, s35
    s_lshl_b32 s34, s34, 5
    s_lshr_b32 s35, s3, 3
    s_add_u32 s60, s34, s35
    s_barrier
    s_barrier
    s_barrier
    ds_read2st64_b64 v[64:67], v6 offset0:0 offset1:8
    v_xor_b32 v17, 8, v6
    v_xor_b32 v18, 16, v6
    v_xor_b32 v19, 24, v6
    v_xor_b32 v20, 32, v6
    v_xor_b32 v21, 40, v6
    v_xor_b32 v22, 48, v6
    v_xor_b32 v23, 56, v6
    v_add_u32 v17, 256, v17
    ds_read2st64_b64 v[68:71], v17 offset0:0 offset1:8
    v_add_u32 v18, 512, v18
    ds_read2st64_b64 v[72:75], v18 offset0:0 offset1:8
    v_add_u32 v19, 768, v19
    ds_read2st64_b64 v[76:79], v19 offset0:0 offset1:8
    v_add_u32 v20, 1024, v20
    ds_read2st64_b64 v[80:83], v20 offset0:0 offset1:8
    v_add_u32 v21, 1280, v21
    ds_read2st64_b64 v[84:87], v21 offset0:0 offset1:8
    v_add_u32 v22, 1536, v22
    ds_read2st64_b64 v[88:91], v22 offset0:0 offset1:8
    v_add_u32 v23, 1792, v23
    ds_read2st64_b64 v[92:95], v23 offset0:0 offset1:8
    s_waitcnt lgkmcnt(0)
    buffer_store_dwordx4 v[64:67], v8, s[12:15], s40 offen sc1
    s_add_u32 s40, s40, 262144
    buffer_store_dwordx4 v[68:71], v8, s[12:15], s40 offen sc1
    s_add_u32 s40, s40, 262144
    buffer_store_dwordx4 v[72:75], v8, s[12:15], s40 offen sc1
    s_add_u32 s40, s40, 262144
    buffer_store_dwordx4 v[76:79], v8, s[12:15], s40 offen sc1
    s_add_u32 s40, s40, 262144
    buffer_store_dwordx4 v[80:83], v8, s[12:15], s40 offen sc1
    s_add_u32 s40, s40, 262144
    buffer_store_dwordx4 v[84:87], v8, s[12:15], s40 offen sc1
    s_add_u32 s40, s40, 262144
    buffer_store_dwordx4 v[88:91], v8, s[12:15], s40 offen sc1
    s_add_u32 s40, s40, 262144
    buffer_store_dwordx4 v[92:95], v8, s[12:15], s40 offen sc1
    s_add_u32 s40, s40, 262144
    s_barrier
    s_waitcnt vmcnt(10)
    v_perm_b32 v96, v228, v224, s61
    v_perm_b32 v100, v228, v224, s62
    v_perm_b32 v104, v229, v225, s61
    v_perm_b32 v108, v229, v225, s62
    v_perm_b32 v112, v230, v226, s61
    v_perm_b32 v116, v230, v226, s62
    v_perm_b32 v120, v231, v227, s61
    v_perm_b32 v124, v231, v227, s62
    v_perm_b32 v97, v236, v232, s61
    v_perm_b32 v101, v236, v232, s62
    v_perm_b32 v105, v237, v233, s61
    v_perm_b32 v109, v237, v233, s62
    v_perm_b32 v113, v238, v234, s61
    v_perm_b32 v117, v238, v234, s62
    v_perm_b32 v121, v239, v235, s61
    v_perm_b32 v125, v239, v235, s62
    v_perm_b32 v98, v244, v240, s61
    v_perm_b32 v102, v244, v240, s62
    v_perm_b32 v106, v245, v241, s61
    v_perm_b32 v110, v245, v241, s62
    v_perm_b32 v114, v246, v242, s61
    v_perm_b32 v118, v246, v242, s62
    v_perm_b32 v122, v247, v243, s61
    v_perm_b32 v126, v247, v243, s62
    v_perm_b32 v99, v252, v248, s61
    v_perm_b32 v103, v252, v248, s62
    v_perm_b32 v107, v253, v249, s61
    v_perm_b32 v111, v253, v249, s62
    v_perm_b32 v115, v254, v250, s61
    v_perm_b32 v119, v254, v250, s62
    v_perm_b32 v123, v255, v251, s61
    v_perm_b32 v127, v255, v251, s62
    v_lshl_or_b32 v56, v57, 16, v56
    ds_write_b128 v40, v[96:99]
    ds_write_b128 v41, v[100:103]
    ds_write_b128 v42, v[104:107]
    ds_write_b128 v43, v[108:111]
    ds_write_b128 v44, v[112:115]
    ds_write_b128 v45, v[116:119]
    ds_write_b128 v46, v[120:123]
    ds_write_b128 v47, v[124:127]
    s_lshl_b32 s35, s57, 5
    s_add_u32 s34, s42, s35
    s_mov_b64 exec, 0xf
    buffer_store_dword v56, v4, s[12:15], s34 offen sc1
    s_mov_b64 exec, -1
    s_waitcnt lgkmcnt(0)
    s_waitcnt vmcnt(9)
    s_lshl_b32 s34, s2, 12
    s_lshl_b32 s35, s57, 11
    s_add_u32 s34, s34, s35
    s_add_u32 s34, s34, 14680064
    buffer_store_dwordx4 v[168:171], v13, s[12:15], s34 offen offset:0 sc1
    buffer_store_dwordx4 v[172:175], v13, s[12:15], s34 offen offset:1024 sc1
    s_barrier
    ds_read_b128 v[64:67], v7 offset:0
    ds_read_b128 v[68:71], v7 offset:512
    ds_read_b128 v[72:75], v7 offset:1024
    ds_read_b128 v[76:79], v7 offset:1536
    ds_read_b128 v[80:83], v7 offset:2048
    ds_read_b128 v[84:87], v7 offset:2560
    ds_read_b128 v[88:91], v7 offset:3072
    ds_read_b128 v[92:95], v7 offset:3584
    s_waitcnt lgkmcnt(0)
    buffer_store_dwordx4 v[64:67], v10, s[12:15], s41 offen sc1
    s_add_u32 s41, s41, 262144
    buffer_store_dwordx4 v[68:71], v10, s[12:15], s41 offen sc1
    s_add_u32 s41, s41, 262144
    buffer_store_dwordx4 v[72:75], v10, s[12:15], s41 offen sc1
    s_add_u32 s41, s41, 262144
    buffer_store_dwordx4 v[76:79], v10, s[12:15], s41 offen sc1
    s_add_u32 s41, s41, 262144
    buffer_store_dwordx4 v[80:83], v10, s[12:15], s41 offen sc1
    s_add_u32 s41, s41, 262144
    buffer_store_dwordx4 v[84:87], v10, s[12:15], s41 offen sc1
    s_add_u32 s41, s41, 262144
    buffer_store_dwordx4 v[88:91], v10, s[12:15], s41 offen sc1
    s_add_u32 s41, s41, 262144
    buffer_store_dwordx4 v[92:95], v10, s[12:15], s41 offen sc1
    s_add_u32 s41, s41, 262144
    s_barrier
    s_barrier
    s_waitcnt vmcnt(0)
    s_mov_b32 s36, s80
    s_and_b32 s37, s81, 0xffff
    s_mov_b32 s38, 2048
    s_mov_b32 s39, 0x00020000
    v_lshlrev_b32 v53, 5, v0
    buffer_load_dwordx4 v[160:163], v53, s[36:39], 0 offen
    buffer_load_dwordx4 v[164:167], v53, s[36:39], 0 offen offset:16
    s_lshl_b32 s34, s60, 11
    buffer_load_dwordx4 v[128:131], v53, s[4:7], s34 offen
    buffer_load_dwordx4 v[132:135], v53, s[4:7], s34 offen offset:16
    s_add_u32 s34, s34, 65536
    buffer_load_dwordx4 v[136:139], v53, s[4:7], s34 offen
    buffer_load_dwordx4 v[140:143], v53, s[4:7], s34 offen offset:16
    s_add_u32 s34, s34, 65536
    buffer_load_dwordx4 v[144:147], v53, s[4:7], s34 offen
    buffer_load_dwordx4 v[148:151], v53, s[4:7], s34 offen offset:16
    s_add_u32 s34, s34, 65536
    buffer_load_dwordx4 v[152:155], v53, s[4:7], s34 offen
    buffer_load_dwordx4 v[156:159], v53, s[4:7], s34 offen offset:16
    s_add_u32 s34, s34, 65536
    s_barrier
    s_cmp_lg_u32 s30, 2
    s_cbranch_scc1 gated__f1
    s_getreg_b32 s34, hwreg(HW_REG_XCC_ID, 0, 4)
    s_or_b32 s34, s34, 16
    v_mov_b32 v62, s34
    s_mov_b64 exec, 1
    buffer_store_byte v62, v1, s[24:27], s33 offen sc1
    s_mov_b64 exec, -1
gated__f1:
    s_mov_b32 s63, 0
    v_mov_b32 v62, 163768
gated_mix__spectral_gfnet__dense_activation_gelu__prompt_kernel_ab3:
    ds_read_b32 v63, v62
    s_waitcnt lgkmcnt(0)
    v_readfirstlane_b32 s34, v63
    s_cmp_ge_u32 s34, 2
    s_cbranch_scc1 gated_mix__spectral_gfnet__dense_activation_gelu__prompt_kernel_ab3d
    s_sleep 1
    s_branch gated_mix__spectral_gfnet__dense_activation_gelu__prompt_kernel_ab3
gated_mix__spectral_gfnet__dense_activation_gelu__prompt_kernel_ab3d:
    s_add_u32 s34, s43, 0
    s_mov_b32 exec_hi, 0x00ffffff
    buffer_load_dword v52, v50, s[20:23], s34 offen
    s_mov_b64 exec, -1
    s_barrier
    s_add_u32 s34, s43, 3670016
    s_mov_b32 exec_hi, 0x00ffffff
    buffer_load_dword v52, v50, s[20:23], s34 offen
    s_mov_b64 exec, -1
    s_barrier
    s_waitcnt vmcnt(2)
    v_mov_b32 v192, 0
    v_mov_b32 v193, 0
    v_mov_b32 v194, 0
    v_mov_b32 v195, 0
    v_dot2c_f32_bf16 v192, v128, v160
    v_dot2c_f32_bf16 v193, v136, v160
    v_dot2c_f32_bf16 v194, v144, v160
    v_dot2c_f32_bf16 v195, v152, v160
    v_dot2c_f32_bf16 v192, v129, v161
    v_dot2c_f32_bf16 v193, v137, v161
    v_dot2c_f32_bf16 v194, v145, v161
    v_dot2c_f32_bf16 v195, v153, v161
    v_dot2c_f32_bf16 v192, v130, v162
    v_dot2c_f32_bf16 v193, v138, v162
    v_dot2c_f32_bf16 v194, v146, v162
    v_dot2c_f32_bf16 v195, v154, v162
    v_dot2c_f32_bf16 v192, v131, v163
    v_dot2c_f32_bf16 v193, v139, v163
    v_dot2c_f32_bf16 v194, v147, v163
    v_dot2c_f32_bf16 v195, v155, v163
    v_dot2c_f32_bf16 v192, v132, v164
    v_dot2c_f32_bf16 v193, v140, v164
    v_dot2c_f32_bf16 v194, v148, v164
    v_dot2c_f32_bf16 v195, v156, v164
    v_dot2c_f32_bf16 v192, v133, v165
    v_dot2c_f32_bf16 v193, v141, v165
    v_dot2c_f32_bf16 v194, v149, v165
    v_dot2c_f32_bf16 v195, v157, v165
    v_dot2c_f32_bf16 v192, v134, v166
    v_dot2c_f32_bf16 v193, v142, v166
    v_dot2c_f32_bf16 v194, v150, v166
    v_dot2c_f32_bf16 v195, v158, v166
    v_dot2c_f32_bf16 v192, v135, v167
    v_dot2c_f32_bf16 v193, v143, v167
    v_dot2c_f32_bf16 v194, v151, v167
    v_dot2c_f32_bf16 v195, v159, v167
    s_barrier
    s_nop 3
    v_add_f32 v192, v192, v192 row_shr:1 bound_ctrl:0
    v_add_f32 v193, v193, v193 row_shr:1 bound_ctrl:0
    v_add_f32 v194, v194, v194 row_shr:1 bound_ctrl:0
    v_add_f32 v195, v195, v195 row_shr:1 bound_ctrl:0
    v_add_f32 v192, v192, v192 row_shr:2 bound_ctrl:0
    v_add_f32 v193, v193, v193 row_shr:2 bound_ctrl:0
    v_add_f32 v194, v194, v194 row_shr:2 bound_ctrl:0
    v_add_f32 v195, v195, v195 row_shr:2 bound_ctrl:0
    v_add_f32 v192, v192, v192 row_shr:4 bound_ctrl:0
    v_add_f32 v193, v193, v193 row_shr:4 bound_ctrl:0
    v_add_f32 v194, v194, v194 row_shr:4 bound_ctrl:0
    v_add_f32 v195, v195, v195 row_shr:4 bound_ctrl:0
    v_add_f32 v192, v192, v192 row_shr:8 bound_ctrl:0
    v_add_f32 v193, v193, v193 row_shr:8 bound_ctrl:0
    v_add_f32 v194, v194, v194 row_shr:8 bound_ctrl:0
    v_add_f32 v195, v195, v195 row_shr:8 bound_ctrl:0
    v_add_f32 v192, v192, v192 row_bcast:15 row_mask:0xa
    v_add_f32 v193, v193, v193 row_bcast:15 row_mask:0xa
    v_add_f32 v194, v194, v194 row_bcast:15 row_mask:0xa
    v_add_f32 v195, v195, v195 row_bcast:15 row_mask:0xa
    v_add_f32 v192, v192, v192 row_bcast:31 row_mask:0xc
    v_add_f32 v193, v193, v193 row_bcast:31 row_mask:0xc
    v_add_f32 v194, v194, v194 row_bcast:31 row_mask:0xc
    v_add_f32 v195, v195, v195 row_bcast:31 row_mask:0xc
    s_barrier
    v_cvt_pk_bf16_f32 v192, v192, v192
    v_cvt_pk_bf16_f32 v193, v193, v193
    v_cvt_pk_bf16_f32 v194, v194, v194
    v_cvt_pk_bf16_f32 v195, v195, v195
    v_and_b32 v192, 0xffff0000, v192
    v_and_b32 v193, 0xffff0000, v193
    v_and_b32 v194, 0xffff0000, v194
    v_and_b32 v195, 0xffff0000, v195
    v_mul_f32 v192, 0xbfb8aa3b, v192
    v_mul_f32 v193, 0xbfb8aa3b, v193
    v_mul_f32 v194, 0xbfb8aa3b, v194
    v_mul_f32 v195, 0xbfb8aa3b, v195
    v_exp_f32 v192, v192
    v_exp_f32 v193, v193
    v_exp_f32 v194, v194
    v_exp_f32 v195, v195
    v_add_f32 v192, 1.0, v192
    v_add_f32 v193, 1.0, v193
    v_add_f32 v194, 1.0, v194
    v_add_f32 v195, 1.0, v195
    v_rcp_f32 v192, v192
    v_rcp_f32 v193, v193
    v_rcp_f32 v194, v194
    v_rcp_f32 v195, v195
    v_cvt_pk_bf16_f32 v192, v192, v192
    v_cvt_pk_bf16_f32 v193, v193, v193
    v_cvt_pk_bf16_f32 v194, v194, v194
    v_cvt_pk_bf16_f32 v195, v195, v195
    v_and_b32 v192, 0xffff0000, v192
    v_and_b32 v193, 0xffff0000, v193
    v_and_b32 v194, 0xffff0000, v194
    v_and_b32 v195, 0xffff0000, v195
    s_lshl_b32 s34, s57, 4
    s_add_u32 s34, s34, 163776
    v_mov_b32 v53, s34
    s_mov_b32 exec_lo, 0
    s_mov_b32 exec_hi, 0x80000000
    ds_write_b128 v53, v[192:195]
    s_mov_b64 exec, -1
    s_waitcnt lgkmcnt(0)
    v_mov_b32 v62, 163768
gated_mix__spectral_gfnet__dense_activation_gelu__prompt_kernel_ab4:
    ds_read_b32 v63, v62
    s_waitcnt lgkmcnt(0)
    v_readfirstlane_b32 s34, v63
    s_cmp_ge_u32 s34, 4
    s_cbranch_scc1 gated_mix__spectral_gfnet__dense_activation_gelu__prompt_kernel_ab4d
    s_sleep 1
    s_branch gated_mix__spectral_gfnet__dense_activation_gelu__prompt_kernel_ab4
gated_mix__spectral_gfnet__dense_activation_gelu__prompt_kernel_ab4d:
    s_cmp_lg_u32 s30, 2
    s_cbranch_scc1 gated__xp1
    v_lshlrev_b32 v59, 2, v0
    v_mov_b32 v60, 0
    s_mov_b32 s51, 0
    buffer_load_dword v60, v59, s[24:27], 0 offen sc1
gated__xp1:
    s_barrier
    s_barrier
    v_mov_b32 v62, 163768
gated_mix__spectral_gfnet__dense_activation_gelu__prompt_kernel_ab5:
    ds_read_b32 v63, v62
    s_waitcnt lgkmcnt(0)
    v_readfirstlane_b32 s34, v63
    s_cmp_ge_u32 s34, 6
    s_cbranch_scc1 gated_mix__spectral_gfnet__dense_activation_gelu__prompt_kernel_ab5d
    s_sleep 1
    s_branch gated_mix__spectral_gfnet__dense_activation_gelu__prompt_kernel_ab5
gated_mix__spectral_gfnet__dense_activation_gelu__prompt_kernel_ab5d:
    s_cmp_lg_u32 s30, 2
    s_cbranch_scc1 gated__xt2
    s_cmp_lg_u32 s51, 0
    s_cbranch_scc1 gated__xt2
    s_mov_b32 s36, 269488144
    v_and_b32 v58, s36, v60
    v_cmp_ne_u32 vcc, s36, v58
    s_cmp_eq_u64 vcc, 0
    s_cbranch_scc1 gated__xu2
    buffer_load_dword v60, v59, s[24:27], 0 offen sc1
    s_branch gated__xt2
gated__xu2:
    s_lshr_b32 s34, s33, 3
    s_lshl_b32 s34, s34, 1
    s_add_u32 s35, s34, 1
    v_readlane_b32 s36, v60, s34
    v_readlane_b32 s37, v60, s35
    s_getreg_b32 s38, hwreg(HW_REG_XCC_ID, 0, 4)
    s_mul_i32 s38, s38, 0x01010101
    s_xor_b32 s36, s36, s38
    s_xor_b32 s37, s37, s38
    s_or_b32 s36, s36, s37
    s_and_b32 s36, s36, 0x0f0f0f0f
    s_cmp_eq_u32 s36, 0
    s_cselect_b32 s36, 2, 1
    v_mov_b32 v62, s36
    v_mov_b32 v63, 163744
    ds_write_b32 v63, v62
    s_waitcnt lgkmcnt(0)
    s_mov_b32 s51, 1
gated__xt2:
    s_barrier
    s_cmp_lg_u32 s63, 0
    s_cbranch_scc1 gated_mix__spectral_gfnet__dense_activation_gelu__prompt_kernel_tl6
    v_mov_b32 v63, 163744
    ds_read_b32 v62, v63
    s_waitcnt lgkmcnt(0)
    v_readfirstlane_b32 s63, v62
    s_cmp_eq_u32 s63, 0
    s_cbranch_scc1 gated_mix__spectral_gfnet__dense_activation_gelu__prompt_kernel_tl6
    s_lshr_b32 s34, s3, 1
    s_lshl_b32 s34, s34, 15
    s_and_b32 s35, s3, 1
    s_lshl_b32 s35, s35, 6
    s_add_u32 s34, s34, s35
    v_lshrrev_b32 v62, 2, v0
    s_mov_b32 s35, 0
    v_xor_b32 v62, s35, v62
    v_lshlrev_b32 v62, 7, v62
    v_and_b32 v63, 3, v0
    v_lshl_add_u32 v62, v63, 4, v62
    s_and_b32 s35, s30, 1
    s_lshl_b32 s36, s35, 14
    s_add_u32 s36, s36, s34
    s_add_u32 s36, s36, 15728640
    s_lshl_b32 s35, s35, 13
    s_add_u32 m0, s35, 135168
    s_nop 0
    buffer_load_dwordx4 v62, s[12:15], s36 offen lds
    s_add_u32 m0, m0, 1024
    s_add_u32 s36, s36, 2048
    buffer_load_dwordx4 v62, s[12:15], s36 offen lds
    s_add_u32 m0, m0, 1024
    s_add_u32 s36, s36, 2048
    buffer_load_dwordx4 v62, s[12:15], s36 offen lds
    s_add_u32 m0, m0, 1024
    s_add_u32 s36, s36, 2048
    buffer_load_dwordx4 v62, s[12:15], s36 offen lds
    s_add_u32 m0, m0, 1024
    s_add_u32 s36, s36, 2048
    buffer_load_dwordx4 v62, s[12:15], s36 offen lds
    s_add_u32 m0, m0, 1024
    s_add_u32 s36, s36, 2048
    buffer_load_dwordx4 v62, s[12:15], s36 offen lds
    s_add_u32 m0, m0, 1024
    s_add_u32 s36, s36, 2048
    buffer_load_dwordx4 v62, s[12:15], s36 offen lds
    s_add_u32 m0, m0, 1024
    s_add_u32 s36, s36, 2048
    buffer_load_dwordx4 v62, s[12:15], s36 offen lds
gated_mix__spectral_gfnet__dense_activation_gelu__prompt_kernel_xd7:
    s_lshl_b32 s35, s30, 13
    s_add_u32 s34, s34, s35
    v_lshrrev_b32 v62, 1, v15
    v_lshlrev_b32 v62, 7, v62
    v_and_b32 v63, 1, v15
    v_lshl_add_u32 v62, v63, 5, v62
    v_lshl_add_u32 v62, v14, 9, v62
    s_add_u32 s34, s34, 19922944
    s_mov_b32 s36, 0
    s_lshl_b32 s36, s36, 7
    v_xor_b32 v63, s36, v62
    v_xor_b32 v61, 256, v63
    buffer_load_dwordx4 v[64:67], v63, s[12:15], s34 offen offset:0 sc1
    buffer_load_dwordx4 v[68:71], v61, s[12:15], s34 offen offset:0 sc1
    buffer_load_dwordx4 v[120:123], v63, s[12:15], s34 offen offset:16 sc1
    buffer_load_dwordx4 v[124:127], v61, s[12:15], s34 offen offset:16 sc1
    s_cmp_lg_u32 s2, 0
    s_cbranch_scc1 gated_mix__spectral_gfnet__dense_activation_gelu__prompt_kernel_now5128
    s_add_u32 s34, s35, 24117248
    buffer_load_dwordx4 v[128:131], v62, s[12:15], s34 offen offset:0 sc1
    buffer_load_dwordx4 v[132:135], v62, s[12:15], s34 offen offset:256 sc1
gated_mix__spectral_gfnet__dense_activation_gelu__prompt_kernel_now5128:
gated_mix__spectral_gfnet__dense_activation_gelu__prompt_kernel_tl6:
    s_cmp_lg_u32 s30, 2
    s_cbranch_scc1 gated__xt3
    s_cmp_lg_u32 s51, 0
    s_cbranch_scc1 gated__xt3
    s_mov_b32 s36, 269488144
    v_and_b32 v58, s36, v60
    v_cmp_ne_u32 vcc, s36, v58
    s_cmp_eq_u64 vcc, 0
    s_cbranch_scc1 gated__xu3
    buffer_load_dword v60, v59, s[24:27], 0 offen sc1
    s_branch gated__xt3
gated__xu3:
    s_lshr_b32 s34, s33, 3
    s_lshl_b32 s34, s34, 1
    s_add_u32 s35, s34, 1
    v_readlane_b32 s36, v60, s34
    v_readlane_b32 s37, v60, s35
    s_getreg_b32 s38, hwreg(HW_REG_XCC_ID, 0, 4)
    s_mul_i32 s38, s38, 0x01010101
    s_xor_b32 s36, s36, s38
    s_xor_b32 s37, s37, s38
    s_or_b32 s36, s36, s37
    s_and_b32 s36, s36, 0x0f0f0f0f
    s_cmp_eq_u32 s36, 0
    s_cselect_b32 s36, 2, 1
    v_mov_b32 v62, s36
    v_mov_b32 v63, 163744
    ds_write_b32 v63, v62
    s_waitcnt lgkmcnt(0)
    s_mov_b32 s51, 1
gated__xt3:
    s_barrier
    s_lshl_b32 s35, s30, 14
    s_add_u32 s34, s35, 43008
    buffer_load_dwordx4 v[192:195], v13, s[16:19], s34 offen offset:0
    buffer_load_dwordx4 v[196:199], v13, s[16:19], s34 offen offset:1024
    buffer_load_dwordx4 v[200:203], v13, s[16:19], s34 offen offset:2048
    buffer_load_dwordx4 v[204:207], v13, s[16:19], s34 offen offset:3072
    s_add_u32 s34, s35, 47104
    buffer_load_dwordx4 v[208:211], v13, s[16:19], s34 offen offset:0
    buffer_load_dwordx4 v[212:215], v13, s[16:19], s34 offen offset:1024
    buffer_load_dwordx4 v[216:219], v13, s[16:19], s34 offen offset:2048
    buffer_load_dwordx4 v[220:223], v13, s[16:19], s34 offen offset:3072
    s_cmp_lg_u32 s30, 2
    s_cbranch_scc1 gated__xt4
    s_cmp_lg_u32 s51, 0
    s_cbranch_scc1 gated__xt4
    s_mov_b32 s36, 269488144
    v_and_b32 v58, s36, v60
    v_cmp_ne_u32 vcc, s36, v58
    s_cmp_eq_u64 vcc, 0
    s_cbranch_scc1 gated__xu4
    buffer_load_dword v60, v59, s[24:27], 0 offen sc1
    s_branch gated__xt4
gated__xu4:
    s_lshr_b32 s34, s33, 3
    s_lshl_b32 s34, s34, 1
    s_add_u32 s35, s34, 1
    v_readlane_b32 s36, v60, s34
    v_readlane_b32 s37, v60, s35
    s_getreg_b32 s38, hwreg(HW_REG_XCC_ID, 0, 4)
    s_mul_i32 s38, s38, 0x01010101
    s_xor_b32 s36, s36, s38
    s_xor_b32 s37, s37, s38
    s_or_b32 s36, s36, s37
    s_and_b32 s36, s36, 0x0f0f0f0f
    s_cmp_eq_u32 s36, 0
    s_cselect_b32 s36, 2, 1
    v_mov_b32 v62, s36
    v_mov_b32 v63, 163744
    ds_write_b32 v63, v62
    s_waitcnt lgkmcnt(0)
    s_mov_b32 s51, 1
gated__xt4:
    s_cmp_lg_u32 s63, 0
    s_cbranch_scc1 gated_mix__spectral_gfnet__dense_activation_gelu__prompt_kernel_tl9
    v_mov_b32 v63, 163744
    ds_read_b32 v62, v63
    s_waitcnt lgkmcnt(0)
    v_readfirstlane_b32 s63, v62
    s_cmp_eq_u32 s63, 0
    s_cbranch_scc1 gated_mix__spectral_gfnet__dense_activation_gelu__prompt_kernel_tl9
    s_lshr_b32 s34, s3, 1
    s_lshl_b32 s34, s34, 15
    s_and_b32 s35, s3, 1
    s_lshl_b32 s35, s35, 6
    s_add_u32 s34, s34, s35
    v_lshrrev_b32 v62, 2, v0
    s_mov_b32 s35, 0
    v_xor_b32 v62, s35, v62
    v_lshlrev_b32 v62, 7, v62
    v_and_b32 v63, 3, v0
    v_lshl_add_u32 v62, v63, 4, v62
    s_and_b32 s35, s30, 1
    s_lshl_b32 s36, s35, 14
    s_add_u32 s36, s36, s34
    s_add_u32 s36, s36, 15728640
    s_lshl_b32 s35, s35, 13
    s_add_u32 m0, s35, 135168
    s_nop 0
    buffer_load_dwordx4 v62, s[12:15], s36 offen lds
    s_add_u32 m0, m0, 1024
    s_add_u32 s36, s36, 2048
    buffer_load_dwordx4 v62, s[12:15], s36 offen lds
    s_add_u32 m0, m0, 1024
    s_add_u32 s36, s36, 2048
    buffer_load_dwordx4 v62, s[12:15], s36 offen lds
    s_add_u32 m0, m0, 1024
    s_add_u32 s36, s36, 2048
    buffer_load_dwordx4 v62, s[12:15], s36 offen lds
    s_add_u32 m0, m0, 1024
    s_add_u32 s36, s36, 2048
    buffer_load_dwordx4 v62, s[12:15], s36 offen lds
    s_add_u32 m0, m0, 1024
    s_add_u32 s36, s36, 2048
    buffer_load_dwordx4 v62, s[12:15], s36 offen lds
    s_add_u32 m0, m0, 1024
    s_add_u32 s36, s36, 2048
    buffer_load_dwordx4 v62, s[12:15], s36 offen lds
    s_add_u32 m0, m0, 1024
    s_add_u32 s36, s36, 2048
    buffer_load_dwordx4 v62, s[12:15], s36 offen lds
gated_mix__spectral_gfnet__dense_activation_gelu__prompt_kernel_xd10:
    s_lshl_b32 s35, s30, 13
    s_add_u32 s34, s34, s35
    v_lshrrev_b32 v62, 1, v15
    v_lshlrev_b32 v62, 7, v62
    v_and_b32 v63, 1, v15
    v_lshl_add_u32 v62, v63, 5, v62
    v_lshl_add_u32 v62, v14, 9, v62
    s_add_u32 s34, s34, 19922944
    s_mov_b32 s36, 0
    s_lshl_b32 s36, s36, 7
    v_xor_b32 v63, s36, v62
    v_xor_b32 v61, 256, v63
    buffer_load_dwordx4 v[64:67], v63, s[12:15], s34 offen offset:0 sc1
    buffer_load_dwordx4 v[68:71], v61, s[12:15], s34 offen offset:0 sc1
    buffer_load_dwordx4 v[120:123], v63, s[12:15], s34 offen offset:16 sc1
    buffer_load_dwordx4 v[124:127], v61, s[12:15], s34 offen offset:16 sc1
    s_cmp_lg_u32 s2, 0
    s_cbranch_scc1 gated_mix__spectral_gfnet__dense_activation_gelu__prompt_kernel_now51211
    s_add_u32 s34, s35, 24117248
    buffer_load_dwordx4 v[128:131], v62, s[12:15], s34 offen offset:0 sc1
    buffer_load_dwordx4 v[132:135], v62, s[12:15], s34 offen offset:256 sc1
gated_mix__spectral_gfnet__dense_activation_gelu__prompt_kernel_now51211:
gated_mix__spectral_gfnet__dense_activation_gelu__prompt_kernel_tl9:
    s_lshl_b32 s35, s30, 14
    s_add_u32 s34, s35, 51200
    buffer_load_dwordx4 v[224:227], v13, s[16:19], s34 offen offset:0
    buffer_load_dwordx4 v[228:231], v13, s[16:19], s34 offen offset:1024
    buffer_load_dwordx4 v[232:235], v13, s[16:19], s34 offen offset:2048
    buffer_load_dwordx4 v[236:239], v13, s[16:19], s34 offen offset:3072
    s_add_u32 s34, s35, 55296
    buffer_load_dwordx4 v[240:243], v13, s[16:19], s34 offen offset:0
    buffer_load_dwordx4 v[244:247], v13, s[16:19], s34 offen offset:1024
    buffer_load_dwordx4 v[248:251], v13, s[16:19], s34 offen offset:2048
    buffer_load_dwordx4 v[252:255], v13, s[16:19], s34 offen offset:3072
    s_mov_b32 s34, 36864
    buffer_load_dwordx4 v[168:171], v13, s[16:19], s34 offen offset:0
    buffer_load_dwordx4 v[172:175], v13, s[16:19], s34 offen offset:1024
    buffer_load_dwordx4 v[176:179], v13, s[16:19], s34 offen offset:2048
    buffer_load_dwordx4 v[180:183], v13, s[16:19], s34 offen offset:3072
    s_mov_b32 s34, 40960
    buffer_load_dwordx4 v[184:187], v13, s[16:19], s34 offen offset:0
    buffer_load_dwordx4 v[188:191], v13, s[16:19], s34 offen offset:1024
    s_waitcnt vmcnt(14)
gated__join:
    s_cmp_lg_u32 s63, 0
    s_cbranch_scc1 gated__x1ok
    s_cmp_lg_u32 s30, 2
    s_cbranch_scc1 gated__lw
    v_mov_b32 v63, 163744
    ds_read_b32 v62, v63
    s_waitcnt lgkmcnt(0)
    v_readfirstlane_b32 s34, v62
    s_cmp_lg_u32 s34, 0
    s_cbranch_scc1 gated__lw
    v_lshlrev_b32 v59, 2, v0
    s_mov_b32 s35, 0
gated__p1b:
    s_sleep 8
    buffer_load_dword v60, v59, s[24:27], 0 offen sc1
    s_add_u32 s35, s35, 1
    s_waitcnt vmcnt(0)
    s_cmp_gt_u32 s35, 400000
    s_cbranch_scc1 gated__p1bd
    s_mov_b32 s36, 269488144
    v_and_b32 v58, s36, v60
    v_cmp_ne_u32 vcc, s36, v58
    s_cmp_eq_u64 vcc, 0
    s_cbranch_scc0 gated__p1b
gated__p1bd:
    s_lshr_b32 s34, s33, 3
    s_lshl_b32 s34, s34, 1
    s_add_u32 s35, s34, 1
    v_readlane_b32 s36, v60, s34
    v_readlane_b32 s37, v60, s35
    s_getreg_b32 s38, hwreg(HW_REG_XCC_ID, 0, 4)
    s_mul_i32 s38, s38, 0x01010101
    s_xor_b32 s36, s36, s38
    s_xor_b32 s37, s37, s38
    s_or_b32 s36, s36, s37
    s_and_b32 s36, s36, 0x0f0f0f0f
    s_cmp_eq_u32 s36, 0
    s_cselect_b32 s36, 2, 1
    v_mov_b32 v62, s36
    v_mov_b32 v63, 163744
    ds_write_b32 v63, v62
    s_waitcnt lgkmcnt(0)
gated__lw:
    v_mov_b32 v63, 163744
    ds_read_b32 v62, v63
    s_waitcnt lgkmcnt(0)
    v_readfirstlane_b32 s34, v62
    s_cmp_eq_u32 s34, 0
    s_cbranch_scc1 gated__lw
    s_lshr_b32 s34, s3, 1
    s_lshl_b32 s34, s34, 15
    s_and_b32 s35, s3, 1
    s_lshl_b32 s35, s35, 6
    s_add_u32 s34, s34, s35
    s_cmp_lt_u32 s30, 2
    s_cbranch_scc1 gated_mix__spectral_gfnet__dense_activation_gelu__prompt_kernel_xd12
    v_lshrrev_b32 v62, 2, v0
    s_mov_b32 s35, 0
    v_xor_b32 v62, s35, v62
    v_lshlrev_b32 v62, 7, v62
    v_and_b32 v63, 3, v0
    v_lshl_add_u32 v62, v63, 4, v62
    s_and_b32 s35, s30, 1
    s_lshl_b32 s36, s35, 14
    s_add_u32 s36, s36, s34
    s_add_u32 s36, s36, 15728640
    s_lshl_b32 s35, s35, 13
    s_add_u32 m0, s35, 135168
    s_nop 0
    buffer_load_dwordx4 v62, s[12:15], s36 offen lds
    s_add_u32 m0, m0, 1024
    s_add_u32 s36, s36, 2048
    buffer_load_dwordx4 v62, s[12:15], s36 offen lds
    s_add_u32 m0, m0, 1024
    s_add_u32 s36, s36, 2048
    buffer_load_dwordx4 v62, s[12:15], s36 offen lds
    s_add_u32 m0, m0, 1024
    s_add_u32 s36, s36, 2048
    buffer_load_dwordx4 v62, s[12:15], s36 offen lds
    s_add_u32 m0, m0, 1024
    s_add_u32 s36, s36, 2048
    buffer_load_dwordx4 v62, s[12:15], s36 offen lds
    s_add_u32 m0, m0, 1024
    s_add_u32 s36, s36, 2048
    buffer_load_dwordx4 v62, s[12:15], s36 offen lds
    s_add_u32 m0, m0, 1024
    s_add_u32 s36, s36, 2048
    buffer_load_dwordx4 v62, s[12:15], s36 offen lds
    s_add_u32 m0, m0, 1024
    s_add_u32 s36, s36, 2048
    buffer_load_dwordx4 v62, s[12:15], s36 offen lds
gated_mix__spectral_gfnet__dense_activation_gelu__prompt_kernel_xd12:
    s_lshl_b32 s35, s30, 13
    s_add_u32 s34, s34, s35
    v_lshrrev_b32 v62, 1, v15
    v_lshlrev_b32 v62, 7, v62
    v_and_b32 v63, 1, v15
    v_lshl_add_u32 v62, v63, 5, v62
    v_lshl_add_u32 v62, v14, 9, v62
    s_add_u32 s34, s34, 19922944
    s_mov_b32 s36, 0
    s_lshl_b32 s36, s36, 7
    v_xor_b32 v63, s36, v62
    v_xor_b32 v61, 256, v63
    buffer_load_dwordx4 v[64:67], v63, s[12:15], s34 offen offset:0 sc1
    buffer_load_dwordx4 v[68:71], v61, s[12:15], s34 offen offset:0 sc1
    buffer_load_dwordx4 v[120:123], v63, s[12:15], s34 offen offset:16 sc1
    buffer_load_dwordx4 v[124:127], v61, s[12:15], s34 offen offset:16 sc1
    s_cmp_lg_u32 s2, 0
    s_cbranch_scc1 gated_mix__spectral_gfnet__dense_activation_gelu__prompt_kernel_now51213
    s_add_u32 s34, s35, 24117248
    buffer_load_dwordx4 v[128:131], v62, s[12:15], s34 offen offset:0 sc1
    buffer_load_dwordx4 v[132:135], v62, s[12:15], s34 offen offset:256 sc1
gated_mix__spectral_gfnet__dense_activation_gelu__prompt_kernel_now51213:
    s_waitcnt vmcnt(0)
gated__x1ok:
    v_lshlrev_b32 v2, 1, v15
    v_xor_b32 v2, v2, v14
    v_lshlrev_b32 v2, 4, v2
    v_lshl_add_u32 v2, v14, 9, v2
    v_add_u32 v2, 135168, v2
    v_xor_b32 v4, 128, v2
    v_xor_b32 v5, 16, v2
    v_xor_b32 v6, 144, v2
    s_lshl_b32 s34, s30, 11
    s_add_u32 s34, s34, 98304
    v_add_u32 v7, s34, v13
    v_add_u32 v8, 98304, v13
    v_and_b32 v9, 7, v14
    v_lshlrev_b32 v9, 17, v9
    v_lshrrev_b32 v10, 1, v15
    v_lshl_add_u32 v9, v10, 6, v9
    v_and_b32 v10, 1, v15
    v_lshlrev_b32 v10, 1, v10
    v_lshrrev_b32 v3, 3, v14
    v_or_b32 v10, v10, v3
    s_bfe_u32 s35, s3, 0x20004
    v_xor_b32 v10, s35, v10
    v_lshl_add_u32 v9, v10, 4, v9
    s_bfe_u32 s34, s3, 0x10006
    s_xor_b32 s34, s34, s3
    v_mov_b32 v3, s34
    v_and_b32 v3, 7, v3
    v_lshl_add_u32 v9, v3, 7, v9
    v_xor_b32 v10, 16, v9
    v_add_u32 v10, 1048576, v10
    s_andn2_b32 s34, s34, 7
    s_lshl_b32 s48, s34, 7
    s_lshl_b32 s34, s30, 15
    s_add_u32 s48, s48, s34
    s_add_u32 s48, s48, 25165824
    s_add_u32 s49, s48, 2097152
    s_waitcnt lgkmcnt(0)
    v_mov_b32 v11, 163732
    v_mov_b32 v12, 1
    s_mov_b64 exec, 1
    ds_add_u32 v11, v12
    s_mov_b64 exec, -1
gated__ls0:
    ds_read_b32 v12, v11
    s_waitcnt lgkmcnt(0)
    v_readfirstlane_b32 s34, v12
    s_cmp_ge_u32 s34, 4
    s_cbranch_scc1 gated__ls0d
    s_sleep 1
    s_branch gated__ls0
gated__ls0d:
    s_and_b32 s34, s3, 7
    s_lshl_b32 s34, s34, 3
    s_lshl_b32 s35, s30, 1
    s_add_u32 s34, s34, s35
    s_lshl_b32 s34, s34, 5
    s_lshr_b32 s35, s3, 3
    s_add_u32 s34, s34, s35
    s_lshl_b32 s50, s34, 11
    ds_read_b128 v[16:19], v2 offset:0
    ds_read_b128 v[20:23], v4 offset:0
    ds_read_b128 v[24:27], v2 offset:256
    ds_read_b128 v[28:31], v4 offset:256
    ds_read_b128 v[32:35], v2 offset:8192
    ds_read_b128 v[36:39], v4 offset:8192
    ds_read_b128 v[40:43], v2 offset:8448
    ds_read_b128 v[44:47], v4 offset:8448
    ds_read_b128 v[72:75], v5 offset:0
    ds_read_b128 v[76:79], v6 offset:0
    ds_read_b128 v[80:83], v5 offset:256
    ds_read_b128 v[84:87], v6 offset:256
    ds_read_b128 v[88:91], v5 offset:8192
    ds_read_b128 v[92:95], v6 offset:8192
    ds_read_b128 v[96:99], v5 offset:8448
    ds_read_b128 v[100:103], v6 offset:8448
    s_cmp_lg_u32 s2, 0
    s_cbranch_scc1 gated__nosp
    s_waitcnt lgkmcnt(0)
    v_lshrrev_b32 v16, 16, v16
    v_lshrrev_b32 v17, 16, v17
    v_lshrrev_b32 v18, 16, v18
    v_lshrrev_b32 v19, 16, v19
    v_lshrrev_b32 v20, 16, v20
    v_lshrrev_b32 v21, 16, v21
    v_lshrrev_b32 v22, 16, v22
    v_lshrrev_b32 v23, 16, v23
    v_lshrrev_b32 v24, 16, v24
    v_lshrrev_b32 v25, 16, v25
    v_lshrrev_b32 v26, 16, v26
    v_lshrrev_b32 v27, 16, v27
    v_lshrrev_b32 v28, 16, v28
    v_lshrrev_b32 v29, 16, v29
    v_lshrrev_b32 v30, 16, v30
    v_lshrrev_b32 v31, 16, v31
    v_lshrrev_b32 v32, 16, v32
    v_lshrrev_b32 v33, 16, v33
    v_lshrrev_b32 v34, 16, v34
    v_lshrrev_b32 v35, 16, v35
    v_lshrrev_b32 v36, 16, v36
    v_lshrrev_b32 v37, 16, v37
    v_lshrrev_b32 v38, 16, v38
    v_lshrrev_b32 v39, 16, v39
    v_lshrrev_b32 v40, 16, v40
    v_lshrrev_b32 v41, 16, v41
    v_lshrrev_b32 v42, 16, v42
    v_lshrrev_b32 v43, 16, v43
    v_lshrrev_b32 v44, 16, v44
    v_lshrrev_b32 v45, 16, v45
    v_lshrrev_b32 v46, 16, v46
    v_lshrrev_b32 v47, 16, v47
    v_mfma_f32_16x16x32_bf16 v[48:51], v[16:19], v[192:195], 0
    v_mfma_f32_16x16x32_bf16 v[52:55], v[16:19], v[208:211], 0
    v_mfma_f32_16x16x32_bf16 v[56:59], v[32:35], v[192:195], 0
    v_mfma_f32_16x16x32_bf16 v[60:63], v[32:35], v[208:211], 0
    v_mfma_f32_16x16x32_bf16 v[48:51], v[20:23], v[196:199], v[48:51]
    v_mfma_f32_16x16x32_bf16 v[52:55], v[20:23], v[212:215], v[52:55]
    v_mfma_f32_16x16x32_bf16 v[56:59], v[36:39], v[196:199], v[56:59]
    v_mfma_f32_16x16x32_bf16 v[60:63], v[36:39], v[212:215], v[60:63]
    v_mfma_f32_16x16x32_bf16 v[48:51], v[24:27], v[200:203], v[48:51]
    v_mfma_f32_16x16x32_bf16 v[52:55], v[24:27], v[216:219], v[52:55]
    v_mfma_f32_16x16x32_bf16 v[56:59], v[40:43], v[200:203], v[56:59]
    v_mfma_f32_16x16x32_bf16 v[60:63], v[40:43], v[216:219], v[60:63]
    v_mfma_f32_16x16x32_bf16 v[48:51], v[28:31], v[204:207], v[48:51]
    v_mfma_f32_16x16x32_bf16 v[52:55], v[28:31], v[220:223], v[52:55]
    v_mfma_f32_16x16x32_bf16 v[56:59], v[44:47], v[204:207], v[56:59]
    v_mfma_f32_16x16x32_bf16 v[60:63], v[44:47], v[220:223], v[60:63]
    s_waitcnt vmcnt(0)
    s_nop 3
    v_pk_mul_f32 v[16:17], v[48:49], v[224:225]
    v_pk_mul_f32 v[24:25], v[48:49], v[228:229]
    v_pk_mul_f32 v[18:19], v[50:51], v[226:227]
    v_pk_mul_f32 v[26:27], v[50:51], v[230:231]
    v_pk_fma_f32 v[16:17], v[52:53], v[228:229], v[16:17] neg_lo:[1,0,0] neg_hi:[1,0,0]
    v_pk_fma_f32 v[24:25], v[52:53], v[224:225], v[24:25]
    v_pk_fma_f32 v[18:19], v[54:55], v[230:231], v[18:19] neg_lo:[1,0,0] neg_hi:[1,0,0]
    v_pk_fma_f32 v[26:27], v[54:55], v[226:227], v[26:27]
    v_pk_mul_f32 v[20:21], v[56:57], v[232:233]
    v_pk_mul_f32 v[28:29], v[56:57], v[236:237]
    v_pk_mul_f32 v[22:23], v[58:59], v[234:235]
    v_pk_mul_f32 v[30:31], v[58:59], v[238:239]
    v_pk_fma_f32 v[20:21], v[60:61], v[236:237], v[20:21] neg_lo:[1,0,0] neg_hi:[1,0,0]
    v_pk_fma_f32 v[28:29], v[60:61], v[232:233], v[28:29]
    v_pk_fma_f32 v[22:23], v[62:63], v[238:239], v[22:23] neg_lo:[1,0,0] neg_hi:[1,0,0]
    v_pk_fma_f32 v[30:31], v[62:63], v[234:235], v[30:31]
    v_cvt_pk_bf16_f32 v32, v16, v17
    v_cvt_pk_bf16_f32 v33, v18, v19
    v_cvt_pk_bf16_f32 v34, v20, v21
    v_cvt_pk_bf16_f32 v35, v22, v23
    v_cvt_pk_bf16_f32 v36, v24, v25
    v_cvt_pk_bf16_f32 v37, v26, v27
    v_cvt_pk_bf16_f32 v38, v28, v29
    v_cvt_pk_bf16_f32 v39, v30, v31
    v_mfma_f32_16x16x32_bf16 v[48:51], v[168:171], v[32:35], 0
    v_mfma_f32_16x16x32_bf16 v[52:55], v[184:187], v[32:35], 0
    v_mfma_f32_16x16x32_bf16 v[56:59], v[172:175], v[32:35], 0
    v_mfma_f32_16x16x32_bf16 v[60:63], v[188:191], v[32:35], 0
    v_mfma_f32_16x16x32_bf16 v[48:51], v[176:179], v[36:39], v[48:51]
    v_mfma_f32_16x16x32_bf16 v[52:55], v[168:171], v[36:39], v[52:55]
    v_mfma_f32_16x16x32_bf16 v[56:59], v[180:183], v[36:39], v[56:59]
    v_mfma_f32_16x16x32_bf16 v[60:63], v[172:175], v[36:39], v[60:63]
    v_lshlrev_b32 v16, 16, v128
    v_and_b32 v20, 0xffff0000, v128
    v_lshlrev_b32 v17, 16, v129
    v_and_b32 v21, 0xffff0000, v129
    v_lshlrev_b32 v18, 16, v130
    v_and_b32 v22, 0xffff0000, v130
    v_lshlrev_b32 v19, 16, v131
    v_and_b32 v23, 0xffff0000, v131
    v_lshlrev_b32 v24, 16, v132
    v_and_b32 v28, 0xffff0000, v132
    v_lshlrev_b32 v25, 16, v133
    v_and_b32 v29, 0xffff0000, v133
    v_lshlrev_b32 v26, 16, v134
    v_and_b32 v30, 0xffff0000, v134
    v_lshlrev_b32 v27, 16, v135
    v_and_b32 v31, 0xffff0000, v135
    v_pk_mul_f32 v[32:33], v[48:49], v[16:17]
    v_pk_mul_f32 v[40:41], v[48:49], v[20:21]
    v_pk_mul_f32 v[34:35], v[50:51], v[18:19]
    v_pk_mul_f32 v[42:43], v[50:51], v[22:23]
    v_pk_fma_f32 v[32:33], v[52:53], v[20:21], v[32:33] neg_lo:[1,0,0] neg_hi:[1,0,0]
    v_pk_fma_f32 v[40:41], v[52:53], v[16:17], v[40:41]
    v_pk_fma_f32 v[34:35], v[54:55], v[22:23], v[34:35] neg_lo:[1,0,0] neg_hi:[1,0,0]
    v_pk_fma_f32 v[42:43], v[54:55], v[18:19], v[42:43]
    v_pk_mul_f32 v[36:37], v[56:57], v[24:25]
    v_pk_mul_f32 v[44:45], v[56:57], v[28:29]
    v_pk_mul_f32 v[38:39], v[58:59], v[26:27]
    v_pk_mul_f32 v[46:47], v[58:59], v[30:31]
    v_pk_fma_f32 v[36:37], v[60:61], v[28:29], v[36:37] neg_lo:[1,0,0] neg_hi:[1,0,0]
    v_pk_fma_f32 v[44:45], v[60:61], v[24:25], v[44:45]
    v_pk_fma_f32 v[38:39], v[62:63], v[30:31], v[38:39] neg_lo:[1,0,0] neg_hi:[1,0,0]
    v_pk_fma_f32 v[46:47], v[62:63], v[26:27], v[46:47]
    v_cvt_pk_bf16_f32 v16, v32, v33
    v_cvt_pk_bf16_f32 v17, v34, v35
    v_cvt_pk_bf16_f32 v18, v36, v37
    v_cvt_pk_bf16_f32 v19, v38, v39
    v_cvt_pk_bf16_f32 v20, v40, v41
    v_cvt_pk_bf16_f32 v21, v42, v43
    v_cvt_pk_bf16_f32 v22, v44, v45
    v_cvt_pk_bf16_f32 v23, v46, v47
    v_mfma_f32_16x16x32_bf16 v[48:51], v[16:19], v[168:171], 0
    v_mfma_f32_16x16x32_bf16 v[52:55], v[16:19], v[176:179], 0
    v_mfma_f32_16x16x32_bf16 v[56:59], v[16:19], v[172:175], 0
    v_mfma_f32_16x16x32_bf16 v[60:63], v[16:19], v[180:183], 0
    v_mfma_f32_16x16x32_bf16 v[48:51], v[20:23], v[184:187], v[48:51]
    v_mfma_f32_16x16x32_bf16 v[52:55], v[20:23], v[168:171], v[52:55]
    v_mfma_f32_16x16x32_bf16 v[56:59], v[20:23], v[188:191], v[56:59]
    v_mfma_f32_16x16x32_bf16 v[60:63], v[20:23], v[172:175], v[60:63]
    s_nop 4
    v_pk_mul_f32 v[32:33], v[48:49], v[240:241]
    v_pk_mul_f32 v[40:41], v[48:49], v[244:245]
    v_pk_mul_f32 v[34:35], v[50:51], v[242:243]
    v_pk_mul_f32 v[42:43], v[50:51], v[246:247]
    v_pk_fma_f32 v[32:33], v[52:53], v[244:245], v[32:33] neg_lo:[1,0,0] neg_hi:[1,0,0]
    v_pk_fma_f32 v[40:41], v[52:53], v[240:241], v[40:41]
    v_pk_fma_f32 v[34:35], v[54:55], v[246:247], v[34:35] neg_lo:[1,0,0] neg_hi:[1,0,0]
    v_pk_fma_f32 v[42:43], v[54:55], v[242:243], v[42:43]
    v_pk_mul_f32 v[36:37], v[56:57], v[248:249]
    v_pk_mul_f32 v[44:45], v[56:57], v[252:253]
    v_pk_mul_f32 v[38:39], v[58:59], v[250:251]
    v_pk_mul_f32 v[46:47], v[58:59], v[254:255]
    v_pk_fma_f32 v[36:37], v[60:61], v[252:253], v[36:37] neg_lo:[1,0,0] neg_hi:[1,0,0]
    v_pk_fma_f32 v[44:45], v[60:61], v[248:249], v[44:45]
    v_pk_fma_f32 v[38:39], v[62:63], v[254:255], v[38:39] neg_lo:[1,0,0] neg_hi:[1,0,0]
    v_pk_fma_f32 v[46:47], v[62:63], v[250:251], v[46:47]
    v_cvt_pk_bf16_f32 v16, v32, -v40
    v_cvt_pk_bf16_f32 v17, v33, -v41
    v_cvt_pk_bf16_f32 v18, v34, -v42
    v_cvt_pk_bf16_f32 v19, v35, -v43
    v_cvt_pk_bf16_f32 v20, v36, -v44
    v_cvt_pk_bf16_f32 v21, v37, -v45
    v_cvt_pk_bf16_f32 v22, v38, -v46
    v_cvt_pk_bf16_f32 v23, v39, -v47
    v_mov_b32 v11, 163760
gated_mix__spectral_gfnet__dense_activation_gelu__prompt_kernel_rf14:
    ds_read_b32 v12, v11
    s_waitcnt lgkmcnt(0)
    v_readfirstlane_b32 s34, v12
    s_cmp_ge_u32 s34, 4
    s_cbranch_scc1 gated_mix__spectral_gfnet__dense_activation_gelu__prompt_kernel_rf14d
    s_sleep 1
    s_branch gated_mix__spectral_gfnet__dense_activation_gelu__prompt_kernel_rf14
gated_mix__spectral_gfnet__dense_activation_gelu__prompt_kernel_rf14d:
    ds_write_b128 v7, v[16:19] offset:16384
    ds_write_b128 v7, v[20:23] offset:17408
    ds_read_b128 v[16:19], v2 offset:0
    ds_read_b128 v[20:23], v4 offset:0
    ds_read_b128 v[24:27], v2 offset:256
    ds_read_b128 v[28:31], v4 offset:256
    ds_read_b128 v[32:35], v2 offset:8192
    ds_read_b128 v[36:39], v4 offset:8192
    ds_read_b128 v[40:43], v2 offset:8448
    ds_read_b128 v[44:47], v4 offset:8448
    s_waitcnt lgkmcnt(0)
    v_and_b32 v16, 0xffff, v16
    v_and_b32 v17, 0xffff, v17
    v_and_b32 v18, 0xffff, v18
    v_and_b32 v19, 0xffff, v19
    v_and_b32 v20, 0xffff, v20
    v_and_b32 v21, 0xffff, v21
    v_and_b32 v22, 0xffff, v22
    v_and_b32 v23, 0xffff, v23
    v_and_b32 v24, 0xffff, v24
    v_and_b32 v25, 0xffff, v25
    v_and_b32 v26, 0xffff, v26
    v_and_b32 v27, 0xffff, v27
    v_and_b32 v28, 0xffff, v28
    v_and_b32 v29, 0xffff, v29
    v_and_b32 v30, 0xffff, v30
    v_and_b32 v31, 0xffff, v31
    v_and_b32 v32, 0xffff, v32
    v_and_b32 v33, 0xffff, v33
    v_and_b32 v34, 0xffff, v34
    v_and_b32 v35, 0xffff, v35
    v_and_b32 v36, 0xffff, v36
    v_and_b32 v37, 0xffff, v37
    v_and_b32 v38, 0xffff, v38
    v_and_b32 v39, 0xffff, v39
    v_and_b32 v40, 0xffff, v40
    v_and_b32 v41, 0xffff, v41
    v_and_b32 v42, 0xffff, v42
    v_and_b32 v43, 0xffff, v43
    v_and_b32 v44, 0xffff, v44
    v_and_b32 v45, 0xffff, v45
    v_and_b32 v46, 0xffff, v46
    v_and_b32 v47, 0xffff, v47
gated__nosp:
    s_waitcnt lgkmcnt(0)
    s_nop 1
    v_mfma_f32_16x16x32_bf16 v[48:51], v[16:19], v[192:195], 0
    v_mfma_f32_16x16x32_bf16 v[52:55], v[16:19], v[208:211], 0
    v_mfma_f32_16x16x32_bf16 v[56:59], v[32:35], v[192:195], 0
    v_mfma_f32_16x16x32_bf16 v[60:63], v[32:35], v[208:211], 0
    v_mfma_f32_16x16x32_bf16 v[48:51], v[20:23], v[196:199], v[48:51]
    v_mfma_f32_16x16x32_bf16 v[52:55], v[20:23], v[212:215], v[52:55]
    v_mfma_f32_16x16x32_bf16 v[56:59], v[36:39], v[196:199], v[56:59]
    v_mfma_f32_16x16x32_bf16 v[60:63], v[36:39], v[212:215], v[60:63]
    v_mfma_f32_16x16x32_bf16 v[48:51], v[24:27], v[200:203], v[48:51]
    v_mfma_f32_16x16x32_bf16 v[52:55], v[24:27], v[216:219], v[52:55]
    v_mfma_f32_16x16x32_bf16 v[56:59], v[40:43], v[200:203], v[56:59]
    v_mfma_f32_16x16x32_bf16 v[60:63], v[40:43], v[216:219], v[60:63]
    v_mfma_f32_16x16x32_bf16 v[48:51], v[28:31], v[204:207], v[48:51]
    v_mfma_f32_16x16x32_bf16 v[52:55], v[28:31], v[220:223], v[52:55]
    v_mfma_f32_16x16x32_bf16 v[56:59], v[44:47], v[204:207], v[56:59]
    v_mfma_f32_16x16x32_bf16 v[60:63], v[44:47], v[220:223], v[60:63]
    v_mfma_f32_16x16x32_bf16 v[104:107], v[72:75], v[192:195], 0
    v_mfma_f32_16x16x32_bf16 v[108:111], v[72:75], v[208:211], 0
    v_mfma_f32_16x16x32_bf16 v[112:115], v[88:91], v[192:195], 0
    v_mfma_f32_16x16x32_bf16 v[116:119], v[88:91], v[208:211], 0
    v_mfma_f32_16x16x32_bf16 v[104:107], v[76:79], v[196:199], v[104:107]
    v_mfma_f32_16x16x32_bf16 v[108:111], v[76:79], v[212:215], v[108:111]
    v_mfma_f32_16x16x32_bf16 v[112:115], v[92:95], v[196:199], v[112:115]
    v_mfma_f32_16x16x32_bf16 v[116:119], v[92:95], v[212:215], v[116:119]
    v_mfma_f32_16x16x32_bf16 v[104:107], v[80:83], v[200:203], v[104:107]
    v_mfma_f32_16x16x32_bf16 v[108:111], v[80:83], v[216:219], v[108:111]
    v_mfma_f32_16x16x32_bf16 v[112:115], v[96:99], v[200:203], v[112:115]
    v_mfma_f32_16x16x32_bf16 v[116:119], v[96:99], v[216:219], v[116:119]
    v_mfma_f32_16x16x32_bf16 v[104:107], v[84:87], v[204:207], v[104:107]
    v_mfma_f32_16x16x32_bf16 v[108:111], v[84:87], v[220:223], v[108:111]
    v_mfma_f32_16x16x32_bf16 v[112:115], v[100:103], v[204:207], v[112:115]
    v_mfma_f32_16x16x32_bf16 v[116:119], v[100:103], v[220:223], v[116:119]
    s_waitcnt vmcnt(0)
    v_pk_mul_f32 v[16:17], v[48:49], v[224:225]
    v_pk_mul_f32 v[24:25], v[48:49], v[228:229]
    v_pk_mul_f32 v[18:19], v[50:51], v[226:227]
    v_pk_mul_f32 v[26:27], v[50:51], v[230:231]
    v_pk_fma_f32 v[16:17], v[52:53], v[228:229], v[16:17] neg_lo:[1,0,0] neg_hi:[1,0,0]
    v_pk_fma_f32 v[24:25], v[52:53], v[224:225], v[24:25]
    v_pk_fma_f32 v[18:19], v[54:55], v[230:231], v[18:19] neg_lo:[1,0,0] neg_hi:[1,0,0]
    v_pk_fma_f32 v[26:27], v[54:55], v[226:227], v[26:27]
    v_pk_mul_f32 v[20:21], v[56:57], v[232:233]
    v_pk_mul_f32 v[28:29], v[56:57], v[236:237]
    v_pk_mul_f32 v[22:23], v[58:59], v[234:235]
    v_pk_mul_f32 v[30:31], v[58:59], v[238:239]
    v_pk_fma_f32 v[20:21], v[60:61], v[236:237], v[20:21] neg_lo:[1,0,0] neg_hi:[1,0,0]
    v_pk_fma_f32 v[28:29], v[60:61], v[232:233], v[28:29]
    v_pk_fma_f32 v[22:23], v[62:63], v[238:239], v[22:23] neg_lo:[1,0,0] neg_hi:[1,0,0]
    v_pk_fma_f32 v[30:31], v[62:63], v[234:235], v[30:31]
    v_cvt_pk_bf16_f32 v32, v16, v17
    v_cvt_pk_bf16_f32 v33, v18, v19
    v_cvt_pk_bf16_f32 v34, v20, v21
    v_cvt_pk_bf16_f32 v35, v22, v23
    v_cvt_pk_bf16_f32 v36, v24, v25
    v_cvt_pk_bf16_f32 v37, v26, v27
    v_cvt_pk_bf16_f32 v38, v28, v29
    v_cvt_pk_bf16_f32 v39, v30, v31
    v_mfma_f32_16x16x32_bf16 v[48:51], v[168:171], v[32:35], 0
    v_mfma_f32_16x16x32_bf16 v[52:55], v[184:187], v[32:35], 0
    v_mfma_f32_16x16x32_bf16 v[56:59], v[172:175], v[32:35], 0
    v_mfma_f32_16x16x32_bf16 v[60:63], v[188:191], v[32:35], 0
    v_mfma_f32_16x16x32_bf16 v[48:51], v[176:179], v[36:39], v[48:51]
    v_mfma_f32_16x16x32_bf16 v[52:55], v[168:171], v[36:39], v[52:55]
    v_mfma_f32_16x16x32_bf16 v[56:59], v[180:183], v[36:39], v[56:59]
    v_mfma_f32_16x16x32_bf16 v[60:63], v[172:175], v[36:39], v[60:63]
    v_pk_mul_f32 v[72:73], v[104:105], v[224:225]
    v_pk_mul_f32 v[80:81], v[104:105], v[228:229]
    v_pk_mul_f32 v[74:75], v[106:107], v[226:227]
    v_pk_mul_f32 v[82:83], v[106:107], v[230:231]
    v_pk_fma_f32 v[72:73], v[108:109], v[228:229], v[72:73] neg_lo:[1,0,0] neg_hi:[1,0,0]
    v_pk_fma_f32 v[80:81], v[108:109], v[224:225], v[80:81]
    v_pk_fma_f32 v[74:75], v[110:111], v[230:231], v[74:75] neg_lo:[1,0,0] neg_hi:[1,0,0]
    v_pk_fma_f32 v[82:83], v[110:111], v[226:227], v[82:83]
    v_pk_mul_f32 v[76:77], v[112:113], v[232:233]
    v_pk_mul_f32 v[84:85], v[112:113], v[236:237]
    v_pk_mul_f32 v[78:79], v[114:115], v[234:235]
    v_pk_mul_f32 v[86:87], v[114:115], v[238:239]
    v_pk_fma_f32 v[76:77], v[116:117], v[236:237], v[76:77] neg_lo:[1,0,0] neg_hi:[1,0,0]
    v_pk_fma_f32 v[84:85], v[116:117], v[232:233], v[84:85]
    v_pk_fma_f32 v[78:79], v[118:119], v[238:239], v[78:79] neg_lo:[1,0,0] neg_hi:[1,0,0]
    v_pk_fma_f32 v[86:87], v[118:119], v[234:235], v[86:87]
    v_cvt_pk_bf16_f32 v88, v72, v73
    v_cvt_pk_bf16_f32 v89, v74, v75
    v_cvt_pk_bf16_f32 v90, v76, v77
    v_cvt_pk_bf16_f32 v91, v78, v79
    v_cvt_pk_bf16_f32 v92, v80, v81
    v_cvt_pk_bf16_f32 v93, v82, v83
    v_cvt_pk_bf16_f32 v94, v84, v85
    v_cvt_pk_bf16_f32 v95, v86, v87
    v_mfma_f32_16x16x32_bf16 v[104:107], v[168:171], v[88:91], 0
    v_mfma_f32_16x16x32_bf16 v[108:111], v[184:187], v[88:91], 0
    v_mfma_f32_16x16x32_bf16 v[112:115], v[172:175], v[88:91], 0
    v_mfma_f32_16x16x32_bf16 v[116:119], v[188:191], v[88:91], 0
    v_mfma_f32_16x16x32_bf16 v[104:107], v[176:179], v[92:95], v[104:107]
    v_mfma_f32_16x16x32_bf16 v[108:111], v[168:171], v[92:95], v[108:111]
    v_mfma_f32_16x16x32_bf16 v[112:115], v[180:183], v[92:95], v[112:115]
    v_mfma_f32_16x16x32_bf16 v[116:119], v[172:175], v[92:95], v[116:119]
    v_lshlrev_b32 v16, 16, v64
    v_and_b32 v20, 0xffff0000, v64
    v_lshlrev_b32 v17, 16, v65
    v_and_b32 v21, 0xffff0000, v65
    v_lshlrev_b32 v18, 16, v66
    v_and_b32 v22, 0xffff0000, v66
    v_lshlrev_b32 v19, 16, v67
    v_and_b32 v23, 0xffff0000, v67
    v_lshlrev_b32 v24, 16, v68
    v_and_b32 v28, 0xffff0000, v68
    v_lshlrev_b32 v25, 16, v69
    v_and_b32 v29, 0xffff0000, v69
    v_lshlrev_b32 v26, 16, v70
    v_and_b32 v30, 0xffff0000, v70
    v_lshlrev_b32 v27, 16, v71
    v_and_b32 v31, 0xffff0000, v71
    v_lshlrev_b32 v72, 16, v120
    v_and_b32 v76, 0xffff0000, v120
    v_lshlrev_b32 v73, 16, v121
    v_and_b32 v77, 0xffff0000, v121
    v_lshlrev_b32 v74, 16, v122
    v_and_b32 v78, 0xffff0000, v122
    v_lshlrev_b32 v75, 16, v123
    v_and_b32 v79, 0xffff0000, v123
    v_lshlrev_b32 v80, 16, v124
    v_and_b32 v84, 0xffff0000, v124
    v_lshlrev_b32 v81, 16, v125
    v_and_b32 v85, 0xffff0000, v125
    v_lshlrev_b32 v82, 16, v126
    v_and_b32 v86, 0xffff0000, v126
    v_lshlrev_b32 v83, 16, v127
    v_and_b32 v87, 0xffff0000, v127
    v_pk_mul_f32 v[32:33], v[48:49], v[16:17]
    v_pk_mul_f32 v[40:41], v[48:49], v[20:21]
    v_pk_mul_f32 v[34:35], v[50:51], v[18:19]
    v_pk_mul_f32 v[42:43], v[50:51], v[22:23]
    v_pk_fma_f32 v[32:33], v[52:53], v[20:21], v[32:33] neg_lo:[1,0,0] neg_hi:[1,0,0]
    v_pk_fma_f32 v[40:41], v[52:53], v[16:17], v[40:41]
    v_pk_fma_f32 v[34:35], v[54:55], v[22:23], v[34:35] neg_lo:[1,0,0] neg_hi:[1,0,0]
    v_pk_fma_f32 v[42:43], v[54:55], v[18:19], v[42:43]
    v_pk_mul_f32 v[36:37], v[56:57], v[24:25]
    v_pk_mul_f32 v[44:45], v[56:57], v[28:29]
    v_pk_mul_f32 v[38:39], v[58:59], v[26:27]
    v_pk_mul_f32 v[46:47], v[58:59], v[30:31]
    v_pk_fma_f32 v[36:37], v[60:61], v[28:29], v[36:37] neg_lo:[1,0,0] neg_hi:[1,0,0]
    v_pk_fma_f32 v[44:45], v[60:61], v[24:25], v[44:45]
    v_pk_fma_f32 v[38:39], v[62:63], v[30:31], v[38:39] neg_lo:[1,0,0] neg_hi:[1,0,0]
    v_pk_fma_f32 v[46:47], v[62:63], v[26:27], v[46:47]
    v_cvt_pk_bf16_f32 v16, v32, v33
    v_cvt_pk_bf16_f32 v17, v34, v35
    v_cvt_pk_bf16_f32 v18, v36, v37
    v_cvt_pk_bf16_f32 v19, v38, v39
    v_cvt_pk_bf16_f32 v20, v40, v41
    v_cvt_pk_bf16_f32 v21, v42, v43
    v_cvt_pk_bf16_f32 v22, v44, v45
    v_cvt_pk_bf16_f32 v23, v46, v47
    v_mfma_f32_16x16x32_bf16 v[48:51], v[16:19], v[168:171], 0
    v_mfma_f32_16x16x32_bf16 v[52:55], v[16:19], v[176:179], 0
    v_mfma_f32_16x16x32_bf16 v[56:59], v[16:19], v[172:175], 0
    v_mfma_f32_16x16x32_bf16 v[60:63], v[16:19], v[180:183], 0
    v_mfma_f32_16x16x32_bf16 v[48:51], v[20:23], v[184:187], v[48:51]
    v_mfma_f32_16x16x32_bf16 v[52:55], v[20:23], v[168:171], v[52:55]
    v_mfma_f32_16x16x32_bf16 v[56:59], v[20:23], v[188:191], v[56:59]
    v_mfma_f32_16x16x32_bf16 v[60:63], v[20:23], v[172:175], v[60:63]
    v_pk_mul_f32 v[88:89], v[104:105], v[72:73]
    v_pk_mul_f32 v[96:97], v[104:105], v[76:77]
    v_pk_mul_f32 v[90:91], v[106:107], v[74:75]
    v_pk_mul_f32 v[98:99], v[106:107], v[78:79]
    v_pk_fma_f32 v[88:89], v[108:109], v[76:77], v[88:89] neg_lo:[1,0,0] neg_hi:[1,0,0]
    v_pk_fma_f32 v[96:97], v[108:109], v[72:73], v[96:97]
    v_pk_fma_f32 v[90:91], v[110:111], v[78:79], v[90:91] neg_lo:[1,0,0] neg_hi:[1,0,0]
    v_pk_fma_f32 v[98:99], v[110:111], v[74:75], v[98:99]
    v_pk_mul_f32 v[92:93], v[112:113], v[80:81]
    v_pk_mul_f32 v[100:101], v[112:113], v[84:85]
    v_pk_mul_f32 v[94:95], v[114:115], v[82:83]
    v_pk_mul_f32 v[102:103], v[114:115], v[86:87]
    v_pk_fma_f32 v[92:93], v[116:117], v[84:85], v[92:93] neg_lo:[1,0,0] neg_hi:[1,0,0]
    v_pk_fma_f32 v[100:101], v[116:117], v[80:81], v[100:101]
    v_pk_fma_f32 v[94:95], v[118:119], v[86:87], v[94:95] neg_lo:[1,0,0] neg_hi:[1,0,0]
    v_pk_fma_f32 v[102:103], v[118:119], v[82:83], v[102:103]
    v_cvt_pk_bf16_f32 v72, v88, v89
    v_cvt_pk_bf16_f32 v73, v90, v91
    v_cvt_pk_bf16_f32 v74, v92, v93
    v_cvt_pk_bf16_f32 v75, v94, v95
    v_cvt_pk_bf16_f32 v76, v96, v97
    v_cvt_pk_bf16_f32 v77, v98, v99
    v_cvt_pk_bf16_f32 v78, v100, v101
    v_cvt_pk_bf16_f32 v79, v102, v103
    v_mfma_f32_16x16x32_bf16 v[104:107], v[72:75], v[168:171], 0
    v_mfma_f32_16x16x32_bf16 v[108:111], v[72:75], v[176:179], 0
    v_mfma_f32_16x16x32_bf16 v[112:115], v[72:75], v[172:175], 0
    v_mfma_f32_16x16x32_bf16 v[116:119], v[72:75], v[180:183], 0
    v_mfma_f32_16x16x32_bf16 v[104:107], v[76:79], v[184:187], v[104:107]
    v_mfma_f32_16x16x32_bf16 v[108:111], v[76:79], v[168:171], v[108:111]
    v_mfma_f32_16x16x32_bf16 v[112:115], v[76:79], v[188:191], v[112:115]
    v_mfma_f32_16x16x32_bf16 v[116:119], v[76:79], v[172:175], v[116:119]
    v_pk_mul_f32 v[32:33], v[48:49], v[240:241]
    v_pk_mul_f32 v[40:41], v[48:49], v[244:245]
    v_pk_mul_f32 v[34:35], v[50:51], v[242:243]
    v_pk_mul_f32 v[42:43], v[50:51], v[246:247]
    v_pk_fma_f32 v[32:33], v[52:53], v[244:245], v[32:33] neg_lo:[1,0,0] neg_hi:[1,0,0]
    v_pk_fma_f32 v[40:41], v[52:53], v[240:241], v[40:41]
    v_pk_fma_f32 v[34:35], v[54:55], v[246:247], v[34:35] neg_lo:[1,0,0] neg_hi:[1,0,0]
    v_pk_fma_f32 v[42:43], v[54:55], v[242:243], v[42:43]
    v_pk_mul_f32 v[36:37], v[56:57], v[248:249]
    v_pk_mul_f32 v[44:45], v[56:57], v[252:253]
    v_pk_mul_f32 v[38:39], v[58:59], v[250:251]
    v_pk_mul_f32 v[46:47], v[58:59], v[254:255]
    v_pk_fma_f32 v[36:37], v[60:61], v[252:253], v[36:37] neg_lo:[1,0,0] neg_hi:[1,0,0]
    v_pk_fma_f32 v[44:45], v[60:61], v[248:249], v[44:45]
    v_pk_fma_f32 v[38:39], v[62:63], v[254:255], v[38:39] neg_lo:[1,0,0] neg_hi:[1,0,0]
    v_pk_fma_f32 v[46:47], v[62:63], v[250:251], v[46:47]
    v_cvt_pk_bf16_f32 v16, v32, -v40
    v_cvt_pk_bf16_f32 v17, v33, -v41
    v_cvt_pk_bf16_f32 v18, v34, -v42
    v_cvt_pk_bf16_f32 v19, v35, -v43
    v_cvt_pk_bf16_f32 v20, v36, -v44
    v_cvt_pk_bf16_f32 v21, v37, -v45
    v_cvt_pk_bf16_f32 v22, v38, -v46
    v_cvt_pk_bf16_f32 v23, v39, -v47
    v_mov_b32 v11, 163760
gated_mix__spectral_gfnet__dense_activation_gelu__prompt_kernel_rf15:
    ds_read_b32 v12, v11
    s_waitcnt lgkmcnt(0)
    v_readfirstlane_b32 s34, v12
    s_cmp_ge_u32 s34, 4
    s_cbranch_scc1 gated_mix__spectral_gfnet__dense_activation_gelu__prompt_kernel_rf15d
    s_sleep 1
    s_branch gated_mix__spectral_gfnet__dense_activation_gelu__prompt_kernel_rf15
gated_mix__spectral_gfnet__dense_activation_gelu__prompt_kernel_rf15d:
    ds_write_b128 v7, v[16:19] offset:0
    ds_write_b128 v7, v[20:23] offset:1024
    v_pk_mul_f32 v[88:89], v[104:105], v[240:241]
    v_pk_mul_f32 v[96:97], v[104:105], v[244:245]
    v_pk_mul_f32 v[90:91], v[106:107], v[242:243]
    v_pk_mul_f32 v[98:99], v[106:107], v[246:247]
    v_pk_fma_f32 v[88:89], v[108:109], v[244:245], v[88:89] neg_lo:[1,0,0] neg_hi:[1,0,0]
    v_pk_fma_f32 v[96:97], v[108:109], v[240:241], v[96:97]
    v_pk_fma_f32 v[90:91], v[110:111], v[246:247], v[90:91] neg_lo:[1,0,0] neg_hi:[1,0,0]
    v_pk_fma_f32 v[98:99], v[110:111], v[242:243], v[98:99]
    v_pk_mul_f32 v[92:93], v[112:113], v[248:249]
    v_pk_mul_f32 v[100:101], v[112:113], v[252:253]
    v_pk_mul_f32 v[94:95], v[114:115], v[250:251]
    v_pk_mul_f32 v[102:103], v[114:115], v[254:255]
    v_pk_fma_f32 v[92:93], v[116:117], v[252:253], v[92:93] neg_lo:[1,0,0] neg_hi:[1,0,0]
    v_pk_fma_f32 v[100:101], v[116:117], v[248:249], v[100:101]
    v_pk_fma_f32 v[94:95], v[118:119], v[254:255], v[94:95] neg_lo:[1,0,0] neg_hi:[1,0,0]
    v_pk_fma_f32 v[102:103], v[118:119], v[250:251], v[102:103]
    v_cvt_pk_bf16_f32 v72, v88, -v96
    v_cvt_pk_bf16_f32 v73, v89, -v97
    v_cvt_pk_bf16_f32 v74, v90, -v98
    v_cvt_pk_bf16_f32 v75, v91, -v99
    v_cvt_pk_bf16_f32 v76, v92, -v100
    v_cvt_pk_bf16_f32 v77, v93, -v101
    v_cvt_pk_bf16_f32 v78, v94, -v102
    v_cvt_pk_bf16_f32 v79, v95, -v103
    ds_write_b128 v7, v[72:75] offset:8192
    ds_write_b128 v7, v[76:79] offset:9216
    s_waitcnt lgkmcnt(0)
    v_mov_b32 v11, 163728
    v_mov_b32 v12, 1
    s_mov_b64 exec, 1
    ds_add_u32 v11, v12
    s_mov_b64 exec, -1
gated__ls1:
    ds_read_b32 v12, v11
    s_waitcnt lgkmcnt(0)
    v_readfirstlane_b32 s34, v12
    s_cmp_ge_u32 s34, 4
    s_cbranch_scc1 gated__ls1d
    s_sleep 1
    s_branch gated__ls1
gated__ls1d:
    ds_read_b128 v[16:19], v8 offset:0
    ds_read_b128 v[20:23], v8 offset:2048
    ds_read_b128 v[24:27], v8 offset:4096
    ds_read_b128 v[28:31], v8 offset:6144
    ds_read_b128 v[32:35], v8 offset:8192
    ds_read_b128 v[36:39], v8 offset:10240
    ds_read_b128 v[40:43], v8 offset:12288
    ds_read_b128 v[44:47], v8 offset:14336
    ds_read_b128 v[48:51], v8 offset:1024
    ds_read_b128 v[52:55], v8 offset:3072
    ds_read_b128 v[56:59], v8 offset:5120
    ds_read_b128 v[60:63], v8 offset:7168
    ds_read_b128 v[64:67], v8 offset:9216
    ds_read_b128 v[68:71], v8 offset:11264
    ds_read_b128 v[72:75], v8 offset:13312
    ds_read_b128 v[76:79], v8 offset:15360
    s_waitcnt lgkmcnt(8)
    v_mfma_f32_16x16x32_bf16 v[96:99], v[192:195], v[16:19], 0
    v_mfma_f32_16x16x32_bf16 v[100:103], v[208:211], v[16:19], 0
    v_mfma_f32_16x16x32_bf16 v[104:107], v[192:195], v[32:35], 0
    v_mfma_f32_16x16x32_bf16 v[108:111], v[208:211], v[32:35], 0
    v_mfma_f32_16x16x32_bf16 v[96:99], v[196:199], v[20:23], v[96:99]
    v_mfma_f32_16x16x32_bf16 v[100:103], v[212:215], v[20:23], v[100:103]
    v_mfma_f32_16x16x32_bf16 v[104:107], v[196:199], v[36:39], v[104:107]
    v_mfma_f32_16x16x32_bf16 v[108:111], v[212:215], v[36:39], v[108:111]
    v_mfma_f32_16x16x32_bf16 v[96:99], v[200:203], v[24:27], v[96:99]
    v_mfma_f32_16x16x32_bf16 v[100:103], v[216:219], v[24:27], v[100:103]
    v_mfma_f32_16x16x32_bf16 v[104:107], v[200:203], v[40:43], v[104:107]
    v_mfma_f32_16x16x32_bf16 v[108:111], v[216:219], v[40:43], v[108:111]
    v_mfma_f32_16x16x32_bf16 v[96:99], v[204:207], v[28:31], v[96:99]
    v_mfma_f32_16x16x32_bf16 v[100:103], v[220:223], v[28:31], v[100:103]
    v_mfma_f32_16x16x32_bf16 v[104:107], v[204:207], v[44:47], v[104:107]
    v_mfma_f32_16x16x32_bf16 v[108:111], v[220:223], v[44:47], v[108:111]
    s_waitcnt lgkmcnt(0)
    v_mfma_f32_16x16x32_bf16 v[112:115], v[192:195], v[48:51], 0
    v_mfma_f32_16x16x32_bf16 v[116:119], v[208:211], v[48:51], 0
    v_mfma_f32_16x16x32_bf16 v[120:123], v[192:195], v[64:67], 0
    v_mfma_f32_16x16x32_bf16 v[124:127], v[208:211], v[64:67], 0
    v_mfma_f32_16x16x32_bf16 v[112:115], v[196:199], v[52:55], v[112:115]
    v_mfma_f32_16x16x32_bf16 v[116:119], v[212:215], v[52:55], v[116:119]
    v_mfma_f32_16x16x32_bf16 v[120:123], v[196:199], v[68:71], v[120:123]
    v_mfma_f32_16x16x32_bf16 v[124:127], v[212:215], v[68:71], v[124:127]
    v_mfma_f32_16x16x32_bf16 v[112:115], v[200:203], v[56:59], v[112:115]
    v_mfma_f32_16x16x32_bf16 v[116:119], v[216:219], v[56:59], v[116:119]
    v_mfma_f32_16x16x32_bf16 v[120:123], v[200:203], v[72:75], v[120:123]
    v_mfma_f32_16x16x32_bf16 v[124:127], v[216:219], v[72:75], v[124:127]
    v_mfma_f32_16x16x32_bf16 v[112:115], v[204:207], v[60:63], v[112:115]
    v_mfma_f32_16x16x32_bf16 v[116:119], v[220:223], v[60:63], v[116:119]
    v_mfma_f32_16x16x32_bf16 v[120:123], v[204:207], v[76:79], v[120:123]
    v_mfma_f32_16x16x32_bf16 v[124:127], v[220:223], v[76:79], v[124:127]
    s_cmp_lg_u32 s2, 0
    s_cbranch_scc1 gated__nosp2
    ds_read_b128 v[128:131], v8 offset:16384
    ds_read_b128 v[132:135], v8 offset:18432
    ds_read_b128 v[136:139], v8 offset:20480
    ds_read_b128 v[140:143], v8 offset:22528
    ds_read_b128 v[144:147], v8 offset:17408
    ds_read_b128 v[148:151], v8 offset:19456
    ds_read_b128 v[152:155], v8 offset:21504
    ds_read_b128 v[156:159], v8 offset:23552
    s_waitcnt lgkmcnt(0)
    v_mfma_f32_16x16x32_bf16 v[80:83], v[192:195], v[128:131], 0
    v_mfma_f32_16x16x32_bf16 v[80:83], v[196:199], v[132:135], v[80:83]
    v_mfma_f32_16x16x32_bf16 v[80:83], v[200:203], v[136:139], v[80:83]
    v_mfma_f32_16x16x32_bf16 v[80:83], v[204:207], v[140:143], v[80:83]
    v_mfma_f32_16x16x32_bf16 v[84:87], v[192:195], v[144:147], 0
    v_mfma_f32_16x16x32_bf16 v[84:87], v[196:199], v[148:151], v[84:87]
    v_mfma_f32_16x16x32_bf16 v[84:87], v[200:203], v[152:155], v[84:87]
    v_mfma_f32_16x16x32_bf16 v[84:87], v[204:207], v[156:159], v[84:87]
    s_nop 7
    v_xor_b32 v100, 0x80000000, v80
    v_xor_b32 v101, 0x80000000, v81
    v_xor_b32 v102, 0x80000000, v82
    v_xor_b32 v103, 0x80000000, v83
    v_xor_b32 v116, 0x80000000, v84
    v_xor_b32 v117, 0x80000000, v85
    v_xor_b32 v118, 0x80000000, v86
    v_xor_b32 v119, 0x80000000, v87
gated__nosp2:
    s_nop 7
    v_cvt_pk_bf16_f32 v16, v96, -v100
    v_cvt_pk_bf16_f32 v17, v104, -v108
    v_cvt_pk_bf16_f32 v18, v97, -v101
    v_cvt_pk_bf16_f32 v19, v105, -v109
    v_cvt_pk_bf16_f32 v20, v98, -v102
    v_cvt_pk_bf16_f32 v21, v106, -v110
    v_cvt_pk_bf16_f32 v22, v99, -v103
    v_cvt_pk_bf16_f32 v23, v107, -v111
    v_mov_b32 v24, v16
    v_mov_b32 v25, v17
    v_mov_b32 v26, v18
    v_mov_b32 v27, v19
    v_mov_b32_dpp v16, v20 row_ror:8 row_mask:0xf bank_mask:0xc
    v_mov_b32_dpp v17, v21 row_ror:8 row_mask:0xf bank_mask:0xc
    v_mov_b32_dpp v18, v22 row_ror:8 row_mask:0xf bank_mask:0xc
    v_mov_b32_dpp v19, v23 row_ror:8 row_mask:0xf bank_mask:0xc
    v_mov_b32_dpp v24, v20 row_ror:8 row_mask:0xf bank_mask:0x3
    v_mov_b32_dpp v25, v21 row_ror:8 row_mask:0xf bank_mask:0x3
    v_mov_b32_dpp v26, v22 row_ror:8 row_mask:0xf bank_mask:0x3
    v_mov_b32_dpp v27, v23 row_ror:8 row_mask:0xf bank_mask:0x3
    v_cvt_pk_bf16_f32 v28, v112, -v116
    v_cvt_pk_bf16_f32 v29, v120, -v124
    v_cvt_pk_bf16_f32 v30, v113, -v117
    v_cvt_pk_bf16_f32 v31, v121, -v125
    v_cvt_pk_bf16_f32 v32, v114, -v118
    v_cvt_pk_bf16_f32 v33, v122, -v126
    v_cvt_pk_bf16_f32 v34, v115, -v119
    v_cvt_pk_bf16_f32 v35, v123, -v127
    v_mov_b32 v36, v28
    v_mov_b32 v37, v29
    v_mov_b32 v38, v30
    v_mov_b32 v39, v31
    v_mov_b32_dpp v28, v32 row_ror:8 row_mask:0xf bank_mask:0xc
    v_mov_b32_dpp v29, v33 row_ror:8 row_mask:0xf bank_mask:0xc
    v_mov_b32_dpp v30, v34 row_ror:8 row_mask:0xf bank_mask:0xc
    v_mov_b32_dpp v31, v35 row_ror:8 row_mask:0xf bank_mask:0xc
    v_mov_b32_dpp v36, v32 row_ror:8 row_mask:0xf bank_mask:0x3
    v_mov_b32_dpp v37, v33 row_ror:8 row_mask:0xf bank_mask:0x3
    v_mov_b32_dpp v38, v34 row_ror:8 row_mask:0xf bank_mask:0x3
    v_mov_b32_dpp v39, v35 row_ror:8 row_mask:0xf bank_mask:0x3
    s_mov_b32 s44, 0
    v_mov_b32 v11, 163712
    v_mov_b32 v12, 1
    buffer_store_dwordx4 v[16:19], v9, s[12:15], s48 offen sc1
    buffer_store_dwordx4 v[24:27], v10, s[12:15], s48 offen sc1
    buffer_store_dwordx4 v[28:31], v9, s[12:15], s49 offen sc1
    buffer_store_dwordx4 v[36:39], v10, s[12:15], s49 offen sc1
    s_cmp_ge_u32 s30, 2
    s_cbranch_scc1 gated__XC
    s_mul_i32 s46, s28, 917504
    s_mul_i32 s38, s31, 458752
    s_add_u32 s46, s46, s38
    s_add_u32 s46, s46, s53
    s_lshl_b32 s38, s32, 1
    s_add_u32 s38, s38, s30
    s_and_b32 s39, s38, 7
    s_lshl_b32 s40, s38, 7
    s_lshr_b32 s41, s38, 3
    s_mul_i32 s41, s41, 458752
    s_add_u32 s41, s41, 14680064
    s_and_b32 s42, s87, 0xffff
    s_and_b32 s43, s77, 0xffff
    s_mov_b32 s22, 42467328
    s_cmp_eq_u32 s39, 3
    s_cselect_b32 s20, s86, s76
    s_cselect_b32 s21, s42, s43
    s_cselect_b32 s22, s22, 7340032
    s_mov_b32 s23, 0x00020000
    s_cselect_b32 s39, 7, 11
    s_cselect_b32 s47, s41, s40
    s_lshl_b32 s56, 8, s39
    s_mul_i32 s38, s31, 224
    s_mul_i32 s38, s38, s56
    s_add_u32 s47, s47, s38
    v_lshrrev_b32 v2, 3, v0
    v_lshlrev_b32 v2, s39, v2
    v_and_b32 v3, 7, v0
    v_lshlrev_b32 v4, 1, v15
    v_xor_b32 v3, v3, v4
    v_lshl_add_u32 v2, v3, 4, v2
    v_mov_b32 v63, 163756
    s_and_b32 s55, s33, 0xf8
    s_lshl_b32 s55, s55, 7
    s_add_u32 s55, s55, 42008580
    v_and_b32 v59, 7, v0
    v_lshlrev_b32 v59, 7, v59
    s_barrier
    s_add_u32 m0, s53, 98304
    s_add_u32 s54, s46, 180224
    buffer_load_dwordx4 v13, s[12:15], s54 offen offset:0 lds
    buffer_load_dwordx4 v13, s[12:15], s54 offen offset:1024 lds
    buffer_load_dwordx4 v13, s[12:15], s54 offen offset:2048 lds
    buffer_load_dwordx4 v13, s[12:15], s54 offen offset:3072 lds
    s_add_u32 m0, s53, 102400
    s_add_u32 s54, s46, 184320
    buffer_load_dwordx4 v13, s[12:15], s54 offen offset:0 lds
    buffer_load_dwordx4 v13, s[12:15], s54 offen offset:1024 lds
    buffer_load_dwordx4 v13, s[12:15], s54 offen offset:2048 lds
    buffer_load_dwordx4 v13, s[12:15], s54 offen offset:3072 lds
    s_mul_i32 s54, s56, 88
    s_add_u32 s54, s54, s47
    s_add_u32 m0, s53, 114688
    s_nop 0
    buffer_load_dwordx4 v2, s[20:23], s54 offen lds
    s_add_u32 m0, m0, 1024
    s_add_u32 s54, s54, s56
    buffer_load_dwordx4 v2, s[20:23], s54 offen lds
    s_add_u32 m0, m0, 1024
    s_add_u32 s54, s54, s56
    buffer_load_dwordx4 v2, s[20:23], s54 offen lds
    s_add_u32 m0, m0, 1024
    s_add_u32 s54, s54, s56
    buffer_load_dwordx4 v2, s[20:23], s54 offen lds
    s_add_u32 m0, m0, 1024
    s_add_u32 s54, s54, s56
    buffer_load_dwordx4 v2, s[20:23], s54 offen lds
    s_add_u32 m0, m0, 1024
    s_add_u32 s54, s54, s56
    buffer_load_dwordx4 v2, s[20:23], s54 offen lds
    s_add_u32 m0, m0, 1024
    s_add_u32 s54, s54, s56
    buffer_load_dwordx4 v2, s[20:23], s54 offen lds
    s_add_u32 m0, m0, 1024
    s_add_u32 s54, s54, s56
    buffer_load_dwordx4 v2, s[20:23], s54 offen lds
    s_barrier
    s_add_u32 m0, s53, 0
    s_add_u32 s54, s46, 229376
    buffer_load_dwordx4 v13, s[12:15], s54 offen offset:0 lds
    buffer_load_dwordx4 v13, s[12:15], s54 offen offset:1024 lds
    buffer_load_dwordx4 v13, s[12:15], s54 offen offset:2048 lds
    buffer_load_dwordx4 v13, s[12:15], s54 offen offset:3072 lds
    s_add_u32 m0, s53, 4096
    s_add_u32 s54, s46, 233472
    buffer_load_dwordx4 v13, s[12:15], s54 offen offset:0 lds
    buffer_load_dwordx4 v13, s[12:15], s54 offen offset:1024 lds
    buffer_load_dwordx4 v13, s[12:15], s54 offen offset:2048 lds
    buffer_load_dwordx4 v13, s[12:15], s54 offen offset:3072 lds
    s_mul_i32 s54, s56, 112
    s_add_u32 s54, s54, s47
    s_add_u32 m0, s53, 16384
    s_nop 0
    buffer_load_dwordx4 v2, s[20:23], s54 offen lds
    s_add_u32 m0, m0, 1024
    s_add_u32 s54, s54, s56
    buffer_load_dwordx4 v2, s[20:23], s54 offen lds
    s_add_u32 m0, m0, 1024
    s_add_u32 s54, s54, s56
    buffer_load_dwordx4 v2, s[20:23], s54 offen lds
    s_add_u32 m0, m0, 1024
    s_add_u32 s54, s54, s56
    buffer_load_dwordx4 v2, s[20:23], s54 offen lds
    s_add_u32 m0, m0, 1024
    s_add_u32 s54, s54, s56
    buffer_load_dwordx4 v2, s[20:23], s54 offen lds
    s_add_u32 m0, m0, 1024
    s_add_u32 s54, s54, s56
    buffer_load_dwordx4 v2, s[20:23], s54 offen lds
    s_add_u32 m0, m0, 1024
    s_add_u32 s54, s54, s56
    buffer_load_dwordx4 v2, s[20:23], s54 offen lds
    s_add_u32 m0, m0, 1024
    s_add_u32 s54, s54, s56
    buffer_load_dwordx4 v2, s[20:23], s54 offen lds
    s_barrier
    s_add_u32 m0, s53, 32768
    s_add_u32 s54, s46, 294912
    buffer_load_dwordx4 v13, s[12:15], s54 offen offset:0 lds
    buffer_load_dwordx4 v13, s[12:15], s54 offen offset:1024 lds
    buffer_load_dwordx4 v13, s[12:15], s54 offen offset:2048 lds
    buffer_load_dwordx4 v13, s[12:15], s54 offen offset:3072 lds
    s_add_u32 m0, s53, 36864
    s_add_u32 s54, s46, 299008
    buffer_load_dwordx4 v13, s[12:15], s54 offen offset:0 lds
    buffer_load_dwordx4 v13, s[12:15], s54 offen offset:1024 lds
    buffer_load_dwordx4 v13, s[12:15], s54 offen offset:2048 lds
    buffer_load_dwordx4 v13, s[12:15], s54 offen offset:3072 lds
    s_mul_i32 s54, s56, 144
    s_add_u32 s54, s54, s47
    s_add_u32 m0, s53, 49152
    s_nop 0
    buffer_load_dwordx4 v2, s[20:23], s54 offen lds
    s_add_u32 m0, m0, 1024
    s_add_u32 s54, s54, s56
    buffer_load_dwordx4 v2, s[20:23], s54 offen lds
    s_add_u32 m0, m0, 1024
    s_add_u32 s54, s54, s56
    buffer_load_dwordx4 v2, s[20:23], s54 offen lds
    s_add_u32 m0, m0, 1024
    s_add_u32 s54, s54, s56
    buffer_load_dwordx4 v2, s[20:23], s54 offen lds
    s_add_u32 m0, m0, 1024
    s_add_u32 s54, s54, s56
    buffer_load_dwordx4 v2, s[20:23], s54 offen lds
    s_add_u32 m0, m0, 1024
    s_add_u32 s54, s54, s56
    buffer_load_dwordx4 v2, s[20:23], s54 offen lds
    s_add_u32 m0, m0, 1024
    s_add_u32 s54, s54, s56
    buffer_load_dwordx4 v2, s[20:23], s54 offen lds
    s_add_u32 m0, m0, 1024
    s_add_u32 s54, s54, s56
    buffer_load_dwordx4 v2, s[20:23], s54 offen lds
    s_waitcnt vmcnt(32)
    s_cmp_lg_u32 s44, 0
    s_cbranch_scc1 gated_mix__spectral_gfnet__dense_activation_gelu__prompt_kernel_za16
    s_getreg_b32 s34, hwreg(HW_REG_IB_STS, 0, 4)
    s_getreg_b32 s35, hwreg(HW_REG_IB_STS, 22, 2)
    s_lshl_b32 s35, s35, 4
    s_or_b32 s34, s34, s35
    s_cmp_gt_u32 s34, 63
    s_cbranch_scc1 gated_mix__spectral_gfnet__dense_activation_gelu__prompt_kernel_za16
    s_mov_b64 exec, 1
    ds_add_u32 v11, v12 offset:52
    s_mov_b64 exec, -1
    s_mov_b32 s44, 1
gated_mix__spectral_gfnet__dense_activation_gelu__prompt_kernel_za16:
    s_waitcnt lgkmcnt(0)
    s_barrier
    s_add_u32 m0, s53, 65536
    s_add_u32 s54, s46, 344064
    buffer_load_dwordx4 v13, s[12:15], s54 offen offset:0 lds
    buffer_load_dwordx4 v13, s[12:15], s54 offen offset:1024 lds
    buffer_load_dwordx4 v13, s[12:15], s54 offen offset:2048 lds
    buffer_load_dwordx4 v13, s[12:15], s54 offen offset:3072 lds
    s_add_u32 m0, s53, 69632
    s_add_u32 s54, s46, 348160
    buffer_load_dwordx4 v13, s[12:15], s54 offen offset:0 lds
    buffer_load_dwordx4 v13, s[12:15], s54 offen offset:1024 lds
    buffer_load_dwordx4 v13, s[12:15], s54 offen offset:2048 lds
    buffer_load_dwordx4 v13, s[12:15], s54 offen offset:3072 lds
    s_mul_i32 s54, s56, 168
    s_add_u32 s54, s54, s47
    s_add_u32 m0, s53, 81920
    s_nop 0
    buffer_load_dwordx4 v2, s[20:23], s54 offen lds
    s_add_u32 m0, m0, 1024
    s_add_u32 s54, s54, s56
    buffer_load_dwordx4 v2, s[20:23], s54 offen lds
    s_add_u32 m0, m0, 1024
    s_add_u32 s54, s54, s56
    buffer_load_dwordx4 v2, s[20:23], s54 offen lds
    s_add_u32 m0, m0, 1024
    s_add_u32 s54, s54, s56
    buffer_load_dwordx4 v2, s[20:23], s54 offen lds
    s_add_u32 m0, m0, 1024
    s_add_u32 s54, s54, s56
    buffer_load_dwordx4 v2, s[20:23], s54 offen lds
    s_add_u32 m0, m0, 1024
    s_add_u32 s54, s54, s56
    buffer_load_dwordx4 v2, s[20:23], s54 offen lds
    s_add_u32 m0, m0, 1024
    s_add_u32 s54, s54, s56
    buffer_load_dwordx4 v2, s[20:23], s54 offen lds
    s_add_u32 m0, m0, 1024
    s_add_u32 s54, s54, s56
    buffer_load_dwordx4 v2, s[20:23], s54 offen lds
    s_waitcnt vmcnt(32)
    s_barrier
    s_add_u32 m0, s53, 98304
    s_add_u32 s54, s46, 409600
    buffer_load_dwordx4 v13, s[12:15], s54 offen offset:0 lds
    buffer_load_dwordx4 v13, s[12:15], s54 offen offset:1024 lds
    buffer_load_dwordx4 v13, s[12:15], s54 offen offset:2048 lds
    buffer_load_dwordx4 v13, s[12:15], s54 offen offset:3072 lds
    s_add_u32 m0, s53, 102400
    s_add_u32 s54, s46, 413696
    buffer_load_dwordx4 v13, s[12:15], s54 offen offset:0 lds
    buffer_load_dwordx4 v13, s[12:15], s54 offen offset:1024 lds
    buffer_load_dwordx4 v13, s[12:15], s54 offen offset:2048 lds
    buffer_load_dwordx4 v13, s[12:15], s54 offen offset:3072 lds
    s_mul_i32 s54, s56, 200
    s_add_u32 s54, s54, s47
    s_add_u32 m0, s53, 114688
    s_nop 0
    buffer_load_dwordx4 v2, s[20:23], s54 offen lds
    s_add_u32 m0, m0, 1024
    s_add_u32 s54, s54, s56
    buffer_load_dwordx4 v2, s[20:23], s54 offen lds
    s_add_u32 m0, m0, 1024
    s_add_u32 s54, s54, s56
    buffer_load_dwordx4 v2, s[20:23], s54 offen lds
    s_add_u32 m0, m0, 1024
    s_add_u32 s54, s54, s56
    buffer_load_dwordx4 v2, s[20:23], s54 offen lds
    s_add_u32 m0, m0, 1024
    s_add_u32 s54, s54, s56
    buffer_load_dwordx4 v2, s[20:23], s54 offen lds
    s_add_u32 m0, m0, 1024
    s_add_u32 s54, s54, s56
    buffer_load_dwordx4 v2, s[20:23], s54 offen lds
    s_add_u32 m0, m0, 1024
    s_add_u32 s54, s54, s56
    buffer_load_dwordx4 v2, s[20:23], s54 offen lds
    s_add_u32 m0, m0, 1024
    s_add_u32 s54, s54, s56
    buffer_load_dwordx4 v2, s[20:23], s54 offen lds
    s_waitcnt vmcnt(32)
    s_barrier
    ds_read_b32 v62, v63
    s_waitcnt lgkmcnt(0)
    v_readfirstlane_b32 s34, v62
    s_cmp_lg_u32 s34, 0
    s_cbranch_scc1 gated__ph2w
    s_mov_b32 s35, 0
gated__ph2b:
    s_sleep 1
    buffer_load_dword v60, v59, s[12:15], s55 offen sc1
    s_add_u32 s35, s35, 1
    s_waitcnt vmcnt(0)
    s_cmp_gt_u32 s35, 400000
    s_cbranch_scc1 gated__ph2bd
    v_cmp_gt_u32 vcc, 1, v60
    s_cmp_eq_u64 vcc, 0
    s_cbranch_scc0 gated__ph2b
gated__ph2bd:
gated__ph2w:
    s_add_u32 m0, s53, 0
    s_add_u32 s54, s46, 16384
    buffer_load_dwordx4 v13, s[12:15], s54 offen offset:0 lds
    buffer_load_dwordx4 v13, s[12:15], s54 offen offset:1024 lds
    buffer_load_dwordx4 v13, s[12:15], s54 offen offset:2048 lds
    buffer_load_dwordx4 v13, s[12:15], s54 offen offset:3072 lds
    s_add_u32 m0, s53, 4096
    s_add_u32 s54, s46, 20480
    buffer_load_dwordx4 v13, s[12:15], s54 offen offset:0 lds
    buffer_load_dwordx4 v13, s[12:15], s54 offen offset:1024 lds
    buffer_load_dwordx4 v13, s[12:15], s54 offen offset:2048 lds
    buffer_load_dwordx4 v13, s[12:15], s54 offen offset:3072 lds
    s_mul_i32 s54, s56, 8
    s_add_u32 s54, s54, s47
    s_add_u32 m0, s53, 16384
    s_nop 0
    buffer_load_dwordx4 v2, s[20:23], s54 offen lds
    s_add_u32 m0, m0, 1024
    s_add_u32 s54, s54, s56
    buffer_load_dwordx4 v2, s[20:23], s54 offen lds
    s_add_u32 m0, m0, 1024
    s_add_u32 s54, s54, s56
    buffer_load_dwordx4 v2, s[20:23], s54 offen lds
    s_add_u32 m0, m0, 1024
    s_add_u32 s54, s54, s56
    buffer_load_dwordx4 v2, s[20:23], s54 offen lds
    s_add_u32 m0, m0, 1024
    s_add_u32 s54, s54, s56
    buffer_load_dwordx4 v2, s[20:23], s54 offen lds
    s_add_u32 m0, m0, 1024
    s_add_u32 s54, s54, s56
    buffer_load_dwordx4 v2, s[20:23], s54 offen lds
    s_add_u32 m0, m0, 1024
    s_add_u32 s54, s54, s56
    buffer_load_dwordx4 v2, s[20:23], s54 offen lds
    s_add_u32 m0, m0, 1024
    s_add_u32 s54, s54, s56
    buffer_load_dwordx4 v2, s[20:23], s54 offen lds
    s_waitcnt vmcnt(32)
    s_barrier
    s_add_u32 m0, s53, 32768
    s_add_u32 s54, s46, 32768
    buffer_load_dwordx4 v13, s[12:15], s54 offen offset:0 lds
    buffer_load_dwordx4 v13, s[12:15], s54 offen offset:1024 lds
    buffer_load_dwordx4 v13, s[12:15], s54 offen offset:2048 lds
    buffer_load_dwordx4 v13, s[12:15], s54 offen offset:3072 lds
    s_add_u32 m0, s53, 36864
    s_add_u32 s54, s46, 36864
    buffer_load_dwordx4 v13, s[12:15], s54 offen offset:0 lds
    buffer_load_dwordx4 v13, s[12:15], s54 offen offset:1024 lds
    buffer_load_dwordx4 v13, s[12:15], s54 offen offset:2048 lds
    buffer_load_dwordx4 v13, s[12:15], s54 offen offset:3072 lds
    s_mul_i32 s54, s56, 16
    s_add_u32 s54, s54, s47
    s_add_u32 m0, s53, 49152
    s_nop 0
    buffer_load_dwordx4 v2, s[20:23], s54 offen lds
    s_add_u32 m0, m0, 1024
    s_add_u32 s54, s54, s56
    buffer_load_dwordx4 v2, s[20:23], s54 offen lds
    s_add_u32 m0, m0, 1024
    s_add_u32 s54, s54, s56
    buffer_load_dwordx4 v2, s[20:23], s54 offen lds
    s_add_u32 m0, m0, 1024
    s_add_u32 s54, s54, s56
    buffer_load_dwordx4 v2, s[20:23], s54 offen lds
    s_add_u32 m0, m0, 1024
    s_add_u32 s54, s54, s56
    buffer_load_dwordx4 v2, s[20:23], s54 offen lds
    s_add_u32 m0, m0, 1024
    s_add_u32 s54, s54, s56
    buffer_load_dwordx4 v2, s[20:23], s54 offen lds
    s_add_u32 m0, m0, 1024
    s_add_u32 s54, s54, s56
    buffer_load_dwordx4 v2, s[20:23], s54 offen lds
    s_add_u32 m0, m0, 1024
    s_add_u32 s54, s54, s56
    buffer_load_dwordx4 v2, s[20:23], s54 offen lds
    s_waitcnt vmcnt(32)
    s_barrier
    s_add_u32 m0, s53, 65536
    s_add_u32 s54, s46, 49152
    buffer_load_dwordx4 v13, s[12:15], s54 offen offset:0 lds
    buffer_load_dwordx4 v13, s[12:15], s54 offen offset:1024 lds
    buffer_load_dwordx4 v13, s[12:15], s54 offen offset:2048 lds
    buffer_load_dwordx4 v13, s[12:15], s54 offen offset:3072 lds
    s_add_u32 m0, s53, 69632
    s_add_u32 s54, s46, 53248
    buffer_load_dwordx4 v13, s[12:15], s54 offen offset:0 lds
    buffer_load_dwordx4 v13, s[12:15], s54 offen offset:1024 lds
    buffer_load_dwordx4 v13, s[12:15], s54 offen offset:2048 lds
    buffer_load_dwordx4 v13, s[12:15], s54 offen offset:3072 lds
    s_mul_i32 s54, s56, 24
    s_add_u32 s54, s54, s47
    s_add_u32 m0, s53, 81920
    s_nop 0
    buffer_load_dwordx4 v2, s[20:23], s54 offen lds
    s_add_u32 m0, m0, 1024
    s_add_u32 s54, s54, s56
    buffer_load_dwordx4 v2, s[20:23], s54 offen lds
    s_add_u32 m0, m0, 1024
    s_add_u32 s54, s54, s56
    buffer_load_dwordx4 v2, s[20:23], s54 offen lds
    s_add_u32 m0, m0, 1024
    s_add_u32 s54, s54, s56
    buffer_load_dwordx4 v2, s[20:23], s54 offen lds
    s_add_u32 m0, m0, 1024
    s_add_u32 s54, s54, s56
    buffer_load_dwordx4 v2, s[20:23], s54 offen lds
    s_add_u32 m0, m0, 1024
    s_add_u32 s54, s54, s56
    buffer_load_dwordx4 v2, s[20:23], s54 offen lds
    s_add_u32 m0, m0, 1024
    s_add_u32 s54, s54, s56
    buffer_load_dwordx4 v2, s[20:23], s54 offen lds
    s_add_u32 m0, m0, 1024
    s_add_u32 s54, s54, s56
    buffer_load_dwordx4 v2, s[20:23], s54 offen lds
    s_waitcnt vmcnt(32)
    s_barrier
    s_add_u32 m0, s53, 98304
    s_add_u32 s54, s46, 81920
    buffer_load_dwordx4 v13, s[12:15], s54 offen offset:0 lds
    buffer_load_dwordx4 v13, s[12:15], s54 offen offset:1024 lds
    buffer_load_dwordx4 v13, s[12:15], s54 offen offset:2048 lds
    buffer_load_dwordx4 v13, s[12:15], s54 offen offset:3072 lds
    s_add_u32 m0, s53, 102400
    s_add_u32 s54, s46, 86016
    buffer_load_dwordx4 v13, s[12:15], s54 offen offset:0 lds
    buffer_load_dwordx4 v13, s[12:15], s54 offen offset:1024 lds
    buffer_load_dwordx4 v13, s[12:15], s54 offen offset:2048 lds
    buffer_load_dwordx4 v13, s[12:15], s54 offen offset:3072 lds
    s_mul_i32 s54, s56, 40
    s_add_u32 s54, s54, s47
    s_add_u32 m0, s53, 114688
    s_nop 0
    buffer_load_dwordx4 v2, s[20:23], s54 offen lds
    s_add_u32 m0, m0, 1024
    s_add_u32 s54, s54, s56
    buffer_load_dwordx4 v2, s[20:23], s54 offen lds
    s_add_u32 m0, m0, 1024
    s_add_u32 s54, s54, s56
    buffer_load_dwordx4 v2, s[20:23], s54 offen lds
    s_add_u32 m0, m0, 1024
    s_add_u32 s54, s54, s56
    buffer_load_dwordx4 v2, s[20:23], s54 offen lds
    s_add_u32 m0, m0, 1024
    s_add_u32 s54, s54, s56
    buffer_load_dwordx4 v2, s[20:23], s54 offen lds
    s_add_u32 m0, m0, 1024
    s_add_u32 s54, s54, s56
    buffer_load_dwordx4 v2, s[20:23], s54 offen lds
    s_add_u32 m0, m0, 1024
    s_add_u32 s54, s54, s56
    buffer_load_dwordx4 v2, s[20:23], s54 offen lds
    s_add_u32 m0, m0, 1024
    s_add_u32 s54, s54, s56
    buffer_load_dwordx4 v2, s[20:23], s54 offen lds
    s_waitcnt vmcnt(32)
    s_barrier
    s_add_u32 m0, s53, 0
    s_add_u32 s54, s46, 98304
    buffer_load_dwordx4 v13, s[12:15], s54 offen offset:0 lds
    buffer_load_dwordx4 v13, s[12:15], s54 offen offset:1024 lds
    buffer_load_dwordx4 v13, s[12:15], s54 offen offset:2048 lds
    buffer_load_dwordx4 v13, s[12:15], s54 offen offset:3072 lds
    s_add_u32 m0, s53, 4096
    s_add_u32 s54, s46, 102400
    buffer_load_dwordx4 v13, s[12:15], s54 offen offset:0 lds
    buffer_load_dwordx4 v13, s[12:15], s54 offen offset:1024 lds
    buffer_load_dwordx4 v13, s[12:15], s54 offen offset:2048 lds
    buffer_load_dwordx4 v13, s[12:15], s54 offen offset:3072 lds
    s_mul_i32 s54, s56, 48
    s_add_u32 s54, s54, s47
    s_add_u32 m0, s53, 16384
    s_nop 0
    buffer_load_dwordx4 v2, s[20:23], s54 offen lds
    s_add_u32 m0, m0, 1024
    s_add_u32 s54, s54, s56
    buffer_load_dwordx4 v2, s[20:23], s54 offen lds
    s_add_u32 m0, m0, 1024
    s_add_u32 s54, s54, s56
    buffer_load_dwordx4 v2, s[20:23], s54 offen lds
    s_add_u32 m0, m0, 1024
    s_add_u32 s54, s54, s56
    buffer_load_dwordx4 v2, s[20:23], s54 offen lds
    s_add_u32 m0, m0, 1024
    s_add_u32 s54, s54, s56
    buffer_load_dwordx4 v2, s[20:23], s54 offen lds
    s_add_u32 m0, m0, 1024
    s_add_u32 s54, s54, s56
    buffer_load_dwordx4 v2, s[20:23], s54 offen lds
    s_add_u32 m0, m0, 1024
    s_add_u32 s54, s54, s56
    buffer_load_dwordx4 v2, s[20:23], s54 offen lds
    s_add_u32 m0, m0, 1024
    s_add_u32 s54, s54, s56
    buffer_load_dwordx4 v2, s[20:23], s54 offen lds
    s_waitcnt vmcnt(32)
    s_barrier
    s_add_u32 m0, s53, 32768
    s_add_u32 s54, s46, 131072
    buffer_load_dwordx4 v13, s[12:15], s54 offen offset:0 lds
    buffer_load_dwordx4 v13, s[12:15], s54 offen offset:1024 lds
    buffer_load_dwordx4 v13, s[12:15], s54 offen offset:2048 lds
    buffer_load_dwordx4 v13, s[12:15], s54 offen offset:3072 lds
    s_add_u32 m0, s53, 36864
    s_add_u32 s54, s46, 135168
    buffer_load_dwordx4 v13, s[12:15], s54 offen offset:0 lds
    buffer_load_dwordx4 v13, s[12:15], s54 offen offset:1024 lds
    buffer_load_dwordx4 v13, s[12:15], s54 offen offset:2048 lds
    buffer_load_dwordx4 v13, s[12:15], s54 offen offset:3072 lds
    s_mul_i32 s54, s56, 64
    s_add_u32 s54, s54, s47
    s_add_u32 m0, s53, 49152
    s_nop 0
    buffer_load_dwordx4 v2, s[20:23], s54 offen lds
    s_add_u32 m0, m0, 1024
    s_add_u32 s54, s54, s56
    buffer_load_dwordx4 v2, s[20:23], s54 offen lds
    s_add_u32 m0, m0, 1024
    s_add_u32 s54, s54, s56
    buffer_load_dwordx4 v2, s[20:23], s54 offen lds
    s_add_u32 m0, m0, 1024
    s_add_u32 s54, s54, s56
    buffer_load_dwordx4 v2, s[20:23], s54 offen lds
    s_add_u32 m0, m0, 1024
    s_add_u32 s54, s54, s56
    buffer_load_dwordx4 v2, s[20:23], s54 offen lds
    s_add_u32 m0, m0, 1024
    s_add_u32 s54, s54, s56
    buffer_load_dwordx4 v2, s[20:23], s54 offen lds
    s_add_u32 m0, m0, 1024
    s_add_u32 s54, s54, s56
    buffer_load_dwordx4 v2, s[20:23], s54 offen lds
    s_add_u32 m0, m0, 1024
    s_add_u32 s54, s54, s56
    buffer_load_dwordx4 v2, s[20:23], s54 offen lds
    s_waitcnt vmcnt(32)
    s_barrier
    s_add_u32 m0, s53, 65536
    s_add_u32 s54, s46, 147456
    buffer_load_dwordx4 v13, s[12:15], s54 offen offset:0 lds
    buffer_load_dwordx4 v13, s[12:15], s54 offen offset:1024 lds
    buffer_load_dwordx4 v13, s[12:15], s54 offen offset:2048 lds
    buffer_load_dwordx4 v13, s[12:15], s54 offen offset:3072 lds
    s_add_u32 m0, s53, 69632
    s_add_u32 s54, s46, 151552
    buffer_load_dwordx4 v13, s[12:15], s54 offen offset:0 lds
    buffer_load_dwordx4 v13, s[12:15], s54 offen offset:1024 lds
    buffer_load_dwordx4 v13, s[12:15], s54 offen offset:2048 lds
    buffer_load_dwordx4 v13, s[12:15], s54 offen offset:3072 lds
    s_mul_i32 s54, s56, 72
    s_add_u32 s54, s54, s47
    s_add_u32 m0, s53, 81920
    s_nop 0
    buffer_load_dwordx4 v2, s[20:23], s54 offen lds
    s_add_u32 m0, m0, 1024
    s_add_u32 s54, s54, s56
    buffer_load_dwordx4 v2, s[20:23], s54 offen lds
    s_add_u32 m0, m0, 1024
    s_add_u32 s54, s54, s56
    buffer_load_dwordx4 v2, s[20:23], s54 offen lds
    s_add_u32 m0, m0, 1024
    s_add_u32 s54, s54, s56
    buffer_load_dwordx4 v2, s[20:23], s54 offen lds
    s_add_u32 m0, m0, 1024
    s_add_u32 s54, s54, s56
    buffer_load_dwordx4 v2, s[20:23], s54 offen lds
    s_add_u32 m0, m0, 1024
    s_add_u32 s54, s54, s56
    buffer_load_dwordx4 v2, s[20:23], s54 offen lds
    s_add_u32 m0, m0, 1024
    s_add_u32 s54, s54, s56
    buffer_load_dwordx4 v2, s[20:23], s54 offen lds
    s_add_u32 m0, m0, 1024
    s_add_u32 s54, s54, s56
    buffer_load_dwordx4 v2, s[20:23], s54 offen lds
    s_waitcnt vmcnt(32)
    s_barrier
    s_add_u32 m0, s53, 98304
    s_add_u32 s54, s46, 163840
    buffer_load_dwordx4 v13, s[12:15], s54 offen offset:0 lds
    buffer_load_dwordx4 v13, s[12:15], s54 offen offset:1024 lds
    buffer_load_dwordx4 v13, s[12:15], s54 offen offset:2048 lds
    buffer_load_dwordx4 v13, s[12:15], s54 offen offset:3072 lds
    s_add_u32 m0, s53, 102400
    s_add_u32 s54, s46, 167936
    buffer_load_dwordx4 v13, s[12:15], s54 offen offset:0 lds
    buffer_load_dwordx4 v13, s[12:15], s54 offen offset:1024 lds
    buffer_load_dwordx4 v13, s[12:15], s54 offen offset:2048 lds
    buffer_load_dwordx4 v13, s[12:15], s54 offen offset:3072 lds
    s_mul_i32 s54, s56, 80
    s_add_u32 s54, s54, s47
    s_add_u32 m0, s53, 114688
    s_nop 0
    buffer_load_dwordx4 v2, s[20:23], s54 offen lds
    s_add_u32 m0, m0, 1024
    s_add_u32 s54, s54, s56
    buffer_load_dwordx4 v2, s[20:23], s54 offen lds
    s_add_u32 m0, m0, 1024
    s_add_u32 s54, s54, s56
    buffer_load_dwordx4 v2, s[20:23], s54 offen lds
    s_add_u32 m0, m0, 1024
    s_add_u32 s54, s54, s56
    buffer_load_dwordx4 v2, s[20:23], s54 offen lds
    s_add_u32 m0, m0, 1024
    s_add_u32 s54, s54, s56
    buffer_load_dwordx4 v2, s[20:23], s54 offen lds
    s_add_u32 m0, m0, 1024
    s_add_u32 s54, s54, s56
    buffer_load_dwordx4 v2, s[20:23], s54 offen lds
    s_add_u32 m0, m0, 1024
    s_add_u32 s54, s54, s56
    buffer_load_dwordx4 v2, s[20:23], s54 offen lds
    s_add_u32 m0, m0, 1024
    s_add_u32 s54, s54, s56
    buffer_load_dwordx4 v2, s[20:23], s54 offen lds
    s_waitcnt vmcnt(32)
    s_barrier
    s_add_u32 m0, s53, 0
    s_add_u32 s54, s46, 196608
    buffer_load_dwordx4 v13, s[12:15], s54 offen offset:0 lds
    buffer_load_dwordx4 v13, s[12:15], s54 offen offset:1024 lds
    buffer_load_dwordx4 v13, s[12:15], s54 offen offset:2048 lds
    buffer_load_dwordx4 v13, s[12:15], s54 offen offset:3072 lds
    s_add_u32 m0, s53, 4096
    s_add_u32 s54, s46, 200704
    buffer_load_dwordx4 v13, s[12:15], s54 offen offset:0 lds
    buffer_load_dwordx4 v13, s[12:15], s54 offen offset:1024 lds
    buffer_load_dwordx4 v13, s[12:15], s54 offen offset:2048 lds
    buffer_load_dwordx4 v13, s[12:15], s54 offen offset:3072 lds
    s_mul_i32 s54, s56, 96
    s_add_u32 s54, s54, s47
    s_add_u32 m0, s53, 16384
    s_nop 0
    buffer_load_dwordx4 v2, s[20:23], s54 offen lds
    s_add_u32 m0, m0, 1024
    s_add_u32 s54, s54, s56
    buffer_load_dwordx4 v2, s[20:23], s54 offen lds
    s_add_u32 m0, m0, 1024
    s_add_u32 s54, s54, s56
    buffer_load_dwordx4 v2, s[20:23], s54 offen lds
    s_add_u32 m0, m0, 1024
    s_add_u32 s54, s54, s56
    buffer_load_dwordx4 v2, s[20:23], s54 offen lds
    s_add_u32 m0, m0, 1024
    s_add_u32 s54, s54, s56
    buffer_load_dwordx4 v2, s[20:23], s54 offen lds
    s_add_u32 m0, m0, 1024
    s_add_u32 s54, s54, s56
    buffer_load_dwordx4 v2, s[20:23], s54 offen lds
    s_add_u32 m0, m0, 1024
    s_add_u32 s54, s54, s56
    buffer_load_dwordx4 v2, s[20:23], s54 offen lds
    s_add_u32 m0, m0, 1024
    s_add_u32 s54, s54, s56
    buffer_load_dwordx4 v2, s[20:23], s54 offen lds
    s_waitcnt vmcnt(32)
    s_barrier
    s_add_u32 m0, s53, 32768
    s_add_u32 s54, s46, 212992
    buffer_load_dwordx4 v13, s[12:15], s54 offen offset:0 lds
    buffer_load_dwordx4 v13, s[12:15], s54 offen offset:1024 lds
    buffer_load_dwordx4 v13, s[12:15], s54 offen offset:2048 lds
    buffer_load_dwordx4 v13, s[12:15], s54 offen offset:3072 lds
    s_add_u32 m0, s53, 36864
    s_add_u32 s54, s46, 217088
    buffer_load_dwordx4 v13, s[12:15], s54 offen offset:0 lds
    buffer_load_dwordx4 v13, s[12:15], s54 offen offset:1024 lds
    buffer_load_dwordx4 v13, s[12:15], s54 offen offset:2048 lds
    buffer_load_dwordx4 v13, s[12:15], s54 offen offset:3072 lds
    s_mul_i32 s54, s56, 104
    s_add_u32 s54, s54, s47
    s_add_u32 m0, s53, 49152
    s_nop 0
    buffer_load_dwordx4 v2, s[20:23], s54 offen lds
    s_add_u32 m0, m0, 1024
    s_add_u32 s54, s54, s56
    buffer_load_dwordx4 v2, s[20:23], s54 offen lds
    s_add_u32 m0, m0, 1024
    s_add_u32 s54, s54, s56
    buffer_load_dwordx4 v2, s[20:23], s54 offen lds
    s_add_u32 m0, m0, 1024
    s_add_u32 s54, s54, s56
    buffer_load_dwordx4 v2, s[20:23], s54 offen lds
    s_add_u32 m0, m0, 1024
    s_add_u32 s54, s54, s56
    buffer_load_dwordx4 v2, s[20:23], s54 offen lds
    s_add_u32 m0, m0, 1024
    s_add_u32 s54, s54, s56
    buffer_load_dwordx4 v2, s[20:23], s54 offen lds
    s_add_u32 m0, m0, 1024
    s_add_u32 s54, s54, s56
    buffer_load_dwordx4 v2, s[20:23], s54 offen lds
    s_add_u32 m0, m0, 1024
    s_add_u32 s54, s54, s56
    buffer_load_dwordx4 v2, s[20:23], s54 offen lds
    s_waitcnt vmcnt(32)
    s_barrier
    s_add_u32 m0, s53, 65536
    s_add_u32 s54, s46, 245760
    buffer_load_dwordx4 v13, s[12:15], s54 offen offset:0 lds
    buffer_load_dwordx4 v13, s[12:15], s54 offen offset:1024 lds
    buffer_load_dwordx4 v13, s[12:15], s54 offen offset:2048 lds
    buffer_load_dwordx4 v13, s[12:15], s54 offen offset:3072 lds
    s_add_u32 m0, s53, 69632
    s_add_u32 s54, s46, 249856
    buffer_load_dwordx4 v13, s[12:15], s54 offen offset:0 lds
    buffer_load_dwordx4 v13, s[12:15], s54 offen offset:1024 lds
    buffer_load_dwordx4 v13, s[12:15], s54 offen offset:2048 lds
    buffer_load_dwordx4 v13, s[12:15], s54 offen offset:3072 lds
    s_mul_i32 s54, s56, 120
    s_add_u32 s54, s54, s47
    s_add_u32 m0, s53, 81920
    s_nop 0
    buffer_load_dwordx4 v2, s[20:23], s54 offen lds
    s_add_u32 m0, m0, 1024
    s_add_u32 s54, s54, s56
    buffer_load_dwordx4 v2, s[20:23], s54 offen lds
    s_add_u32 m0, m0, 1024
    s_add_u32 s54, s54, s56
    buffer_load_dwordx4 v2, s[20:23], s54 offen lds
    s_add_u32 m0, m0, 1024
    s_add_u32 s54, s54, s56
    buffer_load_dwordx4 v2, s[20:23], s54 offen lds
    s_add_u32 m0, m0, 1024
    s_add_u32 s54, s54, s56
    buffer_load_dwordx4 v2, s[20:23], s54 offen lds
    s_add_u32 m0, m0, 1024
    s_add_u32 s54, s54, s56
    buffer_load_dwordx4 v2, s[20:23], s54 offen lds
    s_add_u32 m0, m0, 1024
    s_add_u32 s54, s54, s56
    buffer_load_dwordx4 v2, s[20:23], s54 offen lds
    s_add_u32 m0, m0, 1024
    s_add_u32 s54, s54, s56
    buffer_load_dwordx4 v2, s[20:23], s54 offen lds
    s_waitcnt vmcnt(32)
    s_barrier
    s_add_u32 m0, s53, 98304
    s_add_u32 s54, s46, 262144
    buffer_load_dwordx4 v13, s[12:15], s54 offen offset:0 lds
    buffer_load_dwordx4 v13, s[12:15], s54 offen offset:1024 lds
    buffer_load_dwordx4 v13, s[12:15], s54 offen offset:2048 lds
    buffer_load_dwordx4 v13, s[12:15], s54 offen offset:3072 lds
    s_add_u32 m0, s53, 102400
    s_add_u32 s54, s46, 266240
    buffer_load_dwordx4 v13, s[12:15], s54 offen offset:0 lds
    buffer_load_dwordx4 v13, s[12:15], s54 offen offset:1024 lds
    buffer_load_dwordx4 v13, s[12:15], s54 offen offset:2048 lds
    buffer_load_dwordx4 v13, s[12:15], s54 offen offset:3072 lds
    s_mul_i32 s54, s56, 128
    s_add_u32 s54, s54, s47
    s_add_u32 m0, s53, 114688
    s_nop 0
    buffer_load_dwordx4 v2, s[20:23], s54 offen lds
    s_add_u32 m0, m0, 1024
    s_add_u32 s54, s54, s56
    buffer_load_dwordx4 v2, s[20:23], s54 offen lds
    s_add_u32 m0, m0, 1024
    s_add_u32 s54, s54, s56
    buffer_load_dwordx4 v2, s[20:23], s54 offen lds
    s_add_u32 m0, m0, 1024
    s_add_u32 s54, s54, s56
    buffer_load_dwordx4 v2, s[20:23], s54 offen lds
    s_add_u32 m0, m0, 1024
    s_add_u32 s54, s54, s56
    buffer_load_dwordx4 v2, s[20:23], s54 offen lds
    s_add_u32 m0, m0, 1024
    s_add_u32 s54, s54, s56
    buffer_load_dwordx4 v2, s[20:23], s54 offen lds
    s_add_u32 m0, m0, 1024
    s_add_u32 s54, s54, s56
    buffer_load_dwordx4 v2, s[20:23], s54 offen lds
    s_add_u32 m0, m0, 1024
    s_add_u32 s54, s54, s56
    buffer_load_dwordx4 v2, s[20:23], s54 offen lds
    s_waitcnt vmcnt(32)
    s_barrier
    s_add_u32 m0, s53, 0
    s_add_u32 s54, s46, 278528
    buffer_load_dwordx4 v13, s[12:15], s54 offen offset:0 lds
    buffer_load_dwordx4 v13, s[12:15], s54 offen offset:1024 lds
    buffer_load_dwordx4 v13, s[12:15], s54 offen offset:2048 lds
    buffer_load_dwordx4 v13, s[12:15], s54 offen offset:3072 lds
    s_add_u32 m0, s53, 4096
    s_add_u32 s54, s46, 282624
    buffer_load_dwordx4 v13, s[12:15], s54 offen offset:0 lds
    buffer_load_dwordx4 v13, s[12:15], s54 offen offset:1024 lds
    buffer_load_dwordx4 v13, s[12:15], s54 offen offset:2048 lds
    buffer_load_dwordx4 v13, s[12:15], s54 offen offset:3072 lds
    s_mul_i32 s54, s56, 136
    s_add_u32 s54, s54, s47
    s_add_u32 m0, s53, 16384
    s_nop 0
    buffer_load_dwordx4 v2, s[20:23], s54 offen lds
    s_add_u32 m0, m0, 1024
    s_add_u32 s54, s54, s56
    buffer_load_dwordx4 v2, s[20:23], s54 offen lds
    s_add_u32 m0, m0, 1024
    s_add_u32 s54, s54, s56
    buffer_load_dwordx4 v2, s[20:23], s54 offen lds
    s_add_u32 m0, m0, 1024
    s_add_u32 s54, s54, s56
    buffer_load_dwordx4 v2, s[20:23], s54 offen lds
    s_add_u32 m0, m0, 1024
    s_add_u32 s54, s54, s56
    buffer_load_dwordx4 v2, s[20:23], s54 offen lds
    s_add_u32 m0, m0, 1024
    s_add_u32 s54, s54, s56
    buffer_load_dwordx4 v2, s[20:23], s54 offen lds
    s_add_u32 m0, m0, 1024
    s_add_u32 s54, s54, s56
    buffer_load_dwordx4 v2, s[20:23], s54 offen lds
    s_add_u32 m0, m0, 1024
    s_add_u32 s54, s54, s56
    buffer_load_dwordx4 v2, s[20:23], s54 offen lds
    s_waitcnt vmcnt(32)
    s_barrier
    s_add_u32 m0, s53, 32768
    s_add_u32 s54, s46, 311296
    buffer_load_dwordx4 v13, s[12:15], s54 offen offset:0 lds
    buffer_load_dwordx4 v13, s[12:15], s54 offen offset:1024 lds
    buffer_load_dwordx4 v13, s[12:15], s54 offen offset:2048 lds
    buffer_load_dwordx4 v13, s[12:15], s54 offen offset:3072 lds
    s_add_u32 m0, s53, 36864
    s_add_u32 s54, s46, 315392
    buffer_load_dwordx4 v13, s[12:15], s54 offen offset:0 lds
    buffer_load_dwordx4 v13, s[12:15], s54 offen offset:1024 lds
    buffer_load_dwordx4 v13, s[12:15], s54 offen offset:2048 lds
    buffer_load_dwordx4 v13, s[12:15], s54 offen offset:3072 lds
    s_mul_i32 s54, s56, 152
    s_add_u32 s54, s54, s47
    s_add_u32 m0, s53, 49152
    s_nop 0
    buffer_load_dwordx4 v2, s[20:23], s54 offen lds
    s_add_u32 m0, m0, 1024
    s_add_u32 s54, s54, s56
    buffer_load_dwordx4 v2, s[20:23], s54 offen lds
    s_add_u32 m0, m0, 1024
    s_add_u32 s54, s54, s56
    buffer_load_dwordx4 v2, s[20:23], s54 offen lds
    s_add_u32 m0, m0, 1024
    s_add_u32 s54, s54, s56
    buffer_load_dwordx4 v2, s[20:23], s54 offen lds
    s_add_u32 m0, m0, 1024
    s_add_u32 s54, s54, s56
    buffer_load_dwordx4 v2, s[20:23], s54 offen lds
    s_add_u32 m0, m0, 1024
    s_add_u32 s54, s54, s56
    buffer_load_dwordx4 v2, s[20:23], s54 offen lds
    s_add_u32 m0, m0, 1024
    s_add_u32 s54, s54, s56
    buffer_load_dwordx4 v2, s[20:23], s54 offen lds
    s_add_u32 m0, m0, 1024
    s_add_u32 s54, s54, s56
    buffer_load_dwordx4 v2, s[20:23], s54 offen lds
    s_waitcnt vmcnt(32)
    s_barrier
    s_add_u32 m0, s53, 65536
    s_add_u32 s54, s46, 327680
    buffer_load_dwordx4 v13, s[12:15], s54 offen offset:0 lds
    buffer_load_dwordx4 v13, s[12:15], s54 offen offset:1024 lds
    buffer_load_dwordx4 v13, s[12:15], s54 offen offset:2048 lds
    buffer_load_dwordx4 v13, s[12:15], s54 offen offset:3072 lds
    s_add_u32 m0, s53, 69632
    s_add_u32 s54, s46, 331776
    buffer_load_dwordx4 v13, s[12:15], s54 offen offset:0 lds
    buffer_load_dwordx4 v13, s[12:15], s54 offen offset:1024 lds
    buffer_load_dwordx4 v13, s[12:15], s54 offen offset:2048 lds
    buffer_load_dwordx4 v13, s[12:15], s54 offen offset:3072 lds
    s_mul_i32 s54, s56, 160
    s_add_u32 s54, s54, s47
    s_add_u32 m0, s53, 81920
    s_nop 0
    buffer_load_dwordx4 v2, s[20:23], s54 offen lds
    s_add_u32 m0, m0, 1024
    s_add_u32 s54, s54, s56
    buffer_load_dwordx4 v2, s[20:23], s54 offen lds
    s_add_u32 m0, m0, 1024
    s_add_u32 s54, s54, s56
    buffer_load_dwordx4 v2, s[20:23], s54 offen lds
    s_add_u32 m0, m0, 1024
    s_add_u32 s54, s54, s56
    buffer_load_dwordx4 v2, s[20:23], s54 offen lds
    s_add_u32 m0, m0, 1024
    s_add_u32 s54, s54, s56
    buffer_load_dwordx4 v2, s[20:23], s54 offen lds
    s_add_u32 m0, m0, 1024
    s_add_u32 s54, s54, s56
    buffer_load_dwordx4 v2, s[20:23], s54 offen lds
    s_add_u32 m0, m0, 1024
    s_add_u32 s54, s54, s56
    buffer_load_dwordx4 v2, s[20:23], s54 offen lds
    s_add_u32 m0, m0, 1024
    s_add_u32 s54, s54, s56
    buffer_load_dwordx4 v2, s[20:23], s54 offen lds
    s_waitcnt vmcnt(32)
    s_barrier
    s_add_u32 m0, s53, 98304
    s_add_u32 s54, s46, 360448
    buffer_load_dwordx4 v13, s[12:15], s54 offen offset:0 lds
    buffer_load_dwordx4 v13, s[12:15], s54 offen offset:1024 lds
    buffer_load_dwordx4 v13, s[12:15], s54 offen offset:2048 lds
    buffer_load_dwordx4 v13, s[12:15], s54 offen offset:3072 lds
    s_add_u32 m0, s53, 102400
    s_add_u32 s54, s46, 364544
    buffer_load_dwordx4 v13, s[12:15], s54 offen offset:0 lds
    buffer_load_dwordx4 v13, s[12:15], s54 offen offset:1024 lds
    buffer_load_dwordx4 v13, s[12:15], s54 offen offset:2048 lds
    buffer_load_dwordx4 v13, s[12:15], s54 offen offset:3072 lds
    s_mul_i32 s54, s56, 176
    s_add_u32 s54, s54, s47
    s_add_u32 m0, s53, 114688
    s_nop 0
    buffer_load_dwordx4 v2, s[20:23], s54 offen lds
    s_add_u32 m0, m0, 1024
    s_add_u32 s54, s54, s56
    buffer_load_dwordx4 v2, s[20:23], s54 offen lds
    s_add_u32 m0, m0, 1024
    s_add_u32 s54, s54, s56
    buffer_load_dwordx4 v2, s[20:23], s54 offen lds
    s_add_u32 m0, m0, 1024
    s_add_u32 s54, s54, s56
    buffer_load_dwordx4 v2, s[20:23], s54 offen lds
    s_add_u32 m0, m0, 1024
    s_add_u32 s54, s54, s56
    buffer_load_dwordx4 v2, s[20:23], s54 offen lds
    s_add_u32 m0, m0, 1024
    s_add_u32 s54, s54, s56
    buffer_load_dwordx4 v2, s[20:23], s54 offen lds
    s_add_u32 m0, m0, 1024
    s_add_u32 s54, s54, s56
    buffer_load_dwordx4 v2, s[20:23], s54 offen lds
    s_add_u32 m0, m0, 1024
    s_add_u32 s54, s54, s56
    buffer_load_dwordx4 v2, s[20:23], s54 offen lds
    s_waitcnt vmcnt(32)
    s_barrier
    s_add_u32 m0, s53, 0
    s_add_u32 s54, s46, 376832
    buffer_load_dwordx4 v13, s[12:15], s54 offen offset:0 lds
    buffer_load_dwordx4 v13, s[12:15], s54 offen offset:1024 lds
    buffer_load_dwordx4 v13, s[12:15], s54 offen offset:2048 lds
    buffer_load_dwordx4 v13, s[12:15], s54 offen offset:3072 lds
    s_add_u32 m0, s53, 4096
    s_add_u32 s54, s46, 380928
    buffer_load_dwordx4 v13, s[12:15], s54 offen offset:0 lds
    buffer_load_dwordx4 v13, s[12:15], s54 offen offset:1024 lds
    buffer_load_dwordx4 v13, s[12:15], s54 offen offset:2048 lds
    buffer_load_dwordx4 v13, s[12:15], s54 offen offset:3072 lds
    s_mul_i32 s54, s56, 184
    s_add_u32 s54, s54, s47
    s_add_u32 m0, s53, 16384
    s_nop 0
    buffer_load_dwordx4 v2, s[20:23], s54 offen lds
    s_add_u32 m0, m0, 1024
    s_add_u32 s54, s54, s56
    buffer_load_dwordx4 v2, s[20:23], s54 offen lds
    s_add_u32 m0, m0, 1024
    s_add_u32 s54, s54, s56
    buffer_load_dwordx4 v2, s[20:23], s54 offen lds
    s_add_u32 m0, m0, 1024
    s_add_u32 s54, s54, s56
    buffer_load_dwordx4 v2, s[20:23], s54 offen lds
    s_add_u32 m0, m0, 1024
    s_add_u32 s54, s54, s56
    buffer_load_dwordx4 v2, s[20:23], s54 offen lds
    s_add_u32 m0, m0, 1024
    s_add_u32 s54, s54, s56
    buffer_load_dwordx4 v2, s[20:23], s54 offen lds
    s_add_u32 m0, m0, 1024
    s_add_u32 s54, s54, s56
    buffer_load_dwordx4 v2, s[20:23], s54 offen lds
    s_add_u32 m0, m0, 1024
    s_add_u32 s54, s54, s56
    buffer_load_dwordx4 v2, s[20:23], s54 offen lds
    s_waitcnt vmcnt(32)
    s_barrier
    s_add_u32 m0, s53, 32768
    s_add_u32 s54, s46, 393216
    buffer_load_dwordx4 v13, s[12:15], s54 offen offset:0 lds
    buffer_load_dwordx4 v13, s[12:15], s54 offen offset:1024 lds
    buffer_load_dwordx4 v13, s[12:15], s54 offen offset:2048 lds
    buffer_load_dwordx4 v13, s[12:15], s54 offen offset:3072 lds
    s_add_u32 m0, s53, 36864
    s_add_u32 s54, s46, 397312
    buffer_load_dwordx4 v13, s[12:15], s54 offen offset:0 lds
    buffer_load_dwordx4 v13, s[12:15], s54 offen offset:1024 lds
    buffer_load_dwordx4 v13, s[12:15], s54 offen offset:2048 lds
    buffer_load_dwordx4 v13, s[12:15], s54 offen offset:3072 lds
    s_mul_i32 s54, s56, 192
    s_add_u32 s54, s54, s47
    s_add_u32 m0, s53, 49152
    s_nop 0
    buffer_load_dwordx4 v2, s[20:23], s54 offen lds
    s_add_u32 m0, m0, 1024
    s_add_u32 s54, s54, s56
    buffer_load_dwordx4 v2, s[20:23], s54 offen lds
    s_add_u32 m0, m0, 1024
    s_add_u32 s54, s54, s56
    buffer_load_dwordx4 v2, s[20:23], s54 offen lds
    s_add_u32 m0, m0, 1024
    s_add_u32 s54, s54, s56
    buffer_load_dwordx4 v2, s[20:23], s54 offen lds
    s_add_u32 m0, m0, 1024
    s_add_u32 s54, s54, s56
    buffer_load_dwordx4 v2, s[20:23], s54 offen lds
    s_add_u32 m0, m0, 1024
    s_add_u32 s54, s54, s56
    buffer_load_dwordx4 v2, s[20:23], s54 offen lds
    s_add_u32 m0, m0, 1024
    s_add_u32 s54, s54, s56
    buffer_load_dwordx4 v2, s[20:23], s54 offen lds
    s_add_u32 m0, m0, 1024
    s_add_u32 s54, s54, s56
    buffer_load_dwordx4 v2, s[20:23], s54 offen lds
    s_waitcnt vmcnt(32)
    s_barrier
    s_add_u32 m0, s53, 65536
    s_add_u32 s54, s46, 425984
    buffer_load_dwordx4 v13, s[12:15], s54 offen offset:0 lds
    buffer_load_dwordx4 v13, s[12:15], s54 offen offset:1024 lds
    buffer_load_dwordx4 v13, s[12:15], s54 offen offset:2048 lds
    buffer_load_dwordx4 v13, s[12:15], s54 offen offset:3072 lds
    s_add_u32 m0, s53, 69632
    s_add_u32 s54, s46, 430080
    buffer_load_dwordx4 v13, s[12:15], s54 offen offset:0 lds
    buffer_load_dwordx4 v13, s[12:15], s54 offen offset:1024 lds
    buffer_load_dwordx4 v13, s[12:15], s54 offen offset:2048 lds
    buffer_load_dwordx4 v13, s[12:15], s54 offen offset:3072 lds
    s_mul_i32 s54, s56, 208
    s_add_u32 s54, s54, s47
    s_add_u32 m0, s53, 81920
    s_nop 0
    buffer_load_dwordx4 v2, s[20:23], s54 offen lds
    s_add_u32 m0, m0, 1024
    s_add_u32 s54, s54, s56
    buffer_load_dwordx4 v2, s[20:23], s54 offen lds
    s_add_u32 m0, m0, 1024
    s_add_u32 s54, s54, s56
    buffer_load_dwordx4 v2, s[20:23], s54 offen lds
    s_add_u32 m0, m0, 1024
    s_add_u32 s54, s54, s56
    buffer_load_dwordx4 v2, s[20:23], s54 offen lds
    s_add_u32 m0, m0, 1024
    s_add_u32 s54, s54, s56
    buffer_load_dwordx4 v2, s[20:23], s54 offen lds
    s_add_u32 m0, m0, 1024
    s_add_u32 s54, s54, s56
    buffer_load_dwordx4 v2, s[20:23], s54 offen lds
    s_add_u32 m0, m0, 1024
    s_add_u32 s54, s54, s56
    buffer_load_dwordx4 v2, s[20:23], s54 offen lds
    s_add_u32 m0, m0, 1024
    s_add_u32 s54, s54, s56
    buffer_load_dwordx4 v2, s[20:23], s54 offen lds
    s_waitcnt vmcnt(32)
    s_barrier
    s_add_u32 m0, s53, 98304
    s_add_u32 s54, s46, 442368
    buffer_load_dwordx4 v13, s[12:15], s54 offen offset:0 lds
    buffer_load_dwordx4 v13, s[12:15], s54 offen offset:1024 lds
    buffer_load_dwordx4 v13, s[12:15], s54 offen offset:2048 lds
    buffer_load_dwordx4 v13, s[12:15], s54 offen offset:3072 lds
    s_add_u32 m0, s53, 102400
    s_add_u32 s54, s46, 446464
    buffer_load_dwordx4 v13, s[12:15], s54 offen offset:0 lds
    buffer_load_dwordx4 v13, s[12:15], s54 offen offset:1024 lds
    buffer_load_dwordx4 v13, s[12:15], s54 offen offset:2048 lds
    buffer_load_dwordx4 v13, s[12:15], s54 offen offset:3072 lds
    s_mul_i32 s54, s56, 216
    s_add_u32 s54, s54, s47
    s_add_u32 m0, s53, 114688
    s_nop 0
    buffer_load_dwordx4 v2, s[20:23], s54 offen lds
    s_add_u32 m0, m0, 1024
    s_add_u32 s54, s54, s56
    buffer_load_dwordx4 v2, s[20:23], s54 offen lds
    s_add_u32 m0, m0, 1024
    s_add_u32 s54, s54, s56
    buffer_load_dwordx4 v2, s[20:23], s54 offen lds
    s_add_u32 m0, m0, 1024
    s_add_u32 s54, s54, s56
    buffer_load_dwordx4 v2, s[20:23], s54 offen lds
    s_add_u32 m0, m0, 1024
    s_add_u32 s54, s54, s56
    buffer_load_dwordx4 v2, s[20:23], s54 offen lds
    s_add_u32 m0, m0, 1024
    s_add_u32 s54, s54, s56
    buffer_load_dwordx4 v2, s[20:23], s54 offen lds
    s_add_u32 m0, m0, 1024
    s_add_u32 s54, s54, s56
    buffer_load_dwordx4 v2, s[20:23], s54 offen lds
    s_add_u32 m0, m0, 1024
    s_add_u32 s54, s54, s56
    buffer_load_dwordx4 v2, s[20:23], s54 offen lds
    s_waitcnt vmcnt(32)
    s_barrier
    s_mov_b32 s34, 18432
    buffer_load_dwordx4 v[96:99], v13, s[16:19], s34 offen offset:0
    buffer_load_dwordx4 v[100:103], v13, s[16:19], s34 offen offset:1024
    buffer_load_dwordx4 v[104:107], v13, s[16:19], s34 offen offset:2048
    buffer_load_dwordx4 v[108:111], v13, s[16:19], s34 offen offset:3072
    s_mov_b32 s34, 22528
    buffer_load_dwordx4 v[112:115], v13, s[16:19], s34 offen offset:0
    buffer_load_dwordx4 v[116:119], v13, s[16:19], s34 offen offset:1024
    buffer_load_dwordx4 v[120:123], v13, s[16:19], s34 offen offset:2048
    buffer_load_dwordx4 v[124:127], v13, s[16:19], s34 offen offset:3072
    s_mov_b32 s34, 26624
    buffer_load_dwordx4 v[128:131], v13, s[16:19], s34 offen offset:0
    buffer_load_dwordx4 v[132:135], v13, s[16:19], s34 offen offset:1024
    buffer_load_dwordx4 v[136:139], v13, s[16:19], s34 offen offset:2048
    buffer_load_dwordx4 v[140:143], v13, s[16:19], s34 offen offset:3072
    s_mov_b32 s34, 30720
    buffer_load_dwordx4 v[144:147], v13, s[16:19], s34 offen offset:0
    buffer_load_dwordx4 v[148:151], v13, s[16:19], s34 offen offset:1024
    buffer_load_dwordx4 v[152:155], v13, s[16:19], s34 offen offset:2048
    buffer_load_dwordx4 v[156:159], v13, s[16:19], s34 offen offset:3072
    s_mov_b32 s34, 34816
    buffer_load_dwordx4 v[160:163], v13, s[16:19], s34 offen offset:0
    buffer_load_dwordx4 v[164:167], v13, s[16:19], s34 offen offset:1024
    s_waitcnt vmcnt(34)
    s_barrier
    s_waitcnt vmcnt(18)
    s_barrier
    s_branch gated__T
gated__XC:
    s_mov_b32 s51, 0
    s_mov_b32 s62, 0
    s_mov_b32 s61, 0
    v_lshrrev_b32 v59, 3, v0
    v_lshlrev_b32 v59, 7, v59
    v_and_b32 v58, 7, v0
    v_lshl_add_u32 v59, v58, 2, v59
    s_mov_b32 s55, 42041408
    v_mov_b32 v60, 0
    s_mov_b32 s45, 0
    s_barrier
    s_barrier
    s_barrier
    s_barrier
    s_waitcnt vmcnt(0)
    s_cmp_lg_u32 s44, 0
    s_cbranch_scc1 gated_mix__spectral_gfnet__dense_activation_gelu__prompt_kernel_za17
    s_getreg_b32 s34, hwreg(HW_REG_IB_STS, 0, 4)
    s_getreg_b32 s35, hwreg(HW_REG_IB_STS, 22, 2)
    s_lshl_b32 s35, s35, 4
    s_or_b32 s34, s34, s35
    s_cmp_gt_u32 s34, 0
    s_cbranch_scc1 gated_mix__spectral_gfnet__dense_activation_gelu__prompt_kernel_za17
    s_mov_b64 exec, 1
    ds_add_u32 v11, v12 offset:52
    s_mov_b64 exec, -1
    s_mov_b32 s44, 1
gated_mix__spectral_gfnet__dense_activation_gelu__prompt_kernel_za17:
    s_waitcnt lgkmcnt(0)
    s_barrier
    s_or_b32 s34, s57, s62
    s_cmp_lg_u32 s34, 0
    s_cbranch_scc1 gated_mix__spectral_gfnet__dense_activation_gelu__prompt_kernel_fz18
    ds_read_b32 v58, v11 offset:52
    s_waitcnt lgkmcnt(0)
    v_readfirstlane_b32 s34, v58
    s_cmp_lt_u32 s34, 4
    s_cbranch_scc1 gated_mix__spectral_gfnet__dense_activation_gelu__prompt_kernel_fz18
    s_and_b32 s34, s2, 7
    s_lshl_b32 s34, s34, 7
    s_lshr_b32 s35, s2, 3
    s_add_u32 s34, s34, s35
    s_add_u32 s34, s34, 42041408
    s_mov_b64 exec, 1
    buffer_store_byte v12, v1, s[12:15], s34 offen sc1
    s_mov_b64 exec, -1
    s_mov_b32 s62, 1
gated_mix__spectral_gfnet__dense_activation_gelu__prompt_kernel_fz18:
    s_barrier
    s_barrier
    s_barrier
    s_barrier
    s_barrier
    s_barrier
    s_barrier
    s_barrier
    s_barrier
    s_barrier
    s_barrier
    s_barrier
    s_barrier
    s_barrier
    s_barrier
    s_barrier
    s_barrier
    s_cmp_lg_u32 s57, 0
    s_cbranch_scc1 gated_mix__spectral_gfnet__dense_activation_gelu__prompt_kernel_zp19
    buffer_load_dword v60, v59, s[12:15], s55 offen sc1
gated_mix__spectral_gfnet__dense_activation_gelu__prompt_kernel_zp19:
    s_barrier
    s_barrier
    s_or_b32 s34, s57, s61
    s_cmp_lg_u32 s34, 0
    s_cbranch_scc1 gated_mix__spectral_gfnet__dense_activation_gelu__prompt_kernel_zt20
    s_mov_b32 s36, 16843009
    v_and_b32 v58, s36, v60
    v_cmp_ne_u32 vcc, s36, v58
    s_cmp_eq_u64 vcc, 0
    s_cbranch_scc0 gated_mix__spectral_gfnet__dense_activation_gelu__prompt_kernel_zt20
    ds_write_b32 v11, v12 offset:40
    s_mov_b32 s61, 1
gated_mix__spectral_gfnet__dense_activation_gelu__prompt_kernel_zt20:
    s_barrier
    s_or_b32 s34, s57, s61
    s_cmp_lg_u32 s34, 0
    s_cbranch_scc1 gated_mix__spectral_gfnet__dense_activation_gelu__prompt_kernel_zt21
    s_mov_b32 s36, 16843009
    v_and_b32 v58, s36, v60
    v_cmp_ne_u32 vcc, s36, v58
    s_cmp_eq_u64 vcc, 0
    s_cbranch_scc0 gated_mix__spectral_gfnet__dense_activation_gelu__prompt_kernel_zt21
    ds_write_b32 v11, v12 offset:40
    s_mov_b32 s61, 1
gated_mix__spectral_gfnet__dense_activation_gelu__prompt_kernel_zt21:
    s_waitcnt lgkmcnt(0)
    s_barrier
    ds_read_b32 v58, v11 offset:40
    s_waitcnt lgkmcnt(0)
    v_readfirstlane_b32 s45, v58
    s_cmp_eq_u32 s45, 0
    s_cbranch_scc1 gated_mix__spectral_gfnet__dense_activation_gelu__prompt_kernel_zi22
    v_lshrrev_b32 v7, 2, v0
    s_mov_b32 s34, 0
    v_xor_b32 v7, s34, v7
    v_lshlrev_b32 v7, 7, v7
    v_and_b32 v8, 3, v0
    v_lshl_add_u32 v7, v8, 4, v7
    s_lshr_b32 s34, s3, 1
    s_lshl_b32 s34, s34, 15
    s_and_b32 s35, s3, 1
    s_lshl_b32 s35, s35, 6
    s_add_u32 s34, s34, s35
    s_lshl_b32 s35, s57, 14
    s_add_u32 s34, s34, s35
    s_add_u32 s36, s34, 25165824
    s_lshr_b32 s35, s35, 1
    s_add_u32 m0, s35, 131072
    s_nop 0
    buffer_load_dwordx4 v7, s[12:15], s36 offen lds
    s_add_u32 m0, m0, 1024
    s_add_u32 s36, s36, 2048
    buffer_load_dwordx4 v7, s[12:15], s36 offen lds
    s_add_u32 m0, m0, 1024
    s_add_u32 s36, s36, 2048
    buffer_load_dwordx4 v7, s[12:15], s36 offen lds
    s_add_u32 m0, m0, 1024
    s_add_u32 s36, s36, 2048
    buffer_load_dwordx4 v7, s[12:15], s36 offen lds
    s_add_u32 m0, m0, 1024
    s_add_u32 s36, s36, 2048
    buffer_load_dwordx4 v7, s[12:15], s36 offen lds
    s_add_u32 m0, m0, 1024
    s_add_u32 s36, s36, 2048
    buffer_load_dwordx4 v7, s[12:15], s36 offen lds
    s_add_u32 m0, m0, 1024
    s_add_u32 s36, s36, 2048
    buffer_load_dwordx4 v7, s[12:15], s36 offen lds
    s_add_u32 m0, m0, 1024
    s_add_u32 s36, s36, 2048
    buffer_load_dwordx4 v7, s[12:15], s36 offen lds
    s_mov_b64 exec, 1
    ds_add_u32 v11, v12 offset:60
    s_mov_b64 exec, -1
gated_mix__spectral_gfnet__dense_activation_gelu__prompt_kernel_zi22:
    s_waitcnt lgkmcnt(0)
    s_barrier
    s_mov_b32 s34, 18432
    buffer_load_dwordx4 v[96:99], v13, s[16:19], s34 offen offset:0
    buffer_load_dwordx4 v[100:103], v13, s[16:19], s34 offen offset:1024
    buffer_load_dwordx4 v[104:107], v13, s[16:19], s34 offen offset:2048
    buffer_load_dwordx4 v[108:111], v13, s[16:19], s34 offen offset:3072
    s_mov_b32 s34, 22528
    buffer_load_dwordx4 v[112:115], v13, s[16:19], s34 offen offset:0
    buffer_load_dwordx4 v[116:119], v13, s[16:19], s34 offen offset:1024
    buffer_load_dwordx4 v[120:123], v13, s[16:19], s34 offen offset:2048
    buffer_load_dwordx4 v[124:127], v13, s[16:19], s34 offen offset:3072
    s_mov_b32 s34, 26624
    buffer_load_dwordx4 v[128:131], v13, s[16:19], s34 offen offset:0
    buffer_load_dwordx4 v[132:135], v13, s[16:19], s34 offen offset:1024
    buffer_load_dwordx4 v[136:139], v13, s[16:19], s34 offen offset:2048
    buffer_load_dwordx4 v[140:143], v13, s[16:19], s34 offen offset:3072
    s_mov_b32 s34, 30720
    buffer_load_dwordx4 v[144:147], v13, s[16:19], s34 offen offset:0
    buffer_load_dwordx4 v[148:151], v13, s[16:19], s34 offen offset:1024
    buffer_load_dwordx4 v[152:155], v13, s[16:19], s34 offen offset:2048
    buffer_load_dwordx4 v[156:159], v13, s[16:19], s34 offen offset:3072
    s_mov_b32 s34, 34816
    buffer_load_dwordx4 v[160:163], v13, s[16:19], s34 offen offset:0
    buffer_load_dwordx4 v[164:167], v13, s[16:19], s34 offen offset:1024
    s_waitcnt vmcnt(18)
    s_barrier
    s_or_b32 s34, s57, s61
    s_cmp_lg_u32 s34, 0
    s_cbranch_scc1 gated__T
    s_mov_b32 s35, 0
gated__zb:
    s_sleep 2
    buffer_load_dword v60, v59, s[12:15], s55 offen sc1
    s_add_u32 s35, s35, 1
    s_waitcnt vmcnt(0)
    s_cmp_gt_u32 s35, 400000
    s_cbranch_scc1 gated__zbd
    s_mov_b32 s36, 16843009
    v_and_b32 v58, s36, v60
    v_cmp_ne_u32 vcc, s36, v58
    s_cmp_eq_u64 vcc, 0
    s_cbranch_scc0 gated__zb
gated__zbd:
    ds_write_b32 v11, v12 offset:40
gated__T:
    s_mov_b32 s24, s82
    s_and_b32 s25, s83, 0xffff
    s_mov_b32 s26, 4194304
    s_mov_b32 s27, 0x00020000
    s_mov_b32 s40, s78
    s_and_b32 s41, s79, 0xffff
    s_mov_b32 s42, 2048
    s_mov_b32 s43, 0x00020000
    v_lshlrev_b32 v4, 6, v14
    v_lshl_add_u32 v4, v15, 4, v4
    buffer_load_dwordx4 v[168:171], v4, s[40:43], 0 offen
    buffer_load_dwordx4 v[172:175], v4, s[40:43], 0 offen offset:1024
    v_mov_b32 v11, 163712
    ds_read_b32 v58, v11 offset:60
    v_lshlrev_b32 v2, 10, v14
    v_lshl_add_u32 v2, v15, 7, v2
    v_bfe_u32 v3, v14, 2, 1
    v_lshl_add_u32 v2, v3, 6, v2
    v_and_b32 v3, 3, v14
    v_xor_b32 v3, s30, v3
    v_lshl_add_u32 v2, v3, 4, v2
    v_add_u32 v2, 131072, v2
    v_xor_b32 v3, 64, v2
    s_lshl_b32 s34, s30, 3
    v_add_u32 v9, s34, v11
    ds_read_b64 v[176:177], v9 offset:64
    s_waitcnt lgkmcnt(0)
    v_readfirstlane_b32 s34, v58
    s_cmp_eq_u32 s34, 2
    s_cbranch_scc1 gated__zok
gated__tw:
    ds_read_b32 v58, v11 offset:40
    s_waitcnt lgkmcnt(0)
    v_readfirstlane_b32 s34, v58
    s_cmp_eq_u32 s34, 0
    s_cbranch_scc1 gated__tw
    v_lshrrev_b32 v7, 2, v0
    s_mov_b32 s34, 0
    v_xor_b32 v7, s34, v7
    v_lshlrev_b32 v7, 7, v7
    v_and_b32 v8, 3, v0
    v_lshl_add_u32 v7, v8, 4, v7
    s_lshr_b32 s34, s3, 1
    s_lshl_b32 s34, s34, 15
    s_and_b32 s35, s3, 1
    s_lshl_b32 s35, s35, 6
    s_add_u32 s34, s34, s35
    s_lshl_b32 s35, s30, 13
    s_add_u32 s34, s34, s35
    s_add_u32 s36, s34, 25165824
    s_lshr_b32 s35, s35, 1
    s_add_u32 m0, s35, 131072
    s_nop 0
    buffer_load_dwordx4 v7, s[12:15], s36 offen lds
    s_add_u32 m0, m0, 1024
    s_add_u32 s36, s36, 2048
    buffer_load_dwordx4 v7, s[12:15], s36 offen lds
    s_add_u32 m0, m0, 1024
    s_add_u32 s36, s36, 2048
    buffer_load_dwordx4 v7, s[12:15], s36 offen lds
    s_add_u32 m0, m0, 1024
    s_add_u32 s36, s36, 2048
    buffer_load_dwordx4 v7, s[12:15], s36 offen lds
    s_waitcnt vmcnt(0)
    s_waitcnt lgkmcnt(0)
    v_mov_b32 v11, 163736
    v_mov_b32 v12, 1
    s_mov_b64 exec, 1
    ds_add_u32 v11, v12
    s_mov_b64 exec, -1
gated__ls2:
    ds_read_b32 v12, v11
    s_waitcnt lgkmcnt(0)
    v_readfirstlane_b32 s34, v12
    s_cmp_ge_u32 s34, 4
    s_cbranch_scc1 gated__ls2d
    s_sleep 1
    s_branch gated__ls2
gated__ls2d:
gated__zok:
    s_waitcnt vmcnt(2)
    ds_read_b64 v[16:17], v2 offset:0
    ds_read_b64 v[18:19], v3 offset:0
    ds_read_b64 v[20:21], v2 offset:512
    ds_read_b64 v[22:23], v3 offset:512
    ds_read_b64 v[56:57], v2 offset:8
    ds_read_b64 v[58:59], v3 offset:8
    ds_read_b64 v[60:61], v2 offset:520
    ds_read_b64 v[62:63], v3 offset:520
    s_mov_b32 s34, 0
    s_lshl_b32 s34, s34, 7
    v_xor_b32 v5, s34, v4
    v_xor_b32 v6, 1024, v5
    s_waitcnt lgkmcnt(4)
    v_mfma_f32_16x16x32_bf16 v[24:27], v[16:19], v[96:99], 0
    v_mfma_f32_16x16x32_bf16 v[28:31], v[16:19], v[112:115], 0
    v_mfma_f32_16x16x32_bf16 v[32:35], v[16:19], v[104:107], 0
    v_mfma_f32_16x16x32_bf16 v[36:39], v[16:19], v[120:123], 0
    v_mfma_f32_16x16x32_bf16 v[40:43], v[16:19], v[128:131], 0
    v_mfma_f32_16x16x32_bf16 v[44:47], v[20:23], v[136:139], 0
    v_mfma_f32_16x16x32_bf16 v[48:51], v[16:19], v[132:135], 0
    v_mfma_f32_16x16x32_bf16 v[52:55], v[20:23], v[140:143], 0
    v_mfma_f32_16x16x32_bf16 v[24:27], v[20:23], v[100:103], v[24:27]
    v_mfma_f32_16x16x32_bf16 v[28:31], v[20:23], v[116:119], v[28:31]
    v_mfma_f32_16x16x32_bf16 v[32:35], v[20:23], v[108:111], v[32:35]
    v_mfma_f32_16x16x32_bf16 v[36:39], v[20:23], v[124:127], v[36:39]
    s_waitcnt lgkmcnt(0)
    v_mfma_f32_16x16x32_bf16 v[64:67], v[56:59], v[96:99], 0
    v_mfma_f32_16x16x32_bf16 v[68:71], v[56:59], v[112:115], 0
    v_mfma_f32_16x16x32_bf16 v[72:75], v[56:59], v[104:107], 0
    v_mfma_f32_16x16x32_bf16 v[76:79], v[56:59], v[120:123], 0
    v_mfma_f32_16x16x32_bf16 v[80:83], v[56:59], v[128:131], 0
    v_mfma_f32_16x16x32_bf16 v[84:87], v[60:63], v[136:139], 0
    v_mfma_f32_16x16x32_bf16 v[88:91], v[56:59], v[132:135], 0
    v_mfma_f32_16x16x32_bf16 v[92:95], v[60:63], v[140:143], 0
    v_mfma_f32_16x16x32_bf16 v[64:67], v[60:63], v[100:103], v[64:67]
    v_mfma_f32_16x16x32_bf16 v[68:71], v[60:63], v[116:119], v[68:71]
    v_mfma_f32_16x16x32_bf16 v[72:75], v[60:63], v[108:111], v[72:75]
    v_mfma_f32_16x16x32_bf16 v[76:79], v[60:63], v[124:127], v[76:79]
    s_waitcnt vmcnt(0)
    v_lshlrev_b32 v224, 16, v168
    v_and_b32 v225, 0xffff0000, v168
    v_lshlrev_b32 v226, 16, v169
    v_and_b32 v227, 0xffff0000, v169
    v_lshlrev_b32 v228, 16, v170
    v_and_b32 v229, 0xffff0000, v170
    v_lshlrev_b32 v230, 16, v171
    v_and_b32 v231, 0xffff0000, v171
    v_lshlrev_b32 v232, 16, v172
    v_and_b32 v233, 0xffff0000, v172
    v_lshlrev_b32 v234, 16, v173
    v_and_b32 v235, 0xffff0000, v173
    v_lshlrev_b32 v236, 16, v174
    v_and_b32 v237, 0xffff0000, v174
    v_lshlrev_b32 v238, 16, v175
    v_and_b32 v239, 0xffff0000, v175
    v_sub_f32 v178, 1.0, v176
    v_cvt_pk_bf16_f32 v178, v178, v178
    v_and_b32 v178, 0xffff0000, v178
    v_sub_f32 v179, 1.0, v177
    v_cvt_pk_bf16_f32 v179, v179, v179
    v_and_b32 v179, 0xffff0000, v179
    s_mov_b64 exec, 0xffff
    v_mov_b32 v24, v40
    v_mov_b32 v28, v44
    v_mov_b32 v32, v48
    v_mov_b32 v36, v52
    s_mov_b64 exec, -1
    v_pk_mul_f32 v[40:41], v[24:25], v[144:145]
    v_pk_mul_f32 v[48:49], v[24:25], v[148:149]
    v_pk_mul_f32 v[42:43], v[26:27], v[146:147]
    v_pk_mul_f32 v[50:51], v[26:27], v[150:151]
    v_pk_fma_f32 v[40:41], v[28:29], v[148:149], v[40:41] neg_lo:[1,0,0] neg_hi:[1,0,0]
    v_pk_fma_f32 v[48:49], v[28:29], v[144:145], v[48:49]
    v_pk_fma_f32 v[42:43], v[30:31], v[150:151], v[42:43] neg_lo:[1,0,0] neg_hi:[1,0,0]
    v_pk_fma_f32 v[50:51], v[30:31], v[146:147], v[50:51]
    v_pk_mul_f32 v[44:45], v[32:33], v[152:153]
    v_pk_mul_f32 v[52:53], v[32:33], v[156:157]
    v_pk_mul_f32 v[46:47], v[34:35], v[154:155]
    v_pk_mul_f32 v[54:55], v[34:35], v[158:159]
    v_pk_fma_f32 v[44:45], v[36:37], v[156:157], v[44:45] neg_lo:[1,0,0] neg_hi:[1,0,0]
    v_pk_fma_f32 v[52:53], v[36:37], v[152:153], v[52:53]
    v_pk_fma_f32 v[46:47], v[38:39], v[158:159], v[46:47] neg_lo:[1,0,0] neg_hi:[1,0,0]
    v_pk_fma_f32 v[54:55], v[38:39], v[154:155], v[54:55]
    v_cvt_pk_bf16_f32 v16, v40, v48
    v_cvt_pk_bf16_f32 v17, v41, v49
    v_cvt_pk_bf16_f32 v18, v42, v50
    v_cvt_pk_bf16_f32 v19, v43, v51
    v_cvt_pk_bf16_f32 v20, v44, v52
    v_cvt_pk_bf16_f32 v21, v45, v53
    v_cvt_pk_bf16_f32 v22, v46, v54
    v_cvt_pk_bf16_f32 v23, v47, v55
    v_mfma_f32_16x16x32_bf16 v[24:27], v[16:19], v[160:163], 0
    s_nop 0
    v_mfma_f32_16x16x32_bf16 v[28:31], v[20:23], v[160:163], 0
    v_mfma_f32_16x16x32_bf16 v[32:35], v[16:19], v[164:167], 0
    v_mfma_f32_16x16x32_bf16 v[36:39], v[20:23], v[164:167], 0
    s_mov_b64 exec, 0xffff
    v_mov_b32 v64, v80
    v_mov_b32 v68, v84
    v_mov_b32 v72, v88
    v_mov_b32 v76, v92
    s_mov_b64 exec, -1
    v_pk_mul_f32 v[80:81], v[64:65], v[144:145]
    v_pk_mul_f32 v[88:89], v[64:65], v[148:149]
    v_pk_mul_f32 v[82:83], v[66:67], v[146:147]
    v_pk_mul_f32 v[90:91], v[66:67], v[150:151]
    v_pk_fma_f32 v[80:81], v[68:69], v[148:149], v[80:81] neg_lo:[1,0,0] neg_hi:[1,0,0]
    v_pk_fma_f32 v[88:89], v[68:69], v[144:145], v[88:89]
    v_pk_fma_f32 v[82:83], v[70:71], v[150:151], v[82:83] neg_lo:[1,0,0] neg_hi:[1,0,0]
    v_pk_fma_f32 v[90:91], v[70:71], v[146:147], v[90:91]
    v_pk_mul_f32 v[84:85], v[72:73], v[152:153]
    v_pk_mul_f32 v[92:93], v[72:73], v[156:157]
    v_pk_mul_f32 v[86:87], v[74:75], v[154:155]
    v_pk_mul_f32 v[94:95], v[74:75], v[158:159]
    v_pk_fma_f32 v[84:85], v[76:77], v[156:157], v[84:85] neg_lo:[1,0,0] neg_hi:[1,0,0]
    v_pk_fma_f32 v[92:93], v[76:77], v[152:153], v[92:93]
    v_pk_fma_f32 v[86:87], v[78:79], v[158:159], v[86:87] neg_lo:[1,0,0] neg_hi:[1,0,0]
    v_pk_fma_f32 v[94:95], v[78:79], v[154:155], v[94:95]
    v_cvt_pk_bf16_f32 v56, v80, v88
    v_cvt_pk_bf16_f32 v57, v81, v89
    v_cvt_pk_bf16_f32 v58, v82, v90
    v_cvt_pk_bf16_f32 v59, v83, v91
    v_cvt_pk_bf16_f32 v60, v84, v92
    v_cvt_pk_bf16_f32 v61, v85, v93
    v_cvt_pk_bf16_f32 v62, v86, v94
    v_cvt_pk_bf16_f32 v63, v87, v95
    v_mfma_f32_16x16x32_bf16 v[64:67], v[56:59], v[160:163], 0
    s_nop 0
    v_mfma_f32_16x16x32_bf16 v[68:71], v[60:63], v[160:163], 0
    v_mfma_f32_16x16x32_bf16 v[72:75], v[56:59], v[164:167], 0
    v_mfma_f32_16x16x32_bf16 v[76:79], v[60:63], v[164:167], 0
    v_and_b32 v59, 31, v0
    v_lshlrev_b32 v59, 7, v59
    s_and_b32 s55, s3, 7
    s_lshl_b32 s55, s55, 12
    s_add_u32 s55, s55, 42008640
    v_mov_b32 v60, 0
    v_cvt_pk_bf16_f32 v40, v24, v25
    v_cvt_pk_bf16_f32 v41, v26, v27
    v_cvt_pk_bf16_f32 v42, v28, v29
    v_cvt_pk_bf16_f32 v43, v30, v31
    v_cvt_pk_bf16_f32 v44, v32, v33
    v_cvt_pk_bf16_f32 v45, v34, v35
    v_cvt_pk_bf16_f32 v46, v36, v37
    v_cvt_pk_bf16_f32 v47, v38, v39
    v_lshlrev_b32 v24, 16, v40
    v_and_b32 v25, 0xffff0000, v40
    v_lshlrev_b32 v26, 16, v41
    v_and_b32 v27, 0xffff0000, v41
    v_lshlrev_b32 v28, 16, v42
    v_and_b32 v29, 0xffff0000, v42
    v_lshlrev_b32 v30, 16, v43
    v_and_b32 v31, 0xffff0000, v43
    v_lshlrev_b32 v32, 16, v44
    v_and_b32 v33, 0xffff0000, v44
    v_lshlrev_b32 v34, 16, v45
    v_and_b32 v35, 0xffff0000, v45
    v_lshlrev_b32 v36, 16, v46
    v_and_b32 v37, 0xffff0000, v46
    v_lshlrev_b32 v38, 16, v47
    v_and_b32 v39, 0xffff0000, v47
    v_pk_mul_f32 v[24:25], v[24:25], v[176:177] op_sel:[0,0] op_sel_hi:[1,0]
    v_pk_mul_f32 v[26:27], v[26:27], v[176:177] op_sel:[0,0] op_sel_hi:[1,0]
    v_pk_mul_f32 v[28:29], v[28:29], v[176:177] op_sel:[0,0] op_sel_hi:[1,0]
    v_pk_mul_f32 v[30:31], v[30:31], v[176:177] op_sel:[0,0] op_sel_hi:[1,0]
    v_pk_mul_f32 v[32:33], v[32:33], v[176:177] op_sel:[0,0] op_sel_hi:[1,0]
    v_pk_mul_f32 v[34:35], v[34:35], v[176:177] op_sel:[0,0] op_sel_hi:[1,0]
    v_pk_mul_f32 v[36:37], v[36:37], v[176:177] op_sel:[0,0] op_sel_hi:[1,0]
    v_pk_mul_f32 v[38:39], v[38:39], v[176:177] op_sel:[0,0] op_sel_hi:[1,0]
    v_pk_fma_f32 v[24:25], v[224:225], v[178:179], v[24:25] op_sel:[0,0,0] op_sel_hi:[1,0,1]
    v_pk_fma_f32 v[26:27], v[226:227], v[178:179], v[26:27] op_sel:[0,0,0] op_sel_hi:[1,0,1]
    v_pk_fma_f32 v[28:29], v[228:229], v[178:179], v[28:29] op_sel:[0,0,0] op_sel_hi:[1,0,1]
    v_pk_fma_f32 v[30:31], v[230:231], v[178:179], v[30:31] op_sel:[0,0,0] op_sel_hi:[1,0,1]
    v_pk_fma_f32 v[32:33], v[232:233], v[178:179], v[32:33] op_sel:[0,0,0] op_sel_hi:[1,0,1]
    v_pk_fma_f32 v[34:35], v[234:235], v[178:179], v[34:35] op_sel:[0,0,0] op_sel_hi:[1,0,1]
    v_pk_fma_f32 v[36:37], v[236:237], v[178:179], v[36:37] op_sel:[0,0,0] op_sel_hi:[1,0,1]
    v_pk_fma_f32 v[38:39], v[238:239], v[178:179], v[38:39] op_sel:[0,0,0] op_sel_hi:[1,0,1]
    v_cvt_pk_bf16_f32 v80, v64, v65
    v_cvt_pk_bf16_f32 v81, v66, v67
    v_cvt_pk_bf16_f32 v82, v68, v69
    v_cvt_pk_bf16_f32 v83, v70, v71
    v_cvt_pk_bf16_f32 v84, v72, v73
    v_cvt_pk_bf16_f32 v85, v74, v75
    v_cvt_pk_bf16_f32 v86, v76, v77
    v_cvt_pk_bf16_f32 v87, v78, v79
    v_lshlrev_b32 v64, 16, v80
    v_and_b32 v65, 0xffff0000, v80
    v_lshlrev_b32 v66, 16, v81
    v_and_b32 v67, 0xffff0000, v81
    v_lshlrev_b32 v68, 16, v82
    v_and_b32 v69, 0xffff0000, v82
    v_lshlrev_b32 v70, 16, v83
    v_and_b32 v71, 0xffff0000, v83
    v_lshlrev_b32 v72, 16, v84
    v_and_b32 v73, 0xffff0000, v84
    v_lshlrev_b32 v74, 16, v85
    v_and_b32 v75, 0xffff0000, v85
    v_lshlrev_b32 v76, 16, v86
    v_and_b32 v77, 0xffff0000, v86
    v_lshlrev_b32 v78, 16, v87
    v_and_b32 v79, 0xffff0000, v87
    v_pk_mul_f32 v[64:65], v[64:65], v[176:177] op_sel:[0,1] op_sel_hi:[1,1]
    v_pk_mul_f32 v[66:67], v[66:67], v[176:177] op_sel:[0,1] op_sel_hi:[1,1]
    v_pk_mul_f32 v[68:69], v[68:69], v[176:177] op_sel:[0,1] op_sel_hi:[1,1]
    v_pk_mul_f32 v[70:71], v[70:71], v[176:177] op_sel:[0,1] op_sel_hi:[1,1]
    v_pk_mul_f32 v[72:73], v[72:73], v[176:177] op_sel:[0,1] op_sel_hi:[1,1]
    v_pk_mul_f32 v[74:75], v[74:75], v[176:177] op_sel:[0,1] op_sel_hi:[1,1]
    v_pk_mul_f32 v[76:77], v[76:77], v[176:177] op_sel:[0,1] op_sel_hi:[1,1]
    v_pk_mul_f32 v[78:79], v[78:79], v[176:177] op_sel:[0,1] op_sel_hi:[1,1]
    v_pk_fma_f32 v[64:65], v[224:225], v[178:179], v[64:65] op_sel:[0,1,0] op_sel_hi:[1,1,1]
    v_pk_fma_f32 v[66:67], v[226:227], v[178:179], v[66:67] op_sel:[0,1,0] op_sel_hi:[1,1,1]
    v_pk_fma_f32 v[68:69], v[228:229], v[178:179], v[68:69] op_sel:[0,1,0] op_sel_hi:[1,1,1]
    v_pk_fma_f32 v[70:71], v[230:231], v[178:179], v[70:71] op_sel:[0,1,0] op_sel_hi:[1,1,1]
    v_pk_fma_f32 v[72:73], v[232:233], v[178:179], v[72:73] op_sel:[0,1,0] op_sel_hi:[1,1,1]
    v_pk_fma_f32 v[74:75], v[234:235], v[178:179], v[74:75] op_sel:[0,1,0] op_sel_hi:[1,1,1]
    v_pk_fma_f32 v[76:77], v[236:237], v[178:179], v[76:77] op_sel:[0,1,0] op_sel_hi:[1,1,1]
    v_pk_fma_f32 v[78:79], v[238:239], v[178:179], v[78:79] op_sel:[0,1,0] op_sel_hi:[1,1,1]
    v_mov_b32 v11, 163712
    v_mov_b32 v12, 1
    s_cmp_lg_u32 s30, 0
    s_cbranch_scc1 gated__xw
    s_mov_b32 s35, 0
gated__xp:
    buffer_load_dword v60, v59, s[12:15], s55 offen sc1
    s_add_u32 s35, s35, 1
    s_waitcnt vmcnt(0)
    s_cmp_gt_u32 s35, 400000
    s_cbranch_scc1 gated__xpd
    v_cmp_gt_u32 vcc, 1, v60
    s_cmp_eq_u64 vcc, 0
    s_cbranch_scc0 gated__xp
gated__xpd:
    ds_write_b32 v11, v12 offset:36
    s_branch gated__xwd
gated__xw:
    s_sleep 1
    ds_read_b32 v58, v11 offset:36
    s_waitcnt lgkmcnt(0)
    v_readfirstlane_b32 s34, v58
    s_cmp_eq_u32 s34, 0
    s_cbranch_scc1 gated__xw
gated__xwd:
    s_add_u32 s34, s50, 33554432
    s_nop 1
    buffer_load_dwordx4 v[192:195], v5, s[12:15], s34 offen sc1
    buffer_load_dwordx4 v[196:199], v6, s[12:15], s34 offen sc1
    s_add_u32 s34, s50, 33619968
    buffer_load_dwordx4 v[200:203], v5, s[12:15], s34 offen sc1
    buffer_load_dwordx4 v[204:207], v6, s[12:15], s34 offen sc1
    s_add_u32 s34, s50, 37748736
    buffer_load_dwordx4 v[208:211], v5, s[12:15], s34 offen sc1
    buffer_load_dwordx4 v[212:215], v6, s[12:15], s34 offen sc1
    s_add_u32 s34, s50, 37814272
    buffer_load_dwordx4 v[216:219], v5, s[12:15], s34 offen sc1
    buffer_load_dwordx4 v[220:223], v6, s[12:15], s34 offen sc1
    s_waitcnt vmcnt(0)
    v_lshlrev_b32 v96, 16, v192
    v_and_b32 v97, 0xffff0000, v192
    v_lshlrev_b32 v112, 16, v208
    v_and_b32 v113, 0xffff0000, v208
    v_lshlrev_b32 v98, 16, v193
    v_and_b32 v99, 0xffff0000, v193
    v_lshlrev_b32 v114, 16, v209
    v_and_b32 v115, 0xffff0000, v209
    v_lshlrev_b32 v100, 16, v194
    v_and_b32 v101, 0xffff0000, v194
    v_lshlrev_b32 v116, 16, v210
    v_and_b32 v117, 0xffff0000, v210
    v_lshlrev_b32 v102, 16, v195
    v_and_b32 v103, 0xffff0000, v195
    v_lshlrev_b32 v118, 16, v211
    v_and_b32 v119, 0xffff0000, v211
    v_lshlrev_b32 v104, 16, v196
    v_and_b32 v105, 0xffff0000, v196
    v_lshlrev_b32 v120, 16, v212
    v_and_b32 v121, 0xffff0000, v212
    v_lshlrev_b32 v106, 16, v197
    v_and_b32 v107, 0xffff0000, v197
    v_lshlrev_b32 v122, 16, v213
    v_and_b32 v123, 0xffff0000, v213
    v_lshlrev_b32 v108, 16, v198
    v_and_b32 v109, 0xffff0000, v198
    v_lshlrev_b32 v124, 16, v214
    v_and_b32 v125, 0xffff0000, v214
    v_lshlrev_b32 v110, 16, v199
    v_and_b32 v111, 0xffff0000, v199
    v_lshlrev_b32 v126, 16, v215
    v_and_b32 v127, 0xffff0000, v215
    v_pk_add_f32 v[96:97], v[96:97], v[112:113]
    v_pk_add_f32 v[98:99], v[98:99], v[114:115]
    v_pk_add_f32 v[100:101], v[100:101], v[116:117]
    v_pk_add_f32 v[102:103], v[102:103], v[118:119]
    v_pk_add_f32 v[104:105], v[104:105], v[120:121]
    v_pk_add_f32 v[106:107], v[106:107], v[122:123]
    v_pk_add_f32 v[108:109], v[108:109], v[124:125]
    v_pk_add_f32 v[110:111], v[110:111], v[126:127]
    v_pk_fma_f32 v[24:25], v[96:97], v[178:179], v[24:25] op_sel:[0,0,0] op_sel_hi:[1,0,1]
    v_pk_fma_f32 v[26:27], v[98:99], v[178:179], v[26:27] op_sel:[0,0,0] op_sel_hi:[1,0,1]
    v_pk_fma_f32 v[28:29], v[100:101], v[178:179], v[28:29] op_sel:[0,0,0] op_sel_hi:[1,0,1]
    v_pk_fma_f32 v[30:31], v[102:103], v[178:179], v[30:31] op_sel:[0,0,0] op_sel_hi:[1,0,1]
    v_pk_fma_f32 v[32:33], v[104:105], v[178:179], v[32:33] op_sel:[0,0,0] op_sel_hi:[1,0,1]
    v_pk_fma_f32 v[34:35], v[106:107], v[178:179], v[34:35] op_sel:[0,0,0] op_sel_hi:[1,0,1]
    v_pk_fma_f32 v[36:37], v[108:109], v[178:179], v[36:37] op_sel:[0,0,0] op_sel_hi:[1,0,1]
    v_pk_fma_f32 v[38:39], v[110:111], v[178:179], v[38:39] op_sel:[0,0,0] op_sel_hi:[1,0,1]
    v_cvt_pk_bf16_f32 v192, v24, v25
    v_cvt_pk_bf16_f32 v193, v26, v27
    v_cvt_pk_bf16_f32 v194, v28, v29
    v_cvt_pk_bf16_f32 v195, v30, v31
    v_cvt_pk_bf16_f32 v196, v32, v33
    v_cvt_pk_bf16_f32 v197, v34, v35
    v_cvt_pk_bf16_f32 v198, v36, v37
    v_cvt_pk_bf16_f32 v199, v38, v39
    s_add_u32 s34, s50, 0
    buffer_store_dwordx4 v[192:195], v4, s[24:27], s34 offen offset:0
    buffer_store_dwordx4 v[196:199], v4, s[24:27], s34 offen offset:1024
    v_lshlrev_b32 v128, 16, v200
    v_and_b32 v129, 0xffff0000, v200
    v_lshlrev_b32 v144, 16, v216
    v_and_b32 v145, 0xffff0000, v216
    v_lshlrev_b32 v130, 16, v201
    v_and_b32 v131, 0xffff0000, v201
    v_lshlrev_b32 v146, 16, v217
    v_and_b32 v147, 0xffff0000, v217
    v_lshlrev_b32 v132, 16, v202
    v_and_b32 v133, 0xffff0000, v202
    v_lshlrev_b32 v148, 16, v218
    v_and_b32 v149, 0xffff0000, v218
    v_lshlrev_b32 v134, 16, v203
    v_and_b32 v135, 0xffff0000, v203
    v_lshlrev_b32 v150, 16, v219
    v_and_b32 v151, 0xffff0000, v219
    v_lshlrev_b32 v136, 16, v204
    v_and_b32 v137, 0xffff0000, v204
    v_lshlrev_b32 v152, 16, v220
    v_and_b32 v153, 0xffff0000, v220
    v_lshlrev_b32 v138, 16, v205
    v_and_b32 v139, 0xffff0000, v205
    v_lshlrev_b32 v154, 16, v221
    v_and_b32 v155, 0xffff0000, v221
    v_lshlrev_b32 v140, 16, v206
    v_and_b32 v141, 0xffff0000, v206
    v_lshlrev_b32 v156, 16, v222
    v_and_b32 v157, 0xffff0000, v222
    v_lshlrev_b32 v142, 16, v207
    v_and_b32 v143, 0xffff0000, v207
    v_lshlrev_b32 v158, 16, v223
    v_and_b32 v159, 0xffff0000, v223
    v_pk_add_f32 v[128:129], v[128:129], v[144:145]
    v_pk_add_f32 v[130:131], v[130:131], v[146:147]
    v_pk_add_f32 v[132:133], v[132:133], v[148:149]
    v_pk_add_f32 v[134:135], v[134:135], v[150:151]
    v_pk_add_f32 v[136:137], v[136:137], v[152:153]
    v_pk_add_f32 v[138:139], v[138:139], v[154:155]
    v_pk_add_f32 v[140:141], v[140:141], v[156:157]
    v_pk_add_f32 v[142:143], v[142:143], v[158:159]
    v_pk_fma_f32 v[64:65], v[128:129], v[178:179], v[64:65] op_sel:[0,1,0] op_sel_hi:[1,1,1]
    v_pk_fma_f32 v[66:67], v[130:131], v[178:179], v[66:67] op_sel:[0,1,0] op_sel_hi:[1,1,1]
    v_pk_fma_f32 v[68:69], v[132:133], v[178:179], v[68:69] op_sel:[0,1,0] op_sel_hi:[1,1,1]
    v_pk_fma_f32 v[70:71], v[134:135], v[178:179], v[70:71] op_sel:[0,1,0] op_sel_hi:[1,1,1]
    v_pk_fma_f32 v[72:73], v[136:137], v[178:179], v[72:73] op_sel:[0,1,0] op_sel_hi:[1,1,1]
    v_pk_fma_f32 v[74:75], v[138:139], v[178:179], v[74:75] op_sel:[0,1,0] op_sel_hi:[1,1,1]
    v_pk_fma_f32 v[76:77], v[140:141], v[178:179], v[76:77] op_sel:[0,1,0] op_sel_hi:[1,1,1]
    v_pk_fma_f32 v[78:79], v[142:143], v[178:179], v[78:79] op_sel:[0,1,0] op_sel_hi:[1,1,1]
    v_cvt_pk_bf16_f32 v200, v64, v65
    v_cvt_pk_bf16_f32 v201, v66, v67
    v_cvt_pk_bf16_f32 v202, v68, v69
    v_cvt_pk_bf16_f32 v203, v70, v71
    v_cvt_pk_bf16_f32 v204, v72, v73
    v_cvt_pk_bf16_f32 v205, v74, v75
    v_cvt_pk_bf16_f32 v206, v76, v77
    v_cvt_pk_bf16_f32 v207, v78, v79
    s_add_u32 s34, s50, 65536
    buffer_store_dwordx4 v[200:203], v4, s[24:27], s34 offen offset:0
    buffer_store_dwordx4 v[204:207], v4, s[24:27], s34 offen offset:1024
gated__end:
    s_endpgm
    s_nop 0
    s_nop 0
    s_nop 0
    s_nop 0
gated__Dc:
    s_barrier
    s_and_b32 s59, s2, 3
    s_lshl_b32 s59, s59, 2
    s_add_u32 s59, s59, 1
    s_and_b32 s59, s59, 15
    s_lshl_b32 s60, s59, 7
    s_add_u32 s60, s60, s57
    s_mul_i32 s59, s59, 458752
    s_add_u32 s59, s59, s58
    s_add_u32 m0, s53, 45056
    s_add_u32 s54, s60, 0
    buffer_load_dwordx4 v2, s[4:7], s54 offen lds
    buffer_load_dwordx4 v3, s[4:7], s54 offen offset:1024 lds
    s_add_u32 m0, s53, 47104
    s_add_u32 s54, s60, 32768
    buffer_load_dwordx4 v2, s[4:7], s54 offen lds
    buffer_load_dwordx4 v3, s[4:7], s54 offen offset:1024 lds
    s_add_u32 m0, s53, 49152
    s_add_u32 s54, s60, 65536
    buffer_load_dwordx4 v2, s[4:7], s54 offen lds
    buffer_load_dwordx4 v3, s[4:7], s54 offen offset:1024 lds
    s_add_u32 m0, s53, 51200
    s_add_u32 s54, s60, 98304
    buffer_load_dwordx4 v2, s[4:7], s54 offen lds
    buffer_load_dwordx4 v3, s[4:7], s54 offen offset:1024 lds
    s_add_u32 s54, s59, 0
    s_add_u32 m0, s56, 45056
    s_nop 0
    buffer_load_dwordx4 v16, s[8:11], s54 offen offset:0 lds
    buffer_load_dwordx4 v17, s[8:11], s54 offen offset:1024 lds
    buffer_load_dwordx4 v18, s[8:11], s54 offen offset:2048 lds
    buffer_load_dwordx4 v19, s[8:11], s54 offen offset:3072 lds
    s_add_u32 m0, s56, 49152
    s_nop 0
    buffer_load_dwordx4 v20, s[8:11], s54 offen offset:0 lds
    buffer_load_dwordx4 v21, s[8:11], s54 offen offset:1024 lds
    buffer_load_dwordx4 v22, s[8:11], s54 offen offset:2048 lds
    s_add_u32 s54, s59, 114688
    s_add_u32 m0, s56, 52224
    s_nop 0
    buffer_load_dwordx4 v16, s[8:11], s54 offen offset:0 lds
    buffer_load_dwordx4 v17, s[8:11], s54 offen offset:1024 lds
    buffer_load_dwordx4 v18, s[8:11], s54 offen offset:2048 lds
    buffer_load_dwordx4 v19, s[8:11], s54 offen offset:3072 lds
    s_add_u32 m0, s56, 56320
    s_nop 0
    buffer_load_dwordx4 v20, s[8:11], s54 offen offset:0 lds
    buffer_load_dwordx4 v21, s[8:11], s54 offen offset:1024 lds
    buffer_load_dwordx4 v22, s[8:11], s54 offen offset:2048 lds
    s_and_b32 s59, s2, 3
    s_lshl_b32 s59, s59, 2
    s_add_u32 s59, s59, 2
    s_and_b32 s59, s59, 15
    s_lshl_b32 s60, s59, 7
    s_add_u32 s60, s60, s57
    s_mul_i32 s59, s59, 458752
    s_add_u32 s59, s59, s58
    s_add_u32 m0, s53, 90112
    s_add_u32 s54, s60, 0
    buffer_load_dwordx4 v2, s[4:7], s54 offen lds
    buffer_load_dwordx4 v3, s[4:7], s54 offen offset:1024 lds
    s_add_u32 m0, s53, 92160
    s_add_u32 s54, s60, 32768
    buffer_load_dwordx4 v2, s[4:7], s54 offen lds
    buffer_load_dwordx4 v3, s[4:7], s54 offen offset:1024 lds
    s_add_u32 m0, s53, 94208
    s_add_u32 s54, s60, 65536
    buffer_load_dwordx4 v2, s[4:7], s54 offen lds
    buffer_load_dwordx4 v3, s[4:7], s54 offen offset:1024 lds
    s_add_u32 m0, s53, 96256
    s_add_u32 s54, s60, 98304
    buffer_load_dwordx4 v2, s[4:7], s54 offen lds
    buffer_load_dwordx4 v3, s[4:7], s54 offen offset:1024 lds
    s_add_u32 s54, s59, 0
    s_add_u32 m0, s56, 90112
    s_nop 0
    buffer_load_dwordx4 v16, s[8:11], s54 offen offset:0 lds
    buffer_load_dwordx4 v17, s[8:11], s54 offen offset:1024 lds
    buffer_load_dwordx4 v18, s[8:11], s54 offen offset:2048 lds
    buffer_load_dwordx4 v19, s[8:11], s54 offen offset:3072 lds
    s_add_u32 m0, s56, 94208
    s_nop 0
    buffer_load_dwordx4 v20, s[8:11], s54 offen offset:0 lds
    buffer_load_dwordx4 v21, s[8:11], s54 offen offset:1024 lds
    buffer_load_dwordx4 v22, s[8:11], s54 offen offset:2048 lds
    s_add_u32 s54, s59, 114688
    s_add_u32 m0, s56, 97280
    s_nop 0
    buffer_load_dwordx4 v16, s[8:11], s54 offen offset:0 lds
    buffer_load_dwordx4 v17, s[8:11], s54 offen offset:1024 lds
    buffer_load_dwordx4 v18, s[8:11], s54 offen offset:2048 lds
    buffer_load_dwordx4 v19, s[8:11], s54 offen offset:3072 lds
    s_add_u32 m0, s56, 101376
    s_nop 0
    buffer_load_dwordx4 v20, s[8:11], s54 offen offset:0 lds
    buffer_load_dwordx4 v21, s[8:11], s54 offen offset:1024 lds
    buffer_load_dwordx4 v22, s[8:11], s54 offen offset:2048 lds
    s_mov_b32 s12, s86
    s_and_b32 s13, s87, 0xffff
    s_mov_b32 s14, 42467328
    s_mov_b32 s15, 0x00020000
    s_mov_b32 s24, s84
    s_and_b32 s25, s85, 0xffff
    s_mov_b32 s26, 256
    s_mov_b32 s27, 0x00020000
    s_waitcnt vmcnt(44)
    s_barrier
    s_waitcnt vmcnt(22)
    s_barrier
    s_and_b32 s59, s2, 3
    s_lshl_b32 s59, s59, 2
    s_add_u32 s59, s59, 3
    s_and_b32 s59, s59, 15
    s_lshl_b32 s60, s59, 7
    s_add_u32 s60, s60, s57
    s_mul_i32 s59, s59, 458752
    s_add_u32 s59, s59, s58
    s_add_u32 m0, s53, 0
    s_add_u32 s54, s60, 0
    buffer_load_dwordx4 v2, s[4:7], s54 offen lds
    buffer_load_dwordx4 v3, s[4:7], s54 offen offset:1024 lds
    s_add_u32 m0, s53, 2048
    s_add_u32 s54, s60, 32768
    buffer_load_dwordx4 v2, s[4:7], s54 offen lds
    buffer_load_dwordx4 v3, s[4:7], s54 offen offset:1024 lds
    s_add_u32 m0, s53, 4096
    s_add_u32 s54, s60, 65536
    buffer_load_dwordx4 v2, s[4:7], s54 offen lds
    buffer_load_dwordx4 v3, s[4:7], s54 offen offset:1024 lds
    s_add_u32 m0, s53, 6144
    s_add_u32 s54, s60, 98304
    buffer_load_dwordx4 v2, s[4:7], s54 offen lds
    buffer_load_dwordx4 v3, s[4:7], s54 offen offset:1024 lds
    s_add_u32 s54, s59, 0
    s_add_u32 m0, s56, 0
    s_nop 0
    buffer_load_dwordx4 v16, s[8:11], s54 offen offset:0 lds
    buffer_load_dwordx4 v17, s[8:11], s54 offen offset:1024 lds
    buffer_load_dwordx4 v18, s[8:11], s54 offen offset:2048 lds
    buffer_load_dwordx4 v19, s[8:11], s54 offen offset:3072 lds
    s_add_u32 m0, s56, 4096
    s_nop 0
    buffer_load_dwordx4 v20, s[8:11], s54 offen offset:0 lds
    buffer_load_dwordx4 v21, s[8:11], s54 offen offset:1024 lds
    buffer_load_dwordx4 v22, s[8:11], s54 offen offset:2048 lds
    s_add_u32 s54, s59, 114688
    s_add_u32 m0, s56, 7168
    s_nop 0
    buffer_load_dwordx4 v16, s[8:11], s54 offen offset:0 lds
    buffer_load_dwordx4 v17, s[8:11], s54 offen offset:1024 lds
    buffer_load_dwordx4 v18, s[8:11], s54 offen offset:2048 lds
    buffer_load_dwordx4 v19, s[8:11], s54 offen offset:3072 lds
    s_add_u32 m0, s56, 11264
    s_nop 0
    buffer_load_dwordx4 v20, s[8:11], s54 offen offset:0 lds
    buffer_load_dwordx4 v21, s[8:11], s54 offen offset:1024 lds
    buffer_load_dwordx4 v22, s[8:11], s54 offen offset:2048 lds
    s_waitcnt vmcnt(22)
    s_barrier
    s_and_b32 s59, s2, 3
    s_lshl_b32 s59, s59, 2
    s_add_u32 s59, s59, 4
    s_and_b32 s59, s59, 15
    s_lshl_b32 s60, s59, 7
    s_add_u32 s60, s60, s57
    s_mul_i32 s59, s59, 458752
    s_add_u32 s59, s59, s58
    s_add_u32 m0, s53, 45056
    s_add_u32 s54, s60, 0
    buffer_load_dwordx4 v2, s[4:7], s54 offen lds
    buffer_load_dwordx4 v3, s[4:7], s54 offen offset:1024 lds
    s_add_u32 m0, s53, 47104
    s_add_u32 s54, s60, 32768
    buffer_load_dwordx4 v2, s[4:7], s54 offen lds
    buffer_load_dwordx4 v3, s[4:7], s54 offen offset:1024 lds
    s_add_u32 m0, s53, 49152
    s_add_u32 s54, s60, 65536
    buffer_load_dwordx4 v2, s[4:7], s54 offen lds
    buffer_load_dwordx4 v3, s[4:7], s54 offen offset:1024 lds
    s_add_u32 m0, s53, 51200
    s_add_u32 s54, s60, 98304
    buffer_load_dwordx4 v2, s[4:7], s54 offen lds
    buffer_load_dwordx4 v3, s[4:7], s54 offen offset:1024 lds
    s_add_u32 s54, s59, 0
    s_add_u32 m0, s56, 45056
    s_nop 0
    buffer_load_dwordx4 v16, s[8:11], s54 offen offset:0 lds
    buffer_load_dwordx4 v17, s[8:11], s54 offen offset:1024 lds
    buffer_load_dwordx4 v18, s[8:11], s54 offen offset:2048 lds
    buffer_load_dwordx4 v19, s[8:11], s54 offen offset:3072 lds
    s_add_u32 m0, s56, 49152
    s_nop 0
    buffer_load_dwordx4 v20, s[8:11], s54 offen offset:0 lds
    buffer_load_dwordx4 v21, s[8:11], s54 offen offset:1024 lds
    buffer_load_dwordx4 v22, s[8:11], s54 offen offset:2048 lds
    s_add_u32 s54, s59, 114688
    s_add_u32 m0, s56, 52224
    s_nop 0
    buffer_load_dwordx4 v16, s[8:11], s54 offen offset:0 lds
    buffer_load_dwordx4 v17, s[8:11], s54 offen offset:1024 lds
    buffer_load_dwordx4 v18, s[8:11], s54 offen offset:2048 lds
    buffer_load_dwordx4 v19, s[8:11], s54 offen offset:3072 lds
    s_add_u32 m0, s56, 56320
    s_nop 0
    buffer_load_dwordx4 v20, s[8:11], s54 offen offset:0 lds
    buffer_load_dwordx4 v21, s[8:11], s54 offen offset:1024 lds
    buffer_load_dwordx4 v22, s[8:11], s54 offen offset:2048 lds
    s_waitcnt vmcnt(22)
    s_barrier
    s_and_b32 s59, s2, 3
    s_lshl_b32 s59, s59, 2
    s_add_u32 s59, s59, 5
    s_and_b32 s59, s59, 15
    s_lshl_b32 s60, s59, 7
    s_add_u32 s60, s60, s57
    s_mul_i32 s59, s59, 458752
    s_add_u32 s59, s59, s58
    s_add_u32 m0, s53, 90112
    s_add_u32 s54, s60, 0
    buffer_load_dwordx4 v2, s[4:7], s54 offen lds
    buffer_load_dwordx4 v3, s[4:7], s54 offen offset:1024 lds
    s_add_u32 m0, s53, 92160
    s_add_u32 s54, s60, 32768
    buffer_load_dwordx4 v2, s[4:7], s54 offen lds
    buffer_load_dwordx4 v3, s[4:7], s54 offen offset:1024 lds
    s_add_u32 m0, s53, 94208
    s_add_u32 s54, s60, 65536
    buffer_load_dwordx4 v2, s[4:7], s54 offen lds
    buffer_load_dwordx4 v3, s[4:7], s54 offen offset:1024 lds
    s_add_u32 m0, s53, 96256
    s_add_u32 s54, s60, 98304
    buffer_load_dwordx4 v2, s[4:7], s54 offen lds
    buffer_load_dwordx4 v3, s[4:7], s54 offen offset:1024 lds
    s_add_u32 s54, s59, 0
    s_add_u32 m0, s56, 90112
    s_nop 0
    buffer_load_dwordx4 v16, s[8:11], s54 offen offset:0 lds
    buffer_load_dwordx4 v17, s[8:11], s54 offen offset:1024 lds
    buffer_load_dwordx4 v18, s[8:11], s54 offen offset:2048 lds
    buffer_load_dwordx4 v19, s[8:11], s54 offen offset:3072 lds
    s_add_u32 m0, s56, 94208
    s_nop 0
    buffer_load_dwordx4 v20, s[8:11], s54 offen offset:0 lds
    buffer_load_dwordx4 v21, s[8:11], s54 offen offset:1024 lds
    buffer_load_dwordx4 v22, s[8:11], s54 offen offset:2048 lds
    s_add_u32 s54, s59, 114688
    s_add_u32 m0, s56, 97280
    s_nop 0
    buffer_load_dwordx4 v16, s[8:11], s54 offen offset:0 lds
    buffer_load_dwordx4 v17, s[8:11], s54 offen offset:1024 lds
    buffer_load_dwordx4 v18, s[8:11], s54 offen offset:2048 lds
    buffer_load_dwordx4 v19, s[8:11], s54 offen offset:3072 lds
    s_add_u32 m0, s56, 101376
    s_nop 0
    buffer_load_dwordx4 v20, s[8:11], s54 offen offset:0 lds
    buffer_load_dwordx4 v21, s[8:11], s54 offen offset:1024 lds
    buffer_load_dwordx4 v22, s[8:11], s54 offen offset:2048 lds
    s_waitcnt vmcnt(22)
    s_barrier
    s_and_b32 s59, s2, 3
    s_lshl_b32 s59, s59, 2
    s_add_u32 s59, s59, 6
    s_and_b32 s59, s59, 15
    s_lshl_b32 s60, s59, 7
    s_add_u32 s60, s60, s57
    s_mul_i32 s59, s59, 458752
    s_add_u32 s59, s59, s58
    s_add_u32 m0, s53, 0
    s_add_u32 s54, s60, 0
    buffer_load_dwordx4 v2, s[4:7], s54 offen lds
    buffer_load_dwordx4 v3, s[4:7], s54 offen offset:1024 lds
    s_add_u32 m0, s53, 2048
    s_add_u32 s54, s60, 32768
    buffer_load_dwordx4 v2, s[4:7], s54 offen lds
    buffer_load_dwordx4 v3, s[4:7], s54 offen offset:1024 lds
    s_add_u32 m0, s53, 4096
    s_add_u32 s54, s60, 65536
    buffer_load_dwordx4 v2, s[4:7], s54 offen lds
    buffer_load_dwordx4 v3, s[4:7], s54 offen offset:1024 lds
    s_add_u32 m0, s53, 6144
    s_add_u32 s54, s60, 98304
    buffer_load_dwordx4 v2, s[4:7], s54 offen lds
    buffer_load_dwordx4 v3, s[4:7], s54 offen offset:1024 lds
    s_add_u32 s54, s59, 0
    s_add_u32 m0, s56, 0
    s_nop 0
    buffer_load_dwordx4 v16, s[8:11], s54 offen offset:0 lds
    buffer_load_dwordx4 v17, s[8:11], s54 offen offset:1024 lds
    buffer_load_dwordx4 v18, s[8:11], s54 offen offset:2048 lds
    buffer_load_dwordx4 v19, s[8:11], s54 offen offset:3072 lds
    s_add_u32 m0, s56, 4096
    s_nop 0
    buffer_load_dwordx4 v20, s[8:11], s54 offen offset:0 lds
    buffer_load_dwordx4 v21, s[8:11], s54 offen offset:1024 lds
    buffer_load_dwordx4 v22, s[8:11], s54 offen offset:2048 lds
    s_add_u32 s54, s59, 114688
    s_add_u32 m0, s56, 7168
    s_nop 0
    buffer_load_dwordx4 v16, s[8:11], s54 offen offset:0 lds
    buffer_load_dwordx4 v17, s[8:11], s54 offen offset:1024 lds
    buffer_load_dwordx4 v18, s[8:11], s54 offen offset:2048 lds
    buffer_load_dwordx4 v19, s[8:11], s54 offen offset:3072 lds
    s_add_u32 m0, s56, 11264
    s_nop 0
    buffer_load_dwordx4 v20, s[8:11], s54 offen offset:0 lds
    buffer_load_dwordx4 v21, s[8:11], s54 offen offset:1024 lds
    buffer_load_dwordx4 v22, s[8:11], s54 offen offset:2048 lds
    s_waitcnt vmcnt(22)
    s_barrier
    s_and_b32 s59, s2, 3
    s_lshl_b32 s59, s59, 2
    s_add_u32 s59, s59, 7
    s_and_b32 s59, s59, 15
    s_lshl_b32 s60, s59, 7
    s_add_u32 s60, s60, s57
    s_mul_i32 s59, s59, 458752
    s_add_u32 s59, s59, s58
    s_add_u32 m0, s53, 45056
    s_add_u32 s54, s60, 0
    buffer_load_dwordx4 v2, s[4:7], s54 offen lds
    buffer_load_dwordx4 v3, s[4:7], s54 offen offset:1024 lds
    s_add_u32 m0, s53, 47104
    s_add_u32 s54, s60, 32768
    buffer_load_dwordx4 v2, s[4:7], s54 offen lds
    buffer_load_dwordx4 v3, s[4:7], s54 offen offset:1024 lds
    s_add_u32 m0, s53, 49152
    s_add_u32 s54, s60, 65536
    buffer_load_dwordx4 v2, s[4:7], s54 offen lds
    buffer_load_dwordx4 v3, s[4:7], s54 offen offset:1024 lds
    s_add_u32 m0, s53, 51200
    s_add_u32 s54, s60, 98304
    buffer_load_dwordx4 v2, s[4:7], s54 offen lds
    buffer_load_dwordx4 v3, s[4:7], s54 offen offset:1024 lds
    s_add_u32 s54, s59, 0
    s_add_u32 m0, s56, 45056
    s_nop 0
    buffer_load_dwordx4 v16, s[8:11], s54 offen offset:0 lds
    buffer_load_dwordx4 v17, s[8:11], s54 offen offset:1024 lds
    buffer_load_dwordx4 v18, s[8:11], s54 offen offset:2048 lds
    buffer_load_dwordx4 v19, s[8:11], s54 offen offset:3072 lds
    s_add_u32 m0, s56, 49152
    s_nop 0
    buffer_load_dwordx4 v20, s[8:11], s54 offen offset:0 lds
    buffer_load_dwordx4 v21, s[8:11], s54 offen offset:1024 lds
    buffer_load_dwordx4 v22, s[8:11], s54 offen offset:2048 lds
    s_add_u32 s54, s59, 114688
    s_add_u32 m0, s56, 52224
    s_nop 0
    buffer_load_dwordx4 v16, s[8:11], s54 offen offset:0 lds
    buffer_load_dwordx4 v17, s[8:11], s54 offen offset:1024 lds
    buffer_load_dwordx4 v18, s[8:11], s54 offen offset:2048 lds
    buffer_load_dwordx4 v19, s[8:11], s54 offen offset:3072 lds
    s_add_u32 m0, s56, 56320
    s_nop 0
    buffer_load_dwordx4 v20, s[8:11], s54 offen offset:0 lds
    buffer_load_dwordx4 v21, s[8:11], s54 offen offset:1024 lds
    buffer_load_dwordx4 v22, s[8:11], s54 offen offset:2048 lds
    s_waitcnt vmcnt(22)
    s_barrier
    s_and_b32 s59, s2, 3
    s_lshl_b32 s59, s59, 2
    s_add_u32 s59, s59, 8
    s_and_b32 s59, s59, 15
    s_lshl_b32 s60, s59, 7
    s_add_u32 s60, s60, s57
    s_mul_i32 s59, s59, 458752
    s_add_u32 s59, s59, s58
    s_add_u32 m0, s53, 90112
    s_add_u32 s54, s60, 0
    buffer_load_dwordx4 v2, s[4:7], s54 offen lds
    buffer_load_dwordx4 v3, s[4:7], s54 offen offset:1024 lds
    s_add_u32 m0, s53, 92160
    s_add_u32 s54, s60, 32768
    buffer_load_dwordx4 v2, s[4:7], s54 offen lds
    buffer_load_dwordx4 v3, s[4:7], s54 offen offset:1024 lds
    s_add_u32 m0, s53, 94208
    s_add_u32 s54, s60, 65536
    buffer_load_dwordx4 v2, s[4:7], s54 offen lds
    buffer_load_dwordx4 v3, s[4:7], s54 offen offset:1024 lds
    s_add_u32 m0, s53, 96256
    s_add_u32 s54, s60, 98304
    buffer_load_dwordx4 v2, s[4:7], s54 offen lds
    buffer_load_dwordx4 v3, s[4:7], s54 offen offset:1024 lds
    s_add_u32 s54, s59, 0
    s_add_u32 m0, s56, 90112
    s_nop 0
    buffer_load_dwordx4 v16, s[8:11], s54 offen offset:0 lds
    buffer_load_dwordx4 v17, s[8:11], s54 offen offset:1024 lds
    buffer_load_dwordx4 v18, s[8:11], s54 offen offset:2048 lds
    buffer_load_dwordx4 v19, s[8:11], s54 offen offset:3072 lds
    s_add_u32 m0, s56, 94208
    s_nop 0
    buffer_load_dwordx4 v20, s[8:11], s54 offen offset:0 lds
    buffer_load_dwordx4 v21, s[8:11], s54 offen offset:1024 lds
    buffer_load_dwordx4 v22, s[8:11], s54 offen offset:2048 lds
    s_add_u32 s54, s59, 114688
    s_add_u32 m0, s56, 97280
    s_nop 0
    buffer_load_dwordx4 v16, s[8:11], s54 offen offset:0 lds
    buffer_load_dwordx4 v17, s[8:11], s54 offen offset:1024 lds
    buffer_load_dwordx4 v18, s[8:11], s54 offen offset:2048 lds
    buffer_load_dwordx4 v19, s[8:11], s54 offen offset:3072 lds
    s_add_u32 m0, s56, 101376
    s_nop 0
    buffer_load_dwordx4 v20, s[8:11], s54 offen offset:0 lds
    buffer_load_dwordx4 v21, s[8:11], s54 offen offset:1024 lds
    buffer_load_dwordx4 v22, s[8:11], s54 offen offset:2048 lds
    s_waitcnt vmcnt(22)
    s_barrier
    s_and_b32 s59, s2, 3
    s_lshl_b32 s59, s59, 2
    s_add_u32 s59, s59, 9
    s_and_b32 s59, s59, 15
    s_lshl_b32 s60, s59, 7
    s_add_u32 s60, s60, s57
    s_mul_i32 s59, s59, 458752
    s_add_u32 s59, s59, s58
    s_add_u32 m0, s53, 0
    s_add_u32 s54, s60, 0
    buffer_load_dwordx4 v2, s[4:7], s54 offen lds
    buffer_load_dwordx4 v3, s[4:7], s54 offen offset:1024 lds
    s_add_u32 m0, s53, 2048
    s_add_u32 s54, s60, 32768
    buffer_load_dwordx4 v2, s[4:7], s54 offen lds
    buffer_load_dwordx4 v3, s[4:7], s54 offen offset:1024 lds
    s_add_u32 m0, s53, 4096
    s_add_u32 s54, s60, 65536
    buffer_load_dwordx4 v2, s[4:7], s54 offen lds
    buffer_load_dwordx4 v3, s[4:7], s54 offen offset:1024 lds
    s_add_u32 m0, s53, 6144
    s_add_u32 s54, s60, 98304
    buffer_load_dwordx4 v2, s[4:7], s54 offen lds
    buffer_load_dwordx4 v3, s[4:7], s54 offen offset:1024 lds
    s_add_u32 s54, s59, 0
    s_add_u32 m0, s56, 0
    s_nop 0
    buffer_load_dwordx4 v16, s[8:11], s54 offen offset:0 lds
    buffer_load_dwordx4 v17, s[8:11], s54 offen offset:1024 lds
    buffer_load_dwordx4 v18, s[8:11], s54 offen offset:2048 lds
    buffer_load_dwordx4 v19, s[8:11], s54 offen offset:3072 lds
    s_add_u32 m0, s56, 4096
    s_nop 0
    buffer_load_dwordx4 v20, s[8:11], s54 offen offset:0 lds
    buffer_load_dwordx4 v21, s[8:11], s54 offen offset:1024 lds
    buffer_load_dwordx4 v22, s[8:11], s54 offen offset:2048 lds
    s_add_u32 s54, s59, 114688
    s_add_u32 m0, s56, 7168
    s_nop 0
    buffer_load_dwordx4 v16, s[8:11], s54 offen offset:0 lds
    buffer_load_dwordx4 v17, s[8:11], s54 offen offset:1024 lds
    buffer_load_dwordx4 v18, s[8:11], s54 offen offset:2048 lds
    buffer_load_dwordx4 v19, s[8:11], s54 offen offset:3072 lds
    s_add_u32 m0, s56, 11264
    s_nop 0
    buffer_load_dwordx4 v20, s[8:11], s54 offen offset:0 lds
    buffer_load_dwordx4 v21, s[8:11], s54 offen offset:1024 lds
    buffer_load_dwordx4 v22, s[8:11], s54 offen offset:2048 lds
    v_mov_b32 v62, 163768
    v_mov_b32 v63, 1
    s_mov_b64 exec, 1
    ds_add_u32 v62, v63
    s_mov_b64 exec, -1
    s_waitcnt vmcnt(22)
    s_barrier
    s_and_b32 s59, s2, 3
    s_lshl_b32 s59, s59, 2
    s_add_u32 s59, s59, 10
    s_and_b32 s59, s59, 15
    s_lshl_b32 s60, s59, 7
    s_add_u32 s60, s60, s57
    s_mul_i32 s59, s59, 458752
    s_add_u32 s59, s59, s58
    s_add_u32 m0, s53, 45056
    s_add_u32 s54, s60, 0
    buffer_load_dwordx4 v2, s[4:7], s54 offen lds
    buffer_load_dwordx4 v3, s[4:7], s54 offen offset:1024 lds
    s_add_u32 m0, s53, 47104
    s_add_u32 s54, s60, 32768
    buffer_load_dwordx4 v2, s[4:7], s54 offen lds
    buffer_load_dwordx4 v3, s[4:7], s54 offen offset:1024 lds
    s_add_u32 m0, s53, 49152
    s_add_u32 s54, s60, 65536
    buffer_load_dwordx4 v2, s[4:7], s54 offen lds
    buffer_load_dwordx4 v3, s[4:7], s54 offen offset:1024 lds
    s_add_u32 m0, s53, 51200
    s_add_u32 s54, s60, 98304
    buffer_load_dwordx4 v2, s[4:7], s54 offen lds
    buffer_load_dwordx4 v3, s[4:7], s54 offen offset:1024 lds
    s_add_u32 s54, s59, 0
    s_add_u32 m0, s56, 45056
    s_nop 0
    buffer_load_dwordx4 v16, s[8:11], s54 offen offset:0 lds
    buffer_load_dwordx4 v17, s[8:11], s54 offen offset:1024 lds
    buffer_load_dwordx4 v18, s[8:11], s54 offen offset:2048 lds
    buffer_load_dwordx4 v19, s[8:11], s54 offen offset:3072 lds
    s_add_u32 m0, s56, 49152
    s_nop 0
    buffer_load_dwordx4 v20, s[8:11], s54 offen offset:0 lds
    buffer_load_dwordx4 v21, s[8:11], s54 offen offset:1024 lds
    buffer_load_dwordx4 v22, s[8:11], s54 offen offset:2048 lds
    s_add_u32 s54, s59, 114688
    s_add_u32 m0, s56, 52224
    s_nop 0
    buffer_load_dwordx4 v16, s[8:11], s54 offen offset:0 lds
    buffer_load_dwordx4 v17, s[8:11], s54 offen offset:1024 lds
    buffer_load_dwordx4 v18, s[8:11], s54 offen offset:2048 lds
    buffer_load_dwordx4 v19, s[8:11], s54 offen offset:3072 lds
    s_add_u32 m0, s56, 56320
    s_nop 0
    buffer_load_dwordx4 v20, s[8:11], s54 offen offset:0 lds
    buffer_load_dwordx4 v21, s[8:11], s54 offen offset:1024 lds
    buffer_load_dwordx4 v22, s[8:11], s54 offen offset:2048 lds
    s_waitcnt vmcnt(22)
    s_barrier
    s_and_b32 s59, s2, 3
    s_lshl_b32 s59, s59, 2
    s_add_u32 s59, s59, 11
    s_and_b32 s59, s59, 15
    s_lshl_b32 s60, s59, 7
    s_add_u32 s60, s60, s57
    s_mul_i32 s59, s59, 458752
    s_add_u32 s59, s59, s58
    s_add_u32 m0, s53, 90112
    s_add_u32 s54, s60, 0
    buffer_load_dwordx4 v2, s[4:7], s54 offen lds
    buffer_load_dwordx4 v3, s[4:7], s54 offen offset:1024 lds
    s_add_u32 m0, s53, 92160
    s_add_u32 s54, s60, 32768
    buffer_load_dwordx4 v2, s[4:7], s54 offen lds
    buffer_load_dwordx4 v3, s[4:7], s54 offen offset:1024 lds
    s_add_u32 m0, s53, 94208
    s_add_u32 s54, s60, 65536
    buffer_load_dwordx4 v2, s[4:7], s54 offen lds
    buffer_load_dwordx4 v3, s[4:7], s54 offen offset:1024 lds
    s_add_u32 m0, s53, 96256
    s_add_u32 s54, s60, 98304
    buffer_load_dwordx4 v2, s[4:7], s54 offen lds
    buffer_load_dwordx4 v3, s[4:7], s54 offen offset:1024 lds
    s_add_u32 s54, s59, 0
    s_add_u32 m0, s56, 90112
    s_nop 0
    buffer_load_dwordx4 v16, s[8:11], s54 offen offset:0 lds
    buffer_load_dwordx4 v17, s[8:11], s54 offen offset:1024 lds
    buffer_load_dwordx4 v18, s[8:11], s54 offen offset:2048 lds
    buffer_load_dwordx4 v19, s[8:11], s54 offen offset:3072 lds
    s_add_u32 m0, s56, 94208
    s_nop 0
    buffer_load_dwordx4 v20, s[8:11], s54 offen offset:0 lds
    buffer_load_dwordx4 v21, s[8:11], s54 offen offset:1024 lds
    buffer_load_dwordx4 v22, s[8:11], s54 offen offset:2048 lds
    s_add_u32 s54, s59, 114688
    s_add_u32 m0, s56, 97280
    s_nop 0
    buffer_load_dwordx4 v16, s[8:11], s54 offen offset:0 lds
    buffer_load_dwordx4 v17, s[8:11], s54 offen offset:1024 lds
    buffer_load_dwordx4 v18, s[8:11], s54 offen offset:2048 lds
    buffer_load_dwordx4 v19, s[8:11], s54 offen offset:3072 lds
    s_add_u32 m0, s56, 101376
    s_nop 0
    buffer_load_dwordx4 v20, s[8:11], s54 offen offset:0 lds
    buffer_load_dwordx4 v21, s[8:11], s54 offen offset:1024 lds
    buffer_load_dwordx4 v22, s[8:11], s54 offen offset:2048 lds
    s_waitcnt vmcnt(22)
    s_barrier
    s_and_b32 s59, s2, 3
    s_lshl_b32 s59, s59, 2
    s_add_u32 s59, s59, 12
    s_and_b32 s59, s59, 15
    s_lshl_b32 s60, s59, 7
    s_add_u32 s60, s60, s57
    s_mul_i32 s59, s59, 458752
    s_add_u32 s59, s59, s58
    s_add_u32 m0, s53, 0
    s_add_u32 s54, s60, 0
    buffer_load_dwordx4 v2, s[4:7], s54 offen lds
    buffer_load_dwordx4 v3, s[4:7], s54 offen offset:1024 lds
    s_add_u32 m0, s53, 2048
    s_add_u32 s54, s60, 32768
    buffer_load_dwordx4 v2, s[4:7], s54 offen lds
    buffer_load_dwordx4 v3, s[4:7], s54 offen offset:1024 lds
    s_add_u32 m0, s53, 4096
    s_add_u32 s54, s60, 65536
    buffer_load_dwordx4 v2, s[4:7], s54 offen lds
    buffer_load_dwordx4 v3, s[4:7], s54 offen offset:1024 lds
    s_add_u32 m0, s53, 6144
    s_add_u32 s54, s60, 98304
    buffer_load_dwordx4 v2, s[4:7], s54 offen lds
    buffer_load_dwordx4 v3, s[4:7], s54 offen offset:1024 lds
    s_add_u32 s54, s59, 0
    s_add_u32 m0, s56, 0
    s_nop 0
    buffer_load_dwordx4 v16, s[8:11], s54 offen offset:0 lds
    buffer_load_dwordx4 v17, s[8:11], s54 offen offset:1024 lds
    buffer_load_dwordx4 v18, s[8:11], s54 offen offset:2048 lds
    buffer_load_dwordx4 v19, s[8:11], s54 offen offset:3072 lds
    s_add_u32 m0, s56, 4096
    s_nop 0
    buffer_load_dwordx4 v20, s[8:11], s54 offen offset:0 lds
    buffer_load_dwordx4 v21, s[8:11], s54 offen offset:1024 lds
    buffer_load_dwordx4 v22, s[8:11], s54 offen offset:2048 lds
    s_add_u32 s54, s59, 114688
    s_add_u32 m0, s56, 7168
    s_nop 0
    buffer_load_dwordx4 v16, s[8:11], s54 offen offset:0 lds
    buffer_load_dwordx4 v17, s[8:11], s54 offen offset:1024 lds
    buffer_load_dwordx4 v18, s[8:11], s54 offen offset:2048 lds
    buffer_load_dwordx4 v19, s[8:11], s54 offen offset:3072 lds
    s_add_u32 m0, s56, 11264
    s_nop 0
    buffer_load_dwordx4 v20, s[8:11], s54 offen offset:0 lds
    buffer_load_dwordx4 v21, s[8:11], s54 offen offset:1024 lds
    buffer_load_dwordx4 v22, s[8:11], s54 offen offset:2048 lds
    s_waitcnt vmcnt(22)
    s_barrier
    s_and_b32 s59, s2, 3
    s_lshl_b32 s59, s59, 2
    s_add_u32 s59, s59, 13
    s_and_b32 s59, s59, 15
    s_lshl_b32 s60, s59, 7
    s_add_u32 s60, s60, s57
    s_mul_i32 s59, s59, 458752
    s_add_u32 s59, s59, s58
    s_add_u32 m0, s53, 45056
    s_add_u32 s54, s60, 0
    buffer_load_dwordx4 v2, s[4:7], s54 offen lds
    buffer_load_dwordx4 v3, s[4:7], s54 offen offset:1024 lds
    s_add_u32 m0, s53, 47104
    s_add_u32 s54, s60, 32768
    buffer_load_dwordx4 v2, s[4:7], s54 offen lds
    buffer_load_dwordx4 v3, s[4:7], s54 offen offset:1024 lds
    s_add_u32 m0, s53, 49152
    s_add_u32 s54, s60, 65536
    buffer_load_dwordx4 v2, s[4:7], s54 offen lds
    buffer_load_dwordx4 v3, s[4:7], s54 offen offset:1024 lds
    s_add_u32 m0, s53, 51200
    s_add_u32 s54, s60, 98304
    buffer_load_dwordx4 v2, s[4:7], s54 offen lds
    buffer_load_dwordx4 v3, s[4:7], s54 offen offset:1024 lds
    s_add_u32 s54, s59, 0
    s_add_u32 m0, s56, 45056
    s_nop 0
    buffer_load_dwordx4 v16, s[8:11], s54 offen offset:0 lds
    buffer_load_dwordx4 v17, s[8:11], s54 offen offset:1024 lds
    buffer_load_dwordx4 v18, s[8:11], s54 offen offset:2048 lds
    buffer_load_dwordx4 v19, s[8:11], s54 offen offset:3072 lds
    s_add_u32 m0, s56, 49152
    s_nop 0
    buffer_load_dwordx4 v20, s[8:11], s54 offen offset:0 lds
    buffer_load_dwordx4 v21, s[8:11], s54 offen offset:1024 lds
    buffer_load_dwordx4 v22, s[8:11], s54 offen offset:2048 lds
    s_add_u32 s54, s59, 114688
    s_add_u32 m0, s56, 52224
    s_nop 0
    buffer_load_dwordx4 v16, s[8:11], s54 offen offset:0 lds
    buffer_load_dwordx4 v17, s[8:11], s54 offen offset:1024 lds
    buffer_load_dwordx4 v18, s[8:11], s54 offen offset:2048 lds
    buffer_load_dwordx4 v19, s[8:11], s54 offen offset:3072 lds
    s_add_u32 m0, s56, 56320
    s_nop 0
    buffer_load_dwordx4 v20, s[8:11], s54 offen offset:0 lds
    buffer_load_dwordx4 v21, s[8:11], s54 offen offset:1024 lds
    buffer_load_dwordx4 v22, s[8:11], s54 offen offset:2048 lds
    v_mov_b32 v62, 163768
    v_mov_b32 v63, 1
    s_mov_b64 exec, 1
    ds_add_u32 v62, v63
    s_mov_b64 exec, -1
    s_waitcnt vmcnt(22)
    s_barrier
    s_and_b32 s59, s2, 3
    s_lshl_b32 s59, s59, 2
    s_add_u32 s59, s59, 14
    s_and_b32 s59, s59, 15
    s_lshl_b32 s60, s59, 7
    s_add_u32 s60, s60, s57
    s_mul_i32 s59, s59, 458752
    s_add_u32 s59, s59, s58
    s_add_u32 m0, s53, 90112
    s_add_u32 s54, s60, 0
    buffer_load_dwordx4 v2, s[4:7], s54 offen lds
    buffer_load_dwordx4 v3, s[4:7], s54 offen offset:1024 lds
    s_add_u32 m0, s53, 92160
    s_add_u32 s54, s60, 32768
    buffer_load_dwordx4 v2, s[4:7], s54 offen lds
    buffer_load_dwordx4 v3, s[4:7], s54 offen offset:1024 lds
    s_add_u32 m0, s53, 94208
    s_add_u32 s54, s60, 65536
    buffer_load_dwordx4 v2, s[4:7], s54 offen lds
    buffer_load_dwordx4 v3, s[4:7], s54 offen offset:1024 lds
    s_add_u32 m0, s53, 96256
    s_add_u32 s54, s60, 98304
    buffer_load_dwordx4 v2, s[4:7], s54 offen lds
    buffer_load_dwordx4 v3, s[4:7], s54 offen offset:1024 lds
    s_add_u32 s54, s59, 0
    s_add_u32 m0, s56, 90112
    s_nop 0
    buffer_load_dwordx4 v16, s[8:11], s54 offen offset:0 lds
    buffer_load_dwordx4 v17, s[8:11], s54 offen offset:1024 lds
    buffer_load_dwordx4 v18, s[8:11], s54 offen offset:2048 lds
    buffer_load_dwordx4 v19, s[8:11], s54 offen offset:3072 lds
    s_add_u32 m0, s56, 94208
    s_nop 0
    buffer_load_dwordx4 v20, s[8:11], s54 offen offset:0 lds
    buffer_load_dwordx4 v21, s[8:11], s54 offen offset:1024 lds
    buffer_load_dwordx4 v22, s[8:11], s54 offen offset:2048 lds
    s_add_u32 s54, s59, 114688
    s_add_u32 m0, s56, 97280
    s_nop 0
    buffer_load_dwordx4 v16, s[8:11], s54 offen offset:0 lds
    buffer_load_dwordx4 v17, s[8:11], s54 offen offset:1024 lds
    buffer_load_dwordx4 v18, s[8:11], s54 offen offset:2048 lds
    buffer_load_dwordx4 v19, s[8:11], s54 offen offset:3072 lds
    s_add_u32 m0, s56, 101376
    s_nop 0
    buffer_load_dwordx4 v20, s[8:11], s54 offen offset:0 lds
    buffer_load_dwordx4 v21, s[8:11], s54 offen offset:1024 lds
    buffer_load_dwordx4 v22, s[8:11], s54 offen offset:2048 lds
    s_mov_b32 s63, 0
    s_waitcnt vmcnt(22)
    s_barrier
    s_and_b32 s59, s2, 3
    s_lshl_b32 s59, s59, 2
    s_add_u32 s59, s59, 15
    s_and_b32 s59, s59, 15
    s_lshl_b32 s60, s59, 7
    s_add_u32 s60, s60, s57
    s_mul_i32 s59, s59, 458752
    s_add_u32 s59, s59, s58
    s_add_u32 m0, s53, 0
    s_add_u32 s54, s60, 0
    buffer_load_dwordx4 v2, s[4:7], s54 offen lds
    buffer_load_dwordx4 v3, s[4:7], s54 offen offset:1024 lds
    s_add_u32 m0, s53, 2048
    s_add_u32 s54, s60, 32768
    buffer_load_dwordx4 v2, s[4:7], s54 offen lds
    buffer_load_dwordx4 v3, s[4:7], s54 offen offset:1024 lds
    s_add_u32 m0, s53, 4096
    s_add_u32 s54, s60, 65536
    buffer_load_dwordx4 v2, s[4:7], s54 offen lds
    buffer_load_dwordx4 v3, s[4:7], s54 offen offset:1024 lds
    s_add_u32 m0, s53, 6144
    s_add_u32 s54, s60, 98304
    buffer_load_dwordx4 v2, s[4:7], s54 offen lds
    buffer_load_dwordx4 v3, s[4:7], s54 offen offset:1024 lds
    s_add_u32 s54, s59, 0
    s_add_u32 m0, s56, 0
    s_nop 0
    buffer_load_dwordx4 v16, s[8:11], s54 offen offset:0 lds
    buffer_load_dwordx4 v17, s[8:11], s54 offen offset:1024 lds
    buffer_load_dwordx4 v18, s[8:11], s54 offen offset:2048 lds
    buffer_load_dwordx4 v19, s[8:11], s54 offen offset:3072 lds
    s_add_u32 m0, s56, 4096
    s_nop 0
    buffer_load_dwordx4 v20, s[8:11], s54 offen offset:0 lds
    buffer_load_dwordx4 v21, s[8:11], s54 offen offset:1024 lds
    buffer_load_dwordx4 v22, s[8:11], s54 offen offset:2048 lds
    s_add_u32 s54, s59, 114688
    s_add_u32 m0, s56, 7168
    s_nop 0
    buffer_load_dwordx4 v16, s[8:11], s54 offen offset:0 lds
    buffer_load_dwordx4 v17, s[8:11], s54 offen offset:1024 lds
    buffer_load_dwordx4 v18, s[8:11], s54 offen offset:2048 lds
    buffer_load_dwordx4 v19, s[8:11], s54 offen offset:3072 lds
    s_add_u32 m0, s56, 11264
    s_nop 0
    buffer_load_dwordx4 v20, s[8:11], s54 offen offset:0 lds
    buffer_load_dwordx4 v21, s[8:11], s54 offen offset:1024 lds
    buffer_load_dwordx4 v22, s[8:11], s54 offen offset:2048 lds
    v_mov_b32 v62, 163768
    v_mov_b32 v63, 1
    s_mov_b64 exec, 1
    ds_add_u32 v62, v63
    s_mov_b64 exec, -1
    s_waitcnt vmcnt(22)
    s_barrier
    s_lshl_b32 s35, s30, 14
    s_add_u32 s34, s35, 43008
    buffer_load_dwordx4 v[192:195], v13, s[16:19], s34 offen offset:0
    buffer_load_dwordx4 v[196:199], v13, s[16:19], s34 offen offset:1024
    buffer_load_dwordx4 v[200:203], v13, s[16:19], s34 offen offset:2048
    buffer_load_dwordx4 v[204:207], v13, s[16:19], s34 offen offset:3072
    s_add_u32 s34, s35, 47104
    buffer_load_dwordx4 v[208:211], v13, s[16:19], s34 offen offset:0
    buffer_load_dwordx4 v[212:215], v13, s[16:19], s34 offen offset:1024
    buffer_load_dwordx4 v[216:219], v13, s[16:19], s34 offen offset:2048
    buffer_load_dwordx4 v[220:223], v13, s[16:19], s34 offen offset:3072
    s_waitcnt vmcnt(8)
    s_barrier
    s_cmp_lg_u32 s63, 0
    s_cbranch_scc1 gated_mix__spectral_gfnet__dense_activation_gelu__prompt_kernel_tl1
    v_mov_b32 v63, 163744
    ds_read_b32 v62, v63
    s_waitcnt lgkmcnt(0)
    v_readfirstlane_b32 s63, v62
    s_cmp_eq_u32 s63, 0
    s_cbranch_scc1 gated_mix__spectral_gfnet__dense_activation_gelu__prompt_kernel_tl1
    s_lshr_b32 s34, s3, 1
    s_lshl_b32 s34, s34, 15
    s_and_b32 s35, s3, 1
    s_lshl_b32 s35, s35, 6
    s_add_u32 s34, s34, s35
    s_lshl_b32 s35, s30, 13
    s_add_u32 s34, s34, s35
    v_lshrrev_b32 v62, 1, v15
    v_lshlrev_b32 v62, 7, v62
    v_and_b32 v63, 1, v15
    v_lshl_add_u32 v62, v63, 5, v62
    v_lshl_add_u32 v62, v14, 9, v62
    s_add_u32 s34, s34, 19922944
    s_mov_b32 s36, 0
    s_lshl_b32 s36, s36, 7
    v_xor_b32 v63, s36, v62
    v_xor_b32 v61, 256, v63
    buffer_load_dwordx4 v[64:67], v63, s[12:15], s34 offen offset:0 sc1
    buffer_load_dwordx4 v[68:71], v61, s[12:15], s34 offen offset:0 sc1
    buffer_load_dwordx4 v[120:123], v63, s[12:15], s34 offen offset:16 sc1
    buffer_load_dwordx4 v[124:127], v61, s[12:15], s34 offen offset:16 sc1
    s_cmp_lg_u32 s2, 0
    s_cbranch_scc1 gated_mix__spectral_gfnet__dense_activation_gelu__prompt_kernel_now5122
    s_add_u32 s34, s35, 24117248
    buffer_load_dwordx4 v[128:131], v62, s[12:15], s34 offen offset:0 sc1
    buffer_load_dwordx4 v[132:135], v62, s[12:15], s34 offen offset:256 sc1
gated_mix__spectral_gfnet__dense_activation_gelu__prompt_kernel_now5122:
gated_mix__spectral_gfnet__dense_activation_gelu__prompt_kernel_tl1:
    s_lshl_b32 s35, s30, 14
    s_add_u32 s34, s35, 51200
    buffer_load_dwordx4 v[224:227], v13, s[16:19], s34 offen offset:0
    buffer_load_dwordx4 v[228:231], v13, s[16:19], s34 offen offset:1024
    buffer_load_dwordx4 v[232:235], v13, s[16:19], s34 offen offset:2048
    buffer_load_dwordx4 v[236:239], v13, s[16:19], s34 offen offset:3072
    s_add_u32 s34, s35, 55296
    buffer_load_dwordx4 v[240:243], v13, s[16:19], s34 offen offset:0
    buffer_load_dwordx4 v[244:247], v13, s[16:19], s34 offen offset:1024
    buffer_load_dwordx4 v[248:251], v13, s[16:19], s34 offen offset:2048
    buffer_load_dwordx4 v[252:255], v13, s[16:19], s34 offen offset:3072
    s_mov_b32 s34, 36864
    buffer_load_dwordx4 v[168:171], v13, s[16:19], s34 offen offset:0
    buffer_load_dwordx4 v[172:175], v13, s[16:19], s34 offen offset:1024
    buffer_load_dwordx4 v[176:179], v13, s[16:19], s34 offen offset:2048
    buffer_load_dwordx4 v[180:183], v13, s[16:19], s34 offen offset:3072
    s_mov_b32 s34, 40960
    buffer_load_dwordx4 v[184:187], v13, s[16:19], s34 offen offset:0
    buffer_load_dwordx4 v[188:191], v13, s[16:19], s34 offen offset:1024
    s_waitcnt vmcnt(18)
    s_branch gated__join
gated__Mc:
    s_and_b32 s34, s30, 1
    s_lshr_b32 s35, s30, 1
    s_and_b32 s36, s29, 1
    v_lshrrev_b32 v8, 1, v14
    v_xor_b32 v8, v15, v8
    v_lshlrev_b32 v8, 4, v8
    s_lshl_b32 s37, s35, 13
    v_lshlrev_b32 v9, 7, v14
    v_add3_u32 v2, v8, v9, s37
    v_xor_b32 v3, 64, v2
    v_mov_b32 v12, v2
    v_lshrrev_b32 v8, 2, v14
    v_lshl_add_u32 v7, v15, 3, v8
    v_mul_u32_u24 v8, 448, v7
    v_and_b32 v9, 3, v0
    v_lshl_add_u32 v8, v9, 3, v8
    v_and_b32 v9, 1, v15
    v_lshlrev_b32 v9, 5, v9
    s_add_u32 s37, s34, s36
    s_lshl_b32 s38, s37, 6
    s_add_u32 s39, s38, 16384
    v_add3_u32 v4, v8, v9, s39
    s_add_u32 s39, s39, 32
    v_sub_u32 v5, v8, v9
    v_add_u32 v5, s39, v5
    s_cmp_eq_u32 s36, 0
    s_cselect_b32 s40, 12, 0
    s_add_u32 s40, s40, s34
    s_lshl_b32 s41, s40, 5
    s_add_u32 s39, s41, 16384
    s_cmp_eq_u32 s34, 0
    s_cselect_b64 vcc, -1, 0
    v_add_u32 v10, v8, v9
    v_sub_u32 v11, v8, v9
    v_cndmask_b32 v6, v11, v10, vcc
    v_add_u32 v6, s39, v6
    v_lshlrev_b32 v8, 3, v15
    v_add_u32 v8, 151552, v8
    v_add_u32 v234, s38, v8
    v_add_u32 v235, s41, v8
    s_getpc_b64 s[40:41]
gated__pc:
    s_sub_u32 s40, s40, gated__pc-gated_mix__spectral_gfnet__dense_activation_gelu__prompt_kernel
    s_subb_u32 s41, s41, 0
    s_and_b32 s41, s41, 0xffff
    s_mov_b32 s42, gated__last-gated_mix__spectral_gfnet__dense_activation_gelu__prompt_kernel
    s_mov_b32 s43, 0x00020000
    v_lshlrev_b32 v236, 7, v0
    s_lshr_b32 s44, s2, 3
    s_lshl_b32 s44, s44, 2
    s_add_u32 s44, s44, s30
    s_and_b32 s45, s44, 15
    s_lshl_b32 s45, s45, 13
    s_bitcmp1_b32 s44, 4
    s_cbranch_scc1 gated__pft
    buffer_load_dword v237, v236, s[40:43], s45 offen
    s_branch gated__pfd
gated__pft:
    buffer_load_dword v237, v236, s[16:19], s45 offen
gated__pfd:
    s_waitcnt lgkmcnt(0)
    s_mov_b32 s12, s86
    s_and_b32 s13, s87, 0xffff
    s_mov_b32 s14, 42467328
    s_mov_b32 s15, 0x00020000
    s_lshl_b32 s38, s32, 1
    s_add_u32 s38, s38, s34
    s_and_b32 s39, s38, 7
    s_lshl_b32 s40, s38, 7
    s_lshr_b32 s41, s38, 3
    s_mul_i32 s41, s41, 458752
    s_add_u32 s41, s41, 14680064
    s_and_b32 s42, s87, 0xffff
    s_and_b32 s43, s77, 0xffff
    s_mov_b32 s22, 42467328
    s_cmp_eq_u32 s39, 3
    s_cselect_b32 s20, s86, s76
    s_cselect_b32 s21, s42, s43
    s_cselect_b32 s22, s22, 7340032
    s_mov_b32 s23, 0x00020000
    s_cselect_b32 s39, 7, 11
    s_cselect_b32 s47, s41, s40
    s_lshl_b32 s56, 8, s39
    s_mul_i32 s38, s31, 224
    s_mul_i32 s38, s38, s56
    s_add_u32 s47, s47, s38
    v_lshrrev_b32 v230, 3, v0
    v_lshlrev_b32 v230, s39, v230
    v_and_b32 v231, 7, v0
    v_lshlrev_b32 v232, 1, v15
    v_xor_b32 v231, v231, v232
    v_lshl_add_u32 v230, v231, 4, v230
    s_mul_i32 s46, s28, 917504
    s_mul_i32 s38, s31, 458752
    s_add_u32 s46, s46, s38
    s_lshl_b32 s37, s30, 12
    s_add_u32 s37, s37, 135168
    v_lshlrev_b32 v8, 6, v7
    v_and_b32 v10, 3, v0
    v_lshl_add_u32 v8, v10, 3, v8
    v_add3_u32 v8, v8, v9, s37
    v_xor_b32 v9, 32, v8
    v_lshlrev_b32 v10, 2, v15
    v_xor_b32 v10, v10, v14
    v_lshlrev_b32 v10, 3, v10
    v_lshl_add_u32 v10, v14, 8, v10
    v_add_u32 v10, s37, v10
    s_barrier
    ds_read_b64_tr_b16 v[16:17], v8 offset:0
    ds_read_b64_tr_b16 v[18:19], v8 offset:256
    ds_read_b64_tr_b16 v[20:21], v9 offset:0
    ds_read_b64_tr_b16 v[22:23], v9 offset:256
    ds_read_b64_tr_b16 v[24:25], v8 offset:2048
    ds_read_b64_tr_b16 v[26:27], v8 offset:2304
    ds_read_b64_tr_b16 v[28:29], v9 offset:2048
    ds_read_b64_tr_b16 v[30:31], v9 offset:2304
    s_waitcnt vmcnt(1) lgkmcnt(0)
    v_mfma_f32_16x16x32_bf16 v[32:35], v[16:19], v[104:107], 0
    v_mfma_f32_16x16x32_bf16 v[36:39], v[16:19], v[108:111], 0
    v_mfma_f32_16x16x32_bf16 v[40:43], v[20:23], v[104:107], 0
    v_mfma_f32_16x16x32_bf16 v[44:47], v[20:23], v[108:111], 0
    v_mfma_f32_16x16x32_bf16 v[48:51], v[24:27], v[104:107], 0
    v_mfma_f32_16x16x32_bf16 v[52:55], v[24:27], v[108:111], 0
    v_mfma_f32_16x16x32_bf16 v[56:59], v[28:31], v[104:107], 0
    v_mfma_f32_16x16x32_bf16 v[60:63], v[28:31], v[108:111], 0
    s_nop 0
    v_pk_mul_f32 v[64:65], v[32:33], v[112:113]
    v_pk_mul_f32 v[72:73], v[32:33], v[116:117]
    v_pk_mul_f32 v[66:67], v[34:35], v[114:115]
    v_pk_mul_f32 v[74:75], v[34:35], v[118:119]
    v_pk_fma_f32 v[64:65], v[36:37], v[116:117], v[64:65] neg_lo:[1,0,0] neg_hi:[1,0,0]
    v_pk_fma_f32 v[72:73], v[36:37], v[112:113], v[72:73]
    v_pk_fma_f32 v[66:67], v[38:39], v[118:119], v[66:67] neg_lo:[1,0,0] neg_hi:[1,0,0]
    v_pk_fma_f32 v[74:75], v[38:39], v[114:115], v[74:75]
    v_pk_mul_f32 v[68:69], v[40:41], v[120:121]
    v_pk_mul_f32 v[76:77], v[40:41], v[124:125]
    v_pk_mul_f32 v[70:71], v[42:43], v[122:123]
    v_pk_mul_f32 v[78:79], v[42:43], v[126:127]
    v_pk_fma_f32 v[68:69], v[44:45], v[124:125], v[68:69] neg_lo:[1,0,0] neg_hi:[1,0,0]
    v_pk_fma_f32 v[76:77], v[44:45], v[120:121], v[76:77]
    v_pk_fma_f32 v[70:71], v[46:47], v[126:127], v[70:71] neg_lo:[1,0,0] neg_hi:[1,0,0]
    v_pk_fma_f32 v[78:79], v[46:47], v[122:123], v[78:79]
    v_cvt_pk_bf16_f32 v16, v64, v65
    v_cvt_pk_bf16_f32 v17, v66, v67
    v_cvt_pk_bf16_f32 v18, v68, v69
    v_cvt_pk_bf16_f32 v19, v70, v71
    v_cvt_pk_bf16_f32 v20, v72, v73
    v_cvt_pk_bf16_f32 v21, v74, v75
    v_cvt_pk_bf16_f32 v22, v76, v77
    v_cvt_pk_bf16_f32 v23, v78, v79
    v_mfma_f32_16x16x32_bf16 v[32:35], v[128:131], v[16:19], 0
    v_mfma_f32_16x16x32_bf16 v[36:39], v[136:139], v[16:19], 0
    v_mfma_f32_16x16x32_bf16 v[40:43], v[144:147], v[16:19], 0
    v_mfma_f32_16x16x32_bf16 v[44:47], v[152:155], v[16:19], 0
    v_mfma_f32_16x16x32_bf16 v[176:179], v[160:163], v[16:19], 0
    v_mfma_f32_16x16x32_bf16 v[180:183], v[164:167], v[16:19], 0
    v_mfma_f32_16x16x32_bf16 v[184:187], v[168:171], v[20:23], 0
    v_mfma_f32_16x16x32_bf16 v[188:191], v[172:175], v[20:23], 0
    v_mfma_f32_16x16x32_bf16 v[32:35], v[132:135], v[20:23], v[32:35]
    v_mfma_f32_16x16x32_bf16 v[36:39], v[140:143], v[20:23], v[36:39]
    v_mfma_f32_16x16x32_bf16 v[40:43], v[148:151], v[20:23], v[40:43]
    v_mfma_f32_16x16x32_bf16 v[44:47], v[156:159], v[20:23], v[44:47]
    v_pk_mul_f32 v[80:81], v[48:49], v[112:113]
    v_pk_mul_f32 v[88:89], v[48:49], v[116:117]
    v_pk_mul_f32 v[82:83], v[50:51], v[114:115]
    v_pk_mul_f32 v[90:91], v[50:51], v[118:119]
    v_pk_fma_f32 v[80:81], v[52:53], v[116:117], v[80:81] neg_lo:[1,0,0] neg_hi:[1,0,0]
    v_pk_fma_f32 v[88:89], v[52:53], v[112:113], v[88:89]
    v_pk_fma_f32 v[82:83], v[54:55], v[118:119], v[82:83] neg_lo:[1,0,0] neg_hi:[1,0,0]
    v_pk_fma_f32 v[90:91], v[54:55], v[114:115], v[90:91]
    v_pk_mul_f32 v[84:85], v[56:57], v[120:121]
    v_pk_mul_f32 v[92:93], v[56:57], v[124:125]
    v_pk_mul_f32 v[86:87], v[58:59], v[122:123]
    v_pk_mul_f32 v[94:95], v[58:59], v[126:127]
    v_pk_fma_f32 v[84:85], v[60:61], v[124:125], v[84:85] neg_lo:[1,0,0] neg_hi:[1,0,0]
    v_pk_fma_f32 v[92:93], v[60:61], v[120:121], v[92:93]
    v_pk_fma_f32 v[86:87], v[62:63], v[126:127], v[86:87] neg_lo:[1,0,0] neg_hi:[1,0,0]
    v_pk_fma_f32 v[94:95], v[62:63], v[122:123], v[94:95]
    v_cvt_pk_bf16_f32 v24, v80, v81
    v_cvt_pk_bf16_f32 v25, v82, v83
    v_cvt_pk_bf16_f32 v26, v84, v85
    v_cvt_pk_bf16_f32 v27, v86, v87
    v_cvt_pk_bf16_f32 v28, v88, v89
    v_cvt_pk_bf16_f32 v29, v90, v91
    v_cvt_pk_bf16_f32 v30, v92, v93
    v_cvt_pk_bf16_f32 v31, v94, v95
    v_mfma_f32_16x16x32_bf16 v[48:51], v[128:131], v[24:27], 0
    v_mfma_f32_16x16x32_bf16 v[52:55], v[136:139], v[24:27], 0
    v_mfma_f32_16x16x32_bf16 v[56:59], v[144:147], v[24:27], 0
    v_mfma_f32_16x16x32_bf16 v[60:63], v[152:155], v[24:27], 0
    v_mfma_f32_16x16x32_bf16 v[192:195], v[160:163], v[24:27], 0
    v_mfma_f32_16x16x32_bf16 v[196:199], v[164:167], v[24:27], 0
    v_mfma_f32_16x16x32_bf16 v[200:203], v[168:171], v[28:31], 0
    v_mfma_f32_16x16x32_bf16 v[204:207], v[172:175], v[28:31], 0
    v_mfma_f32_16x16x32_bf16 v[48:51], v[132:135], v[28:31], v[48:51]
    v_mfma_f32_16x16x32_bf16 v[52:55], v[140:143], v[28:31], v[52:55]
    v_mfma_f32_16x16x32_bf16 v[56:59], v[148:151], v[28:31], v[56:59]
    v_mfma_f32_16x16x32_bf16 v[60:63], v[156:159], v[28:31], v[60:63]
    ds_read_b64 v[216:217], v234 offset:0
    ds_read_b64 v[218:219], v234 offset:32
    ds_read_b64 v[220:221], v234 offset:128
    ds_read_b64 v[222:223], v234 offset:160
    ds_read_b64 v[224:225], v234 offset:256
    ds_read_b64 v[226:227], v234 offset:288
    ds_read_b64 v[228:229], v235
    v_cvt_pk_bf16_f32 v64, v32, v33
    v_cvt_pk_bf16_f32 v66, v34, v35
    v_cvt_pk_bf16_f32 v68, v36, v37
    v_cvt_pk_bf16_f32 v70, v38, v39
    v_cvt_pk_bf16_f32 v72, v40, v41
    v_cvt_pk_bf16_f32 v74, v42, v43
    v_cvt_pk_bf16_f32 v76, v44, v45
    v_cvt_pk_bf16_f32 v78, v46, v47
    v_cvt_pk_bf16_f32 v65, v48, v49
    v_cvt_pk_bf16_f32 v67, v50, v51
    v_cvt_pk_bf16_f32 v69, v52, v53
    v_cvt_pk_bf16_f32 v71, v54, v55
    v_cvt_pk_bf16_f32 v73, v56, v57
    v_cvt_pk_bf16_f32 v75, v58, v59
    v_cvt_pk_bf16_f32 v77, v60, v61
    v_cvt_pk_bf16_f32 v79, v62, v63
    s_mov_b32 s38, 0x00010001
    s_mov_b32 s39, 0x00010001
    s_mov_b64 exec, s[38:39]
    v_cvt_pk_bf16_f32 v64, v176, v177
    v_cvt_pk_bf16_f32 v66, v178, v179
    v_cvt_pk_bf16_f32 v68, v180, v181
    v_cvt_pk_bf16_f32 v70, v182, v183
    v_cvt_pk_bf16_f32 v72, v184, v185
    v_cvt_pk_bf16_f32 v74, v186, v187
    v_cvt_pk_bf16_f32 v76, v188, v189
    v_cvt_pk_bf16_f32 v78, v190, v191
    v_cvt_pk_bf16_f32 v65, v192, v193
    v_cvt_pk_bf16_f32 v67, v194, v195
    v_cvt_pk_bf16_f32 v69, v196, v197
    v_cvt_pk_bf16_f32 v71, v198, v199
    v_cvt_pk_bf16_f32 v73, v200, v201
    v_cvt_pk_bf16_f32 v75, v202, v203
    v_cvt_pk_bf16_f32 v77, v204, v205
    v_cvt_pk_bf16_f32 v79, v206, v207
    s_mov_b64 exec, -1
    ds_write_b64 v10, v[64:65] offset:0
    ds_write_b64 v10, v[72:73] offset:128
    v_xor_b32 v11, 8, v10
    ds_write_b64 v11, v[66:67] offset:0
    ds_write_b64 v11, v[74:75] offset:128
    v_xor_b32 v11, 16, v10
    ds_write_b64 v11, v[68:69] offset:0
    ds_write_b64 v11, v[76:77] offset:128
    v_xor_b32 v11, 24, v10
    ds_write_b64 v11, v[70:71] offset:0
    ds_write_b64 v11, v[78:79] offset:128
    s_waitcnt lgkmcnt(8)
    v_lshlrev_b32 v104, 16, v216
    v_and_b32 v105, 0xffff0000, v216
    v_lshlrev_b32 v106, 16, v217
    v_and_b32 v107, 0xffff0000, v217
    v_lshlrev_b32 v120, 16, v218
    v_and_b32 v121, 0xffff0000, v218
    v_lshlrev_b32 v122, 16, v219
    v_and_b32 v123, 0xffff0000, v219
    v_lshlrev_b32 v136, 16, v220
    v_and_b32 v137, 0xffff0000, v220
    v_lshlrev_b32 v138, 16, v221
    v_and_b32 v139, 0xffff0000, v221
    v_lshlrev_b32 v152, 16, v222
    v_and_b32 v153, 0xffff0000, v222
    v_lshlrev_b32 v154, 16, v223
    v_and_b32 v155, 0xffff0000, v223
    v_lshlrev_b32 v168, 16, v224
    v_and_b32 v169, 0xffff0000, v224
    v_lshlrev_b32 v170, 16, v225
    v_and_b32 v171, 0xffff0000, v225
    v_lshlrev_b32 v184, 16, v226
    v_and_b32 v185, 0xffff0000, v226
    v_lshlrev_b32 v186, 16, v227
    v_and_b32 v187, 0xffff0000, v227
    v_lshlrev_b32 v200, 16, v228
    v_and_b32 v201, 0xffff0000, v228
    v_lshlrev_b32 v202, 16, v229
    v_and_b32 v203, 0xffff0000, v229
    v_pk_mov_b32 v[108:109], v[104:105], v[104:105] op_sel:[0,1]
    v_pk_mov_b32 v[110:111], v[106:107], v[106:107] op_sel:[0,1]
    v_pk_mov_b32 v[112:113], v[104:105], v[104:105] op_sel:[0,1]
    v_pk_mov_b32 v[114:115], v[106:107], v[106:107] op_sel:[0,1]
    v_pk_mov_b32 v[116:117], v[104:105], v[104:105] op_sel:[0,1]
    v_pk_mov_b32 v[118:119], v[106:107], v[106:107] op_sel:[0,1]
    v_pk_mov_b32 v[124:125], v[120:121], v[120:121] op_sel:[0,1]
    v_pk_mov_b32 v[126:127], v[122:123], v[122:123] op_sel:[0,1]
    v_pk_mov_b32 v[128:129], v[120:121], v[120:121] op_sel:[0,1]
    v_pk_mov_b32 v[130:131], v[122:123], v[122:123] op_sel:[0,1]
    v_pk_mov_b32 v[132:133], v[120:121], v[120:121] op_sel:[0,1]
    v_pk_mov_b32 v[134:135], v[122:123], v[122:123] op_sel:[0,1]
    v_pk_mov_b32 v[140:141], v[136:137], v[136:137] op_sel:[0,1]
    v_pk_mov_b32 v[142:143], v[138:139], v[138:139] op_sel:[0,1]
    v_pk_mov_b32 v[144:145], v[136:137], v[136:137] op_sel:[0,1]
    v_pk_mov_b32 v[146:147], v[138:139], v[138:139] op_sel:[0,1]
    v_pk_mov_b32 v[148:149], v[136:137], v[136:137] op_sel:[0,1]
    v_pk_mov_b32 v[150:151], v[138:139], v[138:139] op_sel:[0,1]
    v_pk_mov_b32 v[156:157], v[152:153], v[152:153] op_sel:[0,1]
    v_pk_mov_b32 v[158:159], v[154:155], v[154:155] op_sel:[0,1]
    v_pk_mov_b32 v[160:161], v[152:153], v[152:153] op_sel:[0,1]
    v_pk_mov_b32 v[162:163], v[154:155], v[154:155] op_sel:[0,1]
    v_pk_mov_b32 v[164:165], v[152:153], v[152:153] op_sel:[0,1]
    v_pk_mov_b32 v[166:167], v[154:155], v[154:155] op_sel:[0,1]
    v_pk_mov_b32 v[172:173], v[168:169], v[168:169] op_sel:[0,1]
    v_pk_mov_b32 v[174:175], v[170:171], v[170:171] op_sel:[0,1]
    v_pk_mov_b32 v[176:177], v[168:169], v[168:169] op_sel:[0,1]
    v_pk_mov_b32 v[178:179], v[170:171], v[170:171] op_sel:[0,1]
    v_pk_mov_b32 v[180:181], v[168:169], v[168:169] op_sel:[0,1]
    v_pk_mov_b32 v[182:183], v[170:171], v[170:171] op_sel:[0,1]
    v_pk_mov_b32 v[188:189], v[184:185], v[184:185] op_sel:[0,1]
    v_pk_mov_b32 v[190:191], v[186:187], v[186:187] op_sel:[0,1]
    v_pk_mov_b32 v[192:193], v[184:185], v[184:185] op_sel:[0,1]
    v_pk_mov_b32 v[194:195], v[186:187], v[186:187] op_sel:[0,1]
    v_pk_mov_b32 v[196:197], v[184:185], v[184:185] op_sel:[0,1]
    v_pk_mov_b32 v[198:199], v[186:187], v[186:187] op_sel:[0,1]
    v_pk_mov_b32 v[204:205], v[200:201], v[200:201] op_sel:[0,1]
    v_pk_mov_b32 v[206:207], v[202:203], v[202:203] op_sel:[0,1]
    v_pk_mov_b32 v[208:209], v[200:201], v[200:201] op_sel:[0,1]
    v_pk_mov_b32 v[210:211], v[202:203], v[202:203] op_sel:[0,1]
    v_pk_mov_b32 v[212:213], v[200:201], v[200:201] op_sel:[0,1]
    v_pk_mov_b32 v[214:215], v[202:203], v[202:203] op_sel:[0,1]
    s_waitcnt lgkmcnt(0)
    s_barrier
    ds_read_b64_tr_b16 v[48:49], v4 offset:0
    ds_read_b64_tr_b16 v[50:51], v4 offset:1792
    ds_read_b128 v[16:19], v2 offset:0
    ds_read_b128 v[20:23], v2 offset:2048
    ds_read_b128 v[24:27], v2 offset:4096
    ds_read_b128 v[28:31], v2 offset:6144
    ds_read_b64_tr_b16 v[52:53], v5 offset:0
    ds_read_b64_tr_b16 v[54:55], v5 offset:1792
    ds_read_b64_tr_b16 v[56:57], v4 offset:128
    ds_read_b64_tr_b16 v[58:59], v4 offset:1920
    ds_read_b64_tr_b16 v[60:61], v5 offset:128
    ds_read_b64_tr_b16 v[62:63], v5 offset:1920
    ds_read_b64_tr_b16 v[64:65], v4 offset:256
    ds_read_b64_tr_b16 v[66:67], v4 offset:2048
    ds_read_b64_tr_b16 v[68:69], v5 offset:256
    ds_read_b64_tr_b16 v[70:71], v5 offset:2048
    ds_read_b64_tr_b16 v[72:73], v6 offset:0
    ds_read_b64_tr_b16 v[74:75], v6 offset:1792
    s_mov_b32 s52, 0
    s_waitcnt lgkmcnt(0)
    v_mfma_f32_16x16x32_bf16 v[104:107], v[48:51], v[16:19], v[104:107]
    ds_read_b64_tr_b16 v[76:77], v4 offset:14336
    v_mfma_f32_16x16x32_bf16 v[108:111], v[48:51], v[20:23], v[108:111]
    ds_read_b64_tr_b16 v[78:79], v4 offset:16128
    v_mfma_f32_16x16x32_bf16 v[112:115], v[48:51], v[24:27], v[112:115]
    ds_read_b128 v[32:35], v3 offset:0
    v_mfma_f32_16x16x32_bf16 v[116:119], v[48:51], v[28:31], v[116:119]
    ds_read_b128 v[36:39], v3 offset:2048
    v_mfma_f32_16x16x32_bf16 v[120:123], v[52:55], v[16:19], v[120:123]
    ds_read_b128 v[40:43], v3 offset:4096
    v_mfma_f32_16x16x32_bf16 v[124:127], v[52:55], v[20:23], v[124:127]
    ds_read_b128 v[44:47], v3 offset:6144
    v_mfma_f32_16x16x32_bf16 v[128:131], v[52:55], v[24:27], v[128:131]
    ds_read_b64_tr_b16 v[80:81], v5 offset:14336
    v_mfma_f32_16x16x32_bf16 v[132:135], v[52:55], v[28:31], v[132:135]
    ds_read_b64_tr_b16 v[82:83], v5 offset:16128
    v_mfma_f32_16x16x32_bf16 v[136:139], v[56:59], v[16:19], v[136:139]
    ds_read_b64_tr_b16 v[84:85], v4 offset:14464
    v_mfma_f32_16x16x32_bf16 v[140:143], v[56:59], v[20:23], v[140:143]
    ds_read_b64_tr_b16 v[86:87], v4 offset:16256
    v_mfma_f32_16x16x32_bf16 v[144:147], v[56:59], v[24:27], v[144:147]
    ds_read_b64_tr_b16 v[88:89], v5 offset:14464
    v_mfma_f32_16x16x32_bf16 v[148:151], v[56:59], v[28:31], v[148:151]
    ds_read_b64_tr_b16 v[90:91], v5 offset:16256
    v_mfma_f32_16x16x32_bf16 v[152:155], v[60:63], v[16:19], v[152:155]
    ds_read_b64_tr_b16 v[92:93], v4 offset:14592
    v_mfma_f32_16x16x32_bf16 v[156:159], v[60:63], v[20:23], v[156:159]
    ds_read_b64_tr_b16 v[94:95], v4 offset:16384
    v_mfma_f32_16x16x32_bf16 v[160:163], v[60:63], v[24:27], v[160:163]
    ds_read_b64_tr_b16 v[96:97], v5 offset:14592
    v_mfma_f32_16x16x32_bf16 v[164:167], v[60:63], v[28:31], v[164:167]
    ds_read_b64_tr_b16 v[98:99], v5 offset:16384
    v_mfma_f32_16x16x32_bf16 v[168:171], v[64:67], v[16:19], v[168:171]
    ds_read_b64_tr_b16 v[100:101], v6 offset:14336
    v_mfma_f32_16x16x32_bf16 v[172:175], v[64:67], v[20:23], v[172:175]
    ds_read_b64_tr_b16 v[102:103], v6 offset:16128
    v_mfma_f32_16x16x32_bf16 v[176:179], v[64:67], v[24:27], v[176:179]
    v_mfma_f32_16x16x32_bf16 v[180:183], v[64:67], v[28:31], v[180:183]
    v_mfma_f32_16x16x32_bf16 v[184:187], v[68:71], v[16:19], v[184:187]
    v_mfma_f32_16x16x32_bf16 v[188:191], v[68:71], v[20:23], v[188:191]
    v_mfma_f32_16x16x32_bf16 v[192:195], v[68:71], v[24:27], v[192:195]
    v_mfma_f32_16x16x32_bf16 v[196:199], v[68:71], v[28:31], v[196:199]
    v_mfma_f32_16x16x32_bf16 v[200:203], v[72:75], v[16:19], v[200:203]
    v_mfma_f32_16x16x32_bf16 v[204:207], v[72:75], v[20:23], v[204:207]
    v_mfma_f32_16x16x32_bf16 v[208:211], v[72:75], v[24:27], v[208:211]
    v_mfma_f32_16x16x32_bf16 v[212:215], v[72:75], v[28:31], v[212:215]
    s_waitcnt  lgkmcnt(0)
    s_barrier
    v_add_u32 v2, 45056, v2
    v_add_u32 v3, 45056, v3
    v_add_u32 v4, 45056, v4
    v_add_u32 v5, 45056, v5
    v_add_u32 v6, 45056, v6
    v_mfma_f32_16x16x32_bf16 v[104:107], v[76:79], v[32:35], v[104:107]
    ds_read_b64_tr_b16 v[48:49], v4 offset:0
    v_mfma_f32_16x16x32_bf16 v[108:111], v[76:79], v[36:39], v[108:111]
    ds_read_b64_tr_b16 v[50:51], v4 offset:1792
    v_mfma_f32_16x16x32_bf16 v[112:115], v[76:79], v[40:43], v[112:115]
    ds_read_b128 v[16:19], v2 offset:0
    v_mfma_f32_16x16x32_bf16 v[116:119], v[76:79], v[44:47], v[116:119]
    ds_read_b128 v[20:23], v2 offset:2048
    v_mfma_f32_16x16x32_bf16 v[120:123], v[80:83], v[32:35], v[120:123]
    ds_read_b128 v[24:27], v2 offset:4096
    v_mfma_f32_16x16x32_bf16 v[124:127], v[80:83], v[36:39], v[124:127]
    ds_read_b128 v[28:31], v2 offset:6144
    v_mfma_f32_16x16x32_bf16 v[128:131], v[80:83], v[40:43], v[128:131]
    ds_read_b64_tr_b16 v[52:53], v5 offset:0
    v_mfma_f32_16x16x32_bf16 v[132:135], v[80:83], v[44:47], v[132:135]
    ds_read_b64_tr_b16 v[54:55], v5 offset:1792
    v_mfma_f32_16x16x32_bf16 v[136:139], v[84:87], v[32:35], v[136:139]
    ds_read_b64_tr_b16 v[56:57], v4 offset:128
    v_mfma_f32_16x16x32_bf16 v[140:143], v[84:87], v[36:39], v[140:143]
    ds_read_b64_tr_b16 v[58:59], v4 offset:1920
    v_mfma_f32_16x16x32_bf16 v[144:147], v[84:87], v[40:43], v[144:147]
    ds_read_b64_tr_b16 v[60:61], v5 offset:128
    v_mfma_f32_16x16x32_bf16 v[148:151], v[84:87], v[44:47], v[148:151]
    ds_read_b64_tr_b16 v[62:63], v5 offset:1920
    v_mfma_f32_16x16x32_bf16 v[152:155], v[88:91], v[32:35], v[152:155]
    ds_read_b64_tr_b16 v[64:65], v4 offset:256
    v_mfma_f32_16x16x32_bf16 v[156:159], v[88:91], v[36:39], v[156:159]
    ds_read_b64_tr_b16 v[66:67], v4 offset:2048
    v_mfma_f32_16x16x32_bf16 v[160:163], v[88:91], v[40:43], v[160:163]
    ds_read_b64_tr_b16 v[68:69], v5 offset:256
    v_mfma_f32_16x16x32_bf16 v[164:167], v[88:91], v[44:47], v[164:167]
    ds_read_b64_tr_b16 v[70:71], v5 offset:2048
    v_mfma_f32_16x16x32_bf16 v[168:171], v[92:95], v[32:35], v[168:171]
    ds_read_b64_tr_b16 v[72:73], v6 offset:0
    v_mfma_f32_16x16x32_bf16 v[172:175], v[92:95], v[36:39], v[172:175]
    ds_read_b64_tr_b16 v[74:75], v6 offset:1792
    v_mfma_f32_16x16x32_bf16 v[176:179], v[92:95], v[40:43], v[176:179]
    v_mfma_f32_16x16x32_bf16 v[180:183], v[92:95], v[44:47], v[180:183]
    v_mfma_f32_16x16x32_bf16 v[184:187], v[96:99], v[32:35], v[184:187]
    v_mfma_f32_16x16x32_bf16 v[188:191], v[96:99], v[36:39], v[188:191]
    v_mfma_f32_16x16x32_bf16 v[192:195], v[96:99], v[40:43], v[192:195]
    v_mfma_f32_16x16x32_bf16 v[196:199], v[96:99], v[44:47], v[196:199]
    v_mfma_f32_16x16x32_bf16 v[200:203], v[100:103], v[32:35], v[200:203]
    v_mfma_f32_16x16x32_bf16 v[204:207], v[100:103], v[36:39], v[204:207]
    v_mfma_f32_16x16x32_bf16 v[208:211], v[100:103], v[40:43], v[208:211]
    v_mfma_f32_16x16x32_bf16 v[212:215], v[100:103], v[44:47], v[212:215]
    s_waitcnt lgkmcnt(0)
    v_mfma_f32_16x16x32_bf16 v[104:107], v[48:51], v[16:19], v[104:107]
    ds_read_b64_tr_b16 v[76:77], v4 offset:14336
    v_mfma_f32_16x16x32_bf16 v[108:111], v[48:51], v[20:23], v[108:111]
    ds_read_b64_tr_b16 v[78:79], v4 offset:16128
    v_mfma_f32_16x16x32_bf16 v[112:115], v[48:51], v[24:27], v[112:115]
    ds_read_b128 v[32:35], v3 offset:0
    v_mfma_f32_16x16x32_bf16 v[116:119], v[48:51], v[28:31], v[116:119]
    ds_read_b128 v[36:39], v3 offset:2048
    v_mfma_f32_16x16x32_bf16 v[120:123], v[52:55], v[16:19], v[120:123]
    ds_read_b128 v[40:43], v3 offset:4096
    v_mfma_f32_16x16x32_bf16 v[124:127], v[52:55], v[20:23], v[124:127]
    ds_read_b128 v[44:47], v3 offset:6144
    v_mfma_f32_16x16x32_bf16 v[128:131], v[52:55], v[24:27], v[128:131]
    ds_read_b64_tr_b16 v[80:81], v5 offset:14336
    v_mfma_f32_16x16x32_bf16 v[132:135], v[52:55], v[28:31], v[132:135]
    ds_read_b64_tr_b16 v[82:83], v5 offset:16128
    v_mfma_f32_16x16x32_bf16 v[136:139], v[56:59], v[16:19], v[136:139]
    ds_read_b64_tr_b16 v[84:85], v4 offset:14464
    v_mfma_f32_16x16x32_bf16 v[140:143], v[56:59], v[20:23], v[140:143]
    ds_read_b64_tr_b16 v[86:87], v4 offset:16256
    v_mfma_f32_16x16x32_bf16 v[144:147], v[56:59], v[24:27], v[144:147]
    ds_read_b64_tr_b16 v[88:89], v5 offset:14464
    v_mfma_f32_16x16x32_bf16 v[148:151], v[56:59], v[28:31], v[148:151]
    ds_read_b64_tr_b16 v[90:91], v5 offset:16256
    v_mfma_f32_16x16x32_bf16 v[152:155], v[60:63], v[16:19], v[152:155]
    ds_read_b64_tr_b16 v[92:93], v4 offset:14592
    v_mfma_f32_16x16x32_bf16 v[156:159], v[60:63], v[20:23], v[156:159]
    ds_read_b64_tr_b16 v[94:95], v4 offset:16384
    v_mfma_f32_16x16x32_bf16 v[160:163], v[60:63], v[24:27], v[160:163]
    ds_read_b64_tr_b16 v[96:97], v5 offset:14592
    v_mfma_f32_16x16x32_bf16 v[164:167], v[60:63], v[28:31], v[164:167]
    ds_read_b64_tr_b16 v[98:99], v5 offset:16384
    v_mfma_f32_16x16x32_bf16 v[168:171], v[64:67], v[16:19], v[168:171]
    ds_read_b64_tr_b16 v[100:101], v6 offset:14336
    v_mfma_f32_16x16x32_bf16 v[172:175], v[64:67], v[20:23], v[172:175]
    ds_read_b64_tr_b16 v[102:103], v6 offset:16128
    v_mfma_f32_16x16x32_bf16 v[176:179], v[64:67], v[24:27], v[176:179]
    v_mfma_f32_16x16x32_bf16 v[180:183], v[64:67], v[28:31], v[180:183]
    v_mfma_f32_16x16x32_bf16 v[184:187], v[68:71], v[16:19], v[184:187]
    v_mfma_f32_16x16x32_bf16 v[188:191], v[68:71], v[20:23], v[188:191]
    v_mfma_f32_16x16x32_bf16 v[192:195], v[68:71], v[24:27], v[192:195]
    v_mfma_f32_16x16x32_bf16 v[196:199], v[68:71], v[28:31], v[196:199]
    v_mfma_f32_16x16x32_bf16 v[200:203], v[72:75], v[16:19], v[200:203]
    v_mfma_f32_16x16x32_bf16 v[204:207], v[72:75], v[20:23], v[204:207]
    v_mfma_f32_16x16x32_bf16 v[208:211], v[72:75], v[24:27], v[208:211]
    v_mfma_f32_16x16x32_bf16 v[212:215], v[72:75], v[28:31], v[212:215]
    s_waitcnt  lgkmcnt(0)
    s_barrier
    v_add_u32 v2, 45056, v2
    v_add_u32 v3, 45056, v3
    v_add_u32 v4, 45056, v4
    v_add_u32 v5, 45056, v5
    v_add_u32 v6, 45056, v6
    v_mfma_f32_16x16x32_bf16 v[104:107], v[76:79], v[32:35], v[104:107]
    ds_read_b64_tr_b16 v[48:49], v4 offset:0
    v_mfma_f32_16x16x32_bf16 v[108:111], v[76:79], v[36:39], v[108:111]
    ds_read_b64_tr_b16 v[50:51], v4 offset:1792
    v_mfma_f32_16x16x32_bf16 v[112:115], v[76:79], v[40:43], v[112:115]
    ds_read_b128 v[16:19], v2 offset:0
    v_mfma_f32_16x16x32_bf16 v[116:119], v[76:79], v[44:47], v[116:119]
    ds_read_b128 v[20:23], v2 offset:2048
    v_mfma_f32_16x16x32_bf16 v[120:123], v[80:83], v[32:35], v[120:123]
    ds_read_b128 v[24:27], v2 offset:4096
    v_mfma_f32_16x16x32_bf16 v[124:127], v[80:83], v[36:39], v[124:127]
    ds_read_b128 v[28:31], v2 offset:6144
    v_mfma_f32_16x16x32_bf16 v[128:131], v[80:83], v[40:43], v[128:131]
    ds_read_b64_tr_b16 v[52:53], v5 offset:0
    v_mfma_f32_16x16x32_bf16 v[132:135], v[80:83], v[44:47], v[132:135]
    ds_read_b64_tr_b16 v[54:55], v5 offset:1792
    v_mfma_f32_16x16x32_bf16 v[136:139], v[84:87], v[32:35], v[136:139]
    ds_read_b64_tr_b16 v[56:57], v4 offset:128
    v_mfma_f32_16x16x32_bf16 v[140:143], v[84:87], v[36:39], v[140:143]
    ds_read_b64_tr_b16 v[58:59], v4 offset:1920
    v_mfma_f32_16x16x32_bf16 v[144:147], v[84:87], v[40:43], v[144:147]
    ds_read_b64_tr_b16 v[60:61], v5 offset:128
    v_mfma_f32_16x16x32_bf16 v[148:151], v[84:87], v[44:47], v[148:151]
    ds_read_b64_tr_b16 v[62:63], v5 offset:1920
    v_mfma_f32_16x16x32_bf16 v[152:155], v[88:91], v[32:35], v[152:155]
    ds_read_b64_tr_b16 v[64:65], v4 offset:256
    v_mfma_f32_16x16x32_bf16 v[156:159], v[88:91], v[36:39], v[156:159]
    ds_read_b64_tr_b16 v[66:67], v4 offset:2048
    v_mfma_f32_16x16x32_bf16 v[160:163], v[88:91], v[40:43], v[160:163]
    ds_read_b64_tr_b16 v[68:69], v5 offset:256
    v_mfma_f32_16x16x32_bf16 v[164:167], v[88:91], v[44:47], v[164:167]
    ds_read_b64_tr_b16 v[70:71], v5 offset:2048
    v_mfma_f32_16x16x32_bf16 v[168:171], v[92:95], v[32:35], v[168:171]
    ds_read_b64_tr_b16 v[72:73], v6 offset:0
    v_mfma_f32_16x16x32_bf16 v[172:175], v[92:95], v[36:39], v[172:175]
    ds_read_b64_tr_b16 v[74:75], v6 offset:1792
    v_mfma_f32_16x16x32_bf16 v[176:179], v[92:95], v[40:43], v[176:179]
    v_mfma_f32_16x16x32_bf16 v[180:183], v[92:95], v[44:47], v[180:183]
    v_mfma_f32_16x16x32_bf16 v[184:187], v[96:99], v[32:35], v[184:187]
    v_mfma_f32_16x16x32_bf16 v[188:191], v[96:99], v[36:39], v[188:191]
    v_mfma_f32_16x16x32_bf16 v[192:195], v[96:99], v[40:43], v[192:195]
    v_mfma_f32_16x16x32_bf16 v[196:199], v[96:99], v[44:47], v[196:199]
    v_mfma_f32_16x16x32_bf16 v[200:203], v[100:103], v[32:35], v[200:203]
    v_mfma_f32_16x16x32_bf16 v[204:207], v[100:103], v[36:39], v[204:207]
    v_mfma_f32_16x16x32_bf16 v[208:211], v[100:103], v[40:43], v[208:211]
    v_mfma_f32_16x16x32_bf16 v[212:215], v[100:103], v[44:47], v[212:215]
    s_waitcnt lgkmcnt(0)
    v_mfma_f32_16x16x32_bf16 v[104:107], v[48:51], v[16:19], v[104:107]
    ds_read_b64_tr_b16 v[76:77], v4 offset:14336
    v_mfma_f32_16x16x32_bf16 v[108:111], v[48:51], v[20:23], v[108:111]
    ds_read_b64_tr_b16 v[78:79], v4 offset:16128
    v_mfma_f32_16x16x32_bf16 v[112:115], v[48:51], v[24:27], v[112:115]
    ds_read_b128 v[32:35], v3 offset:0
    v_mfma_f32_16x16x32_bf16 v[116:119], v[48:51], v[28:31], v[116:119]
    ds_read_b128 v[36:39], v3 offset:2048
    v_mfma_f32_16x16x32_bf16 v[120:123], v[52:55], v[16:19], v[120:123]
    ds_read_b128 v[40:43], v3 offset:4096
    v_mfma_f32_16x16x32_bf16 v[124:127], v[52:55], v[20:23], v[124:127]
    ds_read_b128 v[44:47], v3 offset:6144
    v_mfma_f32_16x16x32_bf16 v[128:131], v[52:55], v[24:27], v[128:131]
    ds_read_b64_tr_b16 v[80:81], v5 offset:14336
    v_mfma_f32_16x16x32_bf16 v[132:135], v[52:55], v[28:31], v[132:135]
    ds_read_b64_tr_b16 v[82:83], v5 offset:16128
    v_mfma_f32_16x16x32_bf16 v[136:139], v[56:59], v[16:19], v[136:139]
    ds_read_b64_tr_b16 v[84:85], v4 offset:14464
    v_mfma_f32_16x16x32_bf16 v[140:143], v[56:59], v[20:23], v[140:143]
    ds_read_b64_tr_b16 v[86:87], v4 offset:16256
    v_mfma_f32_16x16x32_bf16 v[144:147], v[56:59], v[24:27], v[144:147]
    ds_read_b64_tr_b16 v[88:89], v5 offset:14464
    v_mfma_f32_16x16x32_bf16 v[148:151], v[56:59], v[28:31], v[148:151]
    ds_read_b64_tr_b16 v[90:91], v5 offset:16256
    v_mfma_f32_16x16x32_bf16 v[152:155], v[60:63], v[16:19], v[152:155]
    ds_read_b64_tr_b16 v[92:93], v4 offset:14592
    v_mfma_f32_16x16x32_bf16 v[156:159], v[60:63], v[20:23], v[156:159]
    ds_read_b64_tr_b16 v[94:95], v4 offset:16384
    v_mfma_f32_16x16x32_bf16 v[160:163], v[60:63], v[24:27], v[160:163]
    ds_read_b64_tr_b16 v[96:97], v5 offset:14592
    v_mfma_f32_16x16x32_bf16 v[164:167], v[60:63], v[28:31], v[164:167]
    ds_read_b64_tr_b16 v[98:99], v5 offset:16384
    v_mfma_f32_16x16x32_bf16 v[168:171], v[64:67], v[16:19], v[168:171]
    ds_read_b64_tr_b16 v[100:101], v6 offset:14336
    v_mfma_f32_16x16x32_bf16 v[172:175], v[64:67], v[20:23], v[172:175]
    ds_read_b64_tr_b16 v[102:103], v6 offset:16128
    v_mfma_f32_16x16x32_bf16 v[176:179], v[64:67], v[24:27], v[176:179]
    v_mfma_f32_16x16x32_bf16 v[180:183], v[64:67], v[28:31], v[180:183]
    v_mfma_f32_16x16x32_bf16 v[184:187], v[68:71], v[16:19], v[184:187]
    v_mfma_f32_16x16x32_bf16 v[188:191], v[68:71], v[20:23], v[188:191]
    v_mfma_f32_16x16x32_bf16 v[192:195], v[68:71], v[24:27], v[192:195]
    v_mfma_f32_16x16x32_bf16 v[196:199], v[68:71], v[28:31], v[196:199]
    v_mfma_f32_16x16x32_bf16 v[200:203], v[72:75], v[16:19], v[200:203]
    v_mfma_f32_16x16x32_bf16 v[204:207], v[72:75], v[20:23], v[204:207]
    v_mfma_f32_16x16x32_bf16 v[208:211], v[72:75], v[24:27], v[208:211]
    v_mfma_f32_16x16x32_bf16 v[212:215], v[72:75], v[28:31], v[212:215]
    s_waitcnt  lgkmcnt(0)
    s_barrier
    v_add_u32 v2, 4294877184, v2
    v_add_u32 v3, 4294877184, v3
    v_add_u32 v4, 4294877184, v4
    v_add_u32 v5, 4294877184, v5
    v_add_u32 v6, 4294877184, v6
    v_mfma_f32_16x16x32_bf16 v[104:107], v[76:79], v[32:35], v[104:107]
    ds_read_b64_tr_b16 v[48:49], v4 offset:0
    v_mfma_f32_16x16x32_bf16 v[108:111], v[76:79], v[36:39], v[108:111]
    ds_read_b64_tr_b16 v[50:51], v4 offset:1792
    v_mfma_f32_16x16x32_bf16 v[112:115], v[76:79], v[40:43], v[112:115]
    ds_read_b128 v[16:19], v2 offset:0
    v_mfma_f32_16x16x32_bf16 v[116:119], v[76:79], v[44:47], v[116:119]
    ds_read_b128 v[20:23], v2 offset:2048
    v_mfma_f32_16x16x32_bf16 v[120:123], v[80:83], v[32:35], v[120:123]
    ds_read_b128 v[24:27], v2 offset:4096
    v_mfma_f32_16x16x32_bf16 v[124:127], v[80:83], v[36:39], v[124:127]
    ds_read_b128 v[28:31], v2 offset:6144
    v_mfma_f32_16x16x32_bf16 v[128:131], v[80:83], v[40:43], v[128:131]
    ds_read_b64_tr_b16 v[52:53], v5 offset:0
    v_mfma_f32_16x16x32_bf16 v[132:135], v[80:83], v[44:47], v[132:135]
    ds_read_b64_tr_b16 v[54:55], v5 offset:1792
    v_mfma_f32_16x16x32_bf16 v[136:139], v[84:87], v[32:35], v[136:139]
    ds_read_b64_tr_b16 v[56:57], v4 offset:128
    v_mfma_f32_16x16x32_bf16 v[140:143], v[84:87], v[36:39], v[140:143]
    ds_read_b64_tr_b16 v[58:59], v4 offset:1920
    v_mfma_f32_16x16x32_bf16 v[144:147], v[84:87], v[40:43], v[144:147]
    ds_read_b64_tr_b16 v[60:61], v5 offset:128
    v_mfma_f32_16x16x32_bf16 v[148:151], v[84:87], v[44:47], v[148:151]
    ds_read_b64_tr_b16 v[62:63], v5 offset:1920
    v_mfma_f32_16x16x32_bf16 v[152:155], v[88:91], v[32:35], v[152:155]
    ds_read_b64_tr_b16 v[64:65], v4 offset:256
    v_mfma_f32_16x16x32_bf16 v[156:159], v[88:91], v[36:39], v[156:159]
    ds_read_b64_tr_b16 v[66:67], v4 offset:2048
    v_mfma_f32_16x16x32_bf16 v[160:163], v[88:91], v[40:43], v[160:163]
    ds_read_b64_tr_b16 v[68:69], v5 offset:256
    v_mfma_f32_16x16x32_bf16 v[164:167], v[88:91], v[44:47], v[164:167]
    ds_read_b64_tr_b16 v[70:71], v5 offset:2048
    v_mfma_f32_16x16x32_bf16 v[168:171], v[92:95], v[32:35], v[168:171]
    ds_read_b64_tr_b16 v[72:73], v6 offset:0
    v_mfma_f32_16x16x32_bf16 v[172:175], v[92:95], v[36:39], v[172:175]
    ds_read_b64_tr_b16 v[74:75], v6 offset:1792
    v_mfma_f32_16x16x32_bf16 v[176:179], v[92:95], v[40:43], v[176:179]
    v_mfma_f32_16x16x32_bf16 v[180:183], v[92:95], v[44:47], v[180:183]
    v_mfma_f32_16x16x32_bf16 v[184:187], v[96:99], v[32:35], v[184:187]
    v_mfma_f32_16x16x32_bf16 v[188:191], v[96:99], v[36:39], v[188:191]
    v_mfma_f32_16x16x32_bf16 v[192:195], v[96:99], v[40:43], v[192:195]
    v_mfma_f32_16x16x32_bf16 v[196:199], v[96:99], v[44:47], v[196:199]
    v_mfma_f32_16x16x32_bf16 v[200:203], v[100:103], v[32:35], v[200:203]
    v_mfma_f32_16x16x32_bf16 v[204:207], v[100:103], v[36:39], v[204:207]
    v_mfma_f32_16x16x32_bf16 v[208:211], v[100:103], v[40:43], v[208:211]
    v_mfma_f32_16x16x32_bf16 v[212:215], v[100:103], v[44:47], v[212:215]
    s_waitcnt lgkmcnt(0)
    v_mfma_f32_16x16x32_bf16 v[104:107], v[48:51], v[16:19], v[104:107]
    ds_read_b64_tr_b16 v[76:77], v4 offset:14336
    v_mfma_f32_16x16x32_bf16 v[108:111], v[48:51], v[20:23], v[108:111]
    ds_read_b64_tr_b16 v[78:79], v4 offset:16128
    v_mfma_f32_16x16x32_bf16 v[112:115], v[48:51], v[24:27], v[112:115]
    ds_read_b128 v[32:35], v3 offset:0
    v_mfma_f32_16x16x32_bf16 v[116:119], v[48:51], v[28:31], v[116:119]
    ds_read_b128 v[36:39], v3 offset:2048
    v_mfma_f32_16x16x32_bf16 v[120:123], v[52:55], v[16:19], v[120:123]
    ds_read_b128 v[40:43], v3 offset:4096
    v_mfma_f32_16x16x32_bf16 v[124:127], v[52:55], v[20:23], v[124:127]
    ds_read_b128 v[44:47], v3 offset:6144
    v_mfma_f32_16x16x32_bf16 v[128:131], v[52:55], v[24:27], v[128:131]
    ds_read_b64_tr_b16 v[80:81], v5 offset:14336
    v_mfma_f32_16x16x32_bf16 v[132:135], v[52:55], v[28:31], v[132:135]
    ds_read_b64_tr_b16 v[82:83], v5 offset:16128
    v_mfma_f32_16x16x32_bf16 v[136:139], v[56:59], v[16:19], v[136:139]
    ds_read_b64_tr_b16 v[84:85], v4 offset:14464
    v_mfma_f32_16x16x32_bf16 v[140:143], v[56:59], v[20:23], v[140:143]
    ds_read_b64_tr_b16 v[86:87], v4 offset:16256
    v_mfma_f32_16x16x32_bf16 v[144:147], v[56:59], v[24:27], v[144:147]
    ds_read_b64_tr_b16 v[88:89], v5 offset:14464
    v_mfma_f32_16x16x32_bf16 v[148:151], v[56:59], v[28:31], v[148:151]
    ds_read_b64_tr_b16 v[90:91], v5 offset:16256
    v_mfma_f32_16x16x32_bf16 v[152:155], v[60:63], v[16:19], v[152:155]
    ds_read_b64_tr_b16 v[92:93], v4 offset:14592
    v_mfma_f32_16x16x32_bf16 v[156:159], v[60:63], v[20:23], v[156:159]
    ds_read_b64_tr_b16 v[94:95], v4 offset:16384
    v_mfma_f32_16x16x32_bf16 v[160:163], v[60:63], v[24:27], v[160:163]
    ds_read_b64_tr_b16 v[96:97], v5 offset:14592
    v_mfma_f32_16x16x32_bf16 v[164:167], v[60:63], v[28:31], v[164:167]
    ds_read_b64_tr_b16 v[98:99], v5 offset:16384
    v_mfma_f32_16x16x32_bf16 v[168:171], v[64:67], v[16:19], v[168:171]
    ds_read_b64_tr_b16 v[100:101], v6 offset:14336
    v_mfma_f32_16x16x32_bf16 v[172:175], v[64:67], v[20:23], v[172:175]
    ds_read_b64_tr_b16 v[102:103], v6 offset:16128
    v_mfma_f32_16x16x32_bf16 v[176:179], v[64:67], v[24:27], v[176:179]
    v_mfma_f32_16x16x32_bf16 v[180:183], v[64:67], v[28:31], v[180:183]
    v_mfma_f32_16x16x32_bf16 v[184:187], v[68:71], v[16:19], v[184:187]
    v_mfma_f32_16x16x32_bf16 v[188:191], v[68:71], v[20:23], v[188:191]
    v_mfma_f32_16x16x32_bf16 v[192:195], v[68:71], v[24:27], v[192:195]
    v_mfma_f32_16x16x32_bf16 v[196:199], v[68:71], v[28:31], v[196:199]
    v_mfma_f32_16x16x32_bf16 v[200:203], v[72:75], v[16:19], v[200:203]
    v_mfma_f32_16x16x32_bf16 v[204:207], v[72:75], v[20:23], v[204:207]
    v_mfma_f32_16x16x32_bf16 v[208:211], v[72:75], v[24:27], v[208:211]
    v_mfma_f32_16x16x32_bf16 v[212:215], v[72:75], v[28:31], v[212:215]
    s_waitcnt  lgkmcnt(0)
    s_barrier
    v_add_u32 v2, 45056, v2
    v_add_u32 v3, 45056, v3
    v_add_u32 v4, 45056, v4
    v_add_u32 v5, 45056, v5
    v_add_u32 v6, 45056, v6
    v_mfma_f32_16x16x32_bf16 v[104:107], v[76:79], v[32:35], v[104:107]
    ds_read_b64_tr_b16 v[48:49], v4 offset:0
    v_mfma_f32_16x16x32_bf16 v[108:111], v[76:79], v[36:39], v[108:111]
    ds_read_b64_tr_b16 v[50:51], v4 offset:1792
    v_mfma_f32_16x16x32_bf16 v[112:115], v[76:79], v[40:43], v[112:115]
    ds_read_b128 v[16:19], v2 offset:0
    v_mfma_f32_16x16x32_bf16 v[116:119], v[76:79], v[44:47], v[116:119]
    ds_read_b128 v[20:23], v2 offset:2048
    v_mfma_f32_16x16x32_bf16 v[120:123], v[80:83], v[32:35], v[120:123]
    ds_read_b128 v[24:27], v2 offset:4096
    v_mfma_f32_16x16x32_bf16 v[124:127], v[80:83], v[36:39], v[124:127]
    ds_read_b128 v[28:31], v2 offset:6144
    v_mfma_f32_16x16x32_bf16 v[128:131], v[80:83], v[40:43], v[128:131]
    ds_read_b64_tr_b16 v[52:53], v5 offset:0
    v_mfma_f32_16x16x32_bf16 v[132:135], v[80:83], v[44:47], v[132:135]
    ds_read_b64_tr_b16 v[54:55], v5 offset:1792
    v_mfma_f32_16x16x32_bf16 v[136:139], v[84:87], v[32:35], v[136:139]
    ds_read_b64_tr_b16 v[56:57], v4 offset:128
    v_mfma_f32_16x16x32_bf16 v[140:143], v[84:87], v[36:39], v[140:143]
    ds_read_b64_tr_b16 v[58:59], v4 offset:1920
    v_mfma_f32_16x16x32_bf16 v[144:147], v[84:87], v[40:43], v[144:147]
    ds_read_b64_tr_b16 v[60:61], v5 offset:128
    v_mfma_f32_16x16x32_bf16 v[148:151], v[84:87], v[44:47], v[148:151]
    ds_read_b64_tr_b16 v[62:63], v5 offset:1920
    v_mfma_f32_16x16x32_bf16 v[152:155], v[88:91], v[32:35], v[152:155]
    ds_read_b64_tr_b16 v[64:65], v4 offset:256
    v_mfma_f32_16x16x32_bf16 v[156:159], v[88:91], v[36:39], v[156:159]
    ds_read_b64_tr_b16 v[66:67], v4 offset:2048
    v_mfma_f32_16x16x32_bf16 v[160:163], v[88:91], v[40:43], v[160:163]
    ds_read_b64_tr_b16 v[68:69], v5 offset:256
    v_mfma_f32_16x16x32_bf16 v[164:167], v[88:91], v[44:47], v[164:167]
    ds_read_b64_tr_b16 v[70:71], v5 offset:2048
    v_mfma_f32_16x16x32_bf16 v[168:171], v[92:95], v[32:35], v[168:171]
    ds_read_b64_tr_b16 v[72:73], v6 offset:0
    v_mfma_f32_16x16x32_bf16 v[172:175], v[92:95], v[36:39], v[172:175]
    ds_read_b64_tr_b16 v[74:75], v6 offset:1792
    v_mfma_f32_16x16x32_bf16 v[176:179], v[92:95], v[40:43], v[176:179]
    v_mfma_f32_16x16x32_bf16 v[180:183], v[92:95], v[44:47], v[180:183]
    v_mfma_f32_16x16x32_bf16 v[184:187], v[96:99], v[32:35], v[184:187]
    v_mfma_f32_16x16x32_bf16 v[188:191], v[96:99], v[36:39], v[188:191]
    v_mfma_f32_16x16x32_bf16 v[192:195], v[96:99], v[40:43], v[192:195]
    v_mfma_f32_16x16x32_bf16 v[196:199], v[96:99], v[44:47], v[196:199]
    v_mfma_f32_16x16x32_bf16 v[200:203], v[100:103], v[32:35], v[200:203]
    v_mfma_f32_16x16x32_bf16 v[204:207], v[100:103], v[36:39], v[204:207]
    v_mfma_f32_16x16x32_bf16 v[208:211], v[100:103], v[40:43], v[208:211]
    v_mfma_f32_16x16x32_bf16 v[212:215], v[100:103], v[44:47], v[212:215]
    s_waitcnt lgkmcnt(0)
    v_mfma_f32_16x16x32_bf16 v[104:107], v[48:51], v[16:19], v[104:107]
    ds_read_b64_tr_b16 v[76:77], v4 offset:14336
    v_mfma_f32_16x16x32_bf16 v[108:111], v[48:51], v[20:23], v[108:111]
    ds_read_b64_tr_b16 v[78:79], v4 offset:16128
    v_mfma_f32_16x16x32_bf16 v[112:115], v[48:51], v[24:27], v[112:115]
    ds_read_b128 v[32:35], v3 offset:0
    v_mfma_f32_16x16x32_bf16 v[116:119], v[48:51], v[28:31], v[116:119]
    ds_read_b128 v[36:39], v3 offset:2048
    v_mfma_f32_16x16x32_bf16 v[120:123], v[52:55], v[16:19], v[120:123]
    ds_read_b128 v[40:43], v3 offset:4096
    v_mfma_f32_16x16x32_bf16 v[124:127], v[52:55], v[20:23], v[124:127]
    ds_read_b128 v[44:47], v3 offset:6144
    v_mfma_f32_16x16x32_bf16 v[128:131], v[52:55], v[24:27], v[128:131]
    ds_read_b64_tr_b16 v[80:81], v5 offset:14336
    v_mfma_f32_16x16x32_bf16 v[132:135], v[52:55], v[28:31], v[132:135]
    ds_read_b64_tr_b16 v[82:83], v5 offset:16128
    v_mfma_f32_16x16x32_bf16 v[136:139], v[56:59], v[16:19], v[136:139]
    ds_read_b64_tr_b16 v[84:85], v4 offset:14464
    v_mfma_f32_16x16x32_bf16 v[140:143], v[56:59], v[20:23], v[140:143]
    ds_read_b64_tr_b16 v[86:87], v4 offset:16256
    v_mfma_f32_16x16x32_bf16 v[144:147], v[56:59], v[24:27], v[144:147]
    ds_read_b64_tr_b16 v[88:89], v5 offset:14464
    v_mfma_f32_16x16x32_bf16 v[148:151], v[56:59], v[28:31], v[148:151]
    ds_read_b64_tr_b16 v[90:91], v5 offset:16256
    v_mfma_f32_16x16x32_bf16 v[152:155], v[60:63], v[16:19], v[152:155]
    ds_read_b64_tr_b16 v[92:93], v4 offset:14592
    v_mfma_f32_16x16x32_bf16 v[156:159], v[60:63], v[20:23], v[156:159]
    ds_read_b64_tr_b16 v[94:95], v4 offset:16384
    v_mfma_f32_16x16x32_bf16 v[160:163], v[60:63], v[24:27], v[160:163]
    ds_read_b64_tr_b16 v[96:97], v5 offset:14592
    v_mfma_f32_16x16x32_bf16 v[164:167], v[60:63], v[28:31], v[164:167]
    ds_read_b64_tr_b16 v[98:99], v5 offset:16384
    v_mfma_f32_16x16x32_bf16 v[168:171], v[64:67], v[16:19], v[168:171]
    ds_read_b64_tr_b16 v[100:101], v6 offset:14336
    v_mfma_f32_16x16x32_bf16 v[172:175], v[64:67], v[20:23], v[172:175]
    ds_read_b64_tr_b16 v[102:103], v6 offset:16128
    v_mfma_f32_16x16x32_bf16 v[176:179], v[64:67], v[24:27], v[176:179]
    v_mfma_f32_16x16x32_bf16 v[180:183], v[64:67], v[28:31], v[180:183]
    v_mfma_f32_16x16x32_bf16 v[184:187], v[68:71], v[16:19], v[184:187]
    v_mfma_f32_16x16x32_bf16 v[188:191], v[68:71], v[20:23], v[188:191]
    v_mfma_f32_16x16x32_bf16 v[192:195], v[68:71], v[24:27], v[192:195]
    v_mfma_f32_16x16x32_bf16 v[196:199], v[68:71], v[28:31], v[196:199]
    v_mfma_f32_16x16x32_bf16 v[200:203], v[72:75], v[16:19], v[200:203]
    v_mfma_f32_16x16x32_bf16 v[204:207], v[72:75], v[20:23], v[204:207]
    v_mfma_f32_16x16x32_bf16 v[208:211], v[72:75], v[24:27], v[208:211]
    v_mfma_f32_16x16x32_bf16 v[212:215], v[72:75], v[28:31], v[212:215]
    s_waitcnt  lgkmcnt(0)
    s_barrier
    v_add_u32 v2, 45056, v2
    v_add_u32 v3, 45056, v3
    v_add_u32 v4, 45056, v4
    v_add_u32 v5, 45056, v5
    v_add_u32 v6, 45056, v6
    v_mfma_f32_16x16x32_bf16 v[104:107], v[76:79], v[32:35], v[104:107]
    ds_read_b64_tr_b16 v[48:49], v4 offset:0
    v_mfma_f32_16x16x32_bf16 v[108:111], v[76:79], v[36:39], v[108:111]
    ds_read_b64_tr_b16 v[50:51], v4 offset:1792
    v_mfma_f32_16x16x32_bf16 v[112:115], v[76:79], v[40:43], v[112:115]
    ds_read_b128 v[16:19], v2 offset:0
    v_mfma_f32_16x16x32_bf16 v[116:119], v[76:79], v[44:47], v[116:119]
    ds_read_b128 v[20:23], v2 offset:2048
    v_mfma_f32_16x16x32_bf16 v[120:123], v[80:83], v[32:35], v[120:123]
    ds_read_b128 v[24:27], v2 offset:4096
    v_mfma_f32_16x16x32_bf16 v[124:127], v[80:83], v[36:39], v[124:127]
    ds_read_b128 v[28:31], v2 offset:6144
    v_mfma_f32_16x16x32_bf16 v[128:131], v[80:83], v[40:43], v[128:131]
    ds_read_b64_tr_b16 v[52:53], v5 offset:0
    v_mfma_f32_16x16x32_bf16 v[132:135], v[80:83], v[44:47], v[132:135]
    ds_read_b64_tr_b16 v[54:55], v5 offset:1792
    v_mfma_f32_16x16x32_bf16 v[136:139], v[84:87], v[32:35], v[136:139]
    ds_read_b64_tr_b16 v[56:57], v4 offset:128
    v_mfma_f32_16x16x32_bf16 v[140:143], v[84:87], v[36:39], v[140:143]
    ds_read_b64_tr_b16 v[58:59], v4 offset:1920
    v_mfma_f32_16x16x32_bf16 v[144:147], v[84:87], v[40:43], v[144:147]
    ds_read_b64_tr_b16 v[60:61], v5 offset:128
    v_mfma_f32_16x16x32_bf16 v[148:151], v[84:87], v[44:47], v[148:151]
    ds_read_b64_tr_b16 v[62:63], v5 offset:1920
    v_mfma_f32_16x16x32_bf16 v[152:155], v[88:91], v[32:35], v[152:155]
    ds_read_b64_tr_b16 v[64:65], v4 offset:256
    v_mfma_f32_16x16x32_bf16 v[156:159], v[88:91], v[36:39], v[156:159]
    ds_read_b64_tr_b16 v[66:67], v4 offset:2048
    v_mfma_f32_16x16x32_bf16 v[160:163], v[88:91], v[40:43], v[160:163]
    ds_read_b64_tr_b16 v[68:69], v5 offset:256
    v_mfma_f32_16x16x32_bf16 v[164:167], v[88:91], v[44:47], v[164:167]
    ds_read_b64_tr_b16 v[70:71], v5 offset:2048
    v_mfma_f32_16x16x32_bf16 v[168:171], v[92:95], v[32:35], v[168:171]
    ds_read_b64_tr_b16 v[72:73], v6 offset:0
    v_mfma_f32_16x16x32_bf16 v[172:175], v[92:95], v[36:39], v[172:175]
    ds_read_b64_tr_b16 v[74:75], v6 offset:1792
    v_mfma_f32_16x16x32_bf16 v[176:179], v[92:95], v[40:43], v[176:179]
    v_mfma_f32_16x16x32_bf16 v[180:183], v[92:95], v[44:47], v[180:183]
    v_mfma_f32_16x16x32_bf16 v[184:187], v[96:99], v[32:35], v[184:187]
    v_mfma_f32_16x16x32_bf16 v[188:191], v[96:99], v[36:39], v[188:191]
    v_mfma_f32_16x16x32_bf16 v[192:195], v[96:99], v[40:43], v[192:195]
    v_mfma_f32_16x16x32_bf16 v[196:199], v[96:99], v[44:47], v[196:199]
    v_mfma_f32_16x16x32_bf16 v[200:203], v[100:103], v[32:35], v[200:203]
    v_mfma_f32_16x16x32_bf16 v[204:207], v[100:103], v[36:39], v[204:207]
    v_mfma_f32_16x16x32_bf16 v[208:211], v[100:103], v[40:43], v[208:211]
    v_mfma_f32_16x16x32_bf16 v[212:215], v[100:103], v[44:47], v[212:215]
    s_waitcnt lgkmcnt(0)
    v_mfma_f32_16x16x32_bf16 v[104:107], v[48:51], v[16:19], v[104:107]
    ds_read_b64_tr_b16 v[76:77], v4 offset:14336
    v_mfma_f32_16x16x32_bf16 v[108:111], v[48:51], v[20:23], v[108:111]
    ds_read_b64_tr_b16 v[78:79], v4 offset:16128
    v_mfma_f32_16x16x32_bf16 v[112:115], v[48:51], v[24:27], v[112:115]
    ds_read_b128 v[32:35], v3 offset:0
    v_mfma_f32_16x16x32_bf16 v[116:119], v[48:51], v[28:31], v[116:119]
    ds_read_b128 v[36:39], v3 offset:2048
    v_mfma_f32_16x16x32_bf16 v[120:123], v[52:55], v[16:19], v[120:123]
    ds_read_b128 v[40:43], v3 offset:4096
    v_mfma_f32_16x16x32_bf16 v[124:127], v[52:55], v[20:23], v[124:127]
    ds_read_b128 v[44:47], v3 offset:6144
    v_mfma_f32_16x16x32_bf16 v[128:131], v[52:55], v[24:27], v[128:131]
    ds_read_b64_tr_b16 v[80:81], v5 offset:14336
    v_mfma_f32_16x16x32_bf16 v[132:135], v[52:55], v[28:31], v[132:135]
    ds_read_b64_tr_b16 v[82:83], v5 offset:16128
    v_mfma_f32_16x16x32_bf16 v[136:139], v[56:59], v[16:19], v[136:139]
    ds_read_b64_tr_b16 v[84:85], v4 offset:14464
    v_mfma_f32_16x16x32_bf16 v[140:143], v[56:59], v[20:23], v[140:143]
    ds_read_b64_tr_b16 v[86:87], v4 offset:16256
    v_mfma_f32_16x16x32_bf16 v[144:147], v[56:59], v[24:27], v[144:147]
    ds_read_b64_tr_b16 v[88:89], v5 offset:14464
    v_mfma_f32_16x16x32_bf16 v[148:151], v[56:59], v[28:31], v[148:151]
    ds_read_b64_tr_b16 v[90:91], v5 offset:16256
    v_mfma_f32_16x16x32_bf16 v[152:155], v[60:63], v[16:19], v[152:155]
    ds_read_b64_tr_b16 v[92:93], v4 offset:14592
    v_mfma_f32_16x16x32_bf16 v[156:159], v[60:63], v[20:23], v[156:159]
    ds_read_b64_tr_b16 v[94:95], v4 offset:16384
    v_mfma_f32_16x16x32_bf16 v[160:163], v[60:63], v[24:27], v[160:163]
    ds_read_b64_tr_b16 v[96:97], v5 offset:14592
    v_mfma_f32_16x16x32_bf16 v[164:167], v[60:63], v[28:31], v[164:167]
    ds_read_b64_tr_b16 v[98:99], v5 offset:16384
    v_mfma_f32_16x16x32_bf16 v[168:171], v[64:67], v[16:19], v[168:171]
    ds_read_b64_tr_b16 v[100:101], v6 offset:14336
    v_mfma_f32_16x16x32_bf16 v[172:175], v[64:67], v[20:23], v[172:175]
    ds_read_b64_tr_b16 v[102:103], v6 offset:16128
    v_mfma_f32_16x16x32_bf16 v[176:179], v[64:67], v[24:27], v[176:179]
    v_mfma_f32_16x16x32_bf16 v[180:183], v[64:67], v[28:31], v[180:183]
    v_mfma_f32_16x16x32_bf16 v[184:187], v[68:71], v[16:19], v[184:187]
    v_mfma_f32_16x16x32_bf16 v[188:191], v[68:71], v[20:23], v[188:191]
    v_mfma_f32_16x16x32_bf16 v[192:195], v[68:71], v[24:27], v[192:195]
    v_mfma_f32_16x16x32_bf16 v[196:199], v[68:71], v[28:31], v[196:199]
    v_mfma_f32_16x16x32_bf16 v[200:203], v[72:75], v[16:19], v[200:203]
    v_mfma_f32_16x16x32_bf16 v[204:207], v[72:75], v[20:23], v[204:207]
    v_mfma_f32_16x16x32_bf16 v[208:211], v[72:75], v[24:27], v[208:211]
    v_mfma_f32_16x16x32_bf16 v[212:215], v[72:75], v[28:31], v[212:215]
    s_waitcnt  lgkmcnt(0)
    s_barrier
    v_add_u32 v2, 4294877184, v2
    v_add_u32 v3, 4294877184, v3
    v_add_u32 v4, 4294877184, v4
    v_add_u32 v5, 4294877184, v5
    v_add_u32 v6, 4294877184, v6
    v_mfma_f32_16x16x32_bf16 v[104:107], v[76:79], v[32:35], v[104:107]
    ds_read_b64_tr_b16 v[48:49], v4 offset:0
    v_mfma_f32_16x16x32_bf16 v[108:111], v[76:79], v[36:39], v[108:111]
    ds_read_b64_tr_b16 v[50:51], v4 offset:1792
    v_mfma_f32_16x16x32_bf16 v[112:115], v[76:79], v[40:43], v[112:115]
    ds_read_b128 v[16:19], v2 offset:0
    v_mfma_f32_16x16x32_bf16 v[116:119], v[76:79], v[44:47], v[116:119]
    ds_read_b128 v[20:23], v2 offset:2048
    v_mfma_f32_16x16x32_bf16 v[120:123], v[80:83], v[32:35], v[120:123]
    ds_read_b128 v[24:27], v2 offset:4096
    v_mfma_f32_16x16x32_bf16 v[124:127], v[80:83], v[36:39], v[124:127]
    ds_read_b128 v[28:31], v2 offset:6144
    v_mfma_f32_16x16x32_bf16 v[128:131], v[80:83], v[40:43], v[128:131]
    ds_read_b64_tr_b16 v[52:53], v5 offset:0
    v_mfma_f32_16x16x32_bf16 v[132:135], v[80:83], v[44:47], v[132:135]
    ds_read_b64_tr_b16 v[54:55], v5 offset:1792
    v_mfma_f32_16x16x32_bf16 v[136:139], v[84:87], v[32:35], v[136:139]
    ds_read_b64_tr_b16 v[56:57], v4 offset:128
    v_mfma_f32_16x16x32_bf16 v[140:143], v[84:87], v[36:39], v[140:143]
    ds_read_b64_tr_b16 v[58:59], v4 offset:1920
    v_mfma_f32_16x16x32_bf16 v[144:147], v[84:87], v[40:43], v[144:147]
    ds_read_b64_tr_b16 v[60:61], v5 offset:128
    v_mfma_f32_16x16x32_bf16 v[148:151], v[84:87], v[44:47], v[148:151]
    ds_read_b64_tr_b16 v[62:63], v5 offset:1920
    v_mfma_f32_16x16x32_bf16 v[152:155], v[88:91], v[32:35], v[152:155]
    ds_read_b64_tr_b16 v[64:65], v4 offset:256
    v_mfma_f32_16x16x32_bf16 v[156:159], v[88:91], v[36:39], v[156:159]
    ds_read_b64_tr_b16 v[66:67], v4 offset:2048
    v_mfma_f32_16x16x32_bf16 v[160:163], v[88:91], v[40:43], v[160:163]
    ds_read_b64_tr_b16 v[68:69], v5 offset:256
    v_mfma_f32_16x16x32_bf16 v[164:167], v[88:91], v[44:47], v[164:167]
    ds_read_b64_tr_b16 v[70:71], v5 offset:2048
    v_mfma_f32_16x16x32_bf16 v[168:171], v[92:95], v[32:35], v[168:171]
    ds_read_b64_tr_b16 v[72:73], v6 offset:0
    v_mfma_f32_16x16x32_bf16 v[172:175], v[92:95], v[36:39], v[172:175]
    ds_read_b64_tr_b16 v[74:75], v6 offset:1792
    v_mfma_f32_16x16x32_bf16 v[176:179], v[92:95], v[40:43], v[176:179]
    v_mfma_f32_16x16x32_bf16 v[180:183], v[92:95], v[44:47], v[180:183]
    v_mfma_f32_16x16x32_bf16 v[184:187], v[96:99], v[32:35], v[184:187]
    v_mfma_f32_16x16x32_bf16 v[188:191], v[96:99], v[36:39], v[188:191]
    v_mfma_f32_16x16x32_bf16 v[192:195], v[96:99], v[40:43], v[192:195]
    v_mfma_f32_16x16x32_bf16 v[196:199], v[96:99], v[44:47], v[196:199]
    v_mfma_f32_16x16x32_bf16 v[200:203], v[100:103], v[32:35], v[200:203]
    v_mfma_f32_16x16x32_bf16 v[204:207], v[100:103], v[36:39], v[204:207]
    v_mfma_f32_16x16x32_bf16 v[208:211], v[100:103], v[40:43], v[208:211]
    v_mfma_f32_16x16x32_bf16 v[212:215], v[100:103], v[44:47], v[212:215]
    s_waitcnt lgkmcnt(0)
    v_mfma_f32_16x16x32_bf16 v[104:107], v[48:51], v[16:19], v[104:107]
    ds_read_b64_tr_b16 v[76:77], v4 offset:14336
    v_mfma_f32_16x16x32_bf16 v[108:111], v[48:51], v[20:23], v[108:111]
    ds_read_b64_tr_b16 v[78:79], v4 offset:16128
    v_mfma_f32_16x16x32_bf16 v[112:115], v[48:51], v[24:27], v[112:115]
    ds_read_b128 v[32:35], v3 offset:0
    v_mfma_f32_16x16x32_bf16 v[116:119], v[48:51], v[28:31], v[116:119]
    ds_read_b128 v[36:39], v3 offset:2048
    v_mfma_f32_16x16x32_bf16 v[120:123], v[52:55], v[16:19], v[120:123]
    ds_read_b128 v[40:43], v3 offset:4096
    v_mfma_f32_16x16x32_bf16 v[124:127], v[52:55], v[20:23], v[124:127]
    ds_read_b128 v[44:47], v3 offset:6144
    v_mfma_f32_16x16x32_bf16 v[128:131], v[52:55], v[24:27], v[128:131]
    ds_read_b64_tr_b16 v[80:81], v5 offset:14336
    v_mfma_f32_16x16x32_bf16 v[132:135], v[52:55], v[28:31], v[132:135]
    ds_read_b64_tr_b16 v[82:83], v5 offset:16128
    v_mfma_f32_16x16x32_bf16 v[136:139], v[56:59], v[16:19], v[136:139]
    ds_read_b64_tr_b16 v[84:85], v4 offset:14464
    v_mfma_f32_16x16x32_bf16 v[140:143], v[56:59], v[20:23], v[140:143]
    ds_read_b64_tr_b16 v[86:87], v4 offset:16256
    v_mfma_f32_16x16x32_bf16 v[144:147], v[56:59], v[24:27], v[144:147]
    ds_read_b64_tr_b16 v[88:89], v5 offset:14464
    v_mfma_f32_16x16x32_bf16 v[148:151], v[56:59], v[28:31], v[148:151]
    ds_read_b64_tr_b16 v[90:91], v5 offset:16256
    v_mfma_f32_16x16x32_bf16 v[152:155], v[60:63], v[16:19], v[152:155]
    ds_read_b64_tr_b16 v[92:93], v4 offset:14592
    v_mfma_f32_16x16x32_bf16 v[156:159], v[60:63], v[20:23], v[156:159]
    ds_read_b64_tr_b16 v[94:95], v4 offset:16384
    v_mfma_f32_16x16x32_bf16 v[160:163], v[60:63], v[24:27], v[160:163]
    ds_read_b64_tr_b16 v[96:97], v5 offset:14592
    v_mfma_f32_16x16x32_bf16 v[164:167], v[60:63], v[28:31], v[164:167]
    ds_read_b64_tr_b16 v[98:99], v5 offset:16384
    v_mfma_f32_16x16x32_bf16 v[168:171], v[64:67], v[16:19], v[168:171]
    ds_read_b64_tr_b16 v[100:101], v6 offset:14336
    v_mfma_f32_16x16x32_bf16 v[172:175], v[64:67], v[20:23], v[172:175]
    ds_read_b64_tr_b16 v[102:103], v6 offset:16128
    v_mfma_f32_16x16x32_bf16 v[176:179], v[64:67], v[24:27], v[176:179]
    v_mfma_f32_16x16x32_bf16 v[180:183], v[64:67], v[28:31], v[180:183]
    v_mfma_f32_16x16x32_bf16 v[184:187], v[68:71], v[16:19], v[184:187]
    v_mfma_f32_16x16x32_bf16 v[188:191], v[68:71], v[20:23], v[188:191]
    v_mfma_f32_16x16x32_bf16 v[192:195], v[68:71], v[24:27], v[192:195]
    v_mfma_f32_16x16x32_bf16 v[196:199], v[68:71], v[28:31], v[196:199]
    v_mfma_f32_16x16x32_bf16 v[200:203], v[72:75], v[16:19], v[200:203]
    v_mfma_f32_16x16x32_bf16 v[204:207], v[72:75], v[20:23], v[204:207]
    v_mfma_f32_16x16x32_bf16 v[208:211], v[72:75], v[24:27], v[208:211]
    v_mfma_f32_16x16x32_bf16 v[212:215], v[72:75], v[28:31], v[212:215]
    s_waitcnt  lgkmcnt(0)
    s_barrier
    v_add_u32 v2, 45056, v2
    v_add_u32 v3, 45056, v3
    v_add_u32 v4, 45056, v4
    v_add_u32 v5, 45056, v5
    v_add_u32 v6, 45056, v6
    v_mfma_f32_16x16x32_bf16 v[104:107], v[76:79], v[32:35], v[104:107]
    ds_read_b64_tr_b16 v[48:49], v4 offset:0
    v_mfma_f32_16x16x32_bf16 v[108:111], v[76:79], v[36:39], v[108:111]
    ds_read_b64_tr_b16 v[50:51], v4 offset:1792
    v_mfma_f32_16x16x32_bf16 v[112:115], v[76:79], v[40:43], v[112:115]
    ds_read_b128 v[16:19], v2 offset:0
    v_mfma_f32_16x16x32_bf16 v[116:119], v[76:79], v[44:47], v[116:119]
    ds_read_b128 v[20:23], v2 offset:2048
    v_mfma_f32_16x16x32_bf16 v[120:123], v[80:83], v[32:35], v[120:123]
    ds_read_b128 v[24:27], v2 offset:4096
    v_mfma_f32_16x16x32_bf16 v[124:127], v[80:83], v[36:39], v[124:127]
    ds_read_b128 v[28:31], v2 offset:6144
    v_mfma_f32_16x16x32_bf16 v[128:131], v[80:83], v[40:43], v[128:131]
    ds_read_b64_tr_b16 v[52:53], v5 offset:0
    v_mfma_f32_16x16x32_bf16 v[132:135], v[80:83], v[44:47], v[132:135]
    ds_read_b64_tr_b16 v[54:55], v5 offset:1792
    v_mfma_f32_16x16x32_bf16 v[136:139], v[84:87], v[32:35], v[136:139]
    ds_read_b64_tr_b16 v[56:57], v4 offset:128
    v_mfma_f32_16x16x32_bf16 v[140:143], v[84:87], v[36:39], v[140:143]
    ds_read_b64_tr_b16 v[58:59], v4 offset:1920
    v_mfma_f32_16x16x32_bf16 v[144:147], v[84:87], v[40:43], v[144:147]
    ds_read_b64_tr_b16 v[60:61], v5 offset:128
    v_mfma_f32_16x16x32_bf16 v[148:151], v[84:87], v[44:47], v[148:151]
    ds_read_b64_tr_b16 v[62:63], v5 offset:1920
    v_mfma_f32_16x16x32_bf16 v[152:155], v[88:91], v[32:35], v[152:155]
    ds_read_b64_tr_b16 v[64:65], v4 offset:256
    v_mfma_f32_16x16x32_bf16 v[156:159], v[88:91], v[36:39], v[156:159]
    ds_read_b64_tr_b16 v[66:67], v4 offset:2048
    v_mfma_f32_16x16x32_bf16 v[160:163], v[88:91], v[40:43], v[160:163]
    ds_read_b64_tr_b16 v[68:69], v5 offset:256
    v_mfma_f32_16x16x32_bf16 v[164:167], v[88:91], v[44:47], v[164:167]
    ds_read_b64_tr_b16 v[70:71], v5 offset:2048
    v_mfma_f32_16x16x32_bf16 v[168:171], v[92:95], v[32:35], v[168:171]
    ds_read_b64_tr_b16 v[72:73], v6 offset:0
    v_mfma_f32_16x16x32_bf16 v[172:175], v[92:95], v[36:39], v[172:175]
    ds_read_b64_tr_b16 v[74:75], v6 offset:1792
    v_mfma_f32_16x16x32_bf16 v[176:179], v[92:95], v[40:43], v[176:179]
    v_mfma_f32_16x16x32_bf16 v[180:183], v[92:95], v[44:47], v[180:183]
    v_mfma_f32_16x16x32_bf16 v[184:187], v[96:99], v[32:35], v[184:187]
    v_mfma_f32_16x16x32_bf16 v[188:191], v[96:99], v[36:39], v[188:191]
    v_mfma_f32_16x16x32_bf16 v[192:195], v[96:99], v[40:43], v[192:195]
    v_mfma_f32_16x16x32_bf16 v[196:199], v[96:99], v[44:47], v[196:199]
    v_mfma_f32_16x16x32_bf16 v[200:203], v[100:103], v[32:35], v[200:203]
    v_mfma_f32_16x16x32_bf16 v[204:207], v[100:103], v[36:39], v[204:207]
    v_mfma_f32_16x16x32_bf16 v[208:211], v[100:103], v[40:43], v[208:211]
    v_mfma_f32_16x16x32_bf16 v[212:215], v[100:103], v[44:47], v[212:215]
    s_waitcnt lgkmcnt(0)
    v_mfma_f32_16x16x32_bf16 v[104:107], v[48:51], v[16:19], v[104:107]
    ds_read_b64_tr_b16 v[76:77], v4 offset:14336
    v_mfma_f32_16x16x32_bf16 v[108:111], v[48:51], v[20:23], v[108:111]
    ds_read_b64_tr_b16 v[78:79], v4 offset:16128
    v_mfma_f32_16x16x32_bf16 v[112:115], v[48:51], v[24:27], v[112:115]
    ds_read_b128 v[32:35], v3 offset:0
    v_mfma_f32_16x16x32_bf16 v[116:119], v[48:51], v[28:31], v[116:119]
    ds_read_b128 v[36:39], v3 offset:2048
    v_mfma_f32_16x16x32_bf16 v[120:123], v[52:55], v[16:19], v[120:123]
    ds_read_b128 v[40:43], v3 offset:4096
    v_mfma_f32_16x16x32_bf16 v[124:127], v[52:55], v[20:23], v[124:127]
    ds_read_b128 v[44:47], v3 offset:6144
    v_mfma_f32_16x16x32_bf16 v[128:131], v[52:55], v[24:27], v[128:131]
    ds_read_b64_tr_b16 v[80:81], v5 offset:14336
    v_mfma_f32_16x16x32_bf16 v[132:135], v[52:55], v[28:31], v[132:135]
    ds_read_b64_tr_b16 v[82:83], v5 offset:16128
    v_mfma_f32_16x16x32_bf16 v[136:139], v[56:59], v[16:19], v[136:139]
    ds_read_b64_tr_b16 v[84:85], v4 offset:14464
    v_mfma_f32_16x16x32_bf16 v[140:143], v[56:59], v[20:23], v[140:143]
    ds_read_b64_tr_b16 v[86:87], v4 offset:16256
    v_mfma_f32_16x16x32_bf16 v[144:147], v[56:59], v[24:27], v[144:147]
    ds_read_b64_tr_b16 v[88:89], v5 offset:14464
    v_mfma_f32_16x16x32_bf16 v[148:151], v[56:59], v[28:31], v[148:151]
    ds_read_b64_tr_b16 v[90:91], v5 offset:16256
    v_mfma_f32_16x16x32_bf16 v[152:155], v[60:63], v[16:19], v[152:155]
    ds_read_b64_tr_b16 v[92:93], v4 offset:14592
    v_mfma_f32_16x16x32_bf16 v[156:159], v[60:63], v[20:23], v[156:159]
    ds_read_b64_tr_b16 v[94:95], v4 offset:16384
    v_mfma_f32_16x16x32_bf16 v[160:163], v[60:63], v[24:27], v[160:163]
    ds_read_b64_tr_b16 v[96:97], v5 offset:14592
    v_mfma_f32_16x16x32_bf16 v[164:167], v[60:63], v[28:31], v[164:167]
    ds_read_b64_tr_b16 v[98:99], v5 offset:16384
    v_mfma_f32_16x16x32_bf16 v[168:171], v[64:67], v[16:19], v[168:171]
    ds_read_b64_tr_b16 v[100:101], v6 offset:14336
    v_mfma_f32_16x16x32_bf16 v[172:175], v[64:67], v[20:23], v[172:175]
    ds_read_b64_tr_b16 v[102:103], v6 offset:16128
    v_mfma_f32_16x16x32_bf16 v[176:179], v[64:67], v[24:27], v[176:179]
    v_mfma_f32_16x16x32_bf16 v[180:183], v[64:67], v[28:31], v[180:183]
    v_mfma_f32_16x16x32_bf16 v[184:187], v[68:71], v[16:19], v[184:187]
    v_mfma_f32_16x16x32_bf16 v[188:191], v[68:71], v[20:23], v[188:191]
    v_mfma_f32_16x16x32_bf16 v[192:195], v[68:71], v[24:27], v[192:195]
    v_mfma_f32_16x16x32_bf16 v[196:199], v[68:71], v[28:31], v[196:199]
    v_mfma_f32_16x16x32_bf16 v[200:203], v[72:75], v[16:19], v[200:203]
    v_mfma_f32_16x16x32_bf16 v[204:207], v[72:75], v[20:23], v[204:207]
    v_mfma_f32_16x16x32_bf16 v[208:211], v[72:75], v[24:27], v[208:211]
    v_mfma_f32_16x16x32_bf16 v[212:215], v[72:75], v[28:31], v[212:215]
    s_waitcnt  lgkmcnt(0)
    s_barrier
    v_add_u32 v2, 45056, v2
    v_add_u32 v3, 45056, v3
    v_add_u32 v4, 45056, v4
    v_add_u32 v5, 45056, v5
    v_add_u32 v6, 45056, v6
    v_mfma_f32_16x16x32_bf16 v[104:107], v[76:79], v[32:35], v[104:107]
    ds_read_b64_tr_b16 v[48:49], v4 offset:0
    v_mfma_f32_16x16x32_bf16 v[108:111], v[76:79], v[36:39], v[108:111]
    ds_read_b64_tr_b16 v[50:51], v4 offset:1792
    v_mfma_f32_16x16x32_bf16 v[112:115], v[76:79], v[40:43], v[112:115]
    ds_read_b128 v[16:19], v2 offset:0
    v_mfma_f32_16x16x32_bf16 v[116:119], v[76:79], v[44:47], v[116:119]
    ds_read_b128 v[20:23], v2 offset:2048
    v_mfma_f32_16x16x32_bf16 v[120:123], v[80:83], v[32:35], v[120:123]
    ds_read_b128 v[24:27], v2 offset:4096
    v_mfma_f32_16x16x32_bf16 v[124:127], v[80:83], v[36:39], v[124:127]
    ds_read_b128 v[28:31], v2 offset:6144
    v_mfma_f32_16x16x32_bf16 v[128:131], v[80:83], v[40:43], v[128:131]
    ds_read_b64_tr_b16 v[52:53], v5 offset:0
    v_mfma_f32_16x16x32_bf16 v[132:135], v[80:83], v[44:47], v[132:135]
    ds_read_b64_tr_b16 v[54:55], v5 offset:1792
    v_mfma_f32_16x16x32_bf16 v[136:139], v[84:87], v[32:35], v[136:139]
    ds_read_b64_tr_b16 v[56:57], v4 offset:128
    v_mfma_f32_16x16x32_bf16 v[140:143], v[84:87], v[36:39], v[140:143]
    ds_read_b64_tr_b16 v[58:59], v4 offset:1920
    v_mfma_f32_16x16x32_bf16 v[144:147], v[84:87], v[40:43], v[144:147]
    ds_read_b64_tr_b16 v[60:61], v5 offset:128
    v_mfma_f32_16x16x32_bf16 v[148:151], v[84:87], v[44:47], v[148:151]
    ds_read_b64_tr_b16 v[62:63], v5 offset:1920
    v_mfma_f32_16x16x32_bf16 v[152:155], v[88:91], v[32:35], v[152:155]
    ds_read_b64_tr_b16 v[64:65], v4 offset:256
    v_mfma_f32_16x16x32_bf16 v[156:159], v[88:91], v[36:39], v[156:159]
    ds_read_b64_tr_b16 v[66:67], v4 offset:2048
    v_mfma_f32_16x16x32_bf16 v[160:163], v[88:91], v[40:43], v[160:163]
    ds_read_b64_tr_b16 v[68:69], v5 offset:256
    v_mfma_f32_16x16x32_bf16 v[164:167], v[88:91], v[44:47], v[164:167]
    ds_read_b64_tr_b16 v[70:71], v5 offset:2048
    v_mfma_f32_16x16x32_bf16 v[168:171], v[92:95], v[32:35], v[168:171]
    ds_read_b64_tr_b16 v[72:73], v6 offset:0
    v_mfma_f32_16x16x32_bf16 v[172:175], v[92:95], v[36:39], v[172:175]
    ds_read_b64_tr_b16 v[74:75], v6 offset:1792
    v_mfma_f32_16x16x32_bf16 v[176:179], v[92:95], v[40:43], v[176:179]
    v_mfma_f32_16x16x32_bf16 v[180:183], v[92:95], v[44:47], v[180:183]
    v_mfma_f32_16x16x32_bf16 v[184:187], v[96:99], v[32:35], v[184:187]
    v_mfma_f32_16x16x32_bf16 v[188:191], v[96:99], v[36:39], v[188:191]
    v_mfma_f32_16x16x32_bf16 v[192:195], v[96:99], v[40:43], v[192:195]
    v_mfma_f32_16x16x32_bf16 v[196:199], v[96:99], v[44:47], v[196:199]
    v_mfma_f32_16x16x32_bf16 v[200:203], v[100:103], v[32:35], v[200:203]
    v_mfma_f32_16x16x32_bf16 v[204:207], v[100:103], v[36:39], v[204:207]
    v_mfma_f32_16x16x32_bf16 v[208:211], v[100:103], v[40:43], v[208:211]
    v_mfma_f32_16x16x32_bf16 v[212:215], v[100:103], v[44:47], v[212:215]
    s_waitcnt lgkmcnt(0)
    v_mfma_f32_16x16x32_bf16 v[104:107], v[48:51], v[16:19], v[104:107]
    ds_read_b64_tr_b16 v[76:77], v4 offset:14336
    v_mfma_f32_16x16x32_bf16 v[108:111], v[48:51], v[20:23], v[108:111]
    ds_read_b64_tr_b16 v[78:79], v4 offset:16128
    v_mfma_f32_16x16x32_bf16 v[112:115], v[48:51], v[24:27], v[112:115]
    ds_read_b128 v[32:35], v3 offset:0
    v_mfma_f32_16x16x32_bf16 v[116:119], v[48:51], v[28:31], v[116:119]
    ds_read_b128 v[36:39], v3 offset:2048
    v_mfma_f32_16x16x32_bf16 v[120:123], v[52:55], v[16:19], v[120:123]
    ds_read_b128 v[40:43], v3 offset:4096
    v_mfma_f32_16x16x32_bf16 v[124:127], v[52:55], v[20:23], v[124:127]
    ds_read_b128 v[44:47], v3 offset:6144
    v_mfma_f32_16x16x32_bf16 v[128:131], v[52:55], v[24:27], v[128:131]
    ds_read_b64_tr_b16 v[80:81], v5 offset:14336
    v_mfma_f32_16x16x32_bf16 v[132:135], v[52:55], v[28:31], v[132:135]
    ds_read_b64_tr_b16 v[82:83], v5 offset:16128
    v_mfma_f32_16x16x32_bf16 v[136:139], v[56:59], v[16:19], v[136:139]
    ds_read_b64_tr_b16 v[84:85], v4 offset:14464
    v_mfma_f32_16x16x32_bf16 v[140:143], v[56:59], v[20:23], v[140:143]
    ds_read_b64_tr_b16 v[86:87], v4 offset:16256
    v_mfma_f32_16x16x32_bf16 v[144:147], v[56:59], v[24:27], v[144:147]
    ds_read_b64_tr_b16 v[88:89], v5 offset:14464
    v_mfma_f32_16x16x32_bf16 v[148:151], v[56:59], v[28:31], v[148:151]
    ds_read_b64_tr_b16 v[90:91], v5 offset:16256
    v_mfma_f32_16x16x32_bf16 v[152:155], v[60:63], v[16:19], v[152:155]
    ds_read_b64_tr_b16 v[92:93], v4 offset:14592
    v_mfma_f32_16x16x32_bf16 v[156:159], v[60:63], v[20:23], v[156:159]
    ds_read_b64_tr_b16 v[94:95], v4 offset:16384
    v_mfma_f32_16x16x32_bf16 v[160:163], v[60:63], v[24:27], v[160:163]
    ds_read_b64_tr_b16 v[96:97], v5 offset:14592
    v_mfma_f32_16x16x32_bf16 v[164:167], v[60:63], v[28:31], v[164:167]
    ds_read_b64_tr_b16 v[98:99], v5 offset:16384
    v_mfma_f32_16x16x32_bf16 v[168:171], v[64:67], v[16:19], v[168:171]
    ds_read_b64_tr_b16 v[100:101], v6 offset:14336
    v_mfma_f32_16x16x32_bf16 v[172:175], v[64:67], v[20:23], v[172:175]
    ds_read_b64_tr_b16 v[102:103], v6 offset:16128
    v_mfma_f32_16x16x32_bf16 v[176:179], v[64:67], v[24:27], v[176:179]
    v_mfma_f32_16x16x32_bf16 v[180:183], v[64:67], v[28:31], v[180:183]
    v_mfma_f32_16x16x32_bf16 v[184:187], v[68:71], v[16:19], v[184:187]
    v_mfma_f32_16x16x32_bf16 v[188:191], v[68:71], v[20:23], v[188:191]
    v_mfma_f32_16x16x32_bf16 v[192:195], v[68:71], v[24:27], v[192:195]
    v_mfma_f32_16x16x32_bf16 v[196:199], v[68:71], v[28:31], v[196:199]
    v_mfma_f32_16x16x32_bf16 v[200:203], v[72:75], v[16:19], v[200:203]
    v_mfma_f32_16x16x32_bf16 v[204:207], v[72:75], v[20:23], v[204:207]
    v_mfma_f32_16x16x32_bf16 v[208:211], v[72:75], v[24:27], v[208:211]
    v_mfma_f32_16x16x32_bf16 v[212:215], v[72:75], v[28:31], v[212:215]
    s_waitcnt  lgkmcnt(0)
    s_barrier
    v_add_u32 v2, 4294877184, v2
    v_add_u32 v3, 4294877184, v3
    v_add_u32 v4, 4294877184, v4
    v_add_u32 v5, 4294877184, v5
    v_add_u32 v6, 4294877184, v6
    v_mfma_f32_16x16x32_bf16 v[104:107], v[76:79], v[32:35], v[104:107]
    ds_read_b64_tr_b16 v[48:49], v4 offset:0
    v_mfma_f32_16x16x32_bf16 v[108:111], v[76:79], v[36:39], v[108:111]
    ds_read_b64_tr_b16 v[50:51], v4 offset:1792
    v_mfma_f32_16x16x32_bf16 v[112:115], v[76:79], v[40:43], v[112:115]
    ds_read_b128 v[16:19], v2 offset:0
    v_mfma_f32_16x16x32_bf16 v[116:119], v[76:79], v[44:47], v[116:119]
    ds_read_b128 v[20:23], v2 offset:2048
    v_mfma_f32_16x16x32_bf16 v[120:123], v[80:83], v[32:35], v[120:123]
    ds_read_b128 v[24:27], v2 offset:4096
    v_mfma_f32_16x16x32_bf16 v[124:127], v[80:83], v[36:39], v[124:127]
    ds_read_b128 v[28:31], v2 offset:6144
    v_mfma_f32_16x16x32_bf16 v[128:131], v[80:83], v[40:43], v[128:131]
    ds_read_b64_tr_b16 v[52:53], v5 offset:0
    v_mfma_f32_16x16x32_bf16 v[132:135], v[80:83], v[44:47], v[132:135]
    ds_read_b64_tr_b16 v[54:55], v5 offset:1792
    v_mfma_f32_16x16x32_bf16 v[136:139], v[84:87], v[32:35], v[136:139]
    ds_read_b64_tr_b16 v[56:57], v4 offset:128
    v_mfma_f32_16x16x32_bf16 v[140:143], v[84:87], v[36:39], v[140:143]
    ds_read_b64_tr_b16 v[58:59], v4 offset:1920
    v_mfma_f32_16x16x32_bf16 v[144:147], v[84:87], v[40:43], v[144:147]
    ds_read_b64_tr_b16 v[60:61], v5 offset:128
    v_mfma_f32_16x16x32_bf16 v[148:151], v[84:87], v[44:47], v[148:151]
    ds_read_b64_tr_b16 v[62:63], v5 offset:1920
    v_mfma_f32_16x16x32_bf16 v[152:155], v[88:91], v[32:35], v[152:155]
    ds_read_b64_tr_b16 v[64:65], v4 offset:256
    v_mfma_f32_16x16x32_bf16 v[156:159], v[88:91], v[36:39], v[156:159]
    ds_read_b64_tr_b16 v[66:67], v4 offset:2048
    v_mfma_f32_16x16x32_bf16 v[160:163], v[88:91], v[40:43], v[160:163]
    ds_read_b64_tr_b16 v[68:69], v5 offset:256
    v_mfma_f32_16x16x32_bf16 v[164:167], v[88:91], v[44:47], v[164:167]
    ds_read_b64_tr_b16 v[70:71], v5 offset:2048
    v_mfma_f32_16x16x32_bf16 v[168:171], v[92:95], v[32:35], v[168:171]
    ds_read_b64_tr_b16 v[72:73], v6 offset:0
    v_mfma_f32_16x16x32_bf16 v[172:175], v[92:95], v[36:39], v[172:175]
    ds_read_b64_tr_b16 v[74:75], v6 offset:1792
    v_mfma_f32_16x16x32_bf16 v[176:179], v[92:95], v[40:43], v[176:179]
    v_mfma_f32_16x16x32_bf16 v[180:183], v[92:95], v[44:47], v[180:183]
    v_mfma_f32_16x16x32_bf16 v[184:187], v[96:99], v[32:35], v[184:187]
    v_mfma_f32_16x16x32_bf16 v[188:191], v[96:99], v[36:39], v[188:191]
    v_mfma_f32_16x16x32_bf16 v[192:195], v[96:99], v[40:43], v[192:195]
    v_mfma_f32_16x16x32_bf16 v[196:199], v[96:99], v[44:47], v[196:199]
    v_mfma_f32_16x16x32_bf16 v[200:203], v[100:103], v[32:35], v[200:203]
    v_mfma_f32_16x16x32_bf16 v[204:207], v[100:103], v[36:39], v[204:207]
    v_mfma_f32_16x16x32_bf16 v[208:211], v[100:103], v[40:43], v[208:211]
    v_mfma_f32_16x16x32_bf16 v[212:215], v[100:103], v[44:47], v[212:215]
    s_waitcnt lgkmcnt(0)
    v_mfma_f32_16x16x32_bf16 v[104:107], v[48:51], v[16:19], v[104:107]
    ds_read_b64_tr_b16 v[76:77], v4 offset:14336
    v_mfma_f32_16x16x32_bf16 v[108:111], v[48:51], v[20:23], v[108:111]
    ds_read_b64_tr_b16 v[78:79], v4 offset:16128
    v_mfma_f32_16x16x32_bf16 v[112:115], v[48:51], v[24:27], v[112:115]
    ds_read_b128 v[32:35], v3 offset:0
    v_mfma_f32_16x16x32_bf16 v[116:119], v[48:51], v[28:31], v[116:119]
    ds_read_b128 v[36:39], v3 offset:2048
    v_mfma_f32_16x16x32_bf16 v[120:123], v[52:55], v[16:19], v[120:123]
    ds_read_b128 v[40:43], v3 offset:4096
    v_mfma_f32_16x16x32_bf16 v[124:127], v[52:55], v[20:23], v[124:127]
    ds_read_b128 v[44:47], v3 offset:6144
    v_mfma_f32_16x16x32_bf16 v[128:131], v[52:55], v[24:27], v[128:131]
    ds_read_b64_tr_b16 v[80:81], v5 offset:14336
    v_mfma_f32_16x16x32_bf16 v[132:135], v[52:55], v[28:31], v[132:135]
    ds_read_b64_tr_b16 v[82:83], v5 offset:16128
    v_mfma_f32_16x16x32_bf16 v[136:139], v[56:59], v[16:19], v[136:139]
    ds_read_b64_tr_b16 v[84:85], v4 offset:14464
    v_mfma_f32_16x16x32_bf16 v[140:143], v[56:59], v[20:23], v[140:143]
    ds_read_b64_tr_b16 v[86:87], v4 offset:16256
    v_mfma_f32_16x16x32_bf16 v[144:147], v[56:59], v[24:27], v[144:147]
    ds_read_b64_tr_b16 v[88:89], v5 offset:14464
    v_mfma_f32_16x16x32_bf16 v[148:151], v[56:59], v[28:31], v[148:151]
    ds_read_b64_tr_b16 v[90:91], v5 offset:16256
    v_mfma_f32_16x16x32_bf16 v[152:155], v[60:63], v[16:19], v[152:155]
    ds_read_b64_tr_b16 v[92:93], v4 offset:14592
    v_mfma_f32_16x16x32_bf16 v[156:159], v[60:63], v[20:23], v[156:159]
    ds_read_b64_tr_b16 v[94:95], v4 offset:16384
    v_mfma_f32_16x16x32_bf16 v[160:163], v[60:63], v[24:27], v[160:163]
    ds_read_b64_tr_b16 v[96:97], v5 offset:14592
    v_mfma_f32_16x16x32_bf16 v[164:167], v[60:63], v[28:31], v[164:167]
    ds_read_b64_tr_b16 v[98:99], v5 offset:16384
    v_mfma_f32_16x16x32_bf16 v[168:171], v[64:67], v[16:19], v[168:171]
    ds_read_b64_tr_b16 v[100:101], v6 offset:14336
    v_mfma_f32_16x16x32_bf16 v[172:175], v[64:67], v[20:23], v[172:175]
    ds_read_b64_tr_b16 v[102:103], v6 offset:16128
    v_mfma_f32_16x16x32_bf16 v[176:179], v[64:67], v[24:27], v[176:179]
    v_mfma_f32_16x16x32_bf16 v[180:183], v[64:67], v[28:31], v[180:183]
    v_mfma_f32_16x16x32_bf16 v[184:187], v[68:71], v[16:19], v[184:187]
    v_mfma_f32_16x16x32_bf16 v[188:191], v[68:71], v[20:23], v[188:191]
    v_mfma_f32_16x16x32_bf16 v[192:195], v[68:71], v[24:27], v[192:195]
    v_mfma_f32_16x16x32_bf16 v[196:199], v[68:71], v[28:31], v[196:199]
    v_mfma_f32_16x16x32_bf16 v[200:203], v[72:75], v[16:19], v[200:203]
    v_mfma_f32_16x16x32_bf16 v[204:207], v[72:75], v[20:23], v[204:207]
    v_mfma_f32_16x16x32_bf16 v[208:211], v[72:75], v[24:27], v[208:211]
    v_mfma_f32_16x16x32_bf16 v[212:215], v[72:75], v[28:31], v[212:215]
    s_waitcnt  lgkmcnt(0)
    s_barrier
    v_add_u32 v2, 45056, v2
    v_add_u32 v3, 45056, v3
    v_add_u32 v4, 45056, v4
    v_add_u32 v5, 45056, v5
    v_add_u32 v6, 45056, v6
    v_mfma_f32_16x16x32_bf16 v[104:107], v[76:79], v[32:35], v[104:107]
    ds_read_b64_tr_b16 v[48:49], v4 offset:0
    v_mfma_f32_16x16x32_bf16 v[108:111], v[76:79], v[36:39], v[108:111]
    ds_read_b64_tr_b16 v[50:51], v4 offset:1792
    v_mfma_f32_16x16x32_bf16 v[112:115], v[76:79], v[40:43], v[112:115]
    ds_read_b128 v[16:19], v2 offset:0
    v_mfma_f32_16x16x32_bf16 v[116:119], v[76:79], v[44:47], v[116:119]
    ds_read_b128 v[20:23], v2 offset:2048
    v_mfma_f32_16x16x32_bf16 v[120:123], v[80:83], v[32:35], v[120:123]
    ds_read_b128 v[24:27], v2 offset:4096
    v_mfma_f32_16x16x32_bf16 v[124:127], v[80:83], v[36:39], v[124:127]
    ds_read_b128 v[28:31], v2 offset:6144
    v_mfma_f32_16x16x32_bf16 v[128:131], v[80:83], v[40:43], v[128:131]
    ds_read_b64_tr_b16 v[52:53], v5 offset:0
    v_mfma_f32_16x16x32_bf16 v[132:135], v[80:83], v[44:47], v[132:135]
    ds_read_b64_tr_b16 v[54:55], v5 offset:1792
    v_mfma_f32_16x16x32_bf16 v[136:139], v[84:87], v[32:35], v[136:139]
    ds_read_b64_tr_b16 v[56:57], v4 offset:128
    v_mfma_f32_16x16x32_bf16 v[140:143], v[84:87], v[36:39], v[140:143]
    ds_read_b64_tr_b16 v[58:59], v4 offset:1920
    v_mfma_f32_16x16x32_bf16 v[144:147], v[84:87], v[40:43], v[144:147]
    ds_read_b64_tr_b16 v[60:61], v5 offset:128
    v_mfma_f32_16x16x32_bf16 v[148:151], v[84:87], v[44:47], v[148:151]
    ds_read_b64_tr_b16 v[62:63], v5 offset:1920
    v_mfma_f32_16x16x32_bf16 v[152:155], v[88:91], v[32:35], v[152:155]
    ds_read_b64_tr_b16 v[64:65], v4 offset:256
    v_mfma_f32_16x16x32_bf16 v[156:159], v[88:91], v[36:39], v[156:159]
    ds_read_b64_tr_b16 v[66:67], v4 offset:2048
    v_mfma_f32_16x16x32_bf16 v[160:163], v[88:91], v[40:43], v[160:163]
    ds_read_b64_tr_b16 v[68:69], v5 offset:256
    v_mfma_f32_16x16x32_bf16 v[164:167], v[88:91], v[44:47], v[164:167]
    ds_read_b64_tr_b16 v[70:71], v5 offset:2048
    v_mfma_f32_16x16x32_bf16 v[168:171], v[92:95], v[32:35], v[168:171]
    ds_read_b64_tr_b16 v[72:73], v6 offset:0
    v_mfma_f32_16x16x32_bf16 v[172:175], v[92:95], v[36:39], v[172:175]
    ds_read_b64_tr_b16 v[74:75], v6 offset:1792
    v_mfma_f32_16x16x32_bf16 v[176:179], v[92:95], v[40:43], v[176:179]
    v_mfma_f32_16x16x32_bf16 v[180:183], v[92:95], v[44:47], v[180:183]
    v_mfma_f32_16x16x32_bf16 v[184:187], v[96:99], v[32:35], v[184:187]
    v_mfma_f32_16x16x32_bf16 v[188:191], v[96:99], v[36:39], v[188:191]
    v_mfma_f32_16x16x32_bf16 v[192:195], v[96:99], v[40:43], v[192:195]
    v_mfma_f32_16x16x32_bf16 v[196:199], v[96:99], v[44:47], v[196:199]
    v_mfma_f32_16x16x32_bf16 v[200:203], v[100:103], v[32:35], v[200:203]
    v_mfma_f32_16x16x32_bf16 v[204:207], v[100:103], v[36:39], v[204:207]
    v_mfma_f32_16x16x32_bf16 v[208:211], v[100:103], v[40:43], v[208:211]
    v_mfma_f32_16x16x32_bf16 v[212:215], v[100:103], v[44:47], v[212:215]
    s_waitcnt lgkmcnt(0)
    v_mfma_f32_16x16x32_bf16 v[104:107], v[48:51], v[16:19], v[104:107]
    ds_read_b64_tr_b16 v[76:77], v4 offset:14336
    v_mfma_f32_16x16x32_bf16 v[108:111], v[48:51], v[20:23], v[108:111]
    ds_read_b64_tr_b16 v[78:79], v4 offset:16128
    v_mfma_f32_16x16x32_bf16 v[112:115], v[48:51], v[24:27], v[112:115]
    ds_read_b128 v[32:35], v3 offset:0
    v_mfma_f32_16x16x32_bf16 v[116:119], v[48:51], v[28:31], v[116:119]
    ds_read_b128 v[36:39], v3 offset:2048
    v_mfma_f32_16x16x32_bf16 v[120:123], v[52:55], v[16:19], v[120:123]
    ds_read_b128 v[40:43], v3 offset:4096
    v_mfma_f32_16x16x32_bf16 v[124:127], v[52:55], v[20:23], v[124:127]
    ds_read_b128 v[44:47], v3 offset:6144
    v_mfma_f32_16x16x32_bf16 v[128:131], v[52:55], v[24:27], v[128:131]
    ds_read_b64_tr_b16 v[80:81], v5 offset:14336
    v_mfma_f32_16x16x32_bf16 v[132:135], v[52:55], v[28:31], v[132:135]
    ds_read_b64_tr_b16 v[82:83], v5 offset:16128
    v_mfma_f32_16x16x32_bf16 v[136:139], v[56:59], v[16:19], v[136:139]
    ds_read_b64_tr_b16 v[84:85], v4 offset:14464
    v_mfma_f32_16x16x32_bf16 v[140:143], v[56:59], v[20:23], v[140:143]
    ds_read_b64_tr_b16 v[86:87], v4 offset:16256
    v_mfma_f32_16x16x32_bf16 v[144:147], v[56:59], v[24:27], v[144:147]
    ds_read_b64_tr_b16 v[88:89], v5 offset:14464
    v_mfma_f32_16x16x32_bf16 v[148:151], v[56:59], v[28:31], v[148:151]
    ds_read_b64_tr_b16 v[90:91], v5 offset:16256
    v_mfma_f32_16x16x32_bf16 v[152:155], v[60:63], v[16:19], v[152:155]
    ds_read_b64_tr_b16 v[92:93], v4 offset:14592
    v_mfma_f32_16x16x32_bf16 v[156:159], v[60:63], v[20:23], v[156:159]
    ds_read_b64_tr_b16 v[94:95], v4 offset:16384
    v_mfma_f32_16x16x32_bf16 v[160:163], v[60:63], v[24:27], v[160:163]
    ds_read_b64_tr_b16 v[96:97], v5 offset:14592
    v_mfma_f32_16x16x32_bf16 v[164:167], v[60:63], v[28:31], v[164:167]
    ds_read_b64_tr_b16 v[98:99], v5 offset:16384
    v_mfma_f32_16x16x32_bf16 v[168:171], v[64:67], v[16:19], v[168:171]
    ds_read_b64_tr_b16 v[100:101], v6 offset:14336
    v_mfma_f32_16x16x32_bf16 v[172:175], v[64:67], v[20:23], v[172:175]
    ds_read_b64_tr_b16 v[102:103], v6 offset:16128
    v_mfma_f32_16x16x32_bf16 v[176:179], v[64:67], v[24:27], v[176:179]
    v_mfma_f32_16x16x32_bf16 v[180:183], v[64:67], v[28:31], v[180:183]
    v_mfma_f32_16x16x32_bf16 v[184:187], v[68:71], v[16:19], v[184:187]
    v_mfma_f32_16x16x32_bf16 v[188:191], v[68:71], v[20:23], v[188:191]
    v_mfma_f32_16x16x32_bf16 v[192:195], v[68:71], v[24:27], v[192:195]
    v_mfma_f32_16x16x32_bf16 v[196:199], v[68:71], v[28:31], v[196:199]
    v_mfma_f32_16x16x32_bf16 v[200:203], v[72:75], v[16:19], v[200:203]
    v_mfma_f32_16x16x32_bf16 v[204:207], v[72:75], v[20:23], v[204:207]
    v_mfma_f32_16x16x32_bf16 v[208:211], v[72:75], v[24:27], v[208:211]
    v_mfma_f32_16x16x32_bf16 v[212:215], v[72:75], v[28:31], v[212:215]
    s_waitcnt  lgkmcnt(0)
    s_barrier
    v_add_u32 v2, 45056, v2
    v_add_u32 v3, 45056, v3
    v_add_u32 v4, 45056, v4
    v_add_u32 v5, 45056, v5
    v_add_u32 v6, 45056, v6
    v_mfma_f32_16x16x32_bf16 v[104:107], v[76:79], v[32:35], v[104:107]
    ds_read_b64_tr_b16 v[48:49], v4 offset:0
    v_mfma_f32_16x16x32_bf16 v[108:111], v[76:79], v[36:39], v[108:111]
    ds_read_b64_tr_b16 v[50:51], v4 offset:1792
    v_mfma_f32_16x16x32_bf16 v[112:115], v[76:79], v[40:43], v[112:115]
    ds_read_b128 v[16:19], v2 offset:0
    v_mfma_f32_16x16x32_bf16 v[116:119], v[76:79], v[44:47], v[116:119]
    ds_read_b128 v[20:23], v2 offset:2048
    v_mfma_f32_16x16x32_bf16 v[120:123], v[80:83], v[32:35], v[120:123]
    ds_read_b128 v[24:27], v2 offset:4096
    v_mfma_f32_16x16x32_bf16 v[124:127], v[80:83], v[36:39], v[124:127]
    ds_read_b128 v[28:31], v2 offset:6144
    v_mfma_f32_16x16x32_bf16 v[128:131], v[80:83], v[40:43], v[128:131]
    ds_read_b64_tr_b16 v[52:53], v5 offset:0
    v_mfma_f32_16x16x32_bf16 v[132:135], v[80:83], v[44:47], v[132:135]
    ds_read_b64_tr_b16 v[54:55], v5 offset:1792
    v_mfma_f32_16x16x32_bf16 v[136:139], v[84:87], v[32:35], v[136:139]
    ds_read_b64_tr_b16 v[56:57], v4 offset:128
    v_mfma_f32_16x16x32_bf16 v[140:143], v[84:87], v[36:39], v[140:143]
    ds_read_b64_tr_b16 v[58:59], v4 offset:1920
    v_mfma_f32_16x16x32_bf16 v[144:147], v[84:87], v[40:43], v[144:147]
    ds_read_b64_tr_b16 v[60:61], v5 offset:128
    v_mfma_f32_16x16x32_bf16 v[148:151], v[84:87], v[44:47], v[148:151]
    ds_read_b64_tr_b16 v[62:63], v5 offset:1920
    v_mfma_f32_16x16x32_bf16 v[152:155], v[88:91], v[32:35], v[152:155]
    ds_read_b64_tr_b16 v[64:65], v4 offset:256
    v_mfma_f32_16x16x32_bf16 v[156:159], v[88:91], v[36:39], v[156:159]
    ds_read_b64_tr_b16 v[66:67], v4 offset:2048
    v_mfma_f32_16x16x32_bf16 v[160:163], v[88:91], v[40:43], v[160:163]
    ds_read_b64_tr_b16 v[68:69], v5 offset:256
    v_mfma_f32_16x16x32_bf16 v[164:167], v[88:91], v[44:47], v[164:167]
    ds_read_b64_tr_b16 v[70:71], v5 offset:2048
    v_mfma_f32_16x16x32_bf16 v[168:171], v[92:95], v[32:35], v[168:171]
    ds_read_b64_tr_b16 v[72:73], v6 offset:0
    v_mfma_f32_16x16x32_bf16 v[172:175], v[92:95], v[36:39], v[172:175]
    ds_read_b64_tr_b16 v[74:75], v6 offset:1792
    v_mfma_f32_16x16x32_bf16 v[176:179], v[92:95], v[40:43], v[176:179]
    v_mfma_f32_16x16x32_bf16 v[180:183], v[92:95], v[44:47], v[180:183]
    v_mfma_f32_16x16x32_bf16 v[184:187], v[96:99], v[32:35], v[184:187]
    v_mfma_f32_16x16x32_bf16 v[188:191], v[96:99], v[36:39], v[188:191]
    v_mfma_f32_16x16x32_bf16 v[192:195], v[96:99], v[40:43], v[192:195]
    v_mfma_f32_16x16x32_bf16 v[196:199], v[96:99], v[44:47], v[196:199]
    v_mfma_f32_16x16x32_bf16 v[200:203], v[100:103], v[32:35], v[200:203]
    v_mfma_f32_16x16x32_bf16 v[204:207], v[100:103], v[36:39], v[204:207]
    v_mfma_f32_16x16x32_bf16 v[208:211], v[100:103], v[40:43], v[208:211]
    v_mfma_f32_16x16x32_bf16 v[212:215], v[100:103], v[44:47], v[212:215]
    s_waitcnt lgkmcnt(0)
    v_mfma_f32_16x16x32_bf16 v[104:107], v[48:51], v[16:19], v[104:107]
    ds_read_b64_tr_b16 v[76:77], v4 offset:14336
    v_mfma_f32_16x16x32_bf16 v[108:111], v[48:51], v[20:23], v[108:111]
    ds_read_b64_tr_b16 v[78:79], v4 offset:16128
    v_mfma_f32_16x16x32_bf16 v[112:115], v[48:51], v[24:27], v[112:115]
    ds_read_b128 v[32:35], v3 offset:0
    v_mfma_f32_16x16x32_bf16 v[116:119], v[48:51], v[28:31], v[116:119]
    ds_read_b128 v[36:39], v3 offset:2048
    v_mfma_f32_16x16x32_bf16 v[120:123], v[52:55], v[16:19], v[120:123]
    ds_read_b128 v[40:43], v3 offset:4096
    v_mfma_f32_16x16x32_bf16 v[124:127], v[52:55], v[20:23], v[124:127]
    ds_read_b128 v[44:47], v3 offset:6144
    v_mfma_f32_16x16x32_bf16 v[128:131], v[52:55], v[24:27], v[128:131]
    ds_read_b64_tr_b16 v[80:81], v5 offset:14336
    v_mfma_f32_16x16x32_bf16 v[132:135], v[52:55], v[28:31], v[132:135]
    ds_read_b64_tr_b16 v[82:83], v5 offset:16128
    v_mfma_f32_16x16x32_bf16 v[136:139], v[56:59], v[16:19], v[136:139]
    ds_read_b64_tr_b16 v[84:85], v4 offset:14464
    v_mfma_f32_16x16x32_bf16 v[140:143], v[56:59], v[20:23], v[140:143]
    ds_read_b64_tr_b16 v[86:87], v4 offset:16256
    v_mfma_f32_16x16x32_bf16 v[144:147], v[56:59], v[24:27], v[144:147]
    ds_read_b64_tr_b16 v[88:89], v5 offset:14464
    v_mfma_f32_16x16x32_bf16 v[148:151], v[56:59], v[28:31], v[148:151]
    ds_read_b64_tr_b16 v[90:91], v5 offset:16256
    v_mfma_f32_16x16x32_bf16 v[152:155], v[60:63], v[16:19], v[152:155]
    ds_read_b64_tr_b16 v[92:93], v4 offset:14592
    v_mfma_f32_16x16x32_bf16 v[156:159], v[60:63], v[20:23], v[156:159]
    ds_read_b64_tr_b16 v[94:95], v4 offset:16384
    v_mfma_f32_16x16x32_bf16 v[160:163], v[60:63], v[24:27], v[160:163]
    ds_read_b64_tr_b16 v[96:97], v5 offset:14592
    v_mfma_f32_16x16x32_bf16 v[164:167], v[60:63], v[28:31], v[164:167]
    ds_read_b64_tr_b16 v[98:99], v5 offset:16384
    v_mfma_f32_16x16x32_bf16 v[168:171], v[64:67], v[16:19], v[168:171]
    ds_read_b64_tr_b16 v[100:101], v6 offset:14336
    v_mfma_f32_16x16x32_bf16 v[172:175], v[64:67], v[20:23], v[172:175]
    ds_read_b64_tr_b16 v[102:103], v6 offset:16128
    v_mfma_f32_16x16x32_bf16 v[176:179], v[64:67], v[24:27], v[176:179]
    v_mfma_f32_16x16x32_bf16 v[180:183], v[64:67], v[28:31], v[180:183]
    v_mfma_f32_16x16x32_bf16 v[184:187], v[68:71], v[16:19], v[184:187]
    v_mfma_f32_16x16x32_bf16 v[188:191], v[68:71], v[20:23], v[188:191]
    v_mfma_f32_16x16x32_bf16 v[192:195], v[68:71], v[24:27], v[192:195]
    v_mfma_f32_16x16x32_bf16 v[196:199], v[68:71], v[28:31], v[196:199]
    v_mfma_f32_16x16x32_bf16 v[200:203], v[72:75], v[16:19], v[200:203]
    v_mfma_f32_16x16x32_bf16 v[204:207], v[72:75], v[20:23], v[204:207]
    v_mfma_f32_16x16x32_bf16 v[208:211], v[72:75], v[24:27], v[208:211]
    v_mfma_f32_16x16x32_bf16 v[212:215], v[72:75], v[28:31], v[212:215]
    s_waitcnt  lgkmcnt(0)
    s_barrier
    v_add_u32 v2, 4294877184, v2
    v_add_u32 v3, 4294877184, v3
    v_add_u32 v4, 4294877184, v4
    v_add_u32 v5, 4294877184, v5
    v_add_u32 v6, 4294877184, v6
    v_mfma_f32_16x16x32_bf16 v[104:107], v[76:79], v[32:35], v[104:107]
    ds_read_b64_tr_b16 v[48:49], v4 offset:0
    v_mfma_f32_16x16x32_bf16 v[108:111], v[76:79], v[36:39], v[108:111]
    ds_read_b64_tr_b16 v[50:51], v4 offset:1792
    v_mfma_f32_16x16x32_bf16 v[112:115], v[76:79], v[40:43], v[112:115]
    ds_read_b128 v[16:19], v2 offset:0
    v_mfma_f32_16x16x32_bf16 v[116:119], v[76:79], v[44:47], v[116:119]
    ds_read_b128 v[20:23], v2 offset:2048
    v_mfma_f32_16x16x32_bf16 v[120:123], v[80:83], v[32:35], v[120:123]
    ds_read_b128 v[24:27], v2 offset:4096
    v_mfma_f32_16x16x32_bf16 v[124:127], v[80:83], v[36:39], v[124:127]
    ds_read_b128 v[28:31], v2 offset:6144
    v_mfma_f32_16x16x32_bf16 v[128:131], v[80:83], v[40:43], v[128:131]
    ds_read_b64_tr_b16 v[52:53], v5 offset:0
    v_mfma_f32_16x16x32_bf16 v[132:135], v[80:83], v[44:47], v[132:135]
    ds_read_b64_tr_b16 v[54:55], v5 offset:1792
    v_mfma_f32_16x16x32_bf16 v[136:139], v[84:87], v[32:35], v[136:139]
    ds_read_b64_tr_b16 v[56:57], v4 offset:128
    v_mfma_f32_16x16x32_bf16 v[140:143], v[84:87], v[36:39], v[140:143]
    ds_read_b64_tr_b16 v[58:59], v4 offset:1920
    v_mfma_f32_16x16x32_bf16 v[144:147], v[84:87], v[40:43], v[144:147]
    ds_read_b64_tr_b16 v[60:61], v5 offset:128
    v_mfma_f32_16x16x32_bf16 v[148:151], v[84:87], v[44:47], v[148:151]
    ds_read_b64_tr_b16 v[62:63], v5 offset:1920
    v_mfma_f32_16x16x32_bf16 v[152:155], v[88:91], v[32:35], v[152:155]
    ds_read_b64_tr_b16 v[64:65], v4 offset:256
    v_mfma_f32_16x16x32_bf16 v[156:159], v[88:91], v[36:39], v[156:159]
    ds_read_b64_tr_b16 v[66:67], v4 offset:2048
    v_mfma_f32_16x16x32_bf16 v[160:163], v[88:91], v[40:43], v[160:163]
    ds_read_b64_tr_b16 v[68:69], v5 offset:256
    v_mfma_f32_16x16x32_bf16 v[164:167], v[88:91], v[44:47], v[164:167]
    ds_read_b64_tr_b16 v[70:71], v5 offset:2048
    v_mfma_f32_16x16x32_bf16 v[168:171], v[92:95], v[32:35], v[168:171]
    ds_read_b64_tr_b16 v[72:73], v6 offset:0
    v_mfma_f32_16x16x32_bf16 v[172:175], v[92:95], v[36:39], v[172:175]
    ds_read_b64_tr_b16 v[74:75], v6 offset:1792
    v_mfma_f32_16x16x32_bf16 v[176:179], v[92:95], v[40:43], v[176:179]
    v_mfma_f32_16x16x32_bf16 v[180:183], v[92:95], v[44:47], v[180:183]
    v_mfma_f32_16x16x32_bf16 v[184:187], v[96:99], v[32:35], v[184:187]
    v_mfma_f32_16x16x32_bf16 v[188:191], v[96:99], v[36:39], v[188:191]
    v_mfma_f32_16x16x32_bf16 v[192:195], v[96:99], v[40:43], v[192:195]
    v_mfma_f32_16x16x32_bf16 v[196:199], v[96:99], v[44:47], v[196:199]
    v_mfma_f32_16x16x32_bf16 v[200:203], v[100:103], v[32:35], v[200:203]
    v_mfma_f32_16x16x32_bf16 v[204:207], v[100:103], v[36:39], v[204:207]
    v_mfma_f32_16x16x32_bf16 v[208:211], v[100:103], v[40:43], v[208:211]
    v_mfma_f32_16x16x32_bf16 v[212:215], v[100:103], v[44:47], v[212:215]
    s_waitcnt lgkmcnt(0)
    v_mfma_f32_16x16x32_bf16 v[104:107], v[48:51], v[16:19], v[104:107]
    ds_read_b64_tr_b16 v[76:77], v4 offset:14336
    v_mfma_f32_16x16x32_bf16 v[108:111], v[48:51], v[20:23], v[108:111]
    ds_read_b64_tr_b16 v[78:79], v4 offset:16128
    v_mfma_f32_16x16x32_bf16 v[112:115], v[48:51], v[24:27], v[112:115]
    ds_read_b128 v[32:35], v3 offset:0
    v_mfma_f32_16x16x32_bf16 v[116:119], v[48:51], v[28:31], v[116:119]
    ds_read_b128 v[36:39], v3 offset:2048
    v_mfma_f32_16x16x32_bf16 v[120:123], v[52:55], v[16:19], v[120:123]
    ds_read_b128 v[40:43], v3 offset:4096
    v_mfma_f32_16x16x32_bf16 v[124:127], v[52:55], v[20:23], v[124:127]
    ds_read_b128 v[44:47], v3 offset:6144
    v_mfma_f32_16x16x32_bf16 v[128:131], v[52:55], v[24:27], v[128:131]
    ds_read_b64_tr_b16 v[80:81], v5 offset:14336
    v_mfma_f32_16x16x32_bf16 v[132:135], v[52:55], v[28:31], v[132:135]
    ds_read_b64_tr_b16 v[82:83], v5 offset:16128
    v_mfma_f32_16x16x32_bf16 v[136:139], v[56:59], v[16:19], v[136:139]
    ds_read_b64_tr_b16 v[84:85], v4 offset:14464
    v_mfma_f32_16x16x32_bf16 v[140:143], v[56:59], v[20:23], v[140:143]
    ds_read_b64_tr_b16 v[86:87], v4 offset:16256
    v_mfma_f32_16x16x32_bf16 v[144:147], v[56:59], v[24:27], v[144:147]
    ds_read_b64_tr_b16 v[88:89], v5 offset:14464
    v_mfma_f32_16x16x32_bf16 v[148:151], v[56:59], v[28:31], v[148:151]
    ds_read_b64_tr_b16 v[90:91], v5 offset:16256
    v_mfma_f32_16x16x32_bf16 v[152:155], v[60:63], v[16:19], v[152:155]
    ds_read_b64_tr_b16 v[92:93], v4 offset:14592
    v_mfma_f32_16x16x32_bf16 v[156:159], v[60:63], v[20:23], v[156:159]
    ds_read_b64_tr_b16 v[94:95], v4 offset:16384
    v_mfma_f32_16x16x32_bf16 v[160:163], v[60:63], v[24:27], v[160:163]
    ds_read_b64_tr_b16 v[96:97], v5 offset:14592
    v_mfma_f32_16x16x32_bf16 v[164:167], v[60:63], v[28:31], v[164:167]
    ds_read_b64_tr_b16 v[98:99], v5 offset:16384
    v_mfma_f32_16x16x32_bf16 v[168:171], v[64:67], v[16:19], v[168:171]
    ds_read_b64_tr_b16 v[100:101], v6 offset:14336
    v_mfma_f32_16x16x32_bf16 v[172:175], v[64:67], v[20:23], v[172:175]
    ds_read_b64_tr_b16 v[102:103], v6 offset:16128
    v_mfma_f32_16x16x32_bf16 v[176:179], v[64:67], v[24:27], v[176:179]
    v_mfma_f32_16x16x32_bf16 v[180:183], v[64:67], v[28:31], v[180:183]
    v_mfma_f32_16x16x32_bf16 v[184:187], v[68:71], v[16:19], v[184:187]
    v_mfma_f32_16x16x32_bf16 v[188:191], v[68:71], v[20:23], v[188:191]
    v_mfma_f32_16x16x32_bf16 v[192:195], v[68:71], v[24:27], v[192:195]
    v_mfma_f32_16x16x32_bf16 v[196:199], v[68:71], v[28:31], v[196:199]
    v_mfma_f32_16x16x32_bf16 v[200:203], v[72:75], v[16:19], v[200:203]
    v_mfma_f32_16x16x32_bf16 v[204:207], v[72:75], v[20:23], v[204:207]
    v_mfma_f32_16x16x32_bf16 v[208:211], v[72:75], v[24:27], v[208:211]
    v_mfma_f32_16x16x32_bf16 v[212:215], v[72:75], v[28:31], v[212:215]
    s_waitcnt  lgkmcnt(0)
    s_barrier
    v_add_u32 v2, 45056, v2
    v_add_u32 v3, 45056, v3
    v_add_u32 v4, 45056, v4
    v_add_u32 v5, 45056, v5
    v_add_u32 v6, 45056, v6
    v_mfma_f32_16x16x32_bf16 v[104:107], v[76:79], v[32:35], v[104:107]
    ds_read_b64_tr_b16 v[48:49], v4 offset:0
    v_mfma_f32_16x16x32_bf16 v[108:111], v[76:79], v[36:39], v[108:111]
    ds_read_b64_tr_b16 v[50:51], v4 offset:1792
    v_mfma_f32_16x16x32_bf16 v[112:115], v[76:79], v[40:43], v[112:115]
    ds_read_b128 v[16:19], v2 offset:0
    v_mfma_f32_16x16x32_bf16 v[116:119], v[76:79], v[44:47], v[116:119]
    ds_read_b128 v[20:23], v2 offset:2048
    v_mfma_f32_16x16x32_bf16 v[120:123], v[80:83], v[32:35], v[120:123]
    ds_read_b128 v[24:27], v2 offset:4096
    v_mfma_f32_16x16x32_bf16 v[124:127], v[80:83], v[36:39], v[124:127]
    ds_read_b128 v[28:31], v2 offset:6144
    v_mfma_f32_16x16x32_bf16 v[128:131], v[80:83], v[40:43], v[128:131]
    ds_read_b64_tr_b16 v[52:53], v5 offset:0
    v_mfma_f32_16x16x32_bf16 v[132:135], v[80:83], v[44:47], v[132:135]
    ds_read_b64_tr_b16 v[54:55], v5 offset:1792
    v_mfma_f32_16x16x32_bf16 v[136:139], v[84:87], v[32:35], v[136:139]
    ds_read_b64_tr_b16 v[56:57], v4 offset:128
    v_mfma_f32_16x16x32_bf16 v[140:143], v[84:87], v[36:39], v[140:143]
    ds_read_b64_tr_b16 v[58:59], v4 offset:1920
    v_mfma_f32_16x16x32_bf16 v[144:147], v[84:87], v[40:43], v[144:147]
    ds_read_b64_tr_b16 v[60:61], v5 offset:128
    v_mfma_f32_16x16x32_bf16 v[148:151], v[84:87], v[44:47], v[148:151]
    ds_read_b64_tr_b16 v[62:63], v5 offset:1920
    v_mfma_f32_16x16x32_bf16 v[152:155], v[88:91], v[32:35], v[152:155]
    ds_read_b64_tr_b16 v[64:65], v4 offset:256
    v_mfma_f32_16x16x32_bf16 v[156:159], v[88:91], v[36:39], v[156:159]
    ds_read_b64_tr_b16 v[66:67], v4 offset:2048
    v_mfma_f32_16x16x32_bf16 v[160:163], v[88:91], v[40:43], v[160:163]
    ds_read_b64_tr_b16 v[68:69], v5 offset:256
    v_mfma_f32_16x16x32_bf16 v[164:167], v[88:91], v[44:47], v[164:167]
    ds_read_b64_tr_b16 v[70:71], v5 offset:2048
    v_mfma_f32_16x16x32_bf16 v[168:171], v[92:95], v[32:35], v[168:171]
    ds_read_b64_tr_b16 v[72:73], v6 offset:0
    v_mfma_f32_16x16x32_bf16 v[172:175], v[92:95], v[36:39], v[172:175]
    ds_read_b64_tr_b16 v[74:75], v6 offset:1792
    v_mfma_f32_16x16x32_bf16 v[176:179], v[92:95], v[40:43], v[176:179]
    v_mfma_f32_16x16x32_bf16 v[180:183], v[92:95], v[44:47], v[180:183]
    v_mfma_f32_16x16x32_bf16 v[184:187], v[96:99], v[32:35], v[184:187]
    v_mfma_f32_16x16x32_bf16 v[188:191], v[96:99], v[36:39], v[188:191]
    v_mfma_f32_16x16x32_bf16 v[192:195], v[96:99], v[40:43], v[192:195]
    v_mfma_f32_16x16x32_bf16 v[196:199], v[96:99], v[44:47], v[196:199]
    v_mfma_f32_16x16x32_bf16 v[200:203], v[100:103], v[32:35], v[200:203]
    v_mfma_f32_16x16x32_bf16 v[204:207], v[100:103], v[36:39], v[204:207]
    v_mfma_f32_16x16x32_bf16 v[208:211], v[100:103], v[40:43], v[208:211]
    v_mfma_f32_16x16x32_bf16 v[212:215], v[100:103], v[44:47], v[212:215]
    s_waitcnt lgkmcnt(0)
    v_mfma_f32_16x16x32_bf16 v[104:107], v[48:51], v[16:19], v[104:107]
    ds_read_b64_tr_b16 v[76:77], v4 offset:14336
    v_mfma_f32_16x16x32_bf16 v[108:111], v[48:51], v[20:23], v[108:111]
    ds_read_b64_tr_b16 v[78:79], v4 offset:16128
    v_mfma_f32_16x16x32_bf16 v[112:115], v[48:51], v[24:27], v[112:115]
    ds_read_b128 v[32:35], v3 offset:0
    v_mfma_f32_16x16x32_bf16 v[116:119], v[48:51], v[28:31], v[116:119]
    ds_read_b128 v[36:39], v3 offset:2048
    v_mfma_f32_16x16x32_bf16 v[120:123], v[52:55], v[16:19], v[120:123]
    ds_read_b128 v[40:43], v3 offset:4096
    v_mfma_f32_16x16x32_bf16 v[124:127], v[52:55], v[20:23], v[124:127]
    ds_read_b128 v[44:47], v3 offset:6144
    v_mfma_f32_16x16x32_bf16 v[128:131], v[52:55], v[24:27], v[128:131]
    ds_read_b64_tr_b16 v[80:81], v5 offset:14336
    v_mfma_f32_16x16x32_bf16 v[132:135], v[52:55], v[28:31], v[132:135]
    ds_read_b64_tr_b16 v[82:83], v5 offset:16128
    v_mfma_f32_16x16x32_bf16 v[136:139], v[56:59], v[16:19], v[136:139]
    ds_read_b64_tr_b16 v[84:85], v4 offset:14464
    v_mfma_f32_16x16x32_bf16 v[140:143], v[56:59], v[20:23], v[140:143]
    ds_read_b64_tr_b16 v[86:87], v4 offset:16256
    v_mfma_f32_16x16x32_bf16 v[144:147], v[56:59], v[24:27], v[144:147]
    ds_read_b64_tr_b16 v[88:89], v5 offset:14464
    v_mfma_f32_16x16x32_bf16 v[148:151], v[56:59], v[28:31], v[148:151]
    ds_read_b64_tr_b16 v[90:91], v5 offset:16256
    v_mfma_f32_16x16x32_bf16 v[152:155], v[60:63], v[16:19], v[152:155]
    ds_read_b64_tr_b16 v[92:93], v4 offset:14592
    v_mfma_f32_16x16x32_bf16 v[156:159], v[60:63], v[20:23], v[156:159]
    ds_read_b64_tr_b16 v[94:95], v4 offset:16384
    v_mfma_f32_16x16x32_bf16 v[160:163], v[60:63], v[24:27], v[160:163]
    ds_read_b64_tr_b16 v[96:97], v5 offset:14592
    v_mfma_f32_16x16x32_bf16 v[164:167], v[60:63], v[28:31], v[164:167]
    ds_read_b64_tr_b16 v[98:99], v5 offset:16384
    v_mfma_f32_16x16x32_bf16 v[168:171], v[64:67], v[16:19], v[168:171]
    ds_read_b64_tr_b16 v[100:101], v6 offset:14336
    v_mfma_f32_16x16x32_bf16 v[172:175], v[64:67], v[20:23], v[172:175]
    ds_read_b64_tr_b16 v[102:103], v6 offset:16128
    v_mfma_f32_16x16x32_bf16 v[176:179], v[64:67], v[24:27], v[176:179]
    v_mfma_f32_16x16x32_bf16 v[180:183], v[64:67], v[28:31], v[180:183]
    v_mfma_f32_16x16x32_bf16 v[184:187], v[68:71], v[16:19], v[184:187]
    v_mfma_f32_16x16x32_bf16 v[188:191], v[68:71], v[20:23], v[188:191]
    v_mfma_f32_16x16x32_bf16 v[192:195], v[68:71], v[24:27], v[192:195]
    v_mfma_f32_16x16x32_bf16 v[196:199], v[68:71], v[28:31], v[196:199]
    v_mfma_f32_16x16x32_bf16 v[200:203], v[72:75], v[16:19], v[200:203]
    v_mfma_f32_16x16x32_bf16 v[204:207], v[72:75], v[20:23], v[204:207]
    v_mfma_f32_16x16x32_bf16 v[208:211], v[72:75], v[24:27], v[208:211]
    v_mfma_f32_16x16x32_bf16 v[212:215], v[72:75], v[28:31], v[212:215]
    s_waitcnt  lgkmcnt(0)
    s_barrier
    v_add_u32 v2, 45056, v2
    v_add_u32 v3, 45056, v3
    v_add_u32 v4, 45056, v4
    v_add_u32 v5, 45056, v5
    v_add_u32 v6, 45056, v6
    v_mfma_f32_16x16x32_bf16 v[104:107], v[76:79], v[32:35], v[104:107]
    ds_read_b64_tr_b16 v[48:49], v4 offset:0
    v_mfma_f32_16x16x32_bf16 v[108:111], v[76:79], v[36:39], v[108:111]
    ds_read_b64_tr_b16 v[50:51], v4 offset:1792
    v_mfma_f32_16x16x32_bf16 v[112:115], v[76:79], v[40:43], v[112:115]
    ds_read_b128 v[16:19], v2 offset:0
    v_mfma_f32_16x16x32_bf16 v[116:119], v[76:79], v[44:47], v[116:119]
    ds_read_b128 v[20:23], v2 offset:2048
    v_mfma_f32_16x16x32_bf16 v[120:123], v[80:83], v[32:35], v[120:123]
    ds_read_b128 v[24:27], v2 offset:4096
    v_mfma_f32_16x16x32_bf16 v[124:127], v[80:83], v[36:39], v[124:127]
    ds_read_b128 v[28:31], v2 offset:6144
    v_mfma_f32_16x16x32_bf16 v[128:131], v[80:83], v[40:43], v[128:131]
    ds_read_b64_tr_b16 v[52:53], v5 offset:0
    v_mfma_f32_16x16x32_bf16 v[132:135], v[80:83], v[44:47], v[132:135]
    ds_read_b64_tr_b16 v[54:55], v5 offset:1792
    v_mfma_f32_16x16x32_bf16 v[136:139], v[84:87], v[32:35], v[136:139]
    ds_read_b64_tr_b16 v[56:57], v4 offset:128
    v_mfma_f32_16x16x32_bf16 v[140:143], v[84:87], v[36:39], v[140:143]
    ds_read_b64_tr_b16 v[58:59], v4 offset:1920
    v_mfma_f32_16x16x32_bf16 v[144:147], v[84:87], v[40:43], v[144:147]
    ds_read_b64_tr_b16 v[60:61], v5 offset:128
    v_mfma_f32_16x16x32_bf16 v[148:151], v[84:87], v[44:47], v[148:151]
    ds_read_b64_tr_b16 v[62:63], v5 offset:1920
    v_mfma_f32_16x16x32_bf16 v[152:155], v[88:91], v[32:35], v[152:155]
    ds_read_b64_tr_b16 v[64:65], v4 offset:256
    v_mfma_f32_16x16x32_bf16 v[156:159], v[88:91], v[36:39], v[156:159]
    ds_read_b64_tr_b16 v[66:67], v4 offset:2048
    v_mfma_f32_16x16x32_bf16 v[160:163], v[88:91], v[40:43], v[160:163]
    ds_read_b64_tr_b16 v[68:69], v5 offset:256
    v_mfma_f32_16x16x32_bf16 v[164:167], v[88:91], v[44:47], v[164:167]
    ds_read_b64_tr_b16 v[70:71], v5 offset:2048
    v_mfma_f32_16x16x32_bf16 v[168:171], v[92:95], v[32:35], v[168:171]
    ds_read_b64_tr_b16 v[72:73], v6 offset:0
    v_mfma_f32_16x16x32_bf16 v[172:175], v[92:95], v[36:39], v[172:175]
    ds_read_b64_tr_b16 v[74:75], v6 offset:1792
    v_mfma_f32_16x16x32_bf16 v[176:179], v[92:95], v[40:43], v[176:179]
    v_mfma_f32_16x16x32_bf16 v[180:183], v[92:95], v[44:47], v[180:183]
    v_mfma_f32_16x16x32_bf16 v[184:187], v[96:99], v[32:35], v[184:187]
    v_mfma_f32_16x16x32_bf16 v[188:191], v[96:99], v[36:39], v[188:191]
    v_mfma_f32_16x16x32_bf16 v[192:195], v[96:99], v[40:43], v[192:195]
    v_mfma_f32_16x16x32_bf16 v[196:199], v[96:99], v[44:47], v[196:199]
    v_mfma_f32_16x16x32_bf16 v[200:203], v[100:103], v[32:35], v[200:203]
    v_mfma_f32_16x16x32_bf16 v[204:207], v[100:103], v[36:39], v[204:207]
    v_mfma_f32_16x16x32_bf16 v[208:211], v[100:103], v[40:43], v[208:211]
    v_mfma_f32_16x16x32_bf16 v[212:215], v[100:103], v[44:47], v[212:215]
    s_waitcnt lgkmcnt(0)
    v_mfma_f32_16x16x32_bf16 v[104:107], v[48:51], v[16:19], v[104:107]
    ds_read_b64_tr_b16 v[76:77], v4 offset:14336
    v_mfma_f32_16x16x32_bf16 v[108:111], v[48:51], v[20:23], v[108:111]
    ds_read_b64_tr_b16 v[78:79], v4 offset:16128
    v_mfma_f32_16x16x32_bf16 v[112:115], v[48:51], v[24:27], v[112:115]
    ds_read_b128 v[32:35], v3 offset:0
    v_mfma_f32_16x16x32_bf16 v[116:119], v[48:51], v[28:31], v[116:119]
    ds_read_b128 v[36:39], v3 offset:2048
    v_mfma_f32_16x16x32_bf16 v[120:123], v[52:55], v[16:19], v[120:123]
    ds_read_b128 v[40:43], v3 offset:4096
    v_mfma_f32_16x16x32_bf16 v[124:127], v[52:55], v[20:23], v[124:127]
    ds_read_b128 v[44:47], v3 offset:6144
    v_mfma_f32_16x16x32_bf16 v[128:131], v[52:55], v[24:27], v[128:131]
    ds_read_b64_tr_b16 v[80:81], v5 offset:14336
    v_mfma_f32_16x16x32_bf16 v[132:135], v[52:55], v[28:31], v[132:135]
    ds_read_b64_tr_b16 v[82:83], v5 offset:16128
    v_mfma_f32_16x16x32_bf16 v[136:139], v[56:59], v[16:19], v[136:139]
    ds_read_b64_tr_b16 v[84:85], v4 offset:14464
    v_mfma_f32_16x16x32_bf16 v[140:143], v[56:59], v[20:23], v[140:143]
    ds_read_b64_tr_b16 v[86:87], v4 offset:16256
    v_mfma_f32_16x16x32_bf16 v[144:147], v[56:59], v[24:27], v[144:147]
    ds_read_b64_tr_b16 v[88:89], v5 offset:14464
    v_mfma_f32_16x16x32_bf16 v[148:151], v[56:59], v[28:31], v[148:151]
    ds_read_b64_tr_b16 v[90:91], v5 offset:16256
    v_mfma_f32_16x16x32_bf16 v[152:155], v[60:63], v[16:19], v[152:155]
    ds_read_b64_tr_b16 v[92:93], v4 offset:14592
    v_mfma_f32_16x16x32_bf16 v[156:159], v[60:63], v[20:23], v[156:159]
    ds_read_b64_tr_b16 v[94:95], v4 offset:16384
    v_mfma_f32_16x16x32_bf16 v[160:163], v[60:63], v[24:27], v[160:163]
    ds_read_b64_tr_b16 v[96:97], v5 offset:14592
    v_mfma_f32_16x16x32_bf16 v[164:167], v[60:63], v[28:31], v[164:167]
    ds_read_b64_tr_b16 v[98:99], v5 offset:16384
    v_mfma_f32_16x16x32_bf16 v[168:171], v[64:67], v[16:19], v[168:171]
    ds_read_b64_tr_b16 v[100:101], v6 offset:14336
    v_mfma_f32_16x16x32_bf16 v[172:175], v[64:67], v[20:23], v[172:175]
    ds_read_b64_tr_b16 v[102:103], v6 offset:16128
    v_mfma_f32_16x16x32_bf16 v[176:179], v[64:67], v[24:27], v[176:179]
    v_mfma_f32_16x16x32_bf16 v[180:183], v[64:67], v[28:31], v[180:183]
    v_mfma_f32_16x16x32_bf16 v[184:187], v[68:71], v[16:19], v[184:187]
    v_mfma_f32_16x16x32_bf16 v[188:191], v[68:71], v[20:23], v[188:191]
    v_mfma_f32_16x16x32_bf16 v[192:195], v[68:71], v[24:27], v[192:195]
    v_mfma_f32_16x16x32_bf16 v[196:199], v[68:71], v[28:31], v[196:199]
    v_mfma_f32_16x16x32_bf16 v[200:203], v[72:75], v[16:19], v[200:203]
    v_mfma_f32_16x16x32_bf16 v[204:207], v[72:75], v[20:23], v[204:207]
    v_mfma_f32_16x16x32_bf16 v[208:211], v[72:75], v[24:27], v[208:211]
    v_mfma_f32_16x16x32_bf16 v[212:215], v[72:75], v[28:31], v[212:215]
    s_waitcnt  lgkmcnt(0)
    s_barrier
    v_add_u32 v2, 4294877184, v2
    v_add_u32 v3, 4294877184, v3
    v_add_u32 v4, 4294877184, v4
    v_add_u32 v5, 4294877184, v5
    v_add_u32 v6, 4294877184, v6
    v_mfma_f32_16x16x32_bf16 v[104:107], v[76:79], v[32:35], v[104:107]
    ds_read_b64_tr_b16 v[48:49], v4 offset:0
    v_mfma_f32_16x16x32_bf16 v[108:111], v[76:79], v[36:39], v[108:111]
    ds_read_b64_tr_b16 v[50:51], v4 offset:1792
    v_mfma_f32_16x16x32_bf16 v[112:115], v[76:79], v[40:43], v[112:115]
    ds_read_b128 v[16:19], v2 offset:0
    v_mfma_f32_16x16x32_bf16 v[116:119], v[76:79], v[44:47], v[116:119]
    ds_read_b128 v[20:23], v2 offset:2048
    v_mfma_f32_16x16x32_bf16 v[120:123], v[80:83], v[32:35], v[120:123]
    ds_read_b128 v[24:27], v2 offset:4096
    v_mfma_f32_16x16x32_bf16 v[124:127], v[80:83], v[36:39], v[124:127]
    ds_read_b128 v[28:31], v2 offset:6144
    v_mfma_f32_16x16x32_bf16 v[128:131], v[80:83], v[40:43], v[128:131]
    ds_read_b64_tr_b16 v[52:53], v5 offset:0
    v_mfma_f32_16x16x32_bf16 v[132:135], v[80:83], v[44:47], v[132:135]
    ds_read_b64_tr_b16 v[54:55], v5 offset:1792
    v_mfma_f32_16x16x32_bf16 v[136:139], v[84:87], v[32:35], v[136:139]
    ds_read_b64_tr_b16 v[56:57], v4 offset:128
    v_mfma_f32_16x16x32_bf16 v[140:143], v[84:87], v[36:39], v[140:143]
    ds_read_b64_tr_b16 v[58:59], v4 offset:1920
    v_mfma_f32_16x16x32_bf16 v[144:147], v[84:87], v[40:43], v[144:147]
    ds_read_b64_tr_b16 v[60:61], v5 offset:128
    v_mfma_f32_16x16x32_bf16 v[148:151], v[84:87], v[44:47], v[148:151]
    ds_read_b64_tr_b16 v[62:63], v5 offset:1920
    v_mfma_f32_16x16x32_bf16 v[152:155], v[88:91], v[32:35], v[152:155]
    ds_read_b64_tr_b16 v[64:65], v4 offset:256
    v_mfma_f32_16x16x32_bf16 v[156:159], v[88:91], v[36:39], v[156:159]
    ds_read_b64_tr_b16 v[66:67], v4 offset:2048
    v_mfma_f32_16x16x32_bf16 v[160:163], v[88:91], v[40:43], v[160:163]
    ds_read_b64_tr_b16 v[68:69], v5 offset:256
    v_mfma_f32_16x16x32_bf16 v[164:167], v[88:91], v[44:47], v[164:167]
    ds_read_b64_tr_b16 v[70:71], v5 offset:2048
    v_mfma_f32_16x16x32_bf16 v[168:171], v[92:95], v[32:35], v[168:171]
    ds_read_b64_tr_b16 v[72:73], v6 offset:0
    v_mfma_f32_16x16x32_bf16 v[172:175], v[92:95], v[36:39], v[172:175]
    ds_read_b64_tr_b16 v[74:75], v6 offset:1792
    v_mfma_f32_16x16x32_bf16 v[176:179], v[92:95], v[40:43], v[176:179]
    v_mfma_f32_16x16x32_bf16 v[180:183], v[92:95], v[44:47], v[180:183]
    v_mfma_f32_16x16x32_bf16 v[184:187], v[96:99], v[32:35], v[184:187]
    v_mfma_f32_16x16x32_bf16 v[188:191], v[96:99], v[36:39], v[188:191]
    v_mfma_f32_16x16x32_bf16 v[192:195], v[96:99], v[40:43], v[192:195]
    v_mfma_f32_16x16x32_bf16 v[196:199], v[96:99], v[44:47], v[196:199]
    v_mfma_f32_16x16x32_bf16 v[200:203], v[100:103], v[32:35], v[200:203]
    v_mfma_f32_16x16x32_bf16 v[204:207], v[100:103], v[36:39], v[204:207]
    v_mfma_f32_16x16x32_bf16 v[208:211], v[100:103], v[40:43], v[208:211]
    v_mfma_f32_16x16x32_bf16 v[212:215], v[100:103], v[44:47], v[212:215]
    s_waitcnt lgkmcnt(0)
    v_mfma_f32_16x16x32_bf16 v[104:107], v[48:51], v[16:19], v[104:107]
    ds_read_b64_tr_b16 v[76:77], v4 offset:14336
    v_mfma_f32_16x16x32_bf16 v[108:111], v[48:51], v[20:23], v[108:111]
    ds_read_b64_tr_b16 v[78:79], v4 offset:16128
    v_mfma_f32_16x16x32_bf16 v[112:115], v[48:51], v[24:27], v[112:115]
    ds_read_b128 v[32:35], v3 offset:0
    v_mfma_f32_16x16x32_bf16 v[116:119], v[48:51], v[28:31], v[116:119]
    ds_read_b128 v[36:39], v3 offset:2048
    v_mfma_f32_16x16x32_bf16 v[120:123], v[52:55], v[16:19], v[120:123]
    ds_read_b128 v[40:43], v3 offset:4096
    v_mfma_f32_16x16x32_bf16 v[124:127], v[52:55], v[20:23], v[124:127]
    ds_read_b128 v[44:47], v3 offset:6144
    v_mfma_f32_16x16x32_bf16 v[128:131], v[52:55], v[24:27], v[128:131]
    ds_read_b64_tr_b16 v[80:81], v5 offset:14336
    v_mfma_f32_16x16x32_bf16 v[132:135], v[52:55], v[28:31], v[132:135]
    ds_read_b64_tr_b16 v[82:83], v5 offset:16128
    v_mfma_f32_16x16x32_bf16 v[136:139], v[56:59], v[16:19], v[136:139]
    ds_read_b64_tr_b16 v[84:85], v4 offset:14464
    v_mfma_f32_16x16x32_bf16 v[140:143], v[56:59], v[20:23], v[140:143]
    ds_read_b64_tr_b16 v[86:87], v4 offset:16256
    v_mfma_f32_16x16x32_bf16 v[144:147], v[56:59], v[24:27], v[144:147]
    ds_read_b64_tr_b16 v[88:89], v5 offset:14464
    v_mfma_f32_16x16x32_bf16 v[148:151], v[56:59], v[28:31], v[148:151]
    ds_read_b64_tr_b16 v[90:91], v5 offset:16256
    v_mfma_f32_16x16x32_bf16 v[152:155], v[60:63], v[16:19], v[152:155]
    ds_read_b64_tr_b16 v[92:93], v4 offset:14592
    v_mfma_f32_16x16x32_bf16 v[156:159], v[60:63], v[20:23], v[156:159]
    ds_read_b64_tr_b16 v[94:95], v4 offset:16384
    v_mfma_f32_16x16x32_bf16 v[160:163], v[60:63], v[24:27], v[160:163]
    ds_read_b64_tr_b16 v[96:97], v5 offset:14592
    v_mfma_f32_16x16x32_bf16 v[164:167], v[60:63], v[28:31], v[164:167]
    ds_read_b64_tr_b16 v[98:99], v5 offset:16384
    v_mfma_f32_16x16x32_bf16 v[168:171], v[64:67], v[16:19], v[168:171]
    ds_read_b64_tr_b16 v[100:101], v6 offset:14336
    v_mfma_f32_16x16x32_bf16 v[172:175], v[64:67], v[20:23], v[172:175]
    ds_read_b64_tr_b16 v[102:103], v6 offset:16128
    v_mfma_f32_16x16x32_bf16 v[176:179], v[64:67], v[24:27], v[176:179]
    v_mfma_f32_16x16x32_bf16 v[180:183], v[64:67], v[28:31], v[180:183]
    v_mfma_f32_16x16x32_bf16 v[184:187], v[68:71], v[16:19], v[184:187]
    v_mfma_f32_16x16x32_bf16 v[188:191], v[68:71], v[20:23], v[188:191]
    v_mfma_f32_16x16x32_bf16 v[192:195], v[68:71], v[24:27], v[192:195]
    v_mfma_f32_16x16x32_bf16 v[196:199], v[68:71], v[28:31], v[196:199]
    v_mfma_f32_16x16x32_bf16 v[200:203], v[72:75], v[16:19], v[200:203]
    v_mfma_f32_16x16x32_bf16 v[204:207], v[72:75], v[20:23], v[204:207]
    v_mfma_f32_16x16x32_bf16 v[208:211], v[72:75], v[24:27], v[208:211]
    v_mfma_f32_16x16x32_bf16 v[212:215], v[72:75], v[28:31], v[212:215]
    s_waitcnt  lgkmcnt(0)
    v_mov_b32 v7, 163712
    v_mov_b32 v3, 1
    s_mov_b64 exec, 1
    ds_add_u32 v7, v3 offset:48
    s_mov_b64 exec, -1
    v_mfma_f32_16x16x32_bf16 v[104:107], v[76:79], v[32:35], v[104:107]
    v_mfma_f32_16x16x32_bf16 v[108:111], v[76:79], v[36:39], v[108:111]
    v_mfma_f32_16x16x32_bf16 v[112:115], v[76:79], v[40:43], v[112:115]
    v_mfma_f32_16x16x32_bf16 v[116:119], v[76:79], v[44:47], v[116:119]
    v_mfma_f32_16x16x32_bf16 v[120:123], v[80:83], v[32:35], v[120:123]
    v_mfma_f32_16x16x32_bf16 v[124:127], v[80:83], v[36:39], v[124:127]
    v_mfma_f32_16x16x32_bf16 v[128:131], v[80:83], v[40:43], v[128:131]
    v_mfma_f32_16x16x32_bf16 v[132:135], v[80:83], v[44:47], v[132:135]
    v_mfma_f32_16x16x32_bf16 v[136:139], v[84:87], v[32:35], v[136:139]
    v_mfma_f32_16x16x32_bf16 v[140:143], v[84:87], v[36:39], v[140:143]
    v_mfma_f32_16x16x32_bf16 v[144:147], v[84:87], v[40:43], v[144:147]
    v_mfma_f32_16x16x32_bf16 v[148:151], v[84:87], v[44:47], v[148:151]
    v_mfma_f32_16x16x32_bf16 v[152:155], v[88:91], v[32:35], v[152:155]
    v_mfma_f32_16x16x32_bf16 v[156:159], v[88:91], v[36:39], v[156:159]
    v_mfma_f32_16x16x32_bf16 v[160:163], v[88:91], v[40:43], v[160:163]
    v_mfma_f32_16x16x32_bf16 v[164:167], v[88:91], v[44:47], v[164:167]
    v_mfma_f32_16x16x32_bf16 v[168:171], v[92:95], v[32:35], v[168:171]
    v_mfma_f32_16x16x32_bf16 v[172:175], v[92:95], v[36:39], v[172:175]
    v_mfma_f32_16x16x32_bf16 v[176:179], v[92:95], v[40:43], v[176:179]
    v_mfma_f32_16x16x32_bf16 v[180:183], v[92:95], v[44:47], v[180:183]
    v_mfma_f32_16x16x32_bf16 v[184:187], v[96:99], v[32:35], v[184:187]
    v_mfma_f32_16x16x32_bf16 v[188:191], v[96:99], v[36:39], v[188:191]
    v_mfma_f32_16x16x32_bf16 v[192:195], v[96:99], v[40:43], v[192:195]
    v_mfma_f32_16x16x32_bf16 v[196:199], v[96:99], v[44:47], v[196:199]
    v_mfma_f32_16x16x32_bf16 v[200:203], v[100:103], v[32:35], v[200:203]
    v_mfma_f32_16x16x32_bf16 v[204:207], v[100:103], v[36:39], v[204:207]
    v_mfma_f32_16x16x32_bf16 v[208:211], v[100:103], v[40:43], v[208:211]
    v_mfma_f32_16x16x32_bf16 v[212:215], v[100:103], v[44:47], v[212:215]
    s_waitcnt lgkmcnt(0)
    s_setprio 1
    ds_read_b32 v2, v7 offset:32
    s_mov_b32 s44, 0xbdd2d3e8
    s_mov_b32 s45, 0xbdd2d3e8
    v_mov_b32 v8, 0xc0135761
    v_mov_b32 v9, 0xc0135761
    s_lshl_b32 s37, s34, 6
    v_xor_b32 v10, s37, v12
    s_lshl_b32 s37, s36, 6
    v_xor_b32 v11, s37, v12
    s_mul_i32 s58, s28, 917504
    s_mul_i32 s59, s29, 7
    s_add_u32 s59, s59, s36
    s_lshl_b32 s59, s59, 13
    s_add_u32 s59, s59, s58
    s_lshr_b32 s60, s29, 1
    s_mul_i32 s60, s60, 7
    s_add_u32 s60, s60, 3
    s_lshl_b32 s60, s60, 14
    s_add_u32 s60, s60, s58
    s_lshl_b32 s37, s34, 3
    s_add_u32 s60, s60, s37
    s_waitcnt lgkmcnt(0)
    v_readfirstlane_b32 s63, v2
    s_lshl_b32 s37, s33, 7
    s_add_u32 s37, s37, 42008576
    v_and_b32 v5, 7, v0
    v_lshlrev_b32 v5, 7, v5
    s_and_b32 s55, s33, 0xf8
    s_lshl_b32 s55, s55, 7
    s_add_u32 s55, s55, 42008576
    v_mov_b32 v80, 0
    s_mov_b32 s50, 0
    s_cmp_eq_u32 s63, 2
    s_cbranch_scc0 gated__gslow
    s_add_u32 s61, s59, 0
    s_add_u32 s62, s61, 4096
    v_pk_mul_f32 v[16:17], v[104:105], v[104:105]
    v_pk_mul_f32 v[18:19], v[106:107], v[106:107]
    v_pk_mul_f32 v[20:21], v[120:121], v[120:121]
    v_pk_mul_f32 v[22:23], v[122:123], v[122:123]
    v_pk_fma_f32 v[16:17], v[16:17], s[44:45], v[8:9]
    v_pk_fma_f32 v[18:19], v[18:19], s[44:45], v[8:9]
    v_pk_fma_f32 v[20:21], v[20:21], s[44:45], v[8:9]
    v_pk_fma_f32 v[22:23], v[22:23], s[44:45], v[8:9]
    v_pk_mul_f32 v[16:17], v[16:17], v[104:105]
    v_pk_mul_f32 v[18:19], v[18:19], v[106:107]
    v_pk_mul_f32 v[20:21], v[20:21], v[120:121]
    v_pk_mul_f32 v[22:23], v[22:23], v[122:123]
    v_exp_f32 v16, v16
    v_exp_f32 v17, v17
    v_exp_f32 v18, v18
    v_exp_f32 v19, v19
    v_exp_f32 v20, v20
    v_exp_f32 v21, v21
    v_exp_f32 v22, v22
    v_exp_f32 v23, v23
    v_pk_add_f32 v[16:17], v[16:17], 1.0 op_sel_hi:[1,0]
    v_pk_add_f32 v[18:19], v[18:19], 1.0 op_sel_hi:[1,0]
    v_pk_add_f32 v[20:21], v[20:21], 1.0 op_sel_hi:[1,0]
    v_pk_add_f32 v[22:23], v[22:23], 1.0 op_sel_hi:[1,0]
    v_rcp_f32 v16, v16
    v_rcp_f32 v17, v17
    v_rcp_f32 v18, v18
    v_rcp_f32 v19, v19
    v_rcp_f32 v20, v20
    v_rcp_f32 v21, v21
    v_rcp_f32 v22, v22
    v_rcp_f32 v23, v23
    v_pk_mul_f32 v[16:17], v[16:17], v[104:105]
    v_pk_mul_f32 v[18:19], v[18:19], v[106:107]
    v_pk_mul_f32 v[20:21], v[20:21], v[120:121]
    v_pk_mul_f32 v[22:23], v[22:23], v[122:123]
    v_cvt_pk_bf16_f32 v48, v16, v17
    v_cvt_pk_bf16_f32 v49, v18, v19
    v_cvt_pk_bf16_f32 v50, v20, v21
    v_cvt_pk_bf16_f32 v51, v22, v23
    buffer_store_dwordx4 v[48:51], v10, s[12:15], s61 offen offset:0
    v_pk_mul_f32 v[24:25], v[108:109], v[108:109]
    v_pk_mul_f32 v[26:27], v[110:111], v[110:111]
    v_pk_mul_f32 v[28:29], v[124:125], v[124:125]
    v_pk_mul_f32 v[30:31], v[126:127], v[126:127]
    v_pk_fma_f32 v[24:25], v[24:25], s[44:45], v[8:9]
    v_pk_fma_f32 v[26:27], v[26:27], s[44:45], v[8:9]
    v_pk_fma_f32 v[28:29], v[28:29], s[44:45], v[8:9]
    v_pk_fma_f32 v[30:31], v[30:31], s[44:45], v[8:9]
    v_pk_mul_f32 v[24:25], v[24:25], v[108:109]
    v_pk_mul_f32 v[26:27], v[26:27], v[110:111]
    v_pk_mul_f32 v[28:29], v[28:29], v[124:125]
    v_pk_mul_f32 v[30:31], v[30:31], v[126:127]
    v_exp_f32 v24, v24
    v_exp_f32 v25, v25
    v_exp_f32 v26, v26
    v_exp_f32 v27, v27
    v_exp_f32 v28, v28
    v_exp_f32 v29, v29
    v_exp_f32 v30, v30
    v_exp_f32 v31, v31
    v_pk_add_f32 v[24:25], v[24:25], 1.0 op_sel_hi:[1,0]
    v_pk_add_f32 v[26:27], v[26:27], 1.0 op_sel_hi:[1,0]
    v_pk_add_f32 v[28:29], v[28:29], 1.0 op_sel_hi:[1,0]
    v_pk_add_f32 v[30:31], v[30:31], 1.0 op_sel_hi:[1,0]
    v_rcp_f32 v24, v24
    v_rcp_f32 v25, v25
    v_rcp_f32 v26, v26
    v_rcp_f32 v27, v27
    v_rcp_f32 v28, v28
    v_rcp_f32 v29, v29
    v_rcp_f32 v30, v30
    v_rcp_f32 v31, v31
    v_pk_mul_f32 v[24:25], v[24:25], v[108:109]
    v_pk_mul_f32 v[26:27], v[26:27], v[110:111]
    v_pk_mul_f32 v[28:29], v[28:29], v[124:125]
    v_pk_mul_f32 v[30:31], v[30:31], v[126:127]
    v_cvt_pk_bf16_f32 v52, v24, v25
    v_cvt_pk_bf16_f32 v53, v26, v27
    v_cvt_pk_bf16_f32 v54, v28, v29
    v_cvt_pk_bf16_f32 v55, v30, v31
    buffer_store_dwordx4 v[52:55], v10, s[12:15], s61 offen offset:2048
    v_pk_mul_f32 v[16:17], v[112:113], v[112:113]
    v_pk_mul_f32 v[18:19], v[114:115], v[114:115]
    v_pk_mul_f32 v[20:21], v[128:129], v[128:129]
    v_pk_mul_f32 v[22:23], v[130:131], v[130:131]
    v_pk_fma_f32 v[16:17], v[16:17], s[44:45], v[8:9]
    v_pk_fma_f32 v[18:19], v[18:19], s[44:45], v[8:9]
    v_pk_fma_f32 v[20:21], v[20:21], s[44:45], v[8:9]
    v_pk_fma_f32 v[22:23], v[22:23], s[44:45], v[8:9]
    v_pk_mul_f32 v[16:17], v[16:17], v[112:113]
    v_pk_mul_f32 v[18:19], v[18:19], v[114:115]
    v_pk_mul_f32 v[20:21], v[20:21], v[128:129]
    v_pk_mul_f32 v[22:23], v[22:23], v[130:131]
    v_exp_f32 v16, v16
    v_exp_f32 v17, v17
    v_exp_f32 v18, v18
    v_exp_f32 v19, v19
    v_exp_f32 v20, v20
    v_exp_f32 v21, v21
    v_exp_f32 v22, v22
    v_exp_f32 v23, v23
    v_pk_add_f32 v[16:17], v[16:17], 1.0 op_sel_hi:[1,0]
    v_pk_add_f32 v[18:19], v[18:19], 1.0 op_sel_hi:[1,0]
    v_pk_add_f32 v[20:21], v[20:21], 1.0 op_sel_hi:[1,0]
    v_pk_add_f32 v[22:23], v[22:23], 1.0 op_sel_hi:[1,0]
    v_rcp_f32 v16, v16
    v_rcp_f32 v17, v17
    v_rcp_f32 v18, v18
    v_rcp_f32 v19, v19
    v_rcp_f32 v20, v20
    v_rcp_f32 v21, v21
    v_rcp_f32 v22, v22
    v_rcp_f32 v23, v23
    v_pk_mul_f32 v[16:17], v[16:17], v[112:113]
    v_pk_mul_f32 v[18:19], v[18:19], v[114:115]
    v_pk_mul_f32 v[20:21], v[20:21], v[128:129]
    v_pk_mul_f32 v[22:23], v[22:23], v[130:131]
    v_cvt_pk_bf16_f32 v56, v16, v17
    v_cvt_pk_bf16_f32 v57, v18, v19
    v_cvt_pk_bf16_f32 v58, v20, v21
    v_cvt_pk_bf16_f32 v59, v22, v23
    buffer_store_dwordx4 v[56:59], v10, s[12:15], s62 offen offset:0
    v_pk_mul_f32 v[24:25], v[116:117], v[116:117]
    v_pk_mul_f32 v[26:27], v[118:119], v[118:119]
    v_pk_mul_f32 v[28:29], v[132:133], v[132:133]
    v_pk_mul_f32 v[30:31], v[134:135], v[134:135]
    v_pk_fma_f32 v[24:25], v[24:25], s[44:45], v[8:9]
    v_pk_fma_f32 v[26:27], v[26:27], s[44:45], v[8:9]
    v_pk_fma_f32 v[28:29], v[28:29], s[44:45], v[8:9]
    v_pk_fma_f32 v[30:31], v[30:31], s[44:45], v[8:9]
    v_pk_mul_f32 v[24:25], v[24:25], v[116:117]
    v_pk_mul_f32 v[26:27], v[26:27], v[118:119]
    v_pk_mul_f32 v[28:29], v[28:29], v[132:133]
    v_pk_mul_f32 v[30:31], v[30:31], v[134:135]
    v_exp_f32 v24, v24
    v_exp_f32 v25, v25
    v_exp_f32 v26, v26
    v_exp_f32 v27, v27
    v_exp_f32 v28, v28
    v_exp_f32 v29, v29
    v_exp_f32 v30, v30
    v_exp_f32 v31, v31
    v_pk_add_f32 v[24:25], v[24:25], 1.0 op_sel_hi:[1,0]
    v_pk_add_f32 v[26:27], v[26:27], 1.0 op_sel_hi:[1,0]
    v_pk_add_f32 v[28:29], v[28:29], 1.0 op_sel_hi:[1,0]
    v_pk_add_f32 v[30:31], v[30:31], 1.0 op_sel_hi:[1,0]
    v_rcp_f32 v24, v24
    v_rcp_f32 v25, v25
    v_rcp_f32 v26, v26
    v_rcp_f32 v27, v27
    v_rcp_f32 v28, v28
    v_rcp_f32 v29, v29
    v_rcp_f32 v30, v30
    v_rcp_f32 v31, v31
    v_pk_mul_f32 v[24:25], v[24:25], v[116:117]
    v_pk_mul_f32 v[26:27], v[26:27], v[118:119]
    v_pk_mul_f32 v[28:29], v[28:29], v[132:133]
    v_pk_mul_f32 v[30:31], v[30:31], v[134:135]
    v_cvt_pk_bf16_f32 v60, v24, v25
    v_cvt_pk_bf16_f32 v61, v26, v27
    v_cvt_pk_bf16_f32 v62, v28, v29
    v_cvt_pk_bf16_f32 v63, v30, v31
    buffer_store_dwordx4 v[60:63], v10, s[12:15], s62 offen offset:2048
    s_add_u32 s61, s59, 16384
    s_add_u32 s62, s61, 4096
    v_pk_mul_f32 v[16:17], v[136:137], v[136:137]
    v_pk_mul_f32 v[18:19], v[138:139], v[138:139]
    v_pk_mul_f32 v[20:21], v[152:153], v[152:153]
    v_pk_mul_f32 v[22:23], v[154:155], v[154:155]
    v_pk_fma_f32 v[16:17], v[16:17], s[44:45], v[8:9]
    v_pk_fma_f32 v[18:19], v[18:19], s[44:45], v[8:9]
    v_pk_fma_f32 v[20:21], v[20:21], s[44:45], v[8:9]
    v_pk_fma_f32 v[22:23], v[22:23], s[44:45], v[8:9]
    v_pk_mul_f32 v[16:17], v[16:17], v[136:137]
    v_pk_mul_f32 v[18:19], v[18:19], v[138:139]
    v_pk_mul_f32 v[20:21], v[20:21], v[152:153]
    v_pk_mul_f32 v[22:23], v[22:23], v[154:155]
    v_exp_f32 v16, v16
    v_exp_f32 v17, v17
    v_exp_f32 v18, v18
    v_exp_f32 v19, v19
    v_exp_f32 v20, v20
    v_exp_f32 v21, v21
    v_exp_f32 v22, v22
    v_exp_f32 v23, v23
    v_pk_add_f32 v[16:17], v[16:17], 1.0 op_sel_hi:[1,0]
    v_pk_add_f32 v[18:19], v[18:19], 1.0 op_sel_hi:[1,0]
    v_pk_add_f32 v[20:21], v[20:21], 1.0 op_sel_hi:[1,0]
    v_pk_add_f32 v[22:23], v[22:23], 1.0 op_sel_hi:[1,0]
    v_rcp_f32 v16, v16
    v_rcp_f32 v17, v17
    v_rcp_f32 v18, v18
    v_rcp_f32 v19, v19
    v_rcp_f32 v20, v20
    v_rcp_f32 v21, v21
    v_rcp_f32 v22, v22
    v_rcp_f32 v23, v23
    v_pk_mul_f32 v[16:17], v[16:17], v[136:137]
    v_pk_mul_f32 v[18:19], v[18:19], v[138:139]
    v_pk_mul_f32 v[20:21], v[20:21], v[152:153]
    v_pk_mul_f32 v[22:23], v[22:23], v[154:155]
    v_cvt_pk_bf16_f32 v64, v16, v17
    v_cvt_pk_bf16_f32 v65, v18, v19
    v_cvt_pk_bf16_f32 v66, v20, v21
    v_cvt_pk_bf16_f32 v67, v22, v23
    buffer_store_dwordx4 v[64:67], v10, s[12:15], s61 offen offset:0
    v_pk_mul_f32 v[24:25], v[140:141], v[140:141]
    v_pk_mul_f32 v[26:27], v[142:143], v[142:143]
    v_pk_mul_f32 v[28:29], v[156:157], v[156:157]
    v_pk_mul_f32 v[30:31], v[158:159], v[158:159]
    v_pk_fma_f32 v[24:25], v[24:25], s[44:45], v[8:9]
    v_pk_fma_f32 v[26:27], v[26:27], s[44:45], v[8:9]
    v_pk_fma_f32 v[28:29], v[28:29], s[44:45], v[8:9]
    v_pk_fma_f32 v[30:31], v[30:31], s[44:45], v[8:9]
    v_pk_mul_f32 v[24:25], v[24:25], v[140:141]
    v_pk_mul_f32 v[26:27], v[26:27], v[142:143]
    v_pk_mul_f32 v[28:29], v[28:29], v[156:157]
    v_pk_mul_f32 v[30:31], v[30:31], v[158:159]
    v_exp_f32 v24, v24
    v_exp_f32 v25, v25
    v_exp_f32 v26, v26
    v_exp_f32 v27, v27
    v_exp_f32 v28, v28
    v_exp_f32 v29, v29
    v_exp_f32 v30, v30
    v_exp_f32 v31, v31
    v_pk_add_f32 v[24:25], v[24:25], 1.0 op_sel_hi:[1,0]
    v_pk_add_f32 v[26:27], v[26:27], 1.0 op_sel_hi:[1,0]
    v_pk_add_f32 v[28:29], v[28:29], 1.0 op_sel_hi:[1,0]
    v_pk_add_f32 v[30:31], v[30:31], 1.0 op_sel_hi:[1,0]
    v_rcp_f32 v24, v24
    v_rcp_f32 v25, v25
    v_rcp_f32 v26, v26
    v_rcp_f32 v27, v27
    v_rcp_f32 v28, v28
    v_rcp_f32 v29, v29
    v_rcp_f32 v30, v30
    v_rcp_f32 v31, v31
    v_pk_mul_f32 v[24:25], v[24:25], v[140:141]
    v_pk_mul_f32 v[26:27], v[26:27], v[142:143]
    v_pk_mul_f32 v[28:29], v[28:29], v[156:157]
    v_pk_mul_f32 v[30:31], v[30:31], v[158:159]
    v_cvt_pk_bf16_f32 v68, v24, v25
    v_cvt_pk_bf16_f32 v69, v26, v27
    v_cvt_pk_bf16_f32 v70, v28, v29
    v_cvt_pk_bf16_f32 v71, v30, v31
    buffer_store_dwordx4 v[68:71], v10, s[12:15], s61 offen offset:2048
    s_waitcnt vmcnt(2)
    s_mov_b64 exec, 1
    ds_add_rtn_u32 v2, v7, v3 offset:0
    s_waitcnt lgkmcnt(0)
    v_cmp_eq_u32 vcc, 3, v2
    s_and_b64 exec, exec, vcc
    s_cbranch_execz gated__nsa
    buffer_store_dword v3, v1, s[12:15], s37 offen offset:0
gated__nsa:
    s_mov_b64 exec, -1
    v_pk_mul_f32 v[16:17], v[144:145], v[144:145]
    v_pk_mul_f32 v[18:19], v[146:147], v[146:147]
    v_pk_mul_f32 v[20:21], v[160:161], v[160:161]
    v_pk_mul_f32 v[22:23], v[162:163], v[162:163]
    v_pk_fma_f32 v[16:17], v[16:17], s[44:45], v[8:9]
    v_pk_fma_f32 v[18:19], v[18:19], s[44:45], v[8:9]
    v_pk_fma_f32 v[20:21], v[20:21], s[44:45], v[8:9]
    v_pk_fma_f32 v[22:23], v[22:23], s[44:45], v[8:9]
    v_pk_mul_f32 v[16:17], v[16:17], v[144:145]
    v_pk_mul_f32 v[18:19], v[18:19], v[146:147]
    v_pk_mul_f32 v[20:21], v[20:21], v[160:161]
    v_pk_mul_f32 v[22:23], v[22:23], v[162:163]
    v_exp_f32 v16, v16
    v_exp_f32 v17, v17
    v_exp_f32 v18, v18
    v_exp_f32 v19, v19
    v_exp_f32 v20, v20
    v_exp_f32 v21, v21
    v_exp_f32 v22, v22
    v_exp_f32 v23, v23
    v_pk_add_f32 v[16:17], v[16:17], 1.0 op_sel_hi:[1,0]
    v_pk_add_f32 v[18:19], v[18:19], 1.0 op_sel_hi:[1,0]
    v_pk_add_f32 v[20:21], v[20:21], 1.0 op_sel_hi:[1,0]
    v_pk_add_f32 v[22:23], v[22:23], 1.0 op_sel_hi:[1,0]
    v_rcp_f32 v16, v16
    v_rcp_f32 v17, v17
    v_rcp_f32 v18, v18
    v_rcp_f32 v19, v19
    v_rcp_f32 v20, v20
    v_rcp_f32 v21, v21
    v_rcp_f32 v22, v22
    v_rcp_f32 v23, v23
    v_pk_mul_f32 v[16:17], v[16:17], v[144:145]
    v_pk_mul_f32 v[18:19], v[18:19], v[146:147]
    v_pk_mul_f32 v[20:21], v[20:21], v[160:161]
    v_pk_mul_f32 v[22:23], v[22:23], v[162:163]
    v_cvt_pk_bf16_f32 v72, v16, v17
    v_cvt_pk_bf16_f32 v73, v18, v19
    v_cvt_pk_bf16_f32 v74, v20, v21
    v_cvt_pk_bf16_f32 v75, v22, v23
    buffer_store_dwordx4 v[72:75], v10, s[12:15], s62 offen offset:0
    v_pk_mul_f32 v[24:25], v[148:149], v[148:149]
    v_pk_mul_f32 v[26:27], v[150:151], v[150:151]
    v_pk_mul_f32 v[28:29], v[164:165], v[164:165]
    v_pk_mul_f32 v[30:31], v[166:167], v[166:167]
    v_pk_fma_f32 v[24:25], v[24:25], s[44:45], v[8:9]
    v_pk_fma_f32 v[26:27], v[26:27], s[44:45], v[8:9]
    v_pk_fma_f32 v[28:29], v[28:29], s[44:45], v[8:9]
    v_pk_fma_f32 v[30:31], v[30:31], s[44:45], v[8:9]
    v_pk_mul_f32 v[24:25], v[24:25], v[148:149]
    v_pk_mul_f32 v[26:27], v[26:27], v[150:151]
    v_pk_mul_f32 v[28:29], v[28:29], v[164:165]
    v_pk_mul_f32 v[30:31], v[30:31], v[166:167]
    v_exp_f32 v24, v24
    v_exp_f32 v25, v25
    v_exp_f32 v26, v26
    v_exp_f32 v27, v27
    v_exp_f32 v28, v28
    v_exp_f32 v29, v29
    v_exp_f32 v30, v30
    v_exp_f32 v31, v31
    v_pk_add_f32 v[24:25], v[24:25], 1.0 op_sel_hi:[1,0]
    v_pk_add_f32 v[26:27], v[26:27], 1.0 op_sel_hi:[1,0]
    v_pk_add_f32 v[28:29], v[28:29], 1.0 op_sel_hi:[1,0]
    v_pk_add_f32 v[30:31], v[30:31], 1.0 op_sel_hi:[1,0]
    v_rcp_f32 v24, v24
    v_rcp_f32 v25, v25
    v_rcp_f32 v26, v26
    v_rcp_f32 v27, v27
    v_rcp_f32 v28, v28
    v_rcp_f32 v29, v29
    v_rcp_f32 v30, v30
    v_rcp_f32 v31, v31
    v_pk_mul_f32 v[24:25], v[24:25], v[148:149]
    v_pk_mul_f32 v[26:27], v[26:27], v[150:151]
    v_pk_mul_f32 v[28:29], v[28:29], v[164:165]
    v_pk_mul_f32 v[30:31], v[30:31], v[166:167]
    v_cvt_pk_bf16_f32 v76, v24, v25
    v_cvt_pk_bf16_f32 v77, v26, v27
    v_cvt_pk_bf16_f32 v78, v28, v29
    v_cvt_pk_bf16_f32 v79, v30, v31
    buffer_store_dwordx4 v[76:79], v10, s[12:15], s62 offen offset:2048
gated__mwl:
    ds_read_b32 v2, v7 offset:32
    ds_read_b32 v4, v7 offset:48
    s_waitcnt lgkmcnt(0)
    v_readfirstlane_b32 s38, v2
    v_readfirstlane_b32 s39, v4
    s_cmp_eq_u32 s38, 0
    s_cbranch_scc1 gated__mwl
    s_cmp_lt_u32 s39, 4
    s_cbranch_scc1 gated__mwl
    s_lshl_b32 s57, s30, 12
    s_lshl_b32 s38, s34, 13
    s_lshl_b32 s39, s35, 12
    s_add_u32 s48, s38, s39
    s_lshl_b32 s39, s35, 2
    s_mul_i32 s39, s39, s56
    s_add_u32 s49, s47, s39
    s_mul_i32 s38, s56, 0
    s_add_u32 s38, s38, s49
    s_add_u32 m0, s48, 16384
    s_nop 0
    buffer_load_dwordx4 v230, s[20:23], s38 offen lds
    s_add_u32 m0, m0, 1024
    s_add_u32 s38, s38, s56
    buffer_load_dwordx4 v230, s[20:23], s38 offen lds
    s_add_u32 m0, m0, 1024
    s_add_u32 s38, s38, s56
    buffer_load_dwordx4 v230, s[20:23], s38 offen lds
    s_add_u32 m0, m0, 1024
    s_add_u32 s38, s38, s56
    buffer_load_dwordx4 v230, s[20:23], s38 offen lds
    s_mul_i32 s38, s56, 32
    s_add_u32 s38, s38, s49
    s_add_u32 m0, s48, 49152
    s_nop 0
    buffer_load_dwordx4 v230, s[20:23], s38 offen lds
    s_add_u32 m0, m0, 1024
    s_add_u32 s38, s38, s56
    buffer_load_dwordx4 v230, s[20:23], s38 offen lds
    s_add_u32 m0, m0, 1024
    s_add_u32 s38, s38, s56
    buffer_load_dwordx4 v230, s[20:23], s38 offen lds
    s_add_u32 m0, m0, 1024
    s_add_u32 s38, s38, s56
    buffer_load_dwordx4 v230, s[20:23], s38 offen lds
    s_mul_i32 s38, s56, 56
    s_add_u32 s38, s38, s49
    s_add_u32 m0, s48, 81920
    s_nop 0
    buffer_load_dwordx4 v230, s[20:23], s38 offen lds
    s_add_u32 m0, m0, 1024
    s_add_u32 s38, s38, s56
    buffer_load_dwordx4 v230, s[20:23], s38 offen lds
    s_add_u32 m0, m0, 1024
    s_add_u32 s38, s38, s56
    buffer_load_dwordx4 v230, s[20:23], s38 offen lds
    s_add_u32 m0, m0, 1024
    s_add_u32 s38, s38, s56
    buffer_load_dwordx4 v230, s[20:23], s38 offen lds
    s_add_u32 s61, s59, 32768
    s_add_u32 s62, s61, 4096
    v_pk_mul_f32 v[16:17], v[168:169], v[168:169]
    v_pk_mul_f32 v[18:19], v[170:171], v[170:171]
    v_pk_mul_f32 v[20:21], v[184:185], v[184:185]
    v_pk_mul_f32 v[22:23], v[186:187], v[186:187]
    v_pk_fma_f32 v[16:17], v[16:17], s[44:45], v[8:9]
    v_pk_fma_f32 v[18:19], v[18:19], s[44:45], v[8:9]
    v_pk_fma_f32 v[20:21], v[20:21], s[44:45], v[8:9]
    v_pk_fma_f32 v[22:23], v[22:23], s[44:45], v[8:9]
    v_pk_mul_f32 v[16:17], v[16:17], v[168:169]
    v_pk_mul_f32 v[18:19], v[18:19], v[170:171]
    v_pk_mul_f32 v[20:21], v[20:21], v[184:185]
    v_pk_mul_f32 v[22:23], v[22:23], v[186:187]
    v_exp_f32 v16, v16
    v_exp_f32 v17, v17
    v_exp_f32 v18, v18
    v_exp_f32 v19, v19
    v_exp_f32 v20, v20
    v_exp_f32 v21, v21
    v_exp_f32 v22, v22
    v_exp_f32 v23, v23
    v_pk_add_f32 v[16:17], v[16:17], 1.0 op_sel_hi:[1,0]
    v_pk_add_f32 v[18:19], v[18:19], 1.0 op_sel_hi:[1,0]
    v_pk_add_f32 v[20:21], v[20:21], 1.0 op_sel_hi:[1,0]
    v_pk_add_f32 v[22:23], v[22:23], 1.0 op_sel_hi:[1,0]
    v_rcp_f32 v16, v16
    v_rcp_f32 v17, v17
    v_rcp_f32 v18, v18
    v_rcp_f32 v19, v19
    v_rcp_f32 v20, v20
    v_rcp_f32 v21, v21
    v_rcp_f32 v22, v22
    v_rcp_f32 v23, v23
    v_pk_mul_f32 v[16:17], v[16:17], v[168:169]
    v_pk_mul_f32 v[18:19], v[18:19], v[170:171]
    v_pk_mul_f32 v[20:21], v[20:21], v[184:185]
    v_pk_mul_f32 v[22:23], v[22:23], v[186:187]
    v_cvt_pk_bf16_f32 v48, v16, v17
    v_cvt_pk_bf16_f32 v49, v18, v19
    v_cvt_pk_bf16_f32 v50, v20, v21
    v_cvt_pk_bf16_f32 v51, v22, v23
    buffer_store_dwordx4 v[48:51], v10, s[12:15], s61 offen offset:0
    v_pk_mul_f32 v[24:25], v[172:173], v[172:173]
    v_pk_mul_f32 v[26:27], v[174:175], v[174:175]
    v_pk_mul_f32 v[28:29], v[188:189], v[188:189]
    v_pk_mul_f32 v[30:31], v[190:191], v[190:191]
    v_pk_fma_f32 v[24:25], v[24:25], s[44:45], v[8:9]
    v_pk_fma_f32 v[26:27], v[26:27], s[44:45], v[8:9]
    v_pk_fma_f32 v[28:29], v[28:29], s[44:45], v[8:9]
    v_pk_fma_f32 v[30:31], v[30:31], s[44:45], v[8:9]
    v_pk_mul_f32 v[24:25], v[24:25], v[172:173]
    v_pk_mul_f32 v[26:27], v[26:27], v[174:175]
    v_pk_mul_f32 v[28:29], v[28:29], v[188:189]
    v_pk_mul_f32 v[30:31], v[30:31], v[190:191]
    v_exp_f32 v24, v24
    v_exp_f32 v25, v25
    v_exp_f32 v26, v26
    v_exp_f32 v27, v27
    v_exp_f32 v28, v28
    v_exp_f32 v29, v29
    v_exp_f32 v30, v30
    v_exp_f32 v31, v31
    v_pk_add_f32 v[24:25], v[24:25], 1.0 op_sel_hi:[1,0]
    v_pk_add_f32 v[26:27], v[26:27], 1.0 op_sel_hi:[1,0]
    v_pk_add_f32 v[28:29], v[28:29], 1.0 op_sel_hi:[1,0]
    v_pk_add_f32 v[30:31], v[30:31], 1.0 op_sel_hi:[1,0]
    v_rcp_f32 v24, v24
    v_rcp_f32 v25, v25
    v_rcp_f32 v26, v26
    v_rcp_f32 v27, v27
    v_rcp_f32 v28, v28
    v_rcp_f32 v29, v29
    v_rcp_f32 v30, v30
    v_rcp_f32 v31, v31
    v_pk_mul_f32 v[24:25], v[24:25], v[172:173]
    v_pk_mul_f32 v[26:27], v[26:27], v[174:175]
    v_pk_mul_f32 v[28:29], v[28:29], v[188:189]
    v_pk_mul_f32 v[30:31], v[30:31], v[190:191]
    v_cvt_pk_bf16_f32 v52, v24, v25
    v_cvt_pk_bf16_f32 v53, v26, v27
    v_cvt_pk_bf16_f32 v54, v28, v29
    v_cvt_pk_bf16_f32 v55, v30, v31
    buffer_store_dwordx4 v[52:55], v10, s[12:15], s61 offen offset:2048
    buffer_load_dword v80, v5, s[12:15], s55 offen sc1
    v_pk_mul_f32 v[16:17], v[176:177], v[176:177]
    v_pk_mul_f32 v[18:19], v[178:179], v[178:179]
    v_pk_mul_f32 v[20:21], v[192:193], v[192:193]
    v_pk_mul_f32 v[22:23], v[194:195], v[194:195]
    v_pk_fma_f32 v[16:17], v[16:17], s[44:45], v[8:9]
    v_pk_fma_f32 v[18:19], v[18:19], s[44:45], v[8:9]
    v_pk_fma_f32 v[20:21], v[20:21], s[44:45], v[8:9]
    v_pk_fma_f32 v[22:23], v[22:23], s[44:45], v[8:9]
    v_pk_mul_f32 v[16:17], v[16:17], v[176:177]
    v_pk_mul_f32 v[18:19], v[18:19], v[178:179]
    v_pk_mul_f32 v[20:21], v[20:21], v[192:193]
    v_pk_mul_f32 v[22:23], v[22:23], v[194:195]
    v_exp_f32 v16, v16
    v_exp_f32 v17, v17
    v_exp_f32 v18, v18
    v_exp_f32 v19, v19
    v_exp_f32 v20, v20
    v_exp_f32 v21, v21
    v_exp_f32 v22, v22
    v_exp_f32 v23, v23
    v_pk_add_f32 v[16:17], v[16:17], 1.0 op_sel_hi:[1,0]
    v_pk_add_f32 v[18:19], v[18:19], 1.0 op_sel_hi:[1,0]
    v_pk_add_f32 v[20:21], v[20:21], 1.0 op_sel_hi:[1,0]
    v_pk_add_f32 v[22:23], v[22:23], 1.0 op_sel_hi:[1,0]
    v_rcp_f32 v16, v16
    v_rcp_f32 v17, v17
    v_rcp_f32 v18, v18
    v_rcp_f32 v19, v19
    v_rcp_f32 v20, v20
    v_rcp_f32 v21, v21
    v_rcp_f32 v22, v22
    v_rcp_f32 v23, v23
    v_pk_mul_f32 v[16:17], v[16:17], v[176:177]
    v_pk_mul_f32 v[18:19], v[18:19], v[178:179]
    v_pk_mul_f32 v[20:21], v[20:21], v[192:193]
    v_pk_mul_f32 v[22:23], v[22:23], v[194:195]
    v_cvt_pk_bf16_f32 v56, v16, v17
    v_cvt_pk_bf16_f32 v57, v18, v19
    v_cvt_pk_bf16_f32 v58, v20, v21
    v_cvt_pk_bf16_f32 v59, v22, v23
    buffer_store_dwordx4 v[56:59], v10, s[12:15], s62 offen offset:0
    v_pk_mul_f32 v[24:25], v[180:181], v[180:181]
    v_pk_mul_f32 v[26:27], v[182:183], v[182:183]
    v_pk_mul_f32 v[28:29], v[196:197], v[196:197]
    v_pk_mul_f32 v[30:31], v[198:199], v[198:199]
    v_pk_fma_f32 v[24:25], v[24:25], s[44:45], v[8:9]
    v_pk_fma_f32 v[26:27], v[26:27], s[44:45], v[8:9]
    v_pk_fma_f32 v[28:29], v[28:29], s[44:45], v[8:9]
    v_pk_fma_f32 v[30:31], v[30:31], s[44:45], v[8:9]
    v_pk_mul_f32 v[24:25], v[24:25], v[180:181]
    v_pk_mul_f32 v[26:27], v[26:27], v[182:183]
    v_pk_mul_f32 v[28:29], v[28:29], v[196:197]
    v_pk_mul_f32 v[30:31], v[30:31], v[198:199]
    v_exp_f32 v24, v24
    v_exp_f32 v25, v25
    v_exp_f32 v26, v26
    v_exp_f32 v27, v27
    v_exp_f32 v28, v28
    v_exp_f32 v29, v29
    v_exp_f32 v30, v30
    v_exp_f32 v31, v31
    v_pk_add_f32 v[24:25], v[24:25], 1.0 op_sel_hi:[1,0]
    v_pk_add_f32 v[26:27], v[26:27], 1.0 op_sel_hi:[1,0]
    v_pk_add_f32 v[28:29], v[28:29], 1.0 op_sel_hi:[1,0]
    v_pk_add_f32 v[30:31], v[30:31], 1.0 op_sel_hi:[1,0]
    v_rcp_f32 v24, v24
    v_rcp_f32 v25, v25
    v_rcp_f32 v26, v26
    v_rcp_f32 v27, v27
    v_rcp_f32 v28, v28
    v_rcp_f32 v29, v29
    v_rcp_f32 v30, v30
    v_rcp_f32 v31, v31
    v_pk_mul_f32 v[24:25], v[24:25], v[180:181]
    v_pk_mul_f32 v[26:27], v[26:27], v[182:183]
    v_pk_mul_f32 v[28:29], v[28:29], v[196:197]
    v_pk_mul_f32 v[30:31], v[30:31], v[198:199]
    v_cvt_pk_bf16_f32 v60, v24, v25
    v_cvt_pk_bf16_f32 v61, v26, v27
    v_cvt_pk_bf16_f32 v62, v28, v29
    v_cvt_pk_bf16_f32 v63, v30, v31
    buffer_store_dwordx4 v[60:63], v10, s[12:15], s62 offen offset:2048
    s_add_u32 s62, s60, 4096
    v_cmp_eq_u32 vcc, 0, v80
    s_cmp_eq_u64 vcc, 0
    s_cbranch_scc0 gated__nh
    s_add_u32 s49, s46, s57
    s_add_u32 m0, s57, 0
    s_add_u32 s38, s49, 0
    buffer_load_dwordx4 v13, s[12:15], s38 offen offset:0 lds
    buffer_load_dwordx4 v13, s[12:15], s38 offen offset:1024 lds
    buffer_load_dwordx4 v13, s[12:15], s38 offen offset:2048 lds
    buffer_load_dwordx4 v13, s[12:15], s38 offen offset:3072 lds
    s_add_u32 m0, s57, 32768
    s_add_u32 s38, s49, 65536
    buffer_load_dwordx4 v13, s[12:15], s38 offen offset:0 lds
    buffer_load_dwordx4 v13, s[12:15], s38 offen offset:1024 lds
    buffer_load_dwordx4 v13, s[12:15], s38 offen offset:2048 lds
    buffer_load_dwordx4 v13, s[12:15], s38 offen offset:3072 lds
    s_add_u32 m0, s57, 65536
    s_add_u32 s38, s49, 114688
    buffer_load_dwordx4 v13, s[12:15], s38 offen offset:0 lds
    buffer_load_dwordx4 v13, s[12:15], s38 offen offset:1024 lds
    buffer_load_dwordx4 v13, s[12:15], s38 offen offset:2048 lds
    buffer_load_dwordx4 v13, s[12:15], s38 offen offset:3072 lds
    s_mov_b32 s50, 1
gated__nh:
    v_pk_mul_f32 v[16:17], v[200:201], v[200:201]
    v_pk_mul_f32 v[18:19], v[202:203], v[202:203]
    v_pk_mul_f32 v[20:21], v[204:205], v[204:205]
    v_pk_mul_f32 v[22:23], v[206:207], v[206:207]
    v_pk_fma_f32 v[16:17], v[16:17], s[44:45], v[8:9]
    v_pk_fma_f32 v[18:19], v[18:19], s[44:45], v[8:9]
    v_pk_fma_f32 v[20:21], v[20:21], s[44:45], v[8:9]
    v_pk_fma_f32 v[22:23], v[22:23], s[44:45], v[8:9]
    v_pk_mul_f32 v[16:17], v[16:17], v[200:201]
    v_pk_mul_f32 v[18:19], v[18:19], v[202:203]
    v_pk_mul_f32 v[20:21], v[20:21], v[204:205]
    v_pk_mul_f32 v[22:23], v[22:23], v[206:207]
    v_exp_f32 v16, v16
    v_exp_f32 v17, v17
    v_exp_f32 v18, v18
    v_exp_f32 v19, v19
    v_exp_f32 v20, v20
    v_exp_f32 v21, v21
    v_exp_f32 v22, v22
    v_exp_f32 v23, v23
    v_pk_add_f32 v[16:17], v[16:17], 1.0 op_sel_hi:[1,0]
    v_pk_add_f32 v[18:19], v[18:19], 1.0 op_sel_hi:[1,0]
    v_pk_add_f32 v[20:21], v[20:21], 1.0 op_sel_hi:[1,0]
    v_pk_add_f32 v[22:23], v[22:23], 1.0 op_sel_hi:[1,0]
    v_rcp_f32 v16, v16
    v_rcp_f32 v17, v17
    v_rcp_f32 v18, v18
    v_rcp_f32 v19, v19
    v_rcp_f32 v20, v20
    v_rcp_f32 v21, v21
    v_rcp_f32 v22, v22
    v_rcp_f32 v23, v23
    v_pk_mul_f32 v[16:17], v[16:17], v[200:201]
    v_pk_mul_f32 v[18:19], v[18:19], v[202:203]
    v_pk_mul_f32 v[20:21], v[20:21], v[204:205]
    v_pk_mul_f32 v[22:23], v[22:23], v[206:207]
    v_cvt_pk_bf16_f32 v64, v16, v17
    v_cvt_pk_bf16_f32 v65, v18, v19
    v_cvt_pk_bf16_f32 v66, v20, v21
    v_cvt_pk_bf16_f32 v67, v22, v23
    buffer_store_dwordx2 v[64:65], v11, s[12:15], s60 offen offset:0
    buffer_store_dwordx2 v[66:67], v11, s[12:15], s60 offen offset:2048
    v_pk_mul_f32 v[24:25], v[208:209], v[208:209]
    v_pk_mul_f32 v[26:27], v[210:211], v[210:211]
    v_pk_mul_f32 v[28:29], v[212:213], v[212:213]
    v_pk_mul_f32 v[30:31], v[214:215], v[214:215]
    v_pk_fma_f32 v[24:25], v[24:25], s[44:45], v[8:9]
    v_pk_fma_f32 v[26:27], v[26:27], s[44:45], v[8:9]
    v_pk_fma_f32 v[28:29], v[28:29], s[44:45], v[8:9]
    v_pk_fma_f32 v[30:31], v[30:31], s[44:45], v[8:9]
    v_pk_mul_f32 v[24:25], v[24:25], v[208:209]
    v_pk_mul_f32 v[26:27], v[26:27], v[210:211]
    v_pk_mul_f32 v[28:29], v[28:29], v[212:213]
    v_pk_mul_f32 v[30:31], v[30:31], v[214:215]
    v_exp_f32 v24, v24
    v_exp_f32 v25, v25
    v_exp_f32 v26, v26
    v_exp_f32 v27, v27
    v_exp_f32 v28, v28
    v_exp_f32 v29, v29
    v_exp_f32 v30, v30
    v_exp_f32 v31, v31
    v_pk_add_f32 v[24:25], v[24:25], 1.0 op_sel_hi:[1,0]
    v_pk_add_f32 v[26:27], v[26:27], 1.0 op_sel_hi:[1,0]
    v_pk_add_f32 v[28:29], v[28:29], 1.0 op_sel_hi:[1,0]
    v_pk_add_f32 v[30:31], v[30:31], 1.0 op_sel_hi:[1,0]
    v_rcp_f32 v24, v24
    v_rcp_f32 v25, v25
    v_rcp_f32 v26, v26
    v_rcp_f32 v27, v27
    v_rcp_f32 v28, v28
    v_rcp_f32 v29, v29
    v_rcp_f32 v30, v30
    v_rcp_f32 v31, v31
    v_pk_mul_f32 v[24:25], v[24:25], v[208:209]
    v_pk_mul_f32 v[26:27], v[26:27], v[210:211]
    v_pk_mul_f32 v[28:29], v[28:29], v[212:213]
    v_pk_mul_f32 v[30:31], v[30:31], v[214:215]
    v_cvt_pk_bf16_f32 v68, v24, v25
    v_cvt_pk_bf16_f32 v69, v26, v27
    v_cvt_pk_bf16_f32 v70, v28, v29
    v_cvt_pk_bf16_f32 v71, v30, v31
    buffer_store_dwordx2 v[68:69], v11, s[12:15], s62 offen offset:0
    buffer_store_dwordx2 v[70:71], v11, s[12:15], s62 offen offset:2048
gated__gdone:
    s_setprio 0
    s_cmp_eq_u32 s63, 2
    s_cbranch_scc1 gated__w2d
gated__mws:
    ds_read_b32 v2, v7 offset:32
    ds_read_b32 v4, v7 offset:48
    s_waitcnt lgkmcnt(0)
    v_readfirstlane_b32 s38, v2
    v_readfirstlane_b32 s39, v4
    s_cmp_eq_u32 s38, 0
    s_cbranch_scc1 gated__mws
    s_cmp_lt_u32 s39, 4
    s_cbranch_scc1 gated__mws
    s_lshl_b32 s57, s30, 12
    s_lshl_b32 s38, s34, 13
    s_lshl_b32 s39, s35, 12
    s_add_u32 s48, s38, s39
    s_lshl_b32 s39, s35, 2
    s_mul_i32 s39, s39, s56
    s_add_u32 s49, s47, s39
    s_mul_i32 s38, s56, 0
    s_add_u32 s38, s38, s49
    s_add_u32 m0, s48, 16384
    s_nop 0
    buffer_load_dwordx4 v230, s[20:23], s38 offen lds
    s_add_u32 m0, m0, 1024
    s_add_u32 s38, s38, s56
    buffer_load_dwordx4 v230, s[20:23], s38 offen lds
    s_add_u32 m0, m0, 1024
    s_add_u32 s38, s38, s56
    buffer_load_dwordx4 v230, s[20:23], s38 offen lds
    s_add_u32 m0, m0, 1024
    s_add_u32 s38, s38, s56
    buffer_load_dwordx4 v230, s[20:23], s38 offen lds
    s_mul_i32 s38, s56, 32
    s_add_u32 s38, s38, s49
    s_add_u32 m0, s48, 49152
    s_nop 0
    buffer_load_dwordx4 v230, s[20:23], s38 offen lds
    s_add_u32 m0, m0, 1024
    s_add_u32 s38, s38, s56
    buffer_load_dwordx4 v230, s[20:23], s38 offen lds
    s_add_u32 m0, m0, 1024
    s_add_u32 s38, s38, s56
    buffer_load_dwordx4 v230, s[20:23], s38 offen lds
    s_add_u32 m0, m0, 1024
    s_add_u32 s38, s38, s56
    buffer_load_dwordx4 v230, s[20:23], s38 offen lds
    s_mul_i32 s38, s56, 56
    s_add_u32 s38, s38, s49
    s_add_u32 m0, s48, 81920
    s_nop 0
    buffer_load_dwordx4 v230, s[20:23], s38 offen lds
    s_add_u32 m0, m0, 1024
    s_add_u32 s38, s38, s56
    buffer_load_dwordx4 v230, s[20:23], s38 offen lds
    s_add_u32 m0, m0, 1024
    s_add_u32 s38, s38, s56
    buffer_load_dwordx4 v230, s[20:23], s38 offen lds
    s_add_u32 m0, m0, 1024
    s_add_u32 s38, s38, s56
    buffer_load_dwordx4 v230, s[20:23], s38 offen lds
gated__w2d:
    s_cmp_eq_u32 s63, 2
    s_cbranch_scc1 gated__sig2
    s_waitcnt vmcnt(24)
    s_mov_b64 exec, 1
    ds_add_rtn_u32 v2, v7, v3 offset:0
    s_waitcnt lgkmcnt(0)
    v_cmp_eq_u32 vcc, 3, v2
    s_and_b64 exec, exec, vcc
    s_cbranch_execz gated__nsb
    buffer_store_dword v3, v1, s[12:15], s37 offen offset:0 sc1
gated__nsb:
    s_mov_b64 exec, -1
gated__sig2:
    v_pk_mov_b32 v[104:105], 0, 0
    v_pk_mov_b32 v[106:107], 0, 0
    v_pk_mov_b32 v[108:109], 0, 0
    v_pk_mov_b32 v[110:111], 0, 0
    v_pk_mov_b32 v[112:113], 0, 0
    v_pk_mov_b32 v[114:115], 0, 0
    v_pk_mov_b32 v[116:117], 0, 0
    v_pk_mov_b32 v[118:119], 0, 0
    v_pk_mov_b32 v[120:121], 0, 0
    v_pk_mov_b32 v[122:123], 0, 0
    v_pk_mov_b32 v[124:125], 0, 0
    v_pk_mov_b32 v[126:127], 0, 0
    v_pk_mov_b32 v[128:129], 0, 0
    v_pk_mov_b32 v[130:131], 0, 0
    v_pk_mov_b32 v[132:133], 0, 0
    v_pk_mov_b32 v[134:135], 0, 0
    v_pk_mov_b32 v[136:137], 0, 0
    v_pk_mov_b32 v[138:139], 0, 0
    v_pk_mov_b32 v[140:141], 0, 0
    v_pk_mov_b32 v[142:143], 0, 0
    v_pk_mov_b32 v[144:145], 0, 0
    v_pk_mov_b32 v[146:147], 0, 0
    v_pk_mov_b32 v[148:149], 0, 0
    v_pk_mov_b32 v[150:151], 0, 0
    v_pk_mov_b32 v[152:153], 0, 0
    v_pk_mov_b32 v[154:155], 0, 0
    v_pk_mov_b32 v[156:157], 0, 0
    v_pk_mov_b32 v[158:159], 0, 0
    v_pk_mov_b32 v[160:161], 0, 0
    v_pk_mov_b32 v[162:163], 0, 0
    v_pk_mov_b32 v[164:165], 0, 0
    v_pk_mov_b32 v[166:167], 0, 0
    v_lshrrev_b32 v8, 2, v0
    v_bfe_u32 v9, v0, 3, 2
    v_lshlrev_b32 v9, 5, v9
    v_lshl_add_u32 v8, v8, 7, v9
    v_and_b32 v9, 3, v0
    v_lshl_add_u32 v8, v9, 3, v8
    s_lshl_b32 s39, s34, 13
    s_add_u32 s39, s39, 16384
    v_add_u32 v8, s39, v8
    v_xor_b32 v9, 32, v8
    v_xor_b32 v10, 64, v8
    v_xor_b32 v11, 96, v8
    v_xor_b32 v6, 64, v12
    s_cmp_eq_u32 s63, 2
    s_cbranch_scc0 gated__s2slow
    s_waitcnt vmcnt(0)
    s_mov_b64 exec, 1
    ds_add_rtn_u32 v2, v7, v3 offset:4
    s_waitcnt lgkmcnt(0)
    v_cmp_eq_u32 vcc, 3, v2
    s_and_b64 exec, exec, vcc
    s_cbranch_execz gated__nsc
    buffer_store_dword v3, v1, s[12:15], s37 offen offset:4
gated__nsc:
    s_mov_b64 exec, -1
gated__s2done:
    s_cmp_eq_u32 s50, 1
    s_cbranch_scc1 gated__hdone
    s_mov_b32 s39, 0
gated__ph1:
    buffer_load_dword v80, v5, s[12:15], s55 offen sc1
    s_add_u32 s39, s39, 1
    s_waitcnt vmcnt(0)
    v_cmp_eq_u32 vcc, 0, v80
    s_cmp_gt_u32 s39, 400000
    s_cbranch_scc1 gated__ph1d
    s_cmp_eq_u64 vcc, 0
    s_cbranch_scc0 gated__ph1
gated__ph1d:
    s_add_u32 s49, s46, s57
    s_add_u32 m0, s57, 0
    s_add_u32 s38, s49, 0
    buffer_load_dwordx4 v13, s[12:15], s38 offen offset:0 lds
    buffer_load_dwordx4 v13, s[12:15], s38 offen offset:1024 lds
    buffer_load_dwordx4 v13, s[12:15], s38 offen offset:2048 lds
    buffer_load_dwordx4 v13, s[12:15], s38 offen offset:3072 lds
    s_add_u32 m0, s57, 32768
    s_add_u32 s38, s49, 65536
    buffer_load_dwordx4 v13, s[12:15], s38 offen offset:0 lds
    buffer_load_dwordx4 v13, s[12:15], s38 offen offset:1024 lds
    buffer_load_dwordx4 v13, s[12:15], s38 offen offset:2048 lds
    buffer_load_dwordx4 v13, s[12:15], s38 offen offset:3072 lds
    s_add_u32 m0, s57, 65536
    s_add_u32 s38, s49, 114688
    buffer_load_dwordx4 v13, s[12:15], s38 offen offset:0 lds
    buffer_load_dwordx4 v13, s[12:15], s38 offen offset:1024 lds
    buffer_load_dwordx4 v13, s[12:15], s38 offen offset:2048 lds
    buffer_load_dwordx4 v13, s[12:15], s38 offen offset:3072 lds
gated__hdone:
    buffer_load_dword v81, v5, s[12:15], s55 offen offset:4 sc1
    s_waitcnt vmcnt(9)
    v_mov_b32 v82, v5
    s_lshl_b32 s39, s35, 6
    v_add_u32 v5, s39, v14
    v_lshlrev_b32 v5, 11, v5
    v_and_b32 v4, 1, v15
    v_lshl_add_u32 v5, v4, 5, v5
    v_lshrrev_b32 v4, 1, v15
    v_lshl_add_u32 v5, v4, 4, v5
    s_lshl_b32 s57, s28, 18
    s_lshl_b32 s39, s31, 22
    s_add_u32 s57, s57, s39
    s_lshl_b32 s39, s32, 1
    s_add_u32 s39, s39, s34
    v_mov_b32 v4, s39
    v_lshl_add_u32 v5, v4, 7, v5
    s_add_u32 s57, s57, 33554432
    s_barrier
    ds_read_b64_tr_b16 v[48:49], v8 offset:0
    ds_read_b64_tr_b16 v[50:51], v8 offset:2048
    ds_read_b128 v[16:19], v12 offset:0
    ds_read_b128 v[20:23], v12 offset:2048
    ds_read_b128 v[24:27], v12 offset:4096
    ds_read_b128 v[28:31], v12 offset:6144
    ds_read_b64_tr_b16 v[52:53], v9 offset:0
    ds_read_b64_tr_b16 v[54:55], v9 offset:2048
    ds_read_b64_tr_b16 v[56:57], v10 offset:0
    ds_read_b64_tr_b16 v[58:59], v10 offset:2048
    ds_read_b64_tr_b16 v[60:61], v11 offset:0
    ds_read_b64_tr_b16 v[62:63], v11 offset:2048
    s_mov_b32 s52, 0
    s_waitcnt lgkmcnt(0)
    v_mfma_f32_16x16x32_bf16 v[104:107], v[48:51], v[16:19], v[104:107]
    ds_read_b64_tr_b16 v[64:65], v8 offset:4096
    v_mfma_f32_16x16x32_bf16 v[108:111], v[48:51], v[20:23], v[108:111]
    ds_read_b64_tr_b16 v[66:67], v8 offset:6144
    v_mfma_f32_16x16x32_bf16 v[112:115], v[48:51], v[24:27], v[112:115]
    ds_read_b128 v[32:35], v6 offset:0
    v_mfma_f32_16x16x32_bf16 v[116:119], v[48:51], v[28:31], v[116:119]
    ds_read_b128 v[36:39], v6 offset:2048
    v_mfma_f32_16x16x32_bf16 v[120:123], v[52:55], v[16:19], v[120:123]
    ds_read_b128 v[40:43], v6 offset:4096
    v_mfma_f32_16x16x32_bf16 v[124:127], v[52:55], v[20:23], v[124:127]
    ds_read_b128 v[44:47], v6 offset:6144
    v_mfma_f32_16x16x32_bf16 v[128:131], v[52:55], v[24:27], v[128:131]
    ds_read_b64_tr_b16 v[68:69], v9 offset:4096
    v_mfma_f32_16x16x32_bf16 v[132:135], v[52:55], v[28:31], v[132:135]
    ds_read_b64_tr_b16 v[70:71], v9 offset:6144
    v_mfma_f32_16x16x32_bf16 v[136:139], v[56:59], v[16:19], v[136:139]
    ds_read_b64_tr_b16 v[72:73], v10 offset:4096
    v_mfma_f32_16x16x32_bf16 v[140:143], v[56:59], v[20:23], v[140:143]
    ds_read_b64_tr_b16 v[74:75], v10 offset:6144
    v_mfma_f32_16x16x32_bf16 v[144:147], v[56:59], v[24:27], v[144:147]
    ds_read_b64_tr_b16 v[76:77], v11 offset:4096
    v_mfma_f32_16x16x32_bf16 v[148:151], v[56:59], v[28:31], v[148:151]
    ds_read_b64_tr_b16 v[78:79], v11 offset:6144
    v_mfma_f32_16x16x32_bf16 v[152:155], v[60:63], v[16:19], v[152:155]
    v_mfma_f32_16x16x32_bf16 v[156:159], v[60:63], v[20:23], v[156:159]
    v_mfma_f32_16x16x32_bf16 v[160:163], v[60:63], v[24:27], v[160:163]
    v_mfma_f32_16x16x32_bf16 v[164:167], v[60:63], v[28:31], v[164:167]
    s_waitcnt vmcnt(0) lgkmcnt(0)
    s_barrier
    v_add_u32 v12, 32768, v12
    v_add_u32 v6, 32768, v6
    v_add_u32 v8, 32768, v8
    v_add_u32 v9, 32768, v9
    v_add_u32 v10, 32768, v10
    v_add_u32 v11, 32768, v11
    v_mfma_f32_16x16x32_bf16 v[104:107], v[64:67], v[32:35], v[104:107]
    ds_read_b64_tr_b16 v[48:49], v8 offset:0
    v_mfma_f32_16x16x32_bf16 v[108:111], v[64:67], v[36:39], v[108:111]
    ds_read_b64_tr_b16 v[50:51], v8 offset:2048
    v_mfma_f32_16x16x32_bf16 v[112:115], v[64:67], v[40:43], v[112:115]
    ds_read_b128 v[16:19], v12 offset:0
    v_mfma_f32_16x16x32_bf16 v[116:119], v[64:67], v[44:47], v[116:119]
    ds_read_b128 v[20:23], v12 offset:2048
    v_mfma_f32_16x16x32_bf16 v[120:123], v[68:71], v[32:35], v[120:123]
    ds_read_b128 v[24:27], v12 offset:4096
    v_mfma_f32_16x16x32_bf16 v[124:127], v[68:71], v[36:39], v[124:127]
    ds_read_b128 v[28:31], v12 offset:6144
    v_mfma_f32_16x16x32_bf16 v[128:131], v[68:71], v[40:43], v[128:131]
    ds_read_b64_tr_b16 v[52:53], v9 offset:0
    v_mfma_f32_16x16x32_bf16 v[132:135], v[68:71], v[44:47], v[132:135]
    ds_read_b64_tr_b16 v[54:55], v9 offset:2048
    v_mfma_f32_16x16x32_bf16 v[136:139], v[72:75], v[32:35], v[136:139]
    ds_read_b64_tr_b16 v[56:57], v10 offset:0
    v_mfma_f32_16x16x32_bf16 v[140:143], v[72:75], v[36:39], v[140:143]
    ds_read_b64_tr_b16 v[58:59], v10 offset:2048
    v_mfma_f32_16x16x32_bf16 v[144:147], v[72:75], v[40:43], v[144:147]
    ds_read_b64_tr_b16 v[60:61], v11 offset:0
    v_mfma_f32_16x16x32_bf16 v[148:151], v[72:75], v[44:47], v[148:151]
    ds_read_b64_tr_b16 v[62:63], v11 offset:2048
    v_mfma_f32_16x16x32_bf16 v[152:155], v[76:79], v[32:35], v[152:155]
    v_mfma_f32_16x16x32_bf16 v[156:159], v[76:79], v[36:39], v[156:159]
    v_mfma_f32_16x16x32_bf16 v[160:163], v[76:79], v[40:43], v[160:163]
    v_mfma_f32_16x16x32_bf16 v[164:167], v[76:79], v[44:47], v[164:167]
    s_waitcnt lgkmcnt(0)
    v_mfma_f32_16x16x32_bf16 v[104:107], v[48:51], v[16:19], v[104:107]
    ds_read_b64_tr_b16 v[64:65], v8 offset:4096
    v_mfma_f32_16x16x32_bf16 v[108:111], v[48:51], v[20:23], v[108:111]
    ds_read_b64_tr_b16 v[66:67], v8 offset:6144
    v_mfma_f32_16x16x32_bf16 v[112:115], v[48:51], v[24:27], v[112:115]
    ds_read_b128 v[32:35], v6 offset:0
    v_mfma_f32_16x16x32_bf16 v[116:119], v[48:51], v[28:31], v[116:119]
    ds_read_b128 v[36:39], v6 offset:2048
    v_mfma_f32_16x16x32_bf16 v[120:123], v[52:55], v[16:19], v[120:123]
    ds_read_b128 v[40:43], v6 offset:4096
    v_mfma_f32_16x16x32_bf16 v[124:127], v[52:55], v[20:23], v[124:127]
    ds_read_b128 v[44:47], v6 offset:6144
    v_mfma_f32_16x16x32_bf16 v[128:131], v[52:55], v[24:27], v[128:131]
    ds_read_b64_tr_b16 v[68:69], v9 offset:4096
    v_mfma_f32_16x16x32_bf16 v[132:135], v[52:55], v[28:31], v[132:135]
    ds_read_b64_tr_b16 v[70:71], v9 offset:6144
    v_mfma_f32_16x16x32_bf16 v[136:139], v[56:59], v[16:19], v[136:139]
    ds_read_b64_tr_b16 v[72:73], v10 offset:4096
    v_mfma_f32_16x16x32_bf16 v[140:143], v[56:59], v[20:23], v[140:143]
    ds_read_b64_tr_b16 v[74:75], v10 offset:6144
    v_mfma_f32_16x16x32_bf16 v[144:147], v[56:59], v[24:27], v[144:147]
    ds_read_b64_tr_b16 v[76:77], v11 offset:4096
    v_mfma_f32_16x16x32_bf16 v[148:151], v[56:59], v[28:31], v[148:151]
    ds_read_b64_tr_b16 v[78:79], v11 offset:6144
    v_mfma_f32_16x16x32_bf16 v[152:155], v[60:63], v[16:19], v[152:155]
    v_mfma_f32_16x16x32_bf16 v[156:159], v[60:63], v[20:23], v[156:159]
    v_mfma_f32_16x16x32_bf16 v[160:163], v[60:63], v[24:27], v[160:163]
    v_mfma_f32_16x16x32_bf16 v[164:167], v[60:63], v[28:31], v[164:167]
    s_waitcnt vmcnt(0) lgkmcnt(0)
    s_barrier
    v_add_u32 v12, 32768, v12
    v_add_u32 v6, 32768, v6
    v_add_u32 v8, 32768, v8
    v_add_u32 v9, 32768, v9
    v_add_u32 v10, 32768, v10
    v_add_u32 v11, 32768, v11
    v_mfma_f32_16x16x32_bf16 v[104:107], v[64:67], v[32:35], v[104:107]
    ds_read_b64_tr_b16 v[48:49], v8 offset:0
    v_mfma_f32_16x16x32_bf16 v[108:111], v[64:67], v[36:39], v[108:111]
    ds_read_b64_tr_b16 v[50:51], v8 offset:2048
    v_mfma_f32_16x16x32_bf16 v[112:115], v[64:67], v[40:43], v[112:115]
    ds_read_b128 v[16:19], v12 offset:0
    v_mfma_f32_16x16x32_bf16 v[116:119], v[64:67], v[44:47], v[116:119]
    ds_read_b128 v[20:23], v12 offset:2048
    v_mfma_f32_16x16x32_bf16 v[120:123], v[68:71], v[32:35], v[120:123]
    ds_read_b128 v[24:27], v12 offset:4096
    v_mfma_f32_16x16x32_bf16 v[124:127], v[68:71], v[36:39], v[124:127]
    ds_read_b128 v[28:31], v12 offset:6144
    v_mfma_f32_16x16x32_bf16 v[128:131], v[68:71], v[40:43], v[128:131]
    ds_read_b64_tr_b16 v[52:53], v9 offset:0
    v_mfma_f32_16x16x32_bf16 v[132:135], v[68:71], v[44:47], v[132:135]
    ds_read_b64_tr_b16 v[54:55], v9 offset:2048
    v_mfma_f32_16x16x32_bf16 v[136:139], v[72:75], v[32:35], v[136:139]
    ds_read_b64_tr_b16 v[56:57], v10 offset:0
    v_mfma_f32_16x16x32_bf16 v[140:143], v[72:75], v[36:39], v[140:143]
    ds_read_b64_tr_b16 v[58:59], v10 offset:2048
    v_mfma_f32_16x16x32_bf16 v[144:147], v[72:75], v[40:43], v[144:147]
    ds_read_b64_tr_b16 v[60:61], v11 offset:0
    v_mfma_f32_16x16x32_bf16 v[148:151], v[72:75], v[44:47], v[148:151]
    ds_read_b64_tr_b16 v[62:63], v11 offset:2048
    v_mfma_f32_16x16x32_bf16 v[152:155], v[76:79], v[32:35], v[152:155]
    v_mfma_f32_16x16x32_bf16 v[156:159], v[76:79], v[36:39], v[156:159]
    v_mfma_f32_16x16x32_bf16 v[160:163], v[76:79], v[40:43], v[160:163]
    v_mfma_f32_16x16x32_bf16 v[164:167], v[76:79], v[44:47], v[164:167]
    s_waitcnt lgkmcnt(0)
    v_cmp_eq_u32 vcc, 0, v81
    s_cmp_eq_u64 vcc, 0
    s_cbranch_scc0 gated__nol20
    ds_write_b32 v7, v3 offset:44
    s_branch gated__l2d
gated__nol20:
    buffer_load_dword v81, v82, s[12:15], s55 offen offset:4 sc1
gated__l2d:
    v_mfma_f32_16x16x32_bf16 v[104:107], v[48:51], v[16:19], v[104:107]
    ds_read_b64_tr_b16 v[64:65], v8 offset:4096
    v_mfma_f32_16x16x32_bf16 v[108:111], v[48:51], v[20:23], v[108:111]
    ds_read_b64_tr_b16 v[66:67], v8 offset:6144
    v_mfma_f32_16x16x32_bf16 v[112:115], v[48:51], v[24:27], v[112:115]
    ds_read_b128 v[32:35], v6 offset:0
    v_mfma_f32_16x16x32_bf16 v[116:119], v[48:51], v[28:31], v[116:119]
    ds_read_b128 v[36:39], v6 offset:2048
    v_mfma_f32_16x16x32_bf16 v[120:123], v[52:55], v[16:19], v[120:123]
    ds_read_b128 v[40:43], v6 offset:4096
    v_mfma_f32_16x16x32_bf16 v[124:127], v[52:55], v[20:23], v[124:127]
    ds_read_b128 v[44:47], v6 offset:6144
    v_mfma_f32_16x16x32_bf16 v[128:131], v[52:55], v[24:27], v[128:131]
    ds_read_b64_tr_b16 v[68:69], v9 offset:4096
    v_mfma_f32_16x16x32_bf16 v[132:135], v[52:55], v[28:31], v[132:135]
    ds_read_b64_tr_b16 v[70:71], v9 offset:6144
    v_mfma_f32_16x16x32_bf16 v[136:139], v[56:59], v[16:19], v[136:139]
    ds_read_b64_tr_b16 v[72:73], v10 offset:4096
    v_mfma_f32_16x16x32_bf16 v[140:143], v[56:59], v[20:23], v[140:143]
    ds_read_b64_tr_b16 v[74:75], v10 offset:6144
    v_mfma_f32_16x16x32_bf16 v[144:147], v[56:59], v[24:27], v[144:147]
    ds_read_b64_tr_b16 v[76:77], v11 offset:4096
    v_mfma_f32_16x16x32_bf16 v[148:151], v[56:59], v[28:31], v[148:151]
    ds_read_b64_tr_b16 v[78:79], v11 offset:6144
    v_mfma_f32_16x16x32_bf16 v[152:155], v[60:63], v[16:19], v[152:155]
    v_mfma_f32_16x16x32_bf16 v[156:159], v[60:63], v[20:23], v[156:159]
    v_mfma_f32_16x16x32_bf16 v[160:163], v[60:63], v[24:27], v[160:163]
    v_mfma_f32_16x16x32_bf16 v[164:167], v[60:63], v[28:31], v[164:167]
    s_waitcnt  lgkmcnt(0)
    s_barrier
    v_add_u32 v12, 32768, v12
    v_add_u32 v6, 32768, v6
    v_add_u32 v8, 32768, v8
    v_add_u32 v9, 32768, v9
    v_add_u32 v10, 32768, v10
    v_add_u32 v11, 32768, v11
    v_mfma_f32_16x16x32_bf16 v[104:107], v[64:67], v[32:35], v[104:107]
    ds_read_b64_tr_b16 v[48:49], v8 offset:0
    v_mfma_f32_16x16x32_bf16 v[108:111], v[64:67], v[36:39], v[108:111]
    ds_read_b64_tr_b16 v[50:51], v8 offset:2048
    v_mfma_f32_16x16x32_bf16 v[112:115], v[64:67], v[40:43], v[112:115]
    ds_read_b128 v[16:19], v12 offset:0
    v_mfma_f32_16x16x32_bf16 v[116:119], v[64:67], v[44:47], v[116:119]
    ds_read_b128 v[20:23], v12 offset:2048
    v_mfma_f32_16x16x32_bf16 v[120:123], v[68:71], v[32:35], v[120:123]
    ds_read_b128 v[24:27], v12 offset:4096
    v_mfma_f32_16x16x32_bf16 v[124:127], v[68:71], v[36:39], v[124:127]
    ds_read_b128 v[28:31], v12 offset:6144
    v_mfma_f32_16x16x32_bf16 v[128:131], v[68:71], v[40:43], v[128:131]
    ds_read_b64_tr_b16 v[52:53], v9 offset:0
    v_mfma_f32_16x16x32_bf16 v[132:135], v[68:71], v[44:47], v[132:135]
    ds_read_b64_tr_b16 v[54:55], v9 offset:2048
    v_mfma_f32_16x16x32_bf16 v[136:139], v[72:75], v[32:35], v[136:139]
    ds_read_b64_tr_b16 v[56:57], v10 offset:0
    v_mfma_f32_16x16x32_bf16 v[140:143], v[72:75], v[36:39], v[140:143]
    ds_read_b64_tr_b16 v[58:59], v10 offset:2048
    v_mfma_f32_16x16x32_bf16 v[144:147], v[72:75], v[40:43], v[144:147]
    ds_read_b64_tr_b16 v[60:61], v11 offset:0
    v_mfma_f32_16x16x32_bf16 v[148:151], v[72:75], v[44:47], v[148:151]
    ds_read_b64_tr_b16 v[62:63], v11 offset:2048
    v_mfma_f32_16x16x32_bf16 v[152:155], v[76:79], v[32:35], v[152:155]
    v_mfma_f32_16x16x32_bf16 v[156:159], v[76:79], v[36:39], v[156:159]
    v_mfma_f32_16x16x32_bf16 v[160:163], v[76:79], v[40:43], v[160:163]
    v_mfma_f32_16x16x32_bf16 v[164:167], v[76:79], v[44:47], v[164:167]
    s_waitcnt lgkmcnt(0)
    v_mfma_f32_16x16x32_bf16 v[104:107], v[48:51], v[16:19], v[104:107]
    ds_read_b64_tr_b16 v[64:65], v8 offset:4096
    v_mfma_f32_16x16x32_bf16 v[108:111], v[48:51], v[20:23], v[108:111]
    ds_read_b64_tr_b16 v[66:67], v8 offset:6144
    v_mfma_f32_16x16x32_bf16 v[112:115], v[48:51], v[24:27], v[112:115]
    ds_read_b128 v[32:35], v6 offset:0
    v_mfma_f32_16x16x32_bf16 v[116:119], v[48:51], v[28:31], v[116:119]
    ds_read_b128 v[36:39], v6 offset:2048
    v_mfma_f32_16x16x32_bf16 v[120:123], v[52:55], v[16:19], v[120:123]
    ds_read_b128 v[40:43], v6 offset:4096
    v_mfma_f32_16x16x32_bf16 v[124:127], v[52:55], v[20:23], v[124:127]
    ds_read_b128 v[44:47], v6 offset:6144
    v_mfma_f32_16x16x32_bf16 v[128:131], v[52:55], v[24:27], v[128:131]
    ds_read_b64_tr_b16 v[68:69], v9 offset:4096
    v_mfma_f32_16x16x32_bf16 v[132:135], v[52:55], v[28:31], v[132:135]
    ds_read_b64_tr_b16 v[70:71], v9 offset:6144
    v_mfma_f32_16x16x32_bf16 v[136:139], v[56:59], v[16:19], v[136:139]
    ds_read_b64_tr_b16 v[72:73], v10 offset:4096
    v_mfma_f32_16x16x32_bf16 v[140:143], v[56:59], v[20:23], v[140:143]
    ds_read_b64_tr_b16 v[74:75], v10 offset:6144
    v_mfma_f32_16x16x32_bf16 v[144:147], v[56:59], v[24:27], v[144:147]
    ds_read_b64_tr_b16 v[76:77], v11 offset:4096
    v_mfma_f32_16x16x32_bf16 v[148:151], v[56:59], v[28:31], v[148:151]
    ds_read_b64_tr_b16 v[78:79], v11 offset:6144
    v_mfma_f32_16x16x32_bf16 v[152:155], v[60:63], v[16:19], v[152:155]
    v_mfma_f32_16x16x32_bf16 v[156:159], v[60:63], v[20:23], v[156:159]
    v_mfma_f32_16x16x32_bf16 v[160:163], v[60:63], v[24:27], v[160:163]
    v_mfma_f32_16x16x32_bf16 v[164:167], v[60:63], v[28:31], v[164:167]
    s_waitcnt  lgkmcnt(0)
    s_barrier
    v_add_u32 v12, 4294868992, v12
    v_add_u32 v6, 4294868992, v6
    v_add_u32 v8, 4294868992, v8
    v_add_u32 v9, 4294868992, v9
    v_add_u32 v10, 4294868992, v10
    v_add_u32 v11, 4294868992, v11
    v_mfma_f32_16x16x32_bf16 v[104:107], v[64:67], v[32:35], v[104:107]
    ds_read_b64_tr_b16 v[48:49], v8 offset:0
    v_mfma_f32_16x16x32_bf16 v[108:111], v[64:67], v[36:39], v[108:111]
    ds_read_b64_tr_b16 v[50:51], v8 offset:2048
    v_mfma_f32_16x16x32_bf16 v[112:115], v[64:67], v[40:43], v[112:115]
    ds_read_b128 v[16:19], v12 offset:0
    v_mfma_f32_16x16x32_bf16 v[116:119], v[64:67], v[44:47], v[116:119]
    ds_read_b128 v[20:23], v12 offset:2048
    v_mfma_f32_16x16x32_bf16 v[120:123], v[68:71], v[32:35], v[120:123]
    ds_read_b128 v[24:27], v12 offset:4096
    v_mfma_f32_16x16x32_bf16 v[124:127], v[68:71], v[36:39], v[124:127]
    ds_read_b128 v[28:31], v12 offset:6144
    v_mfma_f32_16x16x32_bf16 v[128:131], v[68:71], v[40:43], v[128:131]
    ds_read_b64_tr_b16 v[52:53], v9 offset:0
    v_mfma_f32_16x16x32_bf16 v[132:135], v[68:71], v[44:47], v[132:135]
    ds_read_b64_tr_b16 v[54:55], v9 offset:2048
    v_mfma_f32_16x16x32_bf16 v[136:139], v[72:75], v[32:35], v[136:139]
    ds_read_b64_tr_b16 v[56:57], v10 offset:0
    v_mfma_f32_16x16x32_bf16 v[140:143], v[72:75], v[36:39], v[140:143]
    ds_read_b64_tr_b16 v[58:59], v10 offset:2048
    v_mfma_f32_16x16x32_bf16 v[144:147], v[72:75], v[40:43], v[144:147]
    ds_read_b64_tr_b16 v[60:61], v11 offset:0
    v_mfma_f32_16x16x32_bf16 v[148:151], v[72:75], v[44:47], v[148:151]
    ds_read_b64_tr_b16 v[62:63], v11 offset:2048
    v_mfma_f32_16x16x32_bf16 v[152:155], v[76:79], v[32:35], v[152:155]
    v_mfma_f32_16x16x32_bf16 v[156:159], v[76:79], v[36:39], v[156:159]
    v_mfma_f32_16x16x32_bf16 v[160:163], v[76:79], v[40:43], v[160:163]
    v_mfma_f32_16x16x32_bf16 v[164:167], v[76:79], v[44:47], v[164:167]
    s_waitcnt lgkmcnt(0)
    v_cmp_eq_u32 vcc, 0, v81
    s_cmp_eq_u64 vcc, 0
    s_cbranch_scc0 gated__nol21
    ds_write_b32 v7, v3 offset:44
gated__nol21:
    v_mfma_f32_16x16x32_bf16 v[104:107], v[48:51], v[16:19], v[104:107]
    ds_read_b64_tr_b16 v[64:65], v8 offset:4096
    v_mfma_f32_16x16x32_bf16 v[108:111], v[48:51], v[20:23], v[108:111]
    ds_read_b64_tr_b16 v[66:67], v8 offset:6144
    v_mfma_f32_16x16x32_bf16 v[112:115], v[48:51], v[24:27], v[112:115]
    ds_read_b128 v[32:35], v6 offset:0
    v_mfma_f32_16x16x32_bf16 v[116:119], v[48:51], v[28:31], v[116:119]
    ds_read_b128 v[36:39], v6 offset:2048
    v_mfma_f32_16x16x32_bf16 v[120:123], v[52:55], v[16:19], v[120:123]
    ds_read_b128 v[40:43], v6 offset:4096
    v_mfma_f32_16x16x32_bf16 v[124:127], v[52:55], v[20:23], v[124:127]
    ds_read_b128 v[44:47], v6 offset:6144
    v_mfma_f32_16x16x32_bf16 v[128:131], v[52:55], v[24:27], v[128:131]
    ds_read_b64_tr_b16 v[68:69], v9 offset:4096
    v_mfma_f32_16x16x32_bf16 v[132:135], v[52:55], v[28:31], v[132:135]
    ds_read_b64_tr_b16 v[70:71], v9 offset:6144
    v_mfma_f32_16x16x32_bf16 v[136:139], v[56:59], v[16:19], v[136:139]
    ds_read_b64_tr_b16 v[72:73], v10 offset:4096
    v_mfma_f32_16x16x32_bf16 v[140:143], v[56:59], v[20:23], v[140:143]
    ds_read_b64_tr_b16 v[74:75], v10 offset:6144
    v_mfma_f32_16x16x32_bf16 v[144:147], v[56:59], v[24:27], v[144:147]
    ds_read_b64_tr_b16 v[76:77], v11 offset:4096
    v_mfma_f32_16x16x32_bf16 v[148:151], v[56:59], v[28:31], v[148:151]
    ds_read_b64_tr_b16 v[78:79], v11 offset:6144
    v_mfma_f32_16x16x32_bf16 v[152:155], v[60:63], v[16:19], v[152:155]
    v_mfma_f32_16x16x32_bf16 v[156:159], v[60:63], v[20:23], v[156:159]
    v_mfma_f32_16x16x32_bf16 v[160:163], v[60:63], v[24:27], v[160:163]
    v_mfma_f32_16x16x32_bf16 v[164:167], v[60:63], v[28:31], v[164:167]
    s_waitcnt  lgkmcnt(0)
    s_barrier
    v_add_u32 v12, 32768, v12
    v_add_u32 v6, 32768, v6
    v_add_u32 v8, 32768, v8
    v_add_u32 v9, 32768, v9
    v_add_u32 v10, 32768, v10
    v_add_u32 v11, 32768, v11
    v_mfma_f32_16x16x32_bf16 v[104:107], v[64:67], v[32:35], v[104:107]
    ds_read_b64_tr_b16 v[48:49], v8 offset:0
    v_mfma_f32_16x16x32_bf16 v[108:111], v[64:67], v[36:39], v[108:111]
    ds_read_b64_tr_b16 v[50:51], v8 offset:2048
    v_mfma_f32_16x16x32_bf16 v[112:115], v[64:67], v[40:43], v[112:115]
    ds_read_b128 v[16:19], v12 offset:0
    v_mfma_f32_16x16x32_bf16 v[116:119], v[64:67], v[44:47], v[116:119]
    ds_read_b128 v[20:23], v12 offset:2048
    v_mfma_f32_16x16x32_bf16 v[120:123], v[68:71], v[32:35], v[120:123]
    ds_read_b128 v[24:27], v12 offset:4096
    v_mfma_f32_16x16x32_bf16 v[124:127], v[68:71], v[36:39], v[124:127]
    ds_read_b128 v[28:31], v12 offset:6144
    v_mfma_f32_16x16x32_bf16 v[128:131], v[68:71], v[40:43], v[128:131]
    ds_read_b64_tr_b16 v[52:53], v9 offset:0
    v_mfma_f32_16x16x32_bf16 v[132:135], v[68:71], v[44:47], v[132:135]
    ds_read_b64_tr_b16 v[54:55], v9 offset:2048
    v_mfma_f32_16x16x32_bf16 v[136:139], v[72:75], v[32:35], v[136:139]
    ds_read_b64_tr_b16 v[56:57], v10 offset:0
    v_mfma_f32_16x16x32_bf16 v[140:143], v[72:75], v[36:39], v[140:143]
    ds_read_b64_tr_b16 v[58:59], v10 offset:2048
    v_mfma_f32_16x16x32_bf16 v[144:147], v[72:75], v[40:43], v[144:147]
    ds_read_b64_tr_b16 v[60:61], v11 offset:0
    v_mfma_f32_16x16x32_bf16 v[148:151], v[72:75], v[44:47], v[148:151]
    ds_read_b64_tr_b16 v[62:63], v11 offset:2048
    v_mfma_f32_16x16x32_bf16 v[152:155], v[76:79], v[32:35], v[152:155]
    v_mfma_f32_16x16x32_bf16 v[156:159], v[76:79], v[36:39], v[156:159]
    v_mfma_f32_16x16x32_bf16 v[160:163], v[76:79], v[40:43], v[160:163]
    v_mfma_f32_16x16x32_bf16 v[164:167], v[76:79], v[44:47], v[164:167]
    s_waitcnt lgkmcnt(0)
    v_mfma_f32_16x16x32_bf16 v[104:107], v[48:51], v[16:19], v[104:107]
    ds_read_b64_tr_b16 v[64:65], v8 offset:4096
    v_mfma_f32_16x16x32_bf16 v[108:111], v[48:51], v[20:23], v[108:111]
    ds_read_b64_tr_b16 v[66:67], v8 offset:6144
    v_mfma_f32_16x16x32_bf16 v[112:115], v[48:51], v[24:27], v[112:115]
    ds_read_b128 v[32:35], v6 offset:0
    v_mfma_f32_16x16x32_bf16 v[116:119], v[48:51], v[28:31], v[116:119]
    ds_read_b128 v[36:39], v6 offset:2048
    v_mfma_f32_16x16x32_bf16 v[120:123], v[52:55], v[16:19], v[120:123]
    ds_read_b128 v[40:43], v6 offset:4096
    v_mfma_f32_16x16x32_bf16 v[124:127], v[52:55], v[20:23], v[124:127]
    ds_read_b128 v[44:47], v6 offset:6144
    v_mfma_f32_16x16x32_bf16 v[128:131], v[52:55], v[24:27], v[128:131]
    ds_read_b64_tr_b16 v[68:69], v9 offset:4096
    v_mfma_f32_16x16x32_bf16 v[132:135], v[52:55], v[28:31], v[132:135]
    ds_read_b64_tr_b16 v[70:71], v9 offset:6144
    v_mfma_f32_16x16x32_bf16 v[136:139], v[56:59], v[16:19], v[136:139]
    ds_read_b64_tr_b16 v[72:73], v10 offset:4096
    v_mfma_f32_16x16x32_bf16 v[140:143], v[56:59], v[20:23], v[140:143]
    ds_read_b64_tr_b16 v[74:75], v10 offset:6144
    v_mfma_f32_16x16x32_bf16 v[144:147], v[56:59], v[24:27], v[144:147]
    ds_read_b64_tr_b16 v[76:77], v11 offset:4096
    v_mfma_f32_16x16x32_bf16 v[148:151], v[56:59], v[28:31], v[148:151]
    ds_read_b64_tr_b16 v[78:79], v11 offset:6144
    v_mfma_f32_16x16x32_bf16 v[152:155], v[60:63], v[16:19], v[152:155]
    v_mfma_f32_16x16x32_bf16 v[156:159], v[60:63], v[20:23], v[156:159]
    v_mfma_f32_16x16x32_bf16 v[160:163], v[60:63], v[24:27], v[160:163]
    v_mfma_f32_16x16x32_bf16 v[164:167], v[60:63], v[28:31], v[164:167]
    s_waitcnt  lgkmcnt(0)
    s_barrier
    v_add_u32 v12, 32768, v12
    v_add_u32 v6, 32768, v6
    v_add_u32 v8, 32768, v8
    v_add_u32 v9, 32768, v9
    v_add_u32 v10, 32768, v10
    v_add_u32 v11, 32768, v11
    v_mfma_f32_16x16x32_bf16 v[104:107], v[64:67], v[32:35], v[104:107]
    ds_read_b64_tr_b16 v[48:49], v8 offset:0
    v_mfma_f32_16x16x32_bf16 v[108:111], v[64:67], v[36:39], v[108:111]
    ds_read_b64_tr_b16 v[50:51], v8 offset:2048
    v_mfma_f32_16x16x32_bf16 v[112:115], v[64:67], v[40:43], v[112:115]
    ds_read_b128 v[16:19], v12 offset:0
    v_mfma_f32_16x16x32_bf16 v[116:119], v[64:67], v[44:47], v[116:119]
    ds_read_b128 v[20:23], v12 offset:2048
    v_mfma_f32_16x16x32_bf16 v[120:123], v[68:71], v[32:35], v[120:123]
    ds_read_b128 v[24:27], v12 offset:4096
    v_mfma_f32_16x16x32_bf16 v[124:127], v[68:71], v[36:39], v[124:127]
    ds_read_b128 v[28:31], v12 offset:6144
    v_mfma_f32_16x16x32_bf16 v[128:131], v[68:71], v[40:43], v[128:131]
    ds_read_b64_tr_b16 v[52:53], v9 offset:0
    v_mfma_f32_16x16x32_bf16 v[132:135], v[68:71], v[44:47], v[132:135]
    ds_read_b64_tr_b16 v[54:55], v9 offset:2048
    v_mfma_f32_16x16x32_bf16 v[136:139], v[72:75], v[32:35], v[136:139]
    ds_read_b64_tr_b16 v[56:57], v10 offset:0
    v_mfma_f32_16x16x32_bf16 v[140:143], v[72:75], v[36:39], v[140:143]
    ds_read_b64_tr_b16 v[58:59], v10 offset:2048
    v_mfma_f32_16x16x32_bf16 v[144:147], v[72:75], v[40:43], v[144:147]
    ds_read_b64_tr_b16 v[60:61], v11 offset:0
    v_mfma_f32_16x16x32_bf16 v[148:151], v[72:75], v[44:47], v[148:151]
    ds_read_b64_tr_b16 v[62:63], v11 offset:2048
    v_mfma_f32_16x16x32_bf16 v[152:155], v[76:79], v[32:35], v[152:155]
    v_mfma_f32_16x16x32_bf16 v[156:159], v[76:79], v[36:39], v[156:159]
    v_mfma_f32_16x16x32_bf16 v[160:163], v[76:79], v[40:43], v[160:163]
    v_mfma_f32_16x16x32_bf16 v[164:167], v[76:79], v[44:47], v[164:167]
    s_waitcnt lgkmcnt(0)
    v_mfma_f32_16x16x32_bf16 v[104:107], v[48:51], v[16:19], v[104:107]
    ds_read_b64_tr_b16 v[64:65], v8 offset:4096
    v_mfma_f32_16x16x32_bf16 v[108:111], v[48:51], v[20:23], v[108:111]
    ds_read_b64_tr_b16 v[66:67], v8 offset:6144
    v_mfma_f32_16x16x32_bf16 v[112:115], v[48:51], v[24:27], v[112:115]
    ds_read_b128 v[32:35], v6 offset:0
    v_mfma_f32_16x16x32_bf16 v[116:119], v[48:51], v[28:31], v[116:119]
    ds_read_b128 v[36:39], v6 offset:2048
    v_mfma_f32_16x16x32_bf16 v[120:123], v[52:55], v[16:19], v[120:123]
    ds_read_b128 v[40:43], v6 offset:4096
    v_mfma_f32_16x16x32_bf16 v[124:127], v[52:55], v[20:23], v[124:127]
    ds_read_b128 v[44:47], v6 offset:6144
    v_mfma_f32_16x16x32_bf16 v[128:131], v[52:55], v[24:27], v[128:131]
    ds_read_b64_tr_b16 v[68:69], v9 offset:4096
    v_mfma_f32_16x16x32_bf16 v[132:135], v[52:55], v[28:31], v[132:135]
    ds_read_b64_tr_b16 v[70:71], v9 offset:6144
    v_mfma_f32_16x16x32_bf16 v[136:139], v[56:59], v[16:19], v[136:139]
    ds_read_b64_tr_b16 v[72:73], v10 offset:4096
    v_mfma_f32_16x16x32_bf16 v[140:143], v[56:59], v[20:23], v[140:143]
    ds_read_b64_tr_b16 v[74:75], v10 offset:6144
    v_mfma_f32_16x16x32_bf16 v[144:147], v[56:59], v[24:27], v[144:147]
    ds_read_b64_tr_b16 v[76:77], v11 offset:4096
    v_mfma_f32_16x16x32_bf16 v[148:151], v[56:59], v[28:31], v[148:151]
    ds_read_b64_tr_b16 v[78:79], v11 offset:6144
    v_mfma_f32_16x16x32_bf16 v[152:155], v[60:63], v[16:19], v[152:155]
    v_mfma_f32_16x16x32_bf16 v[156:159], v[60:63], v[20:23], v[156:159]
    v_mfma_f32_16x16x32_bf16 v[160:163], v[60:63], v[24:27], v[160:163]
    v_mfma_f32_16x16x32_bf16 v[164:167], v[60:63], v[28:31], v[164:167]
    s_waitcnt  lgkmcnt(0)
    s_barrier
    v_add_u32 v12, 32768, v12
    v_add_u32 v6, 32768, v6
    v_add_u32 v8, 32768, v8
    v_add_u32 v9, 32768, v9
    v_add_u32 v10, 32768, v10
    v_add_u32 v11, 32768, v11
    v_mfma_f32_16x16x32_bf16 v[104:107], v[64:67], v[32:35], v[104:107]
    ds_read_b64_tr_b16 v[48:49], v8 offset:0
    v_mfma_f32_16x16x32_bf16 v[108:111], v[64:67], v[36:39], v[108:111]
    ds_read_b64_tr_b16 v[50:51], v8 offset:2048
    v_mfma_f32_16x16x32_bf16 v[112:115], v[64:67], v[40:43], v[112:115]
    ds_read_b128 v[16:19], v12 offset:0
    v_mfma_f32_16x16x32_bf16 v[116:119], v[64:67], v[44:47], v[116:119]
    ds_read_b128 v[20:23], v12 offset:2048
    v_mfma_f32_16x16x32_bf16 v[120:123], v[68:71], v[32:35], v[120:123]
    ds_read_b128 v[24:27], v12 offset:4096
    v_mfma_f32_16x16x32_bf16 v[124:127], v[68:71], v[36:39], v[124:127]
    ds_read_b128 v[28:31], v12 offset:6144
    v_mfma_f32_16x16x32_bf16 v[128:131], v[68:71], v[40:43], v[128:131]
    ds_read_b64_tr_b16 v[52:53], v9 offset:0
    v_mfma_f32_16x16x32_bf16 v[132:135], v[68:71], v[44:47], v[132:135]
    ds_read_b64_tr_b16 v[54:55], v9 offset:2048
    v_mfma_f32_16x16x32_bf16 v[136:139], v[72:75], v[32:35], v[136:139]
    ds_read_b64_tr_b16 v[56:57], v10 offset:0
    v_mfma_f32_16x16x32_bf16 v[140:143], v[72:75], v[36:39], v[140:143]
    ds_read_b64_tr_b16 v[58:59], v10 offset:2048
    v_mfma_f32_16x16x32_bf16 v[144:147], v[72:75], v[40:43], v[144:147]
    ds_read_b64_tr_b16 v[60:61], v11 offset:0
    v_mfma_f32_16x16x32_bf16 v[148:151], v[72:75], v[44:47], v[148:151]
    ds_read_b64_tr_b16 v[62:63], v11 offset:2048
    v_mfma_f32_16x16x32_bf16 v[152:155], v[76:79], v[32:35], v[152:155]
    v_mfma_f32_16x16x32_bf16 v[156:159], v[76:79], v[36:39], v[156:159]
    v_mfma_f32_16x16x32_bf16 v[160:163], v[76:79], v[40:43], v[160:163]
    v_mfma_f32_16x16x32_bf16 v[164:167], v[76:79], v[44:47], v[164:167]
    s_waitcnt lgkmcnt(0)
    v_mfma_f32_16x16x32_bf16 v[104:107], v[48:51], v[16:19], v[104:107]
    ds_read_b64_tr_b16 v[64:65], v8 offset:4096
    v_mfma_f32_16x16x32_bf16 v[108:111], v[48:51], v[20:23], v[108:111]
    ds_read_b64_tr_b16 v[66:67], v8 offset:6144
    v_mfma_f32_16x16x32_bf16 v[112:115], v[48:51], v[24:27], v[112:115]
    ds_read_b128 v[32:35], v6 offset:0
    v_mfma_f32_16x16x32_bf16 v[116:119], v[48:51], v[28:31], v[116:119]
    ds_read_b128 v[36:39], v6 offset:2048
    v_mfma_f32_16x16x32_bf16 v[120:123], v[52:55], v[16:19], v[120:123]
    ds_read_b128 v[40:43], v6 offset:4096
    v_mfma_f32_16x16x32_bf16 v[124:127], v[52:55], v[20:23], v[124:127]
    ds_read_b128 v[44:47], v6 offset:6144
    v_mfma_f32_16x16x32_bf16 v[128:131], v[52:55], v[24:27], v[128:131]
    ds_read_b64_tr_b16 v[68:69], v9 offset:4096
    v_mfma_f32_16x16x32_bf16 v[132:135], v[52:55], v[28:31], v[132:135]
    ds_read_b64_tr_b16 v[70:71], v9 offset:6144
    v_mfma_f32_16x16x32_bf16 v[136:139], v[56:59], v[16:19], v[136:139]
    ds_read_b64_tr_b16 v[72:73], v10 offset:4096
    v_mfma_f32_16x16x32_bf16 v[140:143], v[56:59], v[20:23], v[140:143]
    ds_read_b64_tr_b16 v[74:75], v10 offset:6144
    v_mfma_f32_16x16x32_bf16 v[144:147], v[56:59], v[24:27], v[144:147]
    ds_read_b64_tr_b16 v[76:77], v11 offset:4096
    v_mfma_f32_16x16x32_bf16 v[148:151], v[56:59], v[28:31], v[148:151]
    ds_read_b64_tr_b16 v[78:79], v11 offset:6144
    v_mfma_f32_16x16x32_bf16 v[152:155], v[60:63], v[16:19], v[152:155]
    v_mfma_f32_16x16x32_bf16 v[156:159], v[60:63], v[20:23], v[156:159]
    v_mfma_f32_16x16x32_bf16 v[160:163], v[60:63], v[24:27], v[160:163]
    v_mfma_f32_16x16x32_bf16 v[164:167], v[60:63], v[28:31], v[164:167]
    s_waitcnt  lgkmcnt(0)
    s_barrier
    v_add_u32 v12, 4294868992, v12
    v_add_u32 v6, 4294868992, v6
    v_add_u32 v8, 4294868992, v8
    v_add_u32 v9, 4294868992, v9
    v_add_u32 v10, 4294868992, v10
    v_add_u32 v11, 4294868992, v11
    v_mfma_f32_16x16x32_bf16 v[104:107], v[64:67], v[32:35], v[104:107]
    ds_read_b64_tr_b16 v[48:49], v8 offset:0
    v_mfma_f32_16x16x32_bf16 v[108:111], v[64:67], v[36:39], v[108:111]
    ds_read_b64_tr_b16 v[50:51], v8 offset:2048
    v_mfma_f32_16x16x32_bf16 v[112:115], v[64:67], v[40:43], v[112:115]
    ds_read_b128 v[16:19], v12 offset:0
    v_mfma_f32_16x16x32_bf16 v[116:119], v[64:67], v[44:47], v[116:119]
    ds_read_b128 v[20:23], v12 offset:2048
    v_mfma_f32_16x16x32_bf16 v[120:123], v[68:71], v[32:35], v[120:123]
    ds_read_b128 v[24:27], v12 offset:4096
    v_mfma_f32_16x16x32_bf16 v[124:127], v[68:71], v[36:39], v[124:127]
    ds_read_b128 v[28:31], v12 offset:6144
    v_mfma_f32_16x16x32_bf16 v[128:131], v[68:71], v[40:43], v[128:131]
    ds_read_b64_tr_b16 v[52:53], v9 offset:0
    v_mfma_f32_16x16x32_bf16 v[132:135], v[68:71], v[44:47], v[132:135]
    ds_read_b64_tr_b16 v[54:55], v9 offset:2048
    v_mfma_f32_16x16x32_bf16 v[136:139], v[72:75], v[32:35], v[136:139]
    ds_read_b64_tr_b16 v[56:57], v10 offset:0
    v_mfma_f32_16x16x32_bf16 v[140:143], v[72:75], v[36:39], v[140:143]
    ds_read_b64_tr_b16 v[58:59], v10 offset:2048
    v_mfma_f32_16x16x32_bf16 v[144:147], v[72:75], v[40:43], v[144:147]
    ds_read_b64_tr_b16 v[60:61], v11 offset:0
    v_mfma_f32_16x16x32_bf16 v[148:151], v[72:75], v[44:47], v[148:151]
    ds_read_b64_tr_b16 v[62:63], v11 offset:2048
    v_mfma_f32_16x16x32_bf16 v[152:155], v[76:79], v[32:35], v[152:155]
    v_mfma_f32_16x16x32_bf16 v[156:159], v[76:79], v[36:39], v[156:159]
    v_mfma_f32_16x16x32_bf16 v[160:163], v[76:79], v[40:43], v[160:163]
    v_mfma_f32_16x16x32_bf16 v[164:167], v[76:79], v[44:47], v[164:167]
    s_waitcnt lgkmcnt(0)
    v_mfma_f32_16x16x32_bf16 v[104:107], v[48:51], v[16:19], v[104:107]
    ds_read_b64_tr_b16 v[64:65], v8 offset:4096
    v_mfma_f32_16x16x32_bf16 v[108:111], v[48:51], v[20:23], v[108:111]
    ds_read_b64_tr_b16 v[66:67], v8 offset:6144
    v_mfma_f32_16x16x32_bf16 v[112:115], v[48:51], v[24:27], v[112:115]
    ds_read_b128 v[32:35], v6 offset:0
    v_mfma_f32_16x16x32_bf16 v[116:119], v[48:51], v[28:31], v[116:119]
    ds_read_b128 v[36:39], v6 offset:2048
    v_mfma_f32_16x16x32_bf16 v[120:123], v[52:55], v[16:19], v[120:123]
    ds_read_b128 v[40:43], v6 offset:4096
    v_mfma_f32_16x16x32_bf16 v[124:127], v[52:55], v[20:23], v[124:127]
    ds_read_b128 v[44:47], v6 offset:6144
    v_mfma_f32_16x16x32_bf16 v[128:131], v[52:55], v[24:27], v[128:131]
    ds_read_b64_tr_b16 v[68:69], v9 offset:4096
    v_mfma_f32_16x16x32_bf16 v[132:135], v[52:55], v[28:31], v[132:135]
    ds_read_b64_tr_b16 v[70:71], v9 offset:6144
    v_mfma_f32_16x16x32_bf16 v[136:139], v[56:59], v[16:19], v[136:139]
    ds_read_b64_tr_b16 v[72:73], v10 offset:4096
    v_mfma_f32_16x16x32_bf16 v[140:143], v[56:59], v[20:23], v[140:143]
    ds_read_b64_tr_b16 v[74:75], v10 offset:6144
    v_mfma_f32_16x16x32_bf16 v[144:147], v[56:59], v[24:27], v[144:147]
    ds_read_b64_tr_b16 v[76:77], v11 offset:4096
    v_mfma_f32_16x16x32_bf16 v[148:151], v[56:59], v[28:31], v[148:151]
    ds_read_b64_tr_b16 v[78:79], v11 offset:6144
    v_mfma_f32_16x16x32_bf16 v[152:155], v[60:63], v[16:19], v[152:155]
    v_mfma_f32_16x16x32_bf16 v[156:159], v[60:63], v[20:23], v[156:159]
    v_mfma_f32_16x16x32_bf16 v[160:163], v[60:63], v[24:27], v[160:163]
    v_mfma_f32_16x16x32_bf16 v[164:167], v[60:63], v[28:31], v[164:167]
    s_waitcnt  lgkmcnt(0)
    s_barrier
    v_add_u32 v12, 32768, v12
    v_add_u32 v6, 32768, v6
    v_add_u32 v8, 32768, v8
    v_add_u32 v9, 32768, v9
    v_add_u32 v10, 32768, v10
    v_add_u32 v11, 32768, v11
    v_mfma_f32_16x16x32_bf16 v[104:107], v[64:67], v[32:35], v[104:107]
    ds_read_b64_tr_b16 v[48:49], v8 offset:0
    v_mfma_f32_16x16x32_bf16 v[108:111], v[64:67], v[36:39], v[108:111]
    ds_read_b64_tr_b16 v[50:51], v8 offset:2048
    v_mfma_f32_16x16x32_bf16 v[112:115], v[64:67], v[40:43], v[112:115]
    ds_read_b128 v[16:19], v12 offset:0
    v_mfma_f32_16x16x32_bf16 v[116:119], v[64:67], v[44:47], v[116:119]
    ds_read_b128 v[20:23], v12 offset:2048
    v_mfma_f32_16x16x32_bf16 v[120:123], v[68:71], v[32:35], v[120:123]
    ds_read_b128 v[24:27], v12 offset:4096
    v_mfma_f32_16x16x32_bf16 v[124:127], v[68:71], v[36:39], v[124:127]
    ds_read_b128 v[28:31], v12 offset:6144
    v_mfma_f32_16x16x32_bf16 v[128:131], v[68:71], v[40:43], v[128:131]
    ds_read_b64_tr_b16 v[52:53], v9 offset:0
    v_mfma_f32_16x16x32_bf16 v[132:135], v[68:71], v[44:47], v[132:135]
    ds_read_b64_tr_b16 v[54:55], v9 offset:2048
    v_mfma_f32_16x16x32_bf16 v[136:139], v[72:75], v[32:35], v[136:139]
    ds_read_b64_tr_b16 v[56:57], v10 offset:0
    v_mfma_f32_16x16x32_bf16 v[140:143], v[72:75], v[36:39], v[140:143]
    ds_read_b64_tr_b16 v[58:59], v10 offset:2048
    v_mfma_f32_16x16x32_bf16 v[144:147], v[72:75], v[40:43], v[144:147]
    ds_read_b64_tr_b16 v[60:61], v11 offset:0
    v_mfma_f32_16x16x32_bf16 v[148:151], v[72:75], v[44:47], v[148:151]
    ds_read_b64_tr_b16 v[62:63], v11 offset:2048
    v_mfma_f32_16x16x32_bf16 v[152:155], v[76:79], v[32:35], v[152:155]
    v_mfma_f32_16x16x32_bf16 v[156:159], v[76:79], v[36:39], v[156:159]
    v_mfma_f32_16x16x32_bf16 v[160:163], v[76:79], v[40:43], v[160:163]
    v_mfma_f32_16x16x32_bf16 v[164:167], v[76:79], v[44:47], v[164:167]
    s_waitcnt lgkmcnt(0)
    v_mfma_f32_16x16x32_bf16 v[104:107], v[48:51], v[16:19], v[104:107]
    ds_read_b64_tr_b16 v[64:65], v8 offset:4096
    v_mfma_f32_16x16x32_bf16 v[108:111], v[48:51], v[20:23], v[108:111]
    ds_read_b64_tr_b16 v[66:67], v8 offset:6144
    v_mfma_f32_16x16x32_bf16 v[112:115], v[48:51], v[24:27], v[112:115]
    ds_read_b128 v[32:35], v6 offset:0
    v_mfma_f32_16x16x32_bf16 v[116:119], v[48:51], v[28:31], v[116:119]
    ds_read_b128 v[36:39], v6 offset:2048
    v_mfma_f32_16x16x32_bf16 v[120:123], v[52:55], v[16:19], v[120:123]
    ds_read_b128 v[40:43], v6 offset:4096
    v_mfma_f32_16x16x32_bf16 v[124:127], v[52:55], v[20:23], v[124:127]
    ds_read_b128 v[44:47], v6 offset:6144
    v_mfma_f32_16x16x32_bf16 v[128:131], v[52:55], v[24:27], v[128:131]
    ds_read_b64_tr_b16 v[68:69], v9 offset:4096
    v_mfma_f32_16x16x32_bf16 v[132:135], v[52:55], v[28:31], v[132:135]
    ds_read_b64_tr_b16 v[70:71], v9 offset:6144
    v_mfma_f32_16x16x32_bf16 v[136:139], v[56:59], v[16:19], v[136:139]
    ds_read_b64_tr_b16 v[72:73], v10 offset:4096
    v_mfma_f32_16x16x32_bf16 v[140:143], v[56:59], v[20:23], v[140:143]
    ds_read_b64_tr_b16 v[74:75], v10 offset:6144
    v_mfma_f32_16x16x32_bf16 v[144:147], v[56:59], v[24:27], v[144:147]
    ds_read_b64_tr_b16 v[76:77], v11 offset:4096
    v_mfma_f32_16x16x32_bf16 v[148:151], v[56:59], v[28:31], v[148:151]
    ds_read_b64_tr_b16 v[78:79], v11 offset:6144
    v_mfma_f32_16x16x32_bf16 v[152:155], v[60:63], v[16:19], v[152:155]
    v_mfma_f32_16x16x32_bf16 v[156:159], v[60:63], v[20:23], v[156:159]
    v_mfma_f32_16x16x32_bf16 v[160:163], v[60:63], v[24:27], v[160:163]
    v_mfma_f32_16x16x32_bf16 v[164:167], v[60:63], v[28:31], v[164:167]
    s_waitcnt  lgkmcnt(0)
    s_barrier
    v_add_u32 v12, 32768, v12
    v_add_u32 v6, 32768, v6
    v_add_u32 v8, 32768, v8
    v_add_u32 v9, 32768, v9
    v_add_u32 v10, 32768, v10
    v_add_u32 v11, 32768, v11
    v_mfma_f32_16x16x32_bf16 v[104:107], v[64:67], v[32:35], v[104:107]
    ds_read_b64_tr_b16 v[48:49], v8 offset:0
    v_mfma_f32_16x16x32_bf16 v[108:111], v[64:67], v[36:39], v[108:111]
    ds_read_b64_tr_b16 v[50:51], v8 offset:2048
    v_mfma_f32_16x16x32_bf16 v[112:115], v[64:67], v[40:43], v[112:115]
    ds_read_b128 v[16:19], v12 offset:0
    v_mfma_f32_16x16x32_bf16 v[116:119], v[64:67], v[44:47], v[116:119]
    ds_read_b128 v[20:23], v12 offset:2048
    v_mfma_f32_16x16x32_bf16 v[120:123], v[68:71], v[32:35], v[120:123]
    ds_read_b128 v[24:27], v12 offset:4096
    v_mfma_f32_16x16x32_bf16 v[124:127], v[68:71], v[36:39], v[124:127]
    ds_read_b128 v[28:31], v12 offset:6144
    v_mfma_f32_16x16x32_bf16 v[128:131], v[68:71], v[40:43], v[128:131]
    ds_read_b64_tr_b16 v[52:53], v9 offset:0
    v_mfma_f32_16x16x32_bf16 v[132:135], v[68:71], v[44:47], v[132:135]
    ds_read_b64_tr_b16 v[54:55], v9 offset:2048
    v_mfma_f32_16x16x32_bf16 v[136:139], v[72:75], v[32:35], v[136:139]
    ds_read_b64_tr_b16 v[56:57], v10 offset:0
    v_mfma_f32_16x16x32_bf16 v[140:143], v[72:75], v[36:39], v[140:143]
    ds_read_b64_tr_b16 v[58:59], v10 offset:2048
    v_mfma_f32_16x16x32_bf16 v[144:147], v[72:75], v[40:43], v[144:147]
    ds_read_b64_tr_b16 v[60:61], v11 offset:0
    v_mfma_f32_16x16x32_bf16 v[148:151], v[72:75], v[44:47], v[148:151]
    ds_read_b64_tr_b16 v[62:63], v11 offset:2048
    v_mfma_f32_16x16x32_bf16 v[152:155], v[76:79], v[32:35], v[152:155]
    v_mfma_f32_16x16x32_bf16 v[156:159], v[76:79], v[36:39], v[156:159]
    v_mfma_f32_16x16x32_bf16 v[160:163], v[76:79], v[40:43], v[160:163]
    v_mfma_f32_16x16x32_bf16 v[164:167], v[76:79], v[44:47], v[164:167]
    s_waitcnt lgkmcnt(0)
    v_mfma_f32_16x16x32_bf16 v[104:107], v[48:51], v[16:19], v[104:107]
    ds_read_b64_tr_b16 v[64:65], v8 offset:4096
    v_mfma_f32_16x16x32_bf16 v[108:111], v[48:51], v[20:23], v[108:111]
    ds_read_b64_tr_b16 v[66:67], v8 offset:6144
    v_mfma_f32_16x16x32_bf16 v[112:115], v[48:51], v[24:27], v[112:115]
    ds_read_b128 v[32:35], v6 offset:0
    v_mfma_f32_16x16x32_bf16 v[116:119], v[48:51], v[28:31], v[116:119]
    ds_read_b128 v[36:39], v6 offset:2048
    v_mfma_f32_16x16x32_bf16 v[120:123], v[52:55], v[16:19], v[120:123]
    ds_read_b128 v[40:43], v6 offset:4096
    v_mfma_f32_16x16x32_bf16 v[124:127], v[52:55], v[20:23], v[124:127]
    ds_read_b128 v[44:47], v6 offset:6144
    v_mfma_f32_16x16x32_bf16 v[128:131], v[52:55], v[24:27], v[128:131]
    ds_read_b64_tr_b16 v[68:69], v9 offset:4096
    v_mfma_f32_16x16x32_bf16 v[132:135], v[52:55], v[28:31], v[132:135]
    ds_read_b64_tr_b16 v[70:71], v9 offset:6144
    v_mfma_f32_16x16x32_bf16 v[136:139], v[56:59], v[16:19], v[136:139]
    ds_read_b64_tr_b16 v[72:73], v10 offset:4096
    v_mfma_f32_16x16x32_bf16 v[140:143], v[56:59], v[20:23], v[140:143]
    ds_read_b64_tr_b16 v[74:75], v10 offset:6144
    v_mfma_f32_16x16x32_bf16 v[144:147], v[56:59], v[24:27], v[144:147]
    ds_read_b64_tr_b16 v[76:77], v11 offset:4096
    v_mfma_f32_16x16x32_bf16 v[148:151], v[56:59], v[28:31], v[148:151]
    ds_read_b64_tr_b16 v[78:79], v11 offset:6144
    v_mfma_f32_16x16x32_bf16 v[152:155], v[60:63], v[16:19], v[152:155]
    v_mfma_f32_16x16x32_bf16 v[156:159], v[60:63], v[20:23], v[156:159]
    v_mfma_f32_16x16x32_bf16 v[160:163], v[60:63], v[24:27], v[160:163]
    v_mfma_f32_16x16x32_bf16 v[164:167], v[60:63], v[28:31], v[164:167]
    s_waitcnt  lgkmcnt(0)
    s_barrier
    v_add_u32 v12, 32768, v12
    v_add_u32 v6, 32768, v6
    v_add_u32 v8, 32768, v8
    v_add_u32 v9, 32768, v9
    v_add_u32 v10, 32768, v10
    v_add_u32 v11, 32768, v11
    v_mfma_f32_16x16x32_bf16 v[104:107], v[64:67], v[32:35], v[104:107]
    ds_read_b64_tr_b16 v[48:49], v8 offset:0
    v_mfma_f32_16x16x32_bf16 v[108:111], v[64:67], v[36:39], v[108:111]
    ds_read_b64_tr_b16 v[50:51], v8 offset:2048
    v_mfma_f32_16x16x32_bf16 v[112:115], v[64:67], v[40:43], v[112:115]
    ds_read_b128 v[16:19], v12 offset:0
    v_mfma_f32_16x16x32_bf16 v[116:119], v[64:67], v[44:47], v[116:119]
    ds_read_b128 v[20:23], v12 offset:2048
    v_mfma_f32_16x16x32_bf16 v[120:123], v[68:71], v[32:35], v[120:123]
    ds_read_b128 v[24:27], v12 offset:4096
    v_mfma_f32_16x16x32_bf16 v[124:127], v[68:71], v[36:39], v[124:127]
    ds_read_b128 v[28:31], v12 offset:6144
    v_mfma_f32_16x16x32_bf16 v[128:131], v[68:71], v[40:43], v[128:131]
    ds_read_b64_tr_b16 v[52:53], v9 offset:0
    v_mfma_f32_16x16x32_bf16 v[132:135], v[68:71], v[44:47], v[132:135]
    ds_read_b64_tr_b16 v[54:55], v9 offset:2048
    v_mfma_f32_16x16x32_bf16 v[136:139], v[72:75], v[32:35], v[136:139]
    ds_read_b64_tr_b16 v[56:57], v10 offset:0
    v_mfma_f32_16x16x32_bf16 v[140:143], v[72:75], v[36:39], v[140:143]
    ds_read_b64_tr_b16 v[58:59], v10 offset:2048
    v_mfma_f32_16x16x32_bf16 v[144:147], v[72:75], v[40:43], v[144:147]
    ds_read_b64_tr_b16 v[60:61], v11 offset:0
    v_mfma_f32_16x16x32_bf16 v[148:151], v[72:75], v[44:47], v[148:151]
    ds_read_b64_tr_b16 v[62:63], v11 offset:2048
    v_mfma_f32_16x16x32_bf16 v[152:155], v[76:79], v[32:35], v[152:155]
    v_mfma_f32_16x16x32_bf16 v[156:159], v[76:79], v[36:39], v[156:159]
    v_mfma_f32_16x16x32_bf16 v[160:163], v[76:79], v[40:43], v[160:163]
    v_mfma_f32_16x16x32_bf16 v[164:167], v[76:79], v[44:47], v[164:167]
    s_waitcnt lgkmcnt(0)
    v_mfma_f32_16x16x32_bf16 v[104:107], v[48:51], v[16:19], v[104:107]
    ds_read_b64_tr_b16 v[64:65], v8 offset:4096
    v_mfma_f32_16x16x32_bf16 v[108:111], v[48:51], v[20:23], v[108:111]
    ds_read_b64_tr_b16 v[66:67], v8 offset:6144
    v_mfma_f32_16x16x32_bf16 v[112:115], v[48:51], v[24:27], v[112:115]
    ds_read_b128 v[32:35], v6 offset:0
    v_mfma_f32_16x16x32_bf16 v[116:119], v[48:51], v[28:31], v[116:119]
    ds_read_b128 v[36:39], v6 offset:2048
    v_mfma_f32_16x16x32_bf16 v[120:123], v[52:55], v[16:19], v[120:123]
    ds_read_b128 v[40:43], v6 offset:4096
    v_mfma_f32_16x16x32_bf16 v[124:127], v[52:55], v[20:23], v[124:127]
    ds_read_b128 v[44:47], v6 offset:6144
    v_mfma_f32_16x16x32_bf16 v[128:131], v[52:55], v[24:27], v[128:131]
    ds_read_b64_tr_b16 v[68:69], v9 offset:4096
    v_mfma_f32_16x16x32_bf16 v[132:135], v[52:55], v[28:31], v[132:135]
    ds_read_b64_tr_b16 v[70:71], v9 offset:6144
    v_mfma_f32_16x16x32_bf16 v[136:139], v[56:59], v[16:19], v[136:139]
    ds_read_b64_tr_b16 v[72:73], v10 offset:4096
    v_mfma_f32_16x16x32_bf16 v[140:143], v[56:59], v[20:23], v[140:143]
    ds_read_b64_tr_b16 v[74:75], v10 offset:6144
    v_mfma_f32_16x16x32_bf16 v[144:147], v[56:59], v[24:27], v[144:147]
    ds_read_b64_tr_b16 v[76:77], v11 offset:4096
    v_mfma_f32_16x16x32_bf16 v[148:151], v[56:59], v[28:31], v[148:151]
    ds_read_b64_tr_b16 v[78:79], v11 offset:6144
    v_mfma_f32_16x16x32_bf16 v[152:155], v[60:63], v[16:19], v[152:155]
    v_mfma_f32_16x16x32_bf16 v[156:159], v[60:63], v[20:23], v[156:159]
    v_mfma_f32_16x16x32_bf16 v[160:163], v[60:63], v[24:27], v[160:163]
    v_mfma_f32_16x16x32_bf16 v[164:167], v[60:63], v[28:31], v[164:167]
    s_waitcnt  lgkmcnt(0)
    s_barrier
    v_add_u32 v12, 4294868992, v12
    v_add_u32 v6, 4294868992, v6
    v_add_u32 v8, 4294868992, v8
    v_add_u32 v9, 4294868992, v9
    v_add_u32 v10, 4294868992, v10
    v_add_u32 v11, 4294868992, v11
    v_mfma_f32_16x16x32_bf16 v[104:107], v[64:67], v[32:35], v[104:107]
    ds_read_b64_tr_b16 v[48:49], v8 offset:0
    v_mfma_f32_16x16x32_bf16 v[108:111], v[64:67], v[36:39], v[108:111]
    ds_read_b64_tr_b16 v[50:51], v8 offset:2048
    v_mfma_f32_16x16x32_bf16 v[112:115], v[64:67], v[40:43], v[112:115]
    ds_read_b128 v[16:19], v12 offset:0
    v_mfma_f32_16x16x32_bf16 v[116:119], v[64:67], v[44:47], v[116:119]
    ds_read_b128 v[20:23], v12 offset:2048
    v_mfma_f32_16x16x32_bf16 v[120:123], v[68:71], v[32:35], v[120:123]
    ds_read_b128 v[24:27], v12 offset:4096
    v_mfma_f32_16x16x32_bf16 v[124:127], v[68:71], v[36:39], v[124:127]
    ds_read_b128 v[28:31], v12 offset:6144
    v_mfma_f32_16x16x32_bf16 v[128:131], v[68:71], v[40:43], v[128:131]
    ds_read_b64_tr_b16 v[52:53], v9 offset:0
    v_mfma_f32_16x16x32_bf16 v[132:135], v[68:71], v[44:47], v[132:135]
    ds_read_b64_tr_b16 v[54:55], v9 offset:2048
    v_mfma_f32_16x16x32_bf16 v[136:139], v[72:75], v[32:35], v[136:139]
    ds_read_b64_tr_b16 v[56:57], v10 offset:0
    v_mfma_f32_16x16x32_bf16 v[140:143], v[72:75], v[36:39], v[140:143]
    ds_read_b64_tr_b16 v[58:59], v10 offset:2048
    v_mfma_f32_16x16x32_bf16 v[144:147], v[72:75], v[40:43], v[144:147]
    ds_read_b64_tr_b16 v[60:61], v11 offset:0
    v_mfma_f32_16x16x32_bf16 v[148:151], v[72:75], v[44:47], v[148:151]
    ds_read_b64_tr_b16 v[62:63], v11 offset:2048
    v_mfma_f32_16x16x32_bf16 v[152:155], v[76:79], v[32:35], v[152:155]
    v_mfma_f32_16x16x32_bf16 v[156:159], v[76:79], v[36:39], v[156:159]
    v_mfma_f32_16x16x32_bf16 v[160:163], v[76:79], v[40:43], v[160:163]
    v_mfma_f32_16x16x32_bf16 v[164:167], v[76:79], v[44:47], v[164:167]
    s_waitcnt lgkmcnt(0)
    v_mfma_f32_16x16x32_bf16 v[104:107], v[48:51], v[16:19], v[104:107]
    ds_read_b64_tr_b16 v[64:65], v8 offset:4096
    v_mfma_f32_16x16x32_bf16 v[108:111], v[48:51], v[20:23], v[108:111]
    ds_read_b64_tr_b16 v[66:67], v8 offset:6144
    v_mfma_f32_16x16x32_bf16 v[112:115], v[48:51], v[24:27], v[112:115]
    ds_read_b128 v[32:35], v6 offset:0
    v_mfma_f32_16x16x32_bf16 v[116:119], v[48:51], v[28:31], v[116:119]
    ds_read_b128 v[36:39], v6 offset:2048
    v_mfma_f32_16x16x32_bf16 v[120:123], v[52:55], v[16:19], v[120:123]
    ds_read_b128 v[40:43], v6 offset:4096
    v_mfma_f32_16x16x32_bf16 v[124:127], v[52:55], v[20:23], v[124:127]
    ds_read_b128 v[44:47], v6 offset:6144
    v_mfma_f32_16x16x32_bf16 v[128:131], v[52:55], v[24:27], v[128:131]
    ds_read_b64_tr_b16 v[68:69], v9 offset:4096
    v_mfma_f32_16x16x32_bf16 v[132:135], v[52:55], v[28:31], v[132:135]
    ds_read_b64_tr_b16 v[70:71], v9 offset:6144
    v_mfma_f32_16x16x32_bf16 v[136:139], v[56:59], v[16:19], v[136:139]
    ds_read_b64_tr_b16 v[72:73], v10 offset:4096
    v_mfma_f32_16x16x32_bf16 v[140:143], v[56:59], v[20:23], v[140:143]
    ds_read_b64_tr_b16 v[74:75], v10 offset:6144
    v_mfma_f32_16x16x32_bf16 v[144:147], v[56:59], v[24:27], v[144:147]
    ds_read_b64_tr_b16 v[76:77], v11 offset:4096
    v_mfma_f32_16x16x32_bf16 v[148:151], v[56:59], v[28:31], v[148:151]
    ds_read_b64_tr_b16 v[78:79], v11 offset:6144
    v_mfma_f32_16x16x32_bf16 v[152:155], v[60:63], v[16:19], v[152:155]
    v_mfma_f32_16x16x32_bf16 v[156:159], v[60:63], v[20:23], v[156:159]
    v_mfma_f32_16x16x32_bf16 v[160:163], v[60:63], v[24:27], v[160:163]
    v_mfma_f32_16x16x32_bf16 v[164:167], v[60:63], v[28:31], v[164:167]
    s_waitcnt  lgkmcnt(0)
    s_barrier
    v_add_u32 v12, 32768, v12
    v_add_u32 v6, 32768, v6
    v_add_u32 v8, 32768, v8
    v_add_u32 v9, 32768, v9
    v_add_u32 v10, 32768, v10
    v_add_u32 v11, 32768, v11
    v_mfma_f32_16x16x32_bf16 v[104:107], v[64:67], v[32:35], v[104:107]
    ds_read_b64_tr_b16 v[48:49], v8 offset:0
    v_mfma_f32_16x16x32_bf16 v[108:111], v[64:67], v[36:39], v[108:111]
    ds_read_b64_tr_b16 v[50:51], v8 offset:2048
    v_mfma_f32_16x16x32_bf16 v[112:115], v[64:67], v[40:43], v[112:115]
    ds_read_b128 v[16:19], v12 offset:0
    v_mfma_f32_16x16x32_bf16 v[116:119], v[64:67], v[44:47], v[116:119]
    ds_read_b128 v[20:23], v12 offset:2048
    v_mfma_f32_16x16x32_bf16 v[120:123], v[68:71], v[32:35], v[120:123]
    ds_read_b128 v[24:27], v12 offset:4096
    v_mfma_f32_16x16x32_bf16 v[124:127], v[68:71], v[36:39], v[124:127]
    ds_read_b128 v[28:31], v12 offset:6144
    v_mfma_f32_16x16x32_bf16 v[128:131], v[68:71], v[40:43], v[128:131]
    ds_read_b64_tr_b16 v[52:53], v9 offset:0
    v_mfma_f32_16x16x32_bf16 v[132:135], v[68:71], v[44:47], v[132:135]
    ds_read_b64_tr_b16 v[54:55], v9 offset:2048
    v_mfma_f32_16x16x32_bf16 v[136:139], v[72:75], v[32:35], v[136:139]
    ds_read_b64_tr_b16 v[56:57], v10 offset:0
    v_mfma_f32_16x16x32_bf16 v[140:143], v[72:75], v[36:39], v[140:143]
    ds_read_b64_tr_b16 v[58:59], v10 offset:2048
    v_mfma_f32_16x16x32_bf16 v[144:147], v[72:75], v[40:43], v[144:147]
    ds_read_b64_tr_b16 v[60:61], v11 offset:0
    v_mfma_f32_16x16x32_bf16 v[148:151], v[72:75], v[44:47], v[148:151]
    ds_read_b64_tr_b16 v[62:63], v11 offset:2048
    v_mfma_f32_16x16x32_bf16 v[152:155], v[76:79], v[32:35], v[152:155]
    v_mfma_f32_16x16x32_bf16 v[156:159], v[76:79], v[36:39], v[156:159]
    v_mfma_f32_16x16x32_bf16 v[160:163], v[76:79], v[40:43], v[160:163]
    v_mfma_f32_16x16x32_bf16 v[164:167], v[76:79], v[44:47], v[164:167]
    s_waitcnt lgkmcnt(0)
    v_mfma_f32_16x16x32_bf16 v[104:107], v[48:51], v[16:19], v[104:107]
    ds_read_b64_tr_b16 v[64:65], v8 offset:4096
    v_mfma_f32_16x16x32_bf16 v[108:111], v[48:51], v[20:23], v[108:111]
    ds_read_b64_tr_b16 v[66:67], v8 offset:6144
    v_mfma_f32_16x16x32_bf16 v[112:115], v[48:51], v[24:27], v[112:115]
    ds_read_b128 v[32:35], v6 offset:0
    v_mfma_f32_16x16x32_bf16 v[116:119], v[48:51], v[28:31], v[116:119]
    ds_read_b128 v[36:39], v6 offset:2048
    v_mfma_f32_16x16x32_bf16 v[120:123], v[52:55], v[16:19], v[120:123]
    ds_read_b128 v[40:43], v6 offset:4096
    v_mfma_f32_16x16x32_bf16 v[124:127], v[52:55], v[20:23], v[124:127]
    ds_read_b128 v[44:47], v6 offset:6144
    v_mfma_f32_16x16x32_bf16 v[128:131], v[52:55], v[24:27], v[128:131]
    ds_read_b64_tr_b16 v[68:69], v9 offset:4096
    v_mfma_f32_16x16x32_bf16 v[132:135], v[52:55], v[28:31], v[132:135]
    ds_read_b64_tr_b16 v[70:71], v9 offset:6144
    v_mfma_f32_16x16x32_bf16 v[136:139], v[56:59], v[16:19], v[136:139]
    ds_read_b64_tr_b16 v[72:73], v10 offset:4096
    v_mfma_f32_16x16x32_bf16 v[140:143], v[56:59], v[20:23], v[140:143]
    ds_read_b64_tr_b16 v[74:75], v10 offset:6144
    v_mfma_f32_16x16x32_bf16 v[144:147], v[56:59], v[24:27], v[144:147]
    ds_read_b64_tr_b16 v[76:77], v11 offset:4096
    v_mfma_f32_16x16x32_bf16 v[148:151], v[56:59], v[28:31], v[148:151]
    ds_read_b64_tr_b16 v[78:79], v11 offset:6144
    v_mfma_f32_16x16x32_bf16 v[152:155], v[60:63], v[16:19], v[152:155]
    v_mfma_f32_16x16x32_bf16 v[156:159], v[60:63], v[20:23], v[156:159]
    v_mfma_f32_16x16x32_bf16 v[160:163], v[60:63], v[24:27], v[160:163]
    v_mfma_f32_16x16x32_bf16 v[164:167], v[60:63], v[28:31], v[164:167]
    s_waitcnt  lgkmcnt(0)
    s_barrier
    v_add_u32 v12, 32768, v12
    v_add_u32 v6, 32768, v6
    v_add_u32 v8, 32768, v8
    v_add_u32 v9, 32768, v9
    v_add_u32 v10, 32768, v10
    v_add_u32 v11, 32768, v11
    v_mfma_f32_16x16x32_bf16 v[104:107], v[64:67], v[32:35], v[104:107]
    ds_read_b64_tr_b16 v[48:49], v8 offset:0
    v_mfma_f32_16x16x32_bf16 v[108:111], v[64:67], v[36:39], v[108:111]
    ds_read_b64_tr_b16 v[50:51], v8 offset:2048
    v_mfma_f32_16x16x32_bf16 v[112:115], v[64:67], v[40:43], v[112:115]
    ds_read_b128 v[16:19], v12 offset:0
    v_mfma_f32_16x16x32_bf16 v[116:119], v[64:67], v[44:47], v[116:119]
    ds_read_b128 v[20:23], v12 offset:2048
    v_mfma_f32_16x16x32_bf16 v[120:123], v[68:71], v[32:35], v[120:123]
    ds_read_b128 v[24:27], v12 offset:4096
    v_mfma_f32_16x16x32_bf16 v[124:127], v[68:71], v[36:39], v[124:127]
    ds_read_b128 v[28:31], v12 offset:6144
    v_mfma_f32_16x16x32_bf16 v[128:131], v[68:71], v[40:43], v[128:131]
    ds_read_b64_tr_b16 v[52:53], v9 offset:0
    v_mfma_f32_16x16x32_bf16 v[132:135], v[68:71], v[44:47], v[132:135]
    ds_read_b64_tr_b16 v[54:55], v9 offset:2048
    v_mfma_f32_16x16x32_bf16 v[136:139], v[72:75], v[32:35], v[136:139]
    ds_read_b64_tr_b16 v[56:57], v10 offset:0
    v_mfma_f32_16x16x32_bf16 v[140:143], v[72:75], v[36:39], v[140:143]
    ds_read_b64_tr_b16 v[58:59], v10 offset:2048
    v_mfma_f32_16x16x32_bf16 v[144:147], v[72:75], v[40:43], v[144:147]
    ds_read_b64_tr_b16 v[60:61], v11 offset:0
    v_mfma_f32_16x16x32_bf16 v[148:151], v[72:75], v[44:47], v[148:151]
    ds_read_b64_tr_b16 v[62:63], v11 offset:2048
    v_mfma_f32_16x16x32_bf16 v[152:155], v[76:79], v[32:35], v[152:155]
    v_mfma_f32_16x16x32_bf16 v[156:159], v[76:79], v[36:39], v[156:159]
    v_mfma_f32_16x16x32_bf16 v[160:163], v[76:79], v[40:43], v[160:163]
    v_mfma_f32_16x16x32_bf16 v[164:167], v[76:79], v[44:47], v[164:167]
    s_waitcnt lgkmcnt(0)
    v_mfma_f32_16x16x32_bf16 v[104:107], v[48:51], v[16:19], v[104:107]
    ds_read_b64_tr_b16 v[64:65], v8 offset:4096
    v_mfma_f32_16x16x32_bf16 v[108:111], v[48:51], v[20:23], v[108:111]
    ds_read_b64_tr_b16 v[66:67], v8 offset:6144
    v_mfma_f32_16x16x32_bf16 v[112:115], v[48:51], v[24:27], v[112:115]
    ds_read_b128 v[32:35], v6 offset:0
    v_mfma_f32_16x16x32_bf16 v[116:119], v[48:51], v[28:31], v[116:119]
    ds_read_b128 v[36:39], v6 offset:2048
    v_mfma_f32_16x16x32_bf16 v[120:123], v[52:55], v[16:19], v[120:123]
    ds_read_b128 v[40:43], v6 offset:4096
    v_mfma_f32_16x16x32_bf16 v[124:127], v[52:55], v[20:23], v[124:127]
    ds_read_b128 v[44:47], v6 offset:6144
    v_mfma_f32_16x16x32_bf16 v[128:131], v[52:55], v[24:27], v[128:131]
    ds_read_b64_tr_b16 v[68:69], v9 offset:4096
    v_mfma_f32_16x16x32_bf16 v[132:135], v[52:55], v[28:31], v[132:135]
    ds_read_b64_tr_b16 v[70:71], v9 offset:6144
    v_mfma_f32_16x16x32_bf16 v[136:139], v[56:59], v[16:19], v[136:139]
    ds_read_b64_tr_b16 v[72:73], v10 offset:4096
    v_mfma_f32_16x16x32_bf16 v[140:143], v[56:59], v[20:23], v[140:143]
    ds_read_b64_tr_b16 v[74:75], v10 offset:6144
    v_mfma_f32_16x16x32_bf16 v[144:147], v[56:59], v[24:27], v[144:147]
    ds_read_b64_tr_b16 v[76:77], v11 offset:4096
    v_mfma_f32_16x16x32_bf16 v[148:151], v[56:59], v[28:31], v[148:151]
    ds_read_b64_tr_b16 v[78:79], v11 offset:6144
    v_mfma_f32_16x16x32_bf16 v[152:155], v[60:63], v[16:19], v[152:155]
    v_mfma_f32_16x16x32_bf16 v[156:159], v[60:63], v[20:23], v[156:159]
    v_mfma_f32_16x16x32_bf16 v[160:163], v[60:63], v[24:27], v[160:163]
    v_mfma_f32_16x16x32_bf16 v[164:167], v[60:63], v[28:31], v[164:167]
    s_waitcnt  lgkmcnt(0)
    s_barrier
    v_add_u32 v12, 32768, v12
    v_add_u32 v6, 32768, v6
    v_add_u32 v8, 32768, v8
    v_add_u32 v9, 32768, v9
    v_add_u32 v10, 32768, v10
    v_add_u32 v11, 32768, v11
    v_mfma_f32_16x16x32_bf16 v[104:107], v[64:67], v[32:35], v[104:107]
    ds_read_b64_tr_b16 v[48:49], v8 offset:0
    v_mfma_f32_16x16x32_bf16 v[108:111], v[64:67], v[36:39], v[108:111]
    ds_read_b64_tr_b16 v[50:51], v8 offset:2048
    v_mfma_f32_16x16x32_bf16 v[112:115], v[64:67], v[40:43], v[112:115]
    ds_read_b128 v[16:19], v12 offset:0
    v_mfma_f32_16x16x32_bf16 v[116:119], v[64:67], v[44:47], v[116:119]
    ds_read_b128 v[20:23], v12 offset:2048
    v_mfma_f32_16x16x32_bf16 v[120:123], v[68:71], v[32:35], v[120:123]
    ds_read_b128 v[24:27], v12 offset:4096
    v_mfma_f32_16x16x32_bf16 v[124:127], v[68:71], v[36:39], v[124:127]
    ds_read_b128 v[28:31], v12 offset:6144
    v_mfma_f32_16x16x32_bf16 v[128:131], v[68:71], v[40:43], v[128:131]
    ds_read_b64_tr_b16 v[52:53], v9 offset:0
    v_mfma_f32_16x16x32_bf16 v[132:135], v[68:71], v[44:47], v[132:135]
    ds_read_b64_tr_b16 v[54:55], v9 offset:2048
    v_mfma_f32_16x16x32_bf16 v[136:139], v[72:75], v[32:35], v[136:139]
    ds_read_b64_tr_b16 v[56:57], v10 offset:0
    v_mfma_f32_16x16x32_bf16 v[140:143], v[72:75], v[36:39], v[140:143]
    ds_read_b64_tr_b16 v[58:59], v10 offset:2048
    v_mfma_f32_16x16x32_bf16 v[144:147], v[72:75], v[40:43], v[144:147]
    ds_read_b64_tr_b16 v[60:61], v11 offset:0
    v_mfma_f32_16x16x32_bf16 v[148:151], v[72:75], v[44:47], v[148:151]
    ds_read_b64_tr_b16 v[62:63], v11 offset:2048
    v_mfma_f32_16x16x32_bf16 v[152:155], v[76:79], v[32:35], v[152:155]
    v_mfma_f32_16x16x32_bf16 v[156:159], v[76:79], v[36:39], v[156:159]
    v_mfma_f32_16x16x32_bf16 v[160:163], v[76:79], v[40:43], v[160:163]
    v_mfma_f32_16x16x32_bf16 v[164:167], v[76:79], v[44:47], v[164:167]
    s_waitcnt lgkmcnt(0)
    v_mfma_f32_16x16x32_bf16 v[104:107], v[48:51], v[16:19], v[104:107]
    ds_read_b64_tr_b16 v[64:65], v8 offset:4096
    v_mfma_f32_16x16x32_bf16 v[108:111], v[48:51], v[20:23], v[108:111]
    ds_read_b64_tr_b16 v[66:67], v8 offset:6144
    v_mfma_f32_16x16x32_bf16 v[112:115], v[48:51], v[24:27], v[112:115]
    ds_read_b128 v[32:35], v6 offset:0
    v_mfma_f32_16x16x32_bf16 v[116:119], v[48:51], v[28:31], v[116:119]
    ds_read_b128 v[36:39], v6 offset:2048
    v_mfma_f32_16x16x32_bf16 v[120:123], v[52:55], v[16:19], v[120:123]
    ds_read_b128 v[40:43], v6 offset:4096
    v_mfma_f32_16x16x32_bf16 v[124:127], v[52:55], v[20:23], v[124:127]
    ds_read_b128 v[44:47], v6 offset:6144
    v_mfma_f32_16x16x32_bf16 v[128:131], v[52:55], v[24:27], v[128:131]
    ds_read_b64_tr_b16 v[68:69], v9 offset:4096
    v_mfma_f32_16x16x32_bf16 v[132:135], v[52:55], v[28:31], v[132:135]
    ds_read_b64_tr_b16 v[70:71], v9 offset:6144
    v_mfma_f32_16x16x32_bf16 v[136:139], v[56:59], v[16:19], v[136:139]
    ds_read_b64_tr_b16 v[72:73], v10 offset:4096
    v_mfma_f32_16x16x32_bf16 v[140:143], v[56:59], v[20:23], v[140:143]
    ds_read_b64_tr_b16 v[74:75], v10 offset:6144
    v_mfma_f32_16x16x32_bf16 v[144:147], v[56:59], v[24:27], v[144:147]
    ds_read_b64_tr_b16 v[76:77], v11 offset:4096
    v_mfma_f32_16x16x32_bf16 v[148:151], v[56:59], v[28:31], v[148:151]
    ds_read_b64_tr_b16 v[78:79], v11 offset:6144
    v_mfma_f32_16x16x32_bf16 v[152:155], v[60:63], v[16:19], v[152:155]
    v_mfma_f32_16x16x32_bf16 v[156:159], v[60:63], v[20:23], v[156:159]
    v_mfma_f32_16x16x32_bf16 v[160:163], v[60:63], v[24:27], v[160:163]
    v_mfma_f32_16x16x32_bf16 v[164:167], v[60:63], v[28:31], v[164:167]
    s_waitcnt  lgkmcnt(0)
    s_barrier
    v_add_u32 v12, 4294868992, v12
    v_add_u32 v6, 4294868992, v6
    v_add_u32 v8, 4294868992, v8
    v_add_u32 v9, 4294868992, v9
    v_add_u32 v10, 4294868992, v10
    v_add_u32 v11, 4294868992, v11
    v_mfma_f32_16x16x32_bf16 v[104:107], v[64:67], v[32:35], v[104:107]
    ds_read_b64_tr_b16 v[48:49], v8 offset:0
    v_mfma_f32_16x16x32_bf16 v[108:111], v[64:67], v[36:39], v[108:111]
    ds_read_b64_tr_b16 v[50:51], v8 offset:2048
    v_mfma_f32_16x16x32_bf16 v[112:115], v[64:67], v[40:43], v[112:115]
    ds_read_b128 v[16:19], v12 offset:0
    v_mfma_f32_16x16x32_bf16 v[116:119], v[64:67], v[44:47], v[116:119]
    ds_read_b128 v[20:23], v12 offset:2048
    v_mfma_f32_16x16x32_bf16 v[120:123], v[68:71], v[32:35], v[120:123]
    ds_read_b128 v[24:27], v12 offset:4096
    v_mfma_f32_16x16x32_bf16 v[124:127], v[68:71], v[36:39], v[124:127]
    ds_read_b128 v[28:31], v12 offset:6144
    v_mfma_f32_16x16x32_bf16 v[128:131], v[68:71], v[40:43], v[128:131]
    ds_read_b64_tr_b16 v[52:53], v9 offset:0
    v_mfma_f32_16x16x32_bf16 v[132:135], v[68:71], v[44:47], v[132:135]
    ds_read_b64_tr_b16 v[54:55], v9 offset:2048
    v_mfma_f32_16x16x32_bf16 v[136:139], v[72:75], v[32:35], v[136:139]
    ds_read_b64_tr_b16 v[56:57], v10 offset:0
    v_mfma_f32_16x16x32_bf16 v[140:143], v[72:75], v[36:39], v[140:143]
    ds_read_b64_tr_b16 v[58:59], v10 offset:2048
    v_mfma_f32_16x16x32_bf16 v[144:147], v[72:75], v[40:43], v[144:147]
    ds_read_b64_tr_b16 v[60:61], v11 offset:0
    v_mfma_f32_16x16x32_bf16 v[148:151], v[72:75], v[44:47], v[148:151]
    ds_read_b64_tr_b16 v[62:63], v11 offset:2048
    v_mfma_f32_16x16x32_bf16 v[152:155], v[76:79], v[32:35], v[152:155]
    v_mfma_f32_16x16x32_bf16 v[156:159], v[76:79], v[36:39], v[156:159]
    v_mfma_f32_16x16x32_bf16 v[160:163], v[76:79], v[40:43], v[160:163]
    v_mfma_f32_16x16x32_bf16 v[164:167], v[76:79], v[44:47], v[164:167]
    s_waitcnt lgkmcnt(0)
    v_mfma_f32_16x16x32_bf16 v[104:107], v[48:51], v[16:19], v[104:107]
    ds_read_b64_tr_b16 v[64:65], v8 offset:4096
    v_mfma_f32_16x16x32_bf16 v[108:111], v[48:51], v[20:23], v[108:111]
    ds_read_b64_tr_b16 v[66:67], v8 offset:6144
    v_mfma_f32_16x16x32_bf16 v[112:115], v[48:51], v[24:27], v[112:115]
    ds_read_b128 v[32:35], v6 offset:0
    v_mfma_f32_16x16x32_bf16 v[116:119], v[48:51], v[28:31], v[116:119]
    ds_read_b128 v[36:39], v6 offset:2048
    v_mfma_f32_16x16x32_bf16 v[120:123], v[52:55], v[16:19], v[120:123]
    ds_read_b128 v[40:43], v6 offset:4096
    v_mfma_f32_16x16x32_bf16 v[124:127], v[52:55], v[20:23], v[124:127]
    ds_read_b128 v[44:47], v6 offset:6144
    v_mfma_f32_16x16x32_bf16 v[128:131], v[52:55], v[24:27], v[128:131]
    ds_read_b64_tr_b16 v[68:69], v9 offset:4096
    v_mfma_f32_16x16x32_bf16 v[132:135], v[52:55], v[28:31], v[132:135]
    ds_read_b64_tr_b16 v[70:71], v9 offset:6144
    v_mfma_f32_16x16x32_bf16 v[136:139], v[56:59], v[16:19], v[136:139]
    ds_read_b64_tr_b16 v[72:73], v10 offset:4096
    v_mfma_f32_16x16x32_bf16 v[140:143], v[56:59], v[20:23], v[140:143]
    ds_read_b64_tr_b16 v[74:75], v10 offset:6144
    v_mfma_f32_16x16x32_bf16 v[144:147], v[56:59], v[24:27], v[144:147]
    ds_read_b64_tr_b16 v[76:77], v11 offset:4096
    v_mfma_f32_16x16x32_bf16 v[148:151], v[56:59], v[28:31], v[148:151]
    ds_read_b64_tr_b16 v[78:79], v11 offset:6144
    v_mfma_f32_16x16x32_bf16 v[152:155], v[60:63], v[16:19], v[152:155]
    v_mfma_f32_16x16x32_bf16 v[156:159], v[60:63], v[20:23], v[156:159]
    v_mfma_f32_16x16x32_bf16 v[160:163], v[60:63], v[24:27], v[160:163]
    v_mfma_f32_16x16x32_bf16 v[164:167], v[60:63], v[28:31], v[164:167]
    s_waitcnt  lgkmcnt(0)
    s_barrier
    v_add_u32 v12, 32768, v12
    v_add_u32 v6, 32768, v6
    v_add_u32 v8, 32768, v8
    v_add_u32 v9, 32768, v9
    v_add_u32 v10, 32768, v10
    v_add_u32 v11, 32768, v11
    v_mfma_f32_16x16x32_bf16 v[104:107], v[64:67], v[32:35], v[104:107]
    ds_read_b64_tr_b16 v[48:49], v8 offset:0
    v_mfma_f32_16x16x32_bf16 v[108:111], v[64:67], v[36:39], v[108:111]
    ds_read_b64_tr_b16 v[50:51], v8 offset:2048
    v_mfma_f32_16x16x32_bf16 v[112:115], v[64:67], v[40:43], v[112:115]
    ds_read_b128 v[16:19], v12 offset:0
    v_mfma_f32_16x16x32_bf16 v[116:119], v[64:67], v[44:47], v[116:119]
    ds_read_b128 v[20:23], v12 offset:2048
    v_mfma_f32_16x16x32_bf16 v[120:123], v[68:71], v[32:35], v[120:123]
    ds_read_b128 v[24:27], v12 offset:4096
    v_mfma_f32_16x16x32_bf16 v[124:127], v[68:71], v[36:39], v[124:127]
    ds_read_b128 v[28:31], v12 offset:6144
    v_mfma_f32_16x16x32_bf16 v[128:131], v[68:71], v[40:43], v[128:131]
    ds_read_b64_tr_b16 v[52:53], v9 offset:0
    v_mfma_f32_16x16x32_bf16 v[132:135], v[68:71], v[44:47], v[132:135]
    ds_read_b64_tr_b16 v[54:55], v9 offset:2048
    v_mfma_f32_16x16x32_bf16 v[136:139], v[72:75], v[32:35], v[136:139]
    ds_read_b64_tr_b16 v[56:57], v10 offset:0
    v_mfma_f32_16x16x32_bf16 v[140:143], v[72:75], v[36:39], v[140:143]
    ds_read_b64_tr_b16 v[58:59], v10 offset:2048
    v_mfma_f32_16x16x32_bf16 v[144:147], v[72:75], v[40:43], v[144:147]
    ds_read_b64_tr_b16 v[60:61], v11 offset:0
    v_mfma_f32_16x16x32_bf16 v[148:151], v[72:75], v[44:47], v[148:151]
    ds_read_b64_tr_b16 v[62:63], v11 offset:2048
    v_mfma_f32_16x16x32_bf16 v[152:155], v[76:79], v[32:35], v[152:155]
    v_mfma_f32_16x16x32_bf16 v[156:159], v[76:79], v[36:39], v[156:159]
    v_mfma_f32_16x16x32_bf16 v[160:163], v[76:79], v[40:43], v[160:163]
    v_mfma_f32_16x16x32_bf16 v[164:167], v[76:79], v[44:47], v[164:167]
    s_waitcnt lgkmcnt(0)
    v_mfma_f32_16x16x32_bf16 v[104:107], v[48:51], v[16:19], v[104:107]
    ds_read_b64_tr_b16 v[64:65], v8 offset:4096
    v_mfma_f32_16x16x32_bf16 v[108:111], v[48:51], v[20:23], v[108:111]
    ds_read_b64_tr_b16 v[66:67], v8 offset:6144
    v_mfma_f32_16x16x32_bf16 v[112:115], v[48:51], v[24:27], v[112:115]
    ds_read_b128 v[32:35], v6 offset:0
    v_mfma_f32_16x16x32_bf16 v[116:119], v[48:51], v[28:31], v[116:119]
    ds_read_b128 v[36:39], v6 offset:2048
    v_mfma_f32_16x16x32_bf16 v[120:123], v[52:55], v[16:19], v[120:123]
    ds_read_b128 v[40:43], v6 offset:4096
    v_mfma_f32_16x16x32_bf16 v[124:127], v[52:55], v[20:23], v[124:127]
    ds_read_b128 v[44:47], v6 offset:6144
    v_mfma_f32_16x16x32_bf16 v[128:131], v[52:55], v[24:27], v[128:131]
    ds_read_b64_tr_b16 v[68:69], v9 offset:4096
    v_mfma_f32_16x16x32_bf16 v[132:135], v[52:55], v[28:31], v[132:135]
    ds_read_b64_tr_b16 v[70:71], v9 offset:6144
    v_mfma_f32_16x16x32_bf16 v[136:139], v[56:59], v[16:19], v[136:139]
    ds_read_b64_tr_b16 v[72:73], v10 offset:4096
    v_mfma_f32_16x16x32_bf16 v[140:143], v[56:59], v[20:23], v[140:143]
    ds_read_b64_tr_b16 v[74:75], v10 offset:6144
    v_mfma_f32_16x16x32_bf16 v[144:147], v[56:59], v[24:27], v[144:147]
    ds_read_b64_tr_b16 v[76:77], v11 offset:4096
    v_mfma_f32_16x16x32_bf16 v[148:151], v[56:59], v[28:31], v[148:151]
    ds_read_b64_tr_b16 v[78:79], v11 offset:6144
    v_mfma_f32_16x16x32_bf16 v[152:155], v[60:63], v[16:19], v[152:155]
    v_mfma_f32_16x16x32_bf16 v[156:159], v[60:63], v[20:23], v[156:159]
    v_mfma_f32_16x16x32_bf16 v[160:163], v[60:63], v[24:27], v[160:163]
    v_mfma_f32_16x16x32_bf16 v[164:167], v[60:63], v[28:31], v[164:167]
    s_waitcnt  lgkmcnt(0)
    s_barrier
    v_add_u32 v12, 32768, v12
    v_add_u32 v6, 32768, v6
    v_add_u32 v8, 32768, v8
    v_add_u32 v9, 32768, v9
    v_add_u32 v10, 32768, v10
    v_add_u32 v11, 32768, v11
    v_mfma_f32_16x16x32_bf16 v[104:107], v[64:67], v[32:35], v[104:107]
    ds_read_b64_tr_b16 v[48:49], v8 offset:0
    v_mfma_f32_16x16x32_bf16 v[108:111], v[64:67], v[36:39], v[108:111]
    ds_read_b64_tr_b16 v[50:51], v8 offset:2048
    v_mfma_f32_16x16x32_bf16 v[112:115], v[64:67], v[40:43], v[112:115]
    ds_read_b128 v[16:19], v12 offset:0
    v_mfma_f32_16x16x32_bf16 v[116:119], v[64:67], v[44:47], v[116:119]
    ds_read_b128 v[20:23], v12 offset:2048
    v_mfma_f32_16x16x32_bf16 v[120:123], v[68:71], v[32:35], v[120:123]
    ds_read_b128 v[24:27], v12 offset:4096
    v_mfma_f32_16x16x32_bf16 v[124:127], v[68:71], v[36:39], v[124:127]
    ds_read_b128 v[28:31], v12 offset:6144
    v_mfma_f32_16x16x32_bf16 v[128:131], v[68:71], v[40:43], v[128:131]
    ds_read_b64_tr_b16 v[52:53], v9 offset:0
    v_mfma_f32_16x16x32_bf16 v[132:135], v[68:71], v[44:47], v[132:135]
    ds_read_b64_tr_b16 v[54:55], v9 offset:2048
    v_mfma_f32_16x16x32_bf16 v[136:139], v[72:75], v[32:35], v[136:139]
    ds_read_b64_tr_b16 v[56:57], v10 offset:0
    v_mfma_f32_16x16x32_bf16 v[140:143], v[72:75], v[36:39], v[140:143]
    ds_read_b64_tr_b16 v[58:59], v10 offset:2048
    v_mfma_f32_16x16x32_bf16 v[144:147], v[72:75], v[40:43], v[144:147]
    ds_read_b64_tr_b16 v[60:61], v11 offset:0
    v_mfma_f32_16x16x32_bf16 v[148:151], v[72:75], v[44:47], v[148:151]
    ds_read_b64_tr_b16 v[62:63], v11 offset:2048
    v_mfma_f32_16x16x32_bf16 v[152:155], v[76:79], v[32:35], v[152:155]
    v_mfma_f32_16x16x32_bf16 v[156:159], v[76:79], v[36:39], v[156:159]
    v_mfma_f32_16x16x32_bf16 v[160:163], v[76:79], v[40:43], v[160:163]
    v_mfma_f32_16x16x32_bf16 v[164:167], v[76:79], v[44:47], v[164:167]
    s_waitcnt lgkmcnt(0)
    v_mfma_f32_16x16x32_bf16 v[104:107], v[48:51], v[16:19], v[104:107]
    ds_read_b64_tr_b16 v[64:65], v8 offset:4096
    v_mfma_f32_16x16x32_bf16 v[108:111], v[48:51], v[20:23], v[108:111]
    ds_read_b64_tr_b16 v[66:67], v8 offset:6144
    v_mfma_f32_16x16x32_bf16 v[112:115], v[48:51], v[24:27], v[112:115]
    ds_read_b128 v[32:35], v6 offset:0
    v_mfma_f32_16x16x32_bf16 v[116:119], v[48:51], v[28:31], v[116:119]
    ds_read_b128 v[36:39], v6 offset:2048
    v_mfma_f32_16x16x32_bf16 v[120:123], v[52:55], v[16:19], v[120:123]
    ds_read_b128 v[40:43], v6 offset:4096
    v_mfma_f32_16x16x32_bf16 v[124:127], v[52:55], v[20:23], v[124:127]
    ds_read_b128 v[44:47], v6 offset:6144
    v_mfma_f32_16x16x32_bf16 v[128:131], v[52:55], v[24:27], v[128:131]
    ds_read_b64_tr_b16 v[68:69], v9 offset:4096
    v_mfma_f32_16x16x32_bf16 v[132:135], v[52:55], v[28:31], v[132:135]
    ds_read_b64_tr_b16 v[70:71], v9 offset:6144
    v_mfma_f32_16x16x32_bf16 v[136:139], v[56:59], v[16:19], v[136:139]
    ds_read_b64_tr_b16 v[72:73], v10 offset:4096
    v_mfma_f32_16x16x32_bf16 v[140:143], v[56:59], v[20:23], v[140:143]
    ds_read_b64_tr_b16 v[74:75], v10 offset:6144
    v_mfma_f32_16x16x32_bf16 v[144:147], v[56:59], v[24:27], v[144:147]
    ds_read_b64_tr_b16 v[76:77], v11 offset:4096
    v_mfma_f32_16x16x32_bf16 v[148:151], v[56:59], v[28:31], v[148:151]
    ds_read_b64_tr_b16 v[78:79], v11 offset:6144
    v_mfma_f32_16x16x32_bf16 v[152:155], v[60:63], v[16:19], v[152:155]
    v_mfma_f32_16x16x32_bf16 v[156:159], v[60:63], v[20:23], v[156:159]
    v_mfma_f32_16x16x32_bf16 v[160:163], v[60:63], v[24:27], v[160:163]
    v_mfma_f32_16x16x32_bf16 v[164:167], v[60:63], v[28:31], v[164:167]
    s_waitcnt  lgkmcnt(0)
    s_barrier
    v_add_u32 v12, 32768, v12
    v_add_u32 v6, 32768, v6
    v_add_u32 v8, 32768, v8
    v_add_u32 v9, 32768, v9
    v_add_u32 v10, 32768, v10
    v_add_u32 v11, 32768, v11
    v_mfma_f32_16x16x32_bf16 v[104:107], v[64:67], v[32:35], v[104:107]
    ds_read_b64_tr_b16 v[48:49], v8 offset:0
    v_mfma_f32_16x16x32_bf16 v[108:111], v[64:67], v[36:39], v[108:111]
    ds_read_b64_tr_b16 v[50:51], v8 offset:2048
    v_mfma_f32_16x16x32_bf16 v[112:115], v[64:67], v[40:43], v[112:115]
    ds_read_b128 v[16:19], v12 offset:0
    v_mfma_f32_16x16x32_bf16 v[116:119], v[64:67], v[44:47], v[116:119]
    ds_read_b128 v[20:23], v12 offset:2048
    v_mfma_f32_16x16x32_bf16 v[120:123], v[68:71], v[32:35], v[120:123]
    ds_read_b128 v[24:27], v12 offset:4096
    v_mfma_f32_16x16x32_bf16 v[124:127], v[68:71], v[36:39], v[124:127]
    ds_read_b128 v[28:31], v12 offset:6144
    v_mfma_f32_16x16x32_bf16 v[128:131], v[68:71], v[40:43], v[128:131]
    ds_read_b64_tr_b16 v[52:53], v9 offset:0
    v_mfma_f32_16x16x32_bf16 v[132:135], v[68:71], v[44:47], v[132:135]
    ds_read_b64_tr_b16 v[54:55], v9 offset:2048
    v_mfma_f32_16x16x32_bf16 v[136:139], v[72:75], v[32:35], v[136:139]
    ds_read_b64_tr_b16 v[56:57], v10 offset:0
    v_mfma_f32_16x16x32_bf16 v[140:143], v[72:75], v[36:39], v[140:143]
    ds_read_b64_tr_b16 v[58:59], v10 offset:2048
    v_mfma_f32_16x16x32_bf16 v[144:147], v[72:75], v[40:43], v[144:147]
    ds_read_b64_tr_b16 v[60:61], v11 offset:0
    v_mfma_f32_16x16x32_bf16 v[148:151], v[72:75], v[44:47], v[148:151]
    ds_read_b64_tr_b16 v[62:63], v11 offset:2048
    v_mfma_f32_16x16x32_bf16 v[152:155], v[76:79], v[32:35], v[152:155]
    v_mfma_f32_16x16x32_bf16 v[156:159], v[76:79], v[36:39], v[156:159]
    v_mfma_f32_16x16x32_bf16 v[160:163], v[76:79], v[40:43], v[160:163]
    v_mfma_f32_16x16x32_bf16 v[164:167], v[76:79], v[44:47], v[164:167]
    s_waitcnt lgkmcnt(0)
    v_mfma_f32_16x16x32_bf16 v[104:107], v[48:51], v[16:19], v[104:107]
    ds_read_b64_tr_b16 v[64:65], v8 offset:4096
    v_mfma_f32_16x16x32_bf16 v[108:111], v[48:51], v[20:23], v[108:111]
    ds_read_b64_tr_b16 v[66:67], v8 offset:6144
    v_mfma_f32_16x16x32_bf16 v[112:115], v[48:51], v[24:27], v[112:115]
    ds_read_b128 v[32:35], v6 offset:0
    v_mfma_f32_16x16x32_bf16 v[116:119], v[48:51], v[28:31], v[116:119]
    ds_read_b128 v[36:39], v6 offset:2048
    v_mfma_f32_16x16x32_bf16 v[120:123], v[52:55], v[16:19], v[120:123]
    ds_read_b128 v[40:43], v6 offset:4096
    v_mfma_f32_16x16x32_bf16 v[124:127], v[52:55], v[20:23], v[124:127]
    ds_read_b128 v[44:47], v6 offset:6144
    v_mfma_f32_16x16x32_bf16 v[128:131], v[52:55], v[24:27], v[128:131]
    ds_read_b64_tr_b16 v[68:69], v9 offset:4096
    v_mfma_f32_16x16x32_bf16 v[132:135], v[52:55], v[28:31], v[132:135]
    ds_read_b64_tr_b16 v[70:71], v9 offset:6144
    v_mfma_f32_16x16x32_bf16 v[136:139], v[56:59], v[16:19], v[136:139]
    ds_read_b64_tr_b16 v[72:73], v10 offset:4096
    v_mfma_f32_16x16x32_bf16 v[140:143], v[56:59], v[20:23], v[140:143]
    ds_read_b64_tr_b16 v[74:75], v10 offset:6144
    v_mfma_f32_16x16x32_bf16 v[144:147], v[56:59], v[24:27], v[144:147]
    ds_read_b64_tr_b16 v[76:77], v11 offset:4096
    v_mfma_f32_16x16x32_bf16 v[148:151], v[56:59], v[28:31], v[148:151]
    ds_read_b64_tr_b16 v[78:79], v11 offset:6144
    v_mfma_f32_16x16x32_bf16 v[152:155], v[60:63], v[16:19], v[152:155]
    v_mfma_f32_16x16x32_bf16 v[156:159], v[60:63], v[20:23], v[156:159]
    v_mfma_f32_16x16x32_bf16 v[160:163], v[60:63], v[24:27], v[160:163]
    v_mfma_f32_16x16x32_bf16 v[164:167], v[60:63], v[28:31], v[164:167]
    s_waitcnt  lgkmcnt(0)
    s_barrier
    v_add_u32 v12, 4294868992, v12
    v_add_u32 v6, 4294868992, v6
    v_add_u32 v8, 4294868992, v8
    v_add_u32 v9, 4294868992, v9
    v_add_u32 v10, 4294868992, v10
    v_add_u32 v11, 4294868992, v11
    v_mfma_f32_16x16x32_bf16 v[104:107], v[64:67], v[32:35], v[104:107]
    ds_read_b64_tr_b16 v[48:49], v8 offset:0
    v_mfma_f32_16x16x32_bf16 v[108:111], v[64:67], v[36:39], v[108:111]
    ds_read_b64_tr_b16 v[50:51], v8 offset:2048
    v_mfma_f32_16x16x32_bf16 v[112:115], v[64:67], v[40:43], v[112:115]
    ds_read_b128 v[16:19], v12 offset:0
    v_mfma_f32_16x16x32_bf16 v[116:119], v[64:67], v[44:47], v[116:119]
    ds_read_b128 v[20:23], v12 offset:2048
    v_mfma_f32_16x16x32_bf16 v[120:123], v[68:71], v[32:35], v[120:123]
    ds_read_b128 v[24:27], v12 offset:4096
    v_mfma_f32_16x16x32_bf16 v[124:127], v[68:71], v[36:39], v[124:127]
    ds_read_b128 v[28:31], v12 offset:6144
    v_mfma_f32_16x16x32_bf16 v[128:131], v[68:71], v[40:43], v[128:131]
    ds_read_b64_tr_b16 v[52:53], v9 offset:0
    v_mfma_f32_16x16x32_bf16 v[132:135], v[68:71], v[44:47], v[132:135]
    ds_read_b64_tr_b16 v[54:55], v9 offset:2048
    v_mfma_f32_16x16x32_bf16 v[136:139], v[72:75], v[32:35], v[136:139]
    ds_read_b64_tr_b16 v[56:57], v10 offset:0
    v_mfma_f32_16x16x32_bf16 v[140:143], v[72:75], v[36:39], v[140:143]
    ds_read_b64_tr_b16 v[58:59], v10 offset:2048
    v_mfma_f32_16x16x32_bf16 v[144:147], v[72:75], v[40:43], v[144:147]
    ds_read_b64_tr_b16 v[60:61], v11 offset:0
    v_mfma_f32_16x16x32_bf16 v[148:151], v[72:75], v[44:47], v[148:151]
    ds_read_b64_tr_b16 v[62:63], v11 offset:2048
    v_mfma_f32_16x16x32_bf16 v[152:155], v[76:79], v[32:35], v[152:155]
    v_mfma_f32_16x16x32_bf16 v[156:159], v[76:79], v[36:39], v[156:159]
    v_mfma_f32_16x16x32_bf16 v[160:163], v[76:79], v[40:43], v[160:163]
    v_mfma_f32_16x16x32_bf16 v[164:167], v[76:79], v[44:47], v[164:167]
    s_waitcnt lgkmcnt(0)
    v_mfma_f32_16x16x32_bf16 v[104:107], v[48:51], v[16:19], v[104:107]
    ds_read_b64_tr_b16 v[64:65], v8 offset:4096
    v_mfma_f32_16x16x32_bf16 v[108:111], v[48:51], v[20:23], v[108:111]
    ds_read_b64_tr_b16 v[66:67], v8 offset:6144
    v_mfma_f32_16x16x32_bf16 v[112:115], v[48:51], v[24:27], v[112:115]
    ds_read_b128 v[32:35], v6 offset:0
    v_mfma_f32_16x16x32_bf16 v[116:119], v[48:51], v[28:31], v[116:119]
    ds_read_b128 v[36:39], v6 offset:2048
    v_mfma_f32_16x16x32_bf16 v[120:123], v[52:55], v[16:19], v[120:123]
    ds_read_b128 v[40:43], v6 offset:4096
    v_mfma_f32_16x16x32_bf16 v[124:127], v[52:55], v[20:23], v[124:127]
    ds_read_b128 v[44:47], v6 offset:6144
    v_mfma_f32_16x16x32_bf16 v[128:131], v[52:55], v[24:27], v[128:131]
    ds_read_b64_tr_b16 v[68:69], v9 offset:4096
    v_mfma_f32_16x16x32_bf16 v[132:135], v[52:55], v[28:31], v[132:135]
    ds_read_b64_tr_b16 v[70:71], v9 offset:6144
    v_mfma_f32_16x16x32_bf16 v[136:139], v[56:59], v[16:19], v[136:139]
    ds_read_b64_tr_b16 v[72:73], v10 offset:4096
    v_mfma_f32_16x16x32_bf16 v[140:143], v[56:59], v[20:23], v[140:143]
    ds_read_b64_tr_b16 v[74:75], v10 offset:6144
    v_mfma_f32_16x16x32_bf16 v[144:147], v[56:59], v[24:27], v[144:147]
    ds_read_b64_tr_b16 v[76:77], v11 offset:4096
    v_mfma_f32_16x16x32_bf16 v[148:151], v[56:59], v[28:31], v[148:151]
    ds_read_b64_tr_b16 v[78:79], v11 offset:6144
    v_mfma_f32_16x16x32_bf16 v[152:155], v[60:63], v[16:19], v[152:155]
    v_mfma_f32_16x16x32_bf16 v[156:159], v[60:63], v[20:23], v[156:159]
    v_mfma_f32_16x16x32_bf16 v[160:163], v[60:63], v[24:27], v[160:163]
    v_mfma_f32_16x16x32_bf16 v[164:167], v[60:63], v[28:31], v[164:167]
    s_waitcnt  lgkmcnt(0)
    s_barrier
    v_add_u32 v12, 32768, v12
    v_add_u32 v6, 32768, v6
    v_add_u32 v8, 32768, v8
    v_add_u32 v9, 32768, v9
    v_add_u32 v10, 32768, v10
    v_add_u32 v11, 32768, v11
    v_mfma_f32_16x16x32_bf16 v[104:107], v[64:67], v[32:35], v[104:107]
    ds_read_b64_tr_b16 v[48:49], v8 offset:0
    v_mfma_f32_16x16x32_bf16 v[108:111], v[64:67], v[36:39], v[108:111]
    ds_read_b64_tr_b16 v[50:51], v8 offset:2048
    v_mfma_f32_16x16x32_bf16 v[112:115], v[64:67], v[40:43], v[112:115]
    ds_read_b128 v[16:19], v12 offset:0
    v_mfma_f32_16x16x32_bf16 v[116:119], v[64:67], v[44:47], v[116:119]
    ds_read_b128 v[20:23], v12 offset:2048
    v_mfma_f32_16x16x32_bf16 v[120:123], v[68:71], v[32:35], v[120:123]
    ds_read_b128 v[24:27], v12 offset:4096
    v_mfma_f32_16x16x32_bf16 v[124:127], v[68:71], v[36:39], v[124:127]
    ds_read_b128 v[28:31], v12 offset:6144
    v_mfma_f32_16x16x32_bf16 v[128:131], v[68:71], v[40:43], v[128:131]
    ds_read_b64_tr_b16 v[52:53], v9 offset:0
    v_mfma_f32_16x16x32_bf16 v[132:135], v[68:71], v[44:47], v[132:135]
    ds_read_b64_tr_b16 v[54:55], v9 offset:2048
    v_mfma_f32_16x16x32_bf16 v[136:139], v[72:75], v[32:35], v[136:139]
    ds_read_b64_tr_b16 v[56:57], v10 offset:0
    v_mfma_f32_16x16x32_bf16 v[140:143], v[72:75], v[36:39], v[140:143]
    ds_read_b64_tr_b16 v[58:59], v10 offset:2048
    v_mfma_f32_16x16x32_bf16 v[144:147], v[72:75], v[40:43], v[144:147]
    ds_read_b64_tr_b16 v[60:61], v11 offset:0
    v_mfma_f32_16x16x32_bf16 v[148:151], v[72:75], v[44:47], v[148:151]
    ds_read_b64_tr_b16 v[62:63], v11 offset:2048
    v_mfma_f32_16x16x32_bf16 v[152:155], v[76:79], v[32:35], v[152:155]
    v_mfma_f32_16x16x32_bf16 v[156:159], v[76:79], v[36:39], v[156:159]
    v_mfma_f32_16x16x32_bf16 v[160:163], v[76:79], v[40:43], v[160:163]
    v_mfma_f32_16x16x32_bf16 v[164:167], v[76:79], v[44:47], v[164:167]
    s_waitcnt lgkmcnt(0)
    v_mfma_f32_16x16x32_bf16 v[104:107], v[48:51], v[16:19], v[104:107]
    ds_read_b64_tr_b16 v[64:65], v8 offset:4096
    v_mfma_f32_16x16x32_bf16 v[108:111], v[48:51], v[20:23], v[108:111]
    ds_read_b64_tr_b16 v[66:67], v8 offset:6144
    v_mfma_f32_16x16x32_bf16 v[112:115], v[48:51], v[24:27], v[112:115]
    ds_read_b128 v[32:35], v6 offset:0
    v_mfma_f32_16x16x32_bf16 v[116:119], v[48:51], v[28:31], v[116:119]
    ds_read_b128 v[36:39], v6 offset:2048
    v_mfma_f32_16x16x32_bf16 v[120:123], v[52:55], v[16:19], v[120:123]
    ds_read_b128 v[40:43], v6 offset:4096
    v_mfma_f32_16x16x32_bf16 v[124:127], v[52:55], v[20:23], v[124:127]
    ds_read_b128 v[44:47], v6 offset:6144
    v_mfma_f32_16x16x32_bf16 v[128:131], v[52:55], v[24:27], v[128:131]
    ds_read_b64_tr_b16 v[68:69], v9 offset:4096
    v_mfma_f32_16x16x32_bf16 v[132:135], v[52:55], v[28:31], v[132:135]
    ds_read_b64_tr_b16 v[70:71], v9 offset:6144
    v_mfma_f32_16x16x32_bf16 v[136:139], v[56:59], v[16:19], v[136:139]
    ds_read_b64_tr_b16 v[72:73], v10 offset:4096
    v_mfma_f32_16x16x32_bf16 v[140:143], v[56:59], v[20:23], v[140:143]
    ds_read_b64_tr_b16 v[74:75], v10 offset:6144
    v_mfma_f32_16x16x32_bf16 v[144:147], v[56:59], v[24:27], v[144:147]
    ds_read_b64_tr_b16 v[76:77], v11 offset:4096
    v_mfma_f32_16x16x32_bf16 v[148:151], v[56:59], v[28:31], v[148:151]
    ds_read_b64_tr_b16 v[78:79], v11 offset:6144
    v_mfma_f32_16x16x32_bf16 v[152:155], v[60:63], v[16:19], v[152:155]
    v_mfma_f32_16x16x32_bf16 v[156:159], v[60:63], v[20:23], v[156:159]
    v_mfma_f32_16x16x32_bf16 v[160:163], v[60:63], v[24:27], v[160:163]
    v_mfma_f32_16x16x32_bf16 v[164:167], v[60:63], v[28:31], v[164:167]
    s_waitcnt  lgkmcnt(0)
    s_barrier
    v_add_u32 v12, 32768, v12
    v_add_u32 v6, 32768, v6
    v_add_u32 v8, 32768, v8
    v_add_u32 v9, 32768, v9
    v_add_u32 v10, 32768, v10
    v_add_u32 v11, 32768, v11
    v_mfma_f32_16x16x32_bf16 v[104:107], v[64:67], v[32:35], v[104:107]
    ds_read_b64_tr_b16 v[48:49], v8 offset:0
    v_mfma_f32_16x16x32_bf16 v[108:111], v[64:67], v[36:39], v[108:111]
    ds_read_b64_tr_b16 v[50:51], v8 offset:2048
    v_mfma_f32_16x16x32_bf16 v[112:115], v[64:67], v[40:43], v[112:115]
    ds_read_b128 v[16:19], v12 offset:0
    v_mfma_f32_16x16x32_bf16 v[116:119], v[64:67], v[44:47], v[116:119]
    ds_read_b128 v[20:23], v12 offset:2048
    v_mfma_f32_16x16x32_bf16 v[120:123], v[68:71], v[32:35], v[120:123]
    ds_read_b128 v[24:27], v12 offset:4096
    v_mfma_f32_16x16x32_bf16 v[124:127], v[68:71], v[36:39], v[124:127]
    ds_read_b128 v[28:31], v12 offset:6144
    v_mfma_f32_16x16x32_bf16 v[128:131], v[68:71], v[40:43], v[128:131]
    ds_read_b64_tr_b16 v[52:53], v9 offset:0
    v_mfma_f32_16x16x32_bf16 v[132:135], v[68:71], v[44:47], v[132:135]
    ds_read_b64_tr_b16 v[54:55], v9 offset:2048
    v_mfma_f32_16x16x32_bf16 v[136:139], v[72:75], v[32:35], v[136:139]
    ds_read_b64_tr_b16 v[56:57], v10 offset:0
    v_mfma_f32_16x16x32_bf16 v[140:143], v[72:75], v[36:39], v[140:143]
    ds_read_b64_tr_b16 v[58:59], v10 offset:2048
    v_mfma_f32_16x16x32_bf16 v[144:147], v[72:75], v[40:43], v[144:147]
    ds_read_b64_tr_b16 v[60:61], v11 offset:0
    v_mfma_f32_16x16x32_bf16 v[148:151], v[72:75], v[44:47], v[148:151]
    ds_read_b64_tr_b16 v[62:63], v11 offset:2048
    v_mfma_f32_16x16x32_bf16 v[152:155], v[76:79], v[32:35], v[152:155]
    v_mfma_f32_16x16x32_bf16 v[156:159], v[76:79], v[36:39], v[156:159]
    v_mfma_f32_16x16x32_bf16 v[160:163], v[76:79], v[40:43], v[160:163]
    v_mfma_f32_16x16x32_bf16 v[164:167], v[76:79], v[44:47], v[164:167]
    s_waitcnt lgkmcnt(0)
    v_mfma_f32_16x16x32_bf16 v[104:107], v[48:51], v[16:19], v[104:107]
    ds_read_b64_tr_b16 v[64:65], v8 offset:4096
    v_mfma_f32_16x16x32_bf16 v[108:111], v[48:51], v[20:23], v[108:111]
    ds_read_b64_tr_b16 v[66:67], v8 offset:6144
    v_mfma_f32_16x16x32_bf16 v[112:115], v[48:51], v[24:27], v[112:115]
    ds_read_b128 v[32:35], v6 offset:0
    v_mfma_f32_16x16x32_bf16 v[116:119], v[48:51], v[28:31], v[116:119]
    ds_read_b128 v[36:39], v6 offset:2048
    v_mfma_f32_16x16x32_bf16 v[120:123], v[52:55], v[16:19], v[120:123]
    ds_read_b128 v[40:43], v6 offset:4096
    v_mfma_f32_16x16x32_bf16 v[124:127], v[52:55], v[20:23], v[124:127]
    ds_read_b128 v[44:47], v6 offset:6144
    v_mfma_f32_16x16x32_bf16 v[128:131], v[52:55], v[24:27], v[128:131]
    ds_read_b64_tr_b16 v[68:69], v9 offset:4096
    v_mfma_f32_16x16x32_bf16 v[132:135], v[52:55], v[28:31], v[132:135]
    ds_read_b64_tr_b16 v[70:71], v9 offset:6144
    v_mfma_f32_16x16x32_bf16 v[136:139], v[56:59], v[16:19], v[136:139]
    ds_read_b64_tr_b16 v[72:73], v10 offset:4096
    v_mfma_f32_16x16x32_bf16 v[140:143], v[56:59], v[20:23], v[140:143]
    ds_read_b64_tr_b16 v[74:75], v10 offset:6144
    v_mfma_f32_16x16x32_bf16 v[144:147], v[56:59], v[24:27], v[144:147]
    ds_read_b64_tr_b16 v[76:77], v11 offset:4096
    v_mfma_f32_16x16x32_bf16 v[148:151], v[56:59], v[28:31], v[148:151]
    ds_read_b64_tr_b16 v[78:79], v11 offset:6144
    v_mfma_f32_16x16x32_bf16 v[152:155], v[60:63], v[16:19], v[152:155]
    v_mfma_f32_16x16x32_bf16 v[156:159], v[60:63], v[20:23], v[156:159]
    v_mfma_f32_16x16x32_bf16 v[160:163], v[60:63], v[24:27], v[160:163]
    v_mfma_f32_16x16x32_bf16 v[164:167], v[60:63], v[28:31], v[164:167]
    s_waitcnt  lgkmcnt(0)
    s_barrier
    v_add_u32 v12, 32768, v12
    v_add_u32 v6, 32768, v6
    v_add_u32 v8, 32768, v8
    v_add_u32 v9, 32768, v9
    v_add_u32 v10, 32768, v10
    v_add_u32 v11, 32768, v11
    v_mfma_f32_16x16x32_bf16 v[104:107], v[64:67], v[32:35], v[104:107]
    ds_read_b64_tr_b16 v[48:49], v8 offset:0
    v_mfma_f32_16x16x32_bf16 v[108:111], v[64:67], v[36:39], v[108:111]
    ds_read_b64_tr_b16 v[50:51], v8 offset:2048
    v_mfma_f32_16x16x32_bf16 v[112:115], v[64:67], v[40:43], v[112:115]
    ds_read_b128 v[16:19], v12 offset:0
    v_mfma_f32_16x16x32_bf16 v[116:119], v[64:67], v[44:47], v[116:119]
    ds_read_b128 v[20:23], v12 offset:2048
    v_mfma_f32_16x16x32_bf16 v[120:123], v[68:71], v[32:35], v[120:123]
    ds_read_b128 v[24:27], v12 offset:4096
    v_mfma_f32_16x16x32_bf16 v[124:127], v[68:71], v[36:39], v[124:127]
    ds_read_b128 v[28:31], v12 offset:6144
    v_mfma_f32_16x16x32_bf16 v[128:131], v[68:71], v[40:43], v[128:131]
    ds_read_b64_tr_b16 v[52:53], v9 offset:0
    v_mfma_f32_16x16x32_bf16 v[132:135], v[68:71], v[44:47], v[132:135]
    ds_read_b64_tr_b16 v[54:55], v9 offset:2048
    v_mfma_f32_16x16x32_bf16 v[136:139], v[72:75], v[32:35], v[136:139]
    ds_read_b64_tr_b16 v[56:57], v10 offset:0
    v_mfma_f32_16x16x32_bf16 v[140:143], v[72:75], v[36:39], v[140:143]
    ds_read_b64_tr_b16 v[58:59], v10 offset:2048
    v_mfma_f32_16x16x32_bf16 v[144:147], v[72:75], v[40:43], v[144:147]
    ds_read_b64_tr_b16 v[60:61], v11 offset:0
    v_mfma_f32_16x16x32_bf16 v[148:151], v[72:75], v[44:47], v[148:151]
    ds_read_b64_tr_b16 v[62:63], v11 offset:2048
    v_mfma_f32_16x16x32_bf16 v[152:155], v[76:79], v[32:35], v[152:155]
    v_mfma_f32_16x16x32_bf16 v[156:159], v[76:79], v[36:39], v[156:159]
    v_mfma_f32_16x16x32_bf16 v[160:163], v[76:79], v[40:43], v[160:163]
    v_mfma_f32_16x16x32_bf16 v[164:167], v[76:79], v[44:47], v[164:167]
    s_waitcnt lgkmcnt(0)
    v_mfma_f32_16x16x32_bf16 v[104:107], v[48:51], v[16:19], v[104:107]
    ds_read_b64_tr_b16 v[64:65], v8 offset:4096
    v_mfma_f32_16x16x32_bf16 v[108:111], v[48:51], v[20:23], v[108:111]
    ds_read_b64_tr_b16 v[66:67], v8 offset:6144
    v_mfma_f32_16x16x32_bf16 v[112:115], v[48:51], v[24:27], v[112:115]
    ds_read_b128 v[32:35], v6 offset:0
    v_mfma_f32_16x16x32_bf16 v[116:119], v[48:51], v[28:31], v[116:119]
    ds_read_b128 v[36:39], v6 offset:2048
    v_mfma_f32_16x16x32_bf16 v[120:123], v[52:55], v[16:19], v[120:123]
    ds_read_b128 v[40:43], v6 offset:4096
    v_mfma_f32_16x16x32_bf16 v[124:127], v[52:55], v[20:23], v[124:127]
    ds_read_b128 v[44:47], v6 offset:6144
    v_mfma_f32_16x16x32_bf16 v[128:131], v[52:55], v[24:27], v[128:131]
    ds_read_b64_tr_b16 v[68:69], v9 offset:4096
    v_mfma_f32_16x16x32_bf16 v[132:135], v[52:55], v[28:31], v[132:135]
    ds_read_b64_tr_b16 v[70:71], v9 offset:6144
    v_mfma_f32_16x16x32_bf16 v[136:139], v[56:59], v[16:19], v[136:139]
    ds_read_b64_tr_b16 v[72:73], v10 offset:4096
    v_mfma_f32_16x16x32_bf16 v[140:143], v[56:59], v[20:23], v[140:143]
    ds_read_b64_tr_b16 v[74:75], v10 offset:6144
    v_mfma_f32_16x16x32_bf16 v[144:147], v[56:59], v[24:27], v[144:147]
    ds_read_b64_tr_b16 v[76:77], v11 offset:4096
    v_mfma_f32_16x16x32_bf16 v[148:151], v[56:59], v[28:31], v[148:151]
    ds_read_b64_tr_b16 v[78:79], v11 offset:6144
    v_mfma_f32_16x16x32_bf16 v[152:155], v[60:63], v[16:19], v[152:155]
    v_mfma_f32_16x16x32_bf16 v[156:159], v[60:63], v[20:23], v[156:159]
    v_mfma_f32_16x16x32_bf16 v[160:163], v[60:63], v[24:27], v[160:163]
    v_mfma_f32_16x16x32_bf16 v[164:167], v[60:63], v[28:31], v[164:167]
    s_waitcnt  lgkmcnt(0)
    s_barrier
    v_add_u32 v12, 4294868992, v12
    v_add_u32 v6, 4294868992, v6
    v_add_u32 v8, 4294868992, v8
    v_add_u32 v9, 4294868992, v9
    v_add_u32 v10, 4294868992, v10
    v_add_u32 v11, 4294868992, v11
    v_mfma_f32_16x16x32_bf16 v[104:107], v[64:67], v[32:35], v[104:107]
    ds_read_b64_tr_b16 v[48:49], v8 offset:0
    v_mfma_f32_16x16x32_bf16 v[108:111], v[64:67], v[36:39], v[108:111]
    ds_read_b64_tr_b16 v[50:51], v8 offset:2048
    v_mfma_f32_16x16x32_bf16 v[112:115], v[64:67], v[40:43], v[112:115]
    ds_read_b128 v[16:19], v12 offset:0
    v_mfma_f32_16x16x32_bf16 v[116:119], v[64:67], v[44:47], v[116:119]
    ds_read_b128 v[20:23], v12 offset:2048
    v_mfma_f32_16x16x32_bf16 v[120:123], v[68:71], v[32:35], v[120:123]
    ds_read_b128 v[24:27], v12 offset:4096
    v_mfma_f32_16x16x32_bf16 v[124:127], v[68:71], v[36:39], v[124:127]
    ds_read_b128 v[28:31], v12 offset:6144
    v_mfma_f32_16x16x32_bf16 v[128:131], v[68:71], v[40:43], v[128:131]
    ds_read_b64_tr_b16 v[52:53], v9 offset:0
    v_mfma_f32_16x16x32_bf16 v[132:135], v[68:71], v[44:47], v[132:135]
    ds_read_b64_tr_b16 v[54:55], v9 offset:2048
    v_mfma_f32_16x16x32_bf16 v[136:139], v[72:75], v[32:35], v[136:139]
    ds_read_b64_tr_b16 v[56:57], v10 offset:0
    v_mfma_f32_16x16x32_bf16 v[140:143], v[72:75], v[36:39], v[140:143]
    ds_read_b64_tr_b16 v[58:59], v10 offset:2048
    v_mfma_f32_16x16x32_bf16 v[144:147], v[72:75], v[40:43], v[144:147]
    ds_read_b64_tr_b16 v[60:61], v11 offset:0
    v_mfma_f32_16x16x32_bf16 v[148:151], v[72:75], v[44:47], v[148:151]
    ds_read_b64_tr_b16 v[62:63], v11 offset:2048
    v_mfma_f32_16x16x32_bf16 v[152:155], v[76:79], v[32:35], v[152:155]
    v_mfma_f32_16x16x32_bf16 v[156:159], v[76:79], v[36:39], v[156:159]
    v_mfma_f32_16x16x32_bf16 v[160:163], v[76:79], v[40:43], v[160:163]
    v_mfma_f32_16x16x32_bf16 v[164:167], v[76:79], v[44:47], v[164:167]
    s_waitcnt lgkmcnt(0)
    v_mfma_f32_16x16x32_bf16 v[104:107], v[48:51], v[16:19], v[104:107]
    ds_read_b64_tr_b16 v[64:65], v8 offset:4096
    v_mfma_f32_16x16x32_bf16 v[108:111], v[48:51], v[20:23], v[108:111]
    ds_read_b64_tr_b16 v[66:67], v8 offset:6144
    v_mfma_f32_16x16x32_bf16 v[112:115], v[48:51], v[24:27], v[112:115]
    ds_read_b128 v[32:35], v6 offset:0
    v_mfma_f32_16x16x32_bf16 v[116:119], v[48:51], v[28:31], v[116:119]
    ds_read_b128 v[36:39], v6 offset:2048
    v_mfma_f32_16x16x32_bf16 v[120:123], v[52:55], v[16:19], v[120:123]
    ds_read_b128 v[40:43], v6 offset:4096
    v_mfma_f32_16x16x32_bf16 v[124:127], v[52:55], v[20:23], v[124:127]
    ds_read_b128 v[44:47], v6 offset:6144
    v_mfma_f32_16x16x32_bf16 v[128:131], v[52:55], v[24:27], v[128:131]
    ds_read_b64_tr_b16 v[68:69], v9 offset:4096
    v_mfma_f32_16x16x32_bf16 v[132:135], v[52:55], v[28:31], v[132:135]
    ds_read_b64_tr_b16 v[70:71], v9 offset:6144
    v_mfma_f32_16x16x32_bf16 v[136:139], v[56:59], v[16:19], v[136:139]
    ds_read_b64_tr_b16 v[72:73], v10 offset:4096
    v_mfma_f32_16x16x32_bf16 v[140:143], v[56:59], v[20:23], v[140:143]
    ds_read_b64_tr_b16 v[74:75], v10 offset:6144
    v_mfma_f32_16x16x32_bf16 v[144:147], v[56:59], v[24:27], v[144:147]
    ds_read_b64_tr_b16 v[76:77], v11 offset:4096
    v_mfma_f32_16x16x32_bf16 v[148:151], v[56:59], v[28:31], v[148:151]
    ds_read_b64_tr_b16 v[78:79], v11 offset:6144
    v_mfma_f32_16x16x32_bf16 v[152:155], v[60:63], v[16:19], v[152:155]
    v_mfma_f32_16x16x32_bf16 v[156:159], v[60:63], v[20:23], v[156:159]
    v_mfma_f32_16x16x32_bf16 v[160:163], v[60:63], v[24:27], v[160:163]
    v_mfma_f32_16x16x32_bf16 v[164:167], v[60:63], v[28:31], v[164:167]
    s_waitcnt  lgkmcnt(0)
    s_barrier
    v_add_u32 v12, 32768, v12
    v_add_u32 v6, 32768, v6
    v_add_u32 v8, 32768, v8
    v_add_u32 v9, 32768, v9
    v_add_u32 v10, 32768, v10
    v_add_u32 v11, 32768, v11
    v_mfma_f32_16x16x32_bf16 v[104:107], v[64:67], v[32:35], v[104:107]
    ds_read_b64_tr_b16 v[48:49], v8 offset:0
    v_mfma_f32_16x16x32_bf16 v[108:111], v[64:67], v[36:39], v[108:111]
    ds_read_b64_tr_b16 v[50:51], v8 offset:2048
    v_mfma_f32_16x16x32_bf16 v[112:115], v[64:67], v[40:43], v[112:115]
    ds_read_b128 v[16:19], v12 offset:0
    v_mfma_f32_16x16x32_bf16 v[116:119], v[64:67], v[44:47], v[116:119]
    ds_read_b128 v[20:23], v12 offset:2048
    v_mfma_f32_16x16x32_bf16 v[120:123], v[68:71], v[32:35], v[120:123]
    ds_read_b128 v[24:27], v12 offset:4096
    v_mfma_f32_16x16x32_bf16 v[124:127], v[68:71], v[36:39], v[124:127]
    ds_read_b128 v[28:31], v12 offset:6144
    v_mfma_f32_16x16x32_bf16 v[128:131], v[68:71], v[40:43], v[128:131]
    ds_read_b64_tr_b16 v[52:53], v9 offset:0
    v_mfma_f32_16x16x32_bf16 v[132:135], v[68:71], v[44:47], v[132:135]
    ds_read_b64_tr_b16 v[54:55], v9 offset:2048
    v_mfma_f32_16x16x32_bf16 v[136:139], v[72:75], v[32:35], v[136:139]
    ds_read_b64_tr_b16 v[56:57], v10 offset:0
    v_mfma_f32_16x16x32_bf16 v[140:143], v[72:75], v[36:39], v[140:143]
    ds_read_b64_tr_b16 v[58:59], v10 offset:2048
    v_mfma_f32_16x16x32_bf16 v[144:147], v[72:75], v[40:43], v[144:147]
    ds_read_b64_tr_b16 v[60:61], v11 offset:0
    v_mfma_f32_16x16x32_bf16 v[148:151], v[72:75], v[44:47], v[148:151]
    ds_read_b64_tr_b16 v[62:63], v11 offset:2048
    v_mfma_f32_16x16x32_bf16 v[152:155], v[76:79], v[32:35], v[152:155]
    v_mfma_f32_16x16x32_bf16 v[156:159], v[76:79], v[36:39], v[156:159]
    v_mfma_f32_16x16x32_bf16 v[160:163], v[76:79], v[40:43], v[160:163]
    v_mfma_f32_16x16x32_bf16 v[164:167], v[76:79], v[44:47], v[164:167]
    s_waitcnt lgkmcnt(0)
    v_mfma_f32_16x16x32_bf16 v[104:107], v[48:51], v[16:19], v[104:107]
    ds_read_b64_tr_b16 v[64:65], v8 offset:4096
    v_mfma_f32_16x16x32_bf16 v[108:111], v[48:51], v[20:23], v[108:111]
    ds_read_b64_tr_b16 v[66:67], v8 offset:6144
    v_mfma_f32_16x16x32_bf16 v[112:115], v[48:51], v[24:27], v[112:115]
    ds_read_b128 v[32:35], v6 offset:0
    v_mfma_f32_16x16x32_bf16 v[116:119], v[48:51], v[28:31], v[116:119]
    ds_read_b128 v[36:39], v6 offset:2048
    v_mfma_f32_16x16x32_bf16 v[120:123], v[52:55], v[16:19], v[120:123]
    ds_read_b128 v[40:43], v6 offset:4096
    v_mfma_f32_16x16x32_bf16 v[124:127], v[52:55], v[20:23], v[124:127]
    ds_read_b128 v[44:47], v6 offset:6144
    v_mfma_f32_16x16x32_bf16 v[128:131], v[52:55], v[24:27], v[128:131]
    ds_read_b64_tr_b16 v[68:69], v9 offset:4096
    v_mfma_f32_16x16x32_bf16 v[132:135], v[52:55], v[28:31], v[132:135]
    ds_read_b64_tr_b16 v[70:71], v9 offset:6144
    v_mfma_f32_16x16x32_bf16 v[136:139], v[56:59], v[16:19], v[136:139]
    ds_read_b64_tr_b16 v[72:73], v10 offset:4096
    v_mfma_f32_16x16x32_bf16 v[140:143], v[56:59], v[20:23], v[140:143]
    ds_read_b64_tr_b16 v[74:75], v10 offset:6144
    v_mfma_f32_16x16x32_bf16 v[144:147], v[56:59], v[24:27], v[144:147]
    ds_read_b64_tr_b16 v[76:77], v11 offset:4096
    v_mfma_f32_16x16x32_bf16 v[148:151], v[56:59], v[28:31], v[148:151]
    ds_read_b64_tr_b16 v[78:79], v11 offset:6144
    v_mfma_f32_16x16x32_bf16 v[152:155], v[60:63], v[16:19], v[152:155]
    v_mfma_f32_16x16x32_bf16 v[156:159], v[60:63], v[20:23], v[156:159]
    v_mfma_f32_16x16x32_bf16 v[160:163], v[60:63], v[24:27], v[160:163]
    v_mfma_f32_16x16x32_bf16 v[164:167], v[60:63], v[28:31], v[164:167]
    s_waitcnt  lgkmcnt(0)
    s_barrier
    v_add_u32 v12, 32768, v12
    v_add_u32 v6, 32768, v6
    v_add_u32 v8, 32768, v8
    v_add_u32 v9, 32768, v9
    v_add_u32 v10, 32768, v10
    v_add_u32 v11, 32768, v11
    v_mfma_f32_16x16x32_bf16 v[104:107], v[64:67], v[32:35], v[104:107]
    ds_read_b64_tr_b16 v[48:49], v8 offset:0
    v_mfma_f32_16x16x32_bf16 v[108:111], v[64:67], v[36:39], v[108:111]
    ds_read_b64_tr_b16 v[50:51], v8 offset:2048
    v_mfma_f32_16x16x32_bf16 v[112:115], v[64:67], v[40:43], v[112:115]
    ds_read_b128 v[16:19], v12 offset:0
    v_mfma_f32_16x16x32_bf16 v[116:119], v[64:67], v[44:47], v[116:119]
    ds_read_b128 v[20:23], v12 offset:2048
    v_mfma_f32_16x16x32_bf16 v[120:123], v[68:71], v[32:35], v[120:123]
    ds_read_b128 v[24:27], v12 offset:4096
    v_mfma_f32_16x16x32_bf16 v[124:127], v[68:71], v[36:39], v[124:127]
    ds_read_b128 v[28:31], v12 offset:6144
    v_mfma_f32_16x16x32_bf16 v[128:131], v[68:71], v[40:43], v[128:131]
    ds_read_b64_tr_b16 v[52:53], v9 offset:0
    v_mfma_f32_16x16x32_bf16 v[132:135], v[68:71], v[44:47], v[132:135]
    ds_read_b64_tr_b16 v[54:55], v9 offset:2048
    v_mfma_f32_16x16x32_bf16 v[136:139], v[72:75], v[32:35], v[136:139]
    ds_read_b64_tr_b16 v[56:57], v10 offset:0
    v_mfma_f32_16x16x32_bf16 v[140:143], v[72:75], v[36:39], v[140:143]
    ds_read_b64_tr_b16 v[58:59], v10 offset:2048
    v_mfma_f32_16x16x32_bf16 v[144:147], v[72:75], v[40:43], v[144:147]
    ds_read_b64_tr_b16 v[60:61], v11 offset:0
    v_mfma_f32_16x16x32_bf16 v[148:151], v[72:75], v[44:47], v[148:151]
    ds_read_b64_tr_b16 v[62:63], v11 offset:2048
    v_mfma_f32_16x16x32_bf16 v[152:155], v[76:79], v[32:35], v[152:155]
    v_mfma_f32_16x16x32_bf16 v[156:159], v[76:79], v[36:39], v[156:159]
    v_mfma_f32_16x16x32_bf16 v[160:163], v[76:79], v[40:43], v[160:163]
    v_mfma_f32_16x16x32_bf16 v[164:167], v[76:79], v[44:47], v[164:167]
    s_waitcnt lgkmcnt(0)
    v_mfma_f32_16x16x32_bf16 v[104:107], v[48:51], v[16:19], v[104:107]
    ds_read_b64_tr_b16 v[64:65], v8 offset:4096
    v_mfma_f32_16x16x32_bf16 v[108:111], v[48:51], v[20:23], v[108:111]
    ds_read_b64_tr_b16 v[66:67], v8 offset:6144
    v_mfma_f32_16x16x32_bf16 v[112:115], v[48:51], v[24:27], v[112:115]
    ds_read_b128 v[32:35], v6 offset:0
    v_mfma_f32_16x16x32_bf16 v[116:119], v[48:51], v[28:31], v[116:119]
    ds_read_b128 v[36:39], v6 offset:2048
    v_mfma_f32_16x16x32_bf16 v[120:123], v[52:55], v[16:19], v[120:123]
    ds_read_b128 v[40:43], v6 offset:4096
    v_mfma_f32_16x16x32_bf16 v[124:127], v[52:55], v[20:23], v[124:127]
    ds_read_b128 v[44:47], v6 offset:6144
    v_mfma_f32_16x16x32_bf16 v[128:131], v[52:55], v[24:27], v[128:131]
    ds_read_b64_tr_b16 v[68:69], v9 offset:4096
    v_mfma_f32_16x16x32_bf16 v[132:135], v[52:55], v[28:31], v[132:135]
    ds_read_b64_tr_b16 v[70:71], v9 offset:6144
    v_mfma_f32_16x16x32_bf16 v[136:139], v[56:59], v[16:19], v[136:139]
    ds_read_b64_tr_b16 v[72:73], v10 offset:4096
    v_mfma_f32_16x16x32_bf16 v[140:143], v[56:59], v[20:23], v[140:143]
    ds_read_b64_tr_b16 v[74:75], v10 offset:6144
    v_mfma_f32_16x16x32_bf16 v[144:147], v[56:59], v[24:27], v[144:147]
    ds_read_b64_tr_b16 v[76:77], v11 offset:4096
    v_mfma_f32_16x16x32_bf16 v[148:151], v[56:59], v[28:31], v[148:151]
    ds_read_b64_tr_b16 v[78:79], v11 offset:6144
    v_mfma_f32_16x16x32_bf16 v[152:155], v[60:63], v[16:19], v[152:155]
    v_mfma_f32_16x16x32_bf16 v[156:159], v[60:63], v[20:23], v[156:159]
    v_mfma_f32_16x16x32_bf16 v[160:163], v[60:63], v[24:27], v[160:163]
    v_mfma_f32_16x16x32_bf16 v[164:167], v[60:63], v[28:31], v[164:167]
    s_waitcnt  lgkmcnt(0)
    s_barrier
    v_add_u32 v12, 32768, v12
    v_add_u32 v6, 32768, v6
    v_add_u32 v8, 32768, v8
    v_add_u32 v9, 32768, v9
    v_add_u32 v10, 32768, v10
    v_add_u32 v11, 32768, v11
    v_mfma_f32_16x16x32_bf16 v[104:107], v[64:67], v[32:35], v[104:107]
    ds_read_b64_tr_b16 v[48:49], v8 offset:0
    v_mfma_f32_16x16x32_bf16 v[108:111], v[64:67], v[36:39], v[108:111]
    ds_read_b64_tr_b16 v[50:51], v8 offset:2048
    v_mfma_f32_16x16x32_bf16 v[112:115], v[64:67], v[40:43], v[112:115]
    ds_read_b128 v[16:19], v12 offset:0
    v_mfma_f32_16x16x32_bf16 v[116:119], v[64:67], v[44:47], v[116:119]
    ds_read_b128 v[20:23], v12 offset:2048
    v_mfma_f32_16x16x32_bf16 v[120:123], v[68:71], v[32:35], v[120:123]
    ds_read_b128 v[24:27], v12 offset:4096
    v_mfma_f32_16x16x32_bf16 v[124:127], v[68:71], v[36:39], v[124:127]
    ds_read_b128 v[28:31], v12 offset:6144
    v_mfma_f32_16x16x32_bf16 v[128:131], v[68:71], v[40:43], v[128:131]
    ds_read_b64_tr_b16 v[52:53], v9 offset:0
    v_mfma_f32_16x16x32_bf16 v[132:135], v[68:71], v[44:47], v[132:135]
    ds_read_b64_tr_b16 v[54:55], v9 offset:2048
    v_mfma_f32_16x16x32_bf16 v[136:139], v[72:75], v[32:35], v[136:139]
    ds_read_b64_tr_b16 v[56:57], v10 offset:0
    v_mfma_f32_16x16x32_bf16 v[140:143], v[72:75], v[36:39], v[140:143]
    ds_read_b64_tr_b16 v[58:59], v10 offset:2048
    v_mfma_f32_16x16x32_bf16 v[144:147], v[72:75], v[40:43], v[144:147]
    ds_read_b64_tr_b16 v[60:61], v11 offset:0
    v_mfma_f32_16x16x32_bf16 v[148:151], v[72:75], v[44:47], v[148:151]
    ds_read_b64_tr_b16 v[62:63], v11 offset:2048
    v_mfma_f32_16x16x32_bf16 v[152:155], v[76:79], v[32:35], v[152:155]
    v_mfma_f32_16x16x32_bf16 v[156:159], v[76:79], v[36:39], v[156:159]
    v_mfma_f32_16x16x32_bf16 v[160:163], v[76:79], v[40:43], v[160:163]
    v_mfma_f32_16x16x32_bf16 v[164:167], v[76:79], v[44:47], v[164:167]
    s_waitcnt lgkmcnt(0)
    v_mfma_f32_16x16x32_bf16 v[104:107], v[48:51], v[16:19], v[104:107]
    ds_read_b64_tr_b16 v[64:65], v8 offset:4096
    v_mfma_f32_16x16x32_bf16 v[108:111], v[48:51], v[20:23], v[108:111]
    ds_read_b64_tr_b16 v[66:67], v8 offset:6144
    v_mfma_f32_16x16x32_bf16 v[112:115], v[48:51], v[24:27], v[112:115]
    ds_read_b128 v[32:35], v6 offset:0
    v_mfma_f32_16x16x32_bf16 v[116:119], v[48:51], v[28:31], v[116:119]
    ds_read_b128 v[36:39], v6 offset:2048
    v_mfma_f32_16x16x32_bf16 v[120:123], v[52:55], v[16:19], v[120:123]
    ds_read_b128 v[40:43], v6 offset:4096
    v_mfma_f32_16x16x32_bf16 v[124:127], v[52:55], v[20:23], v[124:127]
    ds_read_b128 v[44:47], v6 offset:6144
    v_mfma_f32_16x16x32_bf16 v[128:131], v[52:55], v[24:27], v[128:131]
    ds_read_b64_tr_b16 v[68:69], v9 offset:4096
    v_mfma_f32_16x16x32_bf16 v[132:135], v[52:55], v[28:31], v[132:135]
    ds_read_b64_tr_b16 v[70:71], v9 offset:6144
    v_mfma_f32_16x16x32_bf16 v[136:139], v[56:59], v[16:19], v[136:139]
    ds_read_b64_tr_b16 v[72:73], v10 offset:4096
    v_mfma_f32_16x16x32_bf16 v[140:143], v[56:59], v[20:23], v[140:143]
    ds_read_b64_tr_b16 v[74:75], v10 offset:6144
    v_mfma_f32_16x16x32_bf16 v[144:147], v[56:59], v[24:27], v[144:147]
    ds_read_b64_tr_b16 v[76:77], v11 offset:4096
    v_mfma_f32_16x16x32_bf16 v[148:151], v[56:59], v[28:31], v[148:151]
    ds_read_b64_tr_b16 v[78:79], v11 offset:6144
    v_mfma_f32_16x16x32_bf16 v[152:155], v[60:63], v[16:19], v[152:155]
    v_mfma_f32_16x16x32_bf16 v[156:159], v[60:63], v[20:23], v[156:159]
    v_mfma_f32_16x16x32_bf16 v[160:163], v[60:63], v[24:27], v[160:163]
    v_mfma_f32_16x16x32_bf16 v[164:167], v[60:63], v[28:31], v[164:167]
    s_waitcnt  lgkmcnt(0)
    v_mfma_f32_16x16x32_bf16 v[104:107], v[64:67], v[32:35], v[104:107]
    v_mfma_f32_16x16x32_bf16 v[108:111], v[64:67], v[36:39], v[108:111]
    v_mfma_f32_16x16x32_bf16 v[112:115], v[64:67], v[40:43], v[112:115]
    v_mfma_f32_16x16x32_bf16 v[116:119], v[64:67], v[44:47], v[116:119]
    v_mfma_f32_16x16x32_bf16 v[120:123], v[68:71], v[32:35], v[120:123]
    v_mfma_f32_16x16x32_bf16 v[124:127], v[68:71], v[36:39], v[124:127]
    v_mfma_f32_16x16x32_bf16 v[128:131], v[68:71], v[40:43], v[128:131]
    v_mfma_f32_16x16x32_bf16 v[132:135], v[68:71], v[44:47], v[132:135]
    v_mfma_f32_16x16x32_bf16 v[136:139], v[72:75], v[32:35], v[136:139]
    v_mfma_f32_16x16x32_bf16 v[140:143], v[72:75], v[36:39], v[140:143]
    v_mfma_f32_16x16x32_bf16 v[144:147], v[72:75], v[40:43], v[144:147]
    v_mfma_f32_16x16x32_bf16 v[148:151], v[72:75], v[44:47], v[148:151]
    v_mfma_f32_16x16x32_bf16 v[152:155], v[76:79], v[32:35], v[152:155]
    v_mfma_f32_16x16x32_bf16 v[156:159], v[76:79], v[36:39], v[156:159]
    v_mfma_f32_16x16x32_bf16 v[160:163], v[76:79], v[40:43], v[160:163]
    v_mfma_f32_16x16x32_bf16 v[164:167], v[76:79], v[44:47], v[164:167]
    s_waitcnt lgkmcnt(0)
    v_cvt_pk_bf16_f32 v16, v104, v105
    v_cvt_pk_bf16_f32 v17, v106, v107
    v_cvt_pk_bf16_f32 v18, v120, v121
    v_cvt_pk_bf16_f32 v19, v122, v123
    v_cvt_pk_bf16_f32 v20, v136, v137
    v_cvt_pk_bf16_f32 v21, v138, v139
    v_cvt_pk_bf16_f32 v22, v152, v153
    v_cvt_pk_bf16_f32 v23, v154, v155
    v_permlane16_swap_b32 v16, v18
    v_permlane16_swap_b32 v17, v19
    v_permlane16_swap_b32 v20, v22
    v_permlane16_swap_b32 v21, v23
    buffer_store_dwordx4 v[16:19], v5, s[12:15], s57 offen offset:0 sc1
    buffer_store_dwordx4 v[20:23], v5, s[12:15], s57 offen offset:64 sc1
    s_add_u32 s57, s57, 32768
    v_cvt_pk_bf16_f32 v24, v108, v109
    v_cvt_pk_bf16_f32 v25, v110, v111
    v_cvt_pk_bf16_f32 v26, v124, v125
    v_cvt_pk_bf16_f32 v27, v126, v127
    v_cvt_pk_bf16_f32 v28, v140, v141
    v_cvt_pk_bf16_f32 v29, v142, v143
    v_cvt_pk_bf16_f32 v30, v156, v157
    v_cvt_pk_bf16_f32 v31, v158, v159
    v_permlane16_swap_b32 v24, v26
    v_permlane16_swap_b32 v25, v27
    v_permlane16_swap_b32 v28, v30
    v_permlane16_swap_b32 v29, v31
    buffer_store_dwordx4 v[24:27], v5, s[12:15], s57 offen offset:0 sc1
    buffer_store_dwordx4 v[28:31], v5, s[12:15], s57 offen offset:64 sc1
    s_add_u32 s57, s57, 32768
    v_cvt_pk_bf16_f32 v32, v112, v113
    v_cvt_pk_bf16_f32 v33, v114, v115
    v_cvt_pk_bf16_f32 v34, v128, v129
    v_cvt_pk_bf16_f32 v35, v130, v131
    v_cvt_pk_bf16_f32 v36, v144, v145
    v_cvt_pk_bf16_f32 v37, v146, v147
    v_cvt_pk_bf16_f32 v38, v160, v161
    v_cvt_pk_bf16_f32 v39, v162, v163
    v_permlane16_swap_b32 v32, v34
    v_permlane16_swap_b32 v33, v35
    v_permlane16_swap_b32 v36, v38
    v_permlane16_swap_b32 v37, v39
    buffer_store_dwordx4 v[32:35], v5, s[12:15], s57 offen offset:0 sc1
    buffer_store_dwordx4 v[36:39], v5, s[12:15], s57 offen offset:64 sc1
    s_add_u32 s57, s57, 32768
    v_cvt_pk_bf16_f32 v40, v116, v117
    v_cvt_pk_bf16_f32 v41, v118, v119
    v_cvt_pk_bf16_f32 v42, v132, v133
    v_cvt_pk_bf16_f32 v43, v134, v135
    v_cvt_pk_bf16_f32 v44, v148, v149
    v_cvt_pk_bf16_f32 v45, v150, v151
    v_cvt_pk_bf16_f32 v46, v164, v165
    v_cvt_pk_bf16_f32 v47, v166, v167
    v_permlane16_swap_b32 v40, v42
    v_permlane16_swap_b32 v41, v43
    v_permlane16_swap_b32 v44, v46
    v_permlane16_swap_b32 v45, v47
    buffer_store_dwordx4 v[40:43], v5, s[12:15], s57 offen offset:0 sc1
    buffer_store_dwordx4 v[44:47], v5, s[12:15], s57 offen offset:64 sc1
    s_add_u32 s57, s57, 32768
    s_waitcnt vmcnt(0)
    s_mov_b64 exec, 1
    ds_add_rtn_u32 v2, v7, v3 offset:8
    s_waitcnt lgkmcnt(0)
    v_cmp_eq_u32 vcc, 3, v2
    s_and_b64 exec, exec, vcc
    s_cbranch_execz gated__nsx
    buffer_store_dword v3, v1, s[12:15], s37 offen offset:64 sc1
gated__nsx:
    s_mov_b64 exec, -1
    s_endpgm
gated__gslow:
    s_add_u32 s61, s59, 0
    s_add_u32 s62, s61, 4096
    v_pk_mul_f32 v[16:17], v[104:105], v[104:105]
    v_pk_mul_f32 v[18:19], v[106:107], v[106:107]
    v_pk_mul_f32 v[20:21], v[120:121], v[120:121]
    v_pk_mul_f32 v[22:23], v[122:123], v[122:123]
    v_pk_fma_f32 v[16:17], v[16:17], s[44:45], v[8:9]
    v_pk_fma_f32 v[18:19], v[18:19], s[44:45], v[8:9]
    v_pk_fma_f32 v[20:21], v[20:21], s[44:45], v[8:9]
    v_pk_fma_f32 v[22:23], v[22:23], s[44:45], v[8:9]
    v_pk_mul_f32 v[16:17], v[16:17], v[104:105]
    v_pk_mul_f32 v[18:19], v[18:19], v[106:107]
    v_pk_mul_f32 v[20:21], v[20:21], v[120:121]
    v_pk_mul_f32 v[22:23], v[22:23], v[122:123]
    v_exp_f32 v16, v16
    v_exp_f32 v17, v17
    v_exp_f32 v18, v18
    v_exp_f32 v19, v19
    v_exp_f32 v20, v20
    v_exp_f32 v21, v21
    v_exp_f32 v22, v22
    v_exp_f32 v23, v23
    v_pk_add_f32 v[16:17], v[16:17], 1.0 op_sel_hi:[1,0]
    v_pk_add_f32 v[18:19], v[18:19], 1.0 op_sel_hi:[1,0]
    v_pk_add_f32 v[20:21], v[20:21], 1.0 op_sel_hi:[1,0]
    v_pk_add_f32 v[22:23], v[22:23], 1.0 op_sel_hi:[1,0]
    v_rcp_f32 v16, v16
    v_rcp_f32 v17, v17
    v_rcp_f32 v18, v18
    v_rcp_f32 v19, v19
    v_rcp_f32 v20, v20
    v_rcp_f32 v21, v21
    v_rcp_f32 v22, v22
    v_rcp_f32 v23, v23
    v_pk_mul_f32 v[16:17], v[16:17], v[104:105]
    v_pk_mul_f32 v[18:19], v[18:19], v[106:107]
    v_pk_mul_f32 v[20:21], v[20:21], v[120:121]
    v_pk_mul_f32 v[22:23], v[22:23], v[122:123]
    v_cvt_pk_bf16_f32 v48, v16, v17
    v_cvt_pk_bf16_f32 v49, v18, v19
    v_cvt_pk_bf16_f32 v50, v20, v21
    v_cvt_pk_bf16_f32 v51, v22, v23
    buffer_store_dwordx4 v[48:51], v10, s[12:15], s61 offen offset:0 sc1
    v_pk_mul_f32 v[24:25], v[108:109], v[108:109]
    v_pk_mul_f32 v[26:27], v[110:111], v[110:111]
    v_pk_mul_f32 v[28:29], v[124:125], v[124:125]
    v_pk_mul_f32 v[30:31], v[126:127], v[126:127]
    v_pk_fma_f32 v[24:25], v[24:25], s[44:45], v[8:9]
    v_pk_fma_f32 v[26:27], v[26:27], s[44:45], v[8:9]
    v_pk_fma_f32 v[28:29], v[28:29], s[44:45], v[8:9]
    v_pk_fma_f32 v[30:31], v[30:31], s[44:45], v[8:9]
    v_pk_mul_f32 v[24:25], v[24:25], v[108:109]
    v_pk_mul_f32 v[26:27], v[26:27], v[110:111]
    v_pk_mul_f32 v[28:29], v[28:29], v[124:125]
    v_pk_mul_f32 v[30:31], v[30:31], v[126:127]
    v_exp_f32 v24, v24
    v_exp_f32 v25, v25
    v_exp_f32 v26, v26
    v_exp_f32 v27, v27
    v_exp_f32 v28, v28
    v_exp_f32 v29, v29
    v_exp_f32 v30, v30
    v_exp_f32 v31, v31
    v_pk_add_f32 v[24:25], v[24:25], 1.0 op_sel_hi:[1,0]
    v_pk_add_f32 v[26:27], v[26:27], 1.0 op_sel_hi:[1,0]
    v_pk_add_f32 v[28:29], v[28:29], 1.0 op_sel_hi:[1,0]
    v_pk_add_f32 v[30:31], v[30:31], 1.0 op_sel_hi:[1,0]
    v_rcp_f32 v24, v24
    v_rcp_f32 v25, v25
    v_rcp_f32 v26, v26
    v_rcp_f32 v27, v27
    v_rcp_f32 v28, v28
    v_rcp_f32 v29, v29
    v_rcp_f32 v30, v30
    v_rcp_f32 v31, v31
    v_pk_mul_f32 v[24:25], v[24:25], v[108:109]
    v_pk_mul_f32 v[26:27], v[26:27], v[110:111]
    v_pk_mul_f32 v[28:29], v[28:29], v[124:125]
    v_pk_mul_f32 v[30:31], v[30:31], v[126:127]
    v_cvt_pk_bf16_f32 v52, v24, v25
    v_cvt_pk_bf16_f32 v53, v26, v27
    v_cvt_pk_bf16_f32 v54, v28, v29
    v_cvt_pk_bf16_f32 v55, v30, v31
    buffer_store_dwordx4 v[52:55], v10, s[12:15], s61 offen offset:2048 sc1
    v_pk_mul_f32 v[16:17], v[112:113], v[112:113]
    v_pk_mul_f32 v[18:19], v[114:115], v[114:115]
    v_pk_mul_f32 v[20:21], v[128:129], v[128:129]
    v_pk_mul_f32 v[22:23], v[130:131], v[130:131]
    v_pk_fma_f32 v[16:17], v[16:17], s[44:45], v[8:9]
    v_pk_fma_f32 v[18:19], v[18:19], s[44:45], v[8:9]
    v_pk_fma_f32 v[20:21], v[20:21], s[44:45], v[8:9]
    v_pk_fma_f32 v[22:23], v[22:23], s[44:45], v[8:9]
    v_pk_mul_f32 v[16:17], v[16:17], v[112:113]
    v_pk_mul_f32 v[18:19], v[18:19], v[114:115]
    v_pk_mul_f32 v[20:21], v[20:21], v[128:129]
    v_pk_mul_f32 v[22:23], v[22:23], v[130:131]
    v_exp_f32 v16, v16
    v_exp_f32 v17, v17
    v_exp_f32 v18, v18
    v_exp_f32 v19, v19
    v_exp_f32 v20, v20
    v_exp_f32 v21, v21
    v_exp_f32 v22, v22
    v_exp_f32 v23, v23
    v_pk_add_f32 v[16:17], v[16:17], 1.0 op_sel_hi:[1,0]
    v_pk_add_f32 v[18:19], v[18:19], 1.0 op_sel_hi:[1,0]
    v_pk_add_f32 v[20:21], v[20:21], 1.0 op_sel_hi:[1,0]
    v_pk_add_f32 v[22:23], v[22:23], 1.0 op_sel_hi:[1,0]
    v_rcp_f32 v16, v16
    v_rcp_f32 v17, v17
    v_rcp_f32 v18, v18
    v_rcp_f32 v19, v19
    v_rcp_f32 v20, v20
    v_rcp_f32 v21, v21
    v_rcp_f32 v22, v22
    v_rcp_f32 v23, v23
    v_pk_mul_f32 v[16:17], v[16:17], v[112:113]
    v_pk_mul_f32 v[18:19], v[18:19], v[114:115]
    v_pk_mul_f32 v[20:21], v[20:21], v[128:129]
    v_pk_mul_f32 v[22:23], v[22:23], v[130:131]
    v_cvt_pk_bf16_f32 v56, v16, v17
    v_cvt_pk_bf16_f32 v57, v18, v19
    v_cvt_pk_bf16_f32 v58, v20, v21
    v_cvt_pk_bf16_f32 v59, v22, v23
    buffer_store_dwordx4 v[56:59], v10, s[12:15], s62 offen offset:0 sc1
    v_pk_mul_f32 v[24:25], v[116:117], v[116:117]
    v_pk_mul_f32 v[26:27], v[118:119], v[118:119]
    v_pk_mul_f32 v[28:29], v[132:133], v[132:133]
    v_pk_mul_f32 v[30:31], v[134:135], v[134:135]
    v_pk_fma_f32 v[24:25], v[24:25], s[44:45], v[8:9]
    v_pk_fma_f32 v[26:27], v[26:27], s[44:45], v[8:9]
    v_pk_fma_f32 v[28:29], v[28:29], s[44:45], v[8:9]
    v_pk_fma_f32 v[30:31], v[30:31], s[44:45], v[8:9]
    v_pk_mul_f32 v[24:25], v[24:25], v[116:117]
    v_pk_mul_f32 v[26:27], v[26:27], v[118:119]
    v_pk_mul_f32 v[28:29], v[28:29], v[132:133]
    v_pk_mul_f32 v[30:31], v[30:31], v[134:135]
    v_exp_f32 v24, v24
    v_exp_f32 v25, v25
    v_exp_f32 v26, v26
    v_exp_f32 v27, v27
    v_exp_f32 v28, v28
    v_exp_f32 v29, v29
    v_exp_f32 v30, v30
    v_exp_f32 v31, v31
    v_pk_add_f32 v[24:25], v[24:25], 1.0 op_sel_hi:[1,0]
    v_pk_add_f32 v[26:27], v[26:27], 1.0 op_sel_hi:[1,0]
    v_pk_add_f32 v[28:29], v[28:29], 1.0 op_sel_hi:[1,0]
    v_pk_add_f32 v[30:31], v[30:31], 1.0 op_sel_hi:[1,0]
    v_rcp_f32 v24, v24
    v_rcp_f32 v25, v25
    v_rcp_f32 v26, v26
    v_rcp_f32 v27, v27
    v_rcp_f32 v28, v28
    v_rcp_f32 v29, v29
    v_rcp_f32 v30, v30
    v_rcp_f32 v31, v31
    v_pk_mul_f32 v[24:25], v[24:25], v[116:117]
    v_pk_mul_f32 v[26:27], v[26:27], v[118:119]
    v_pk_mul_f32 v[28:29], v[28:29], v[132:133]
    v_pk_mul_f32 v[30:31], v[30:31], v[134:135]
    v_cvt_pk_bf16_f32 v60, v24, v25
    v_cvt_pk_bf16_f32 v61, v26, v27
    v_cvt_pk_bf16_f32 v62, v28, v29
    v_cvt_pk_bf16_f32 v63, v30, v31
    buffer_store_dwordx4 v[60:63], v10, s[12:15], s62 offen offset:2048 sc1
    s_add_u32 s61, s59, 16384
    s_add_u32 s62, s61, 4096
    v_pk_mul_f32 v[16:17], v[136:137], v[136:137]
    v_pk_mul_f32 v[18:19], v[138:139], v[138:139]
    v_pk_mul_f32 v[20:21], v[152:153], v[152:153]
    v_pk_mul_f32 v[22:23], v[154:155], v[154:155]
    v_pk_fma_f32 v[16:17], v[16:17], s[44:45], v[8:9]
    v_pk_fma_f32 v[18:19], v[18:19], s[44:45], v[8:9]
    v_pk_fma_f32 v[20:21], v[20:21], s[44:45], v[8:9]
    v_pk_fma_f32 v[22:23], v[22:23], s[44:45], v[8:9]
    v_pk_mul_f32 v[16:17], v[16:17], v[136:137]
    v_pk_mul_f32 v[18:19], v[18:19], v[138:139]
    v_pk_mul_f32 v[20:21], v[20:21], v[152:153]
    v_pk_mul_f32 v[22:23], v[22:23], v[154:155]
    v_exp_f32 v16, v16
    v_exp_f32 v17, v17
    v_exp_f32 v18, v18
    v_exp_f32 v19, v19
    v_exp_f32 v20, v20
    v_exp_f32 v21, v21
    v_exp_f32 v22, v22
    v_exp_f32 v23, v23
    v_pk_add_f32 v[16:17], v[16:17], 1.0 op_sel_hi:[1,0]
    v_pk_add_f32 v[18:19], v[18:19], 1.0 op_sel_hi:[1,0]
    v_pk_add_f32 v[20:21], v[20:21], 1.0 op_sel_hi:[1,0]
    v_pk_add_f32 v[22:23], v[22:23], 1.0 op_sel_hi:[1,0]
    v_rcp_f32 v16, v16
    v_rcp_f32 v17, v17
    v_rcp_f32 v18, v18
    v_rcp_f32 v19, v19
    v_rcp_f32 v20, v20
    v_rcp_f32 v21, v21
    v_rcp_f32 v22, v22
    v_rcp_f32 v23, v23
    v_pk_mul_f32 v[16:17], v[16:17], v[136:137]
    v_pk_mul_f32 v[18:19], v[18:19], v[138:139]
    v_pk_mul_f32 v[20:21], v[20:21], v[152:153]
    v_pk_mul_f32 v[22:23], v[22:23], v[154:155]
    v_cvt_pk_bf16_f32 v64, v16, v17
    v_cvt_pk_bf16_f32 v65, v18, v19
    v_cvt_pk_bf16_f32 v66, v20, v21
    v_cvt_pk_bf16_f32 v67, v22, v23
    buffer_store_dwordx4 v[64:67], v10, s[12:15], s61 offen offset:0 sc1
    v_pk_mul_f32 v[24:25], v[140:141], v[140:141]
    v_pk_mul_f32 v[26:27], v[142:143], v[142:143]
    v_pk_mul_f32 v[28:29], v[156:157], v[156:157]
    v_pk_mul_f32 v[30:31], v[158:159], v[158:159]
    v_pk_fma_f32 v[24:25], v[24:25], s[44:45], v[8:9]
    v_pk_fma_f32 v[26:27], v[26:27], s[44:45], v[8:9]
    v_pk_fma_f32 v[28:29], v[28:29], s[44:45], v[8:9]
    v_pk_fma_f32 v[30:31], v[30:31], s[44:45], v[8:9]
    v_pk_mul_f32 v[24:25], v[24:25], v[140:141]
    v_pk_mul_f32 v[26:27], v[26:27], v[142:143]
    v_pk_mul_f32 v[28:29], v[28:29], v[156:157]
    v_pk_mul_f32 v[30:31], v[30:31], v[158:159]
    v_exp_f32 v24, v24
    v_exp_f32 v25, v25
    v_exp_f32 v26, v26
    v_exp_f32 v27, v27
    v_exp_f32 v28, v28
    v_exp_f32 v29, v29
    v_exp_f32 v30, v30
    v_exp_f32 v31, v31
    v_pk_add_f32 v[24:25], v[24:25], 1.0 op_sel_hi:[1,0]
    v_pk_add_f32 v[26:27], v[26:27], 1.0 op_sel_hi:[1,0]
    v_pk_add_f32 v[28:29], v[28:29], 1.0 op_sel_hi:[1,0]
    v_pk_add_f32 v[30:31], v[30:31], 1.0 op_sel_hi:[1,0]
    v_rcp_f32 v24, v24
    v_rcp_f32 v25, v25
    v_rcp_f32 v26, v26
    v_rcp_f32 v27, v27
    v_rcp_f32 v28, v28
    v_rcp_f32 v29, v29
    v_rcp_f32 v30, v30
    v_rcp_f32 v31, v31
    v_pk_mul_f32 v[24:25], v[24:25], v[140:141]
    v_pk_mul_f32 v[26:27], v[26:27], v[142:143]
    v_pk_mul_f32 v[28:29], v[28:29], v[156:157]
    v_pk_mul_f32 v[30:31], v[30:31], v[158:159]
    v_cvt_pk_bf16_f32 v68, v24, v25
    v_cvt_pk_bf16_f32 v69, v26, v27
    v_cvt_pk_bf16_f32 v70, v28, v29
    v_cvt_pk_bf16_f32 v71, v30, v31
    buffer_store_dwordx4 v[68:71], v10, s[12:15], s61 offen offset:2048 sc1
    v_pk_mul_f32 v[16:17], v[144:145], v[144:145]
    v_pk_mul_f32 v[18:19], v[146:147], v[146:147]
    v_pk_mul_f32 v[20:21], v[160:161], v[160:161]
    v_pk_mul_f32 v[22:23], v[162:163], v[162:163]
    v_pk_fma_f32 v[16:17], v[16:17], s[44:45], v[8:9]
    v_pk_fma_f32 v[18:19], v[18:19], s[44:45], v[8:9]
    v_pk_fma_f32 v[20:21], v[20:21], s[44:45], v[8:9]
    v_pk_fma_f32 v[22:23], v[22:23], s[44:45], v[8:9]
    v_pk_mul_f32 v[16:17], v[16:17], v[144:145]
    v_pk_mul_f32 v[18:19], v[18:19], v[146:147]
    v_pk_mul_f32 v[20:21], v[20:21], v[160:161]
    v_pk_mul_f32 v[22:23], v[22:23], v[162:163]
    v_exp_f32 v16, v16
    v_exp_f32 v17, v17
    v_exp_f32 v18, v18
    v_exp_f32 v19, v19
    v_exp_f32 v20, v20
    v_exp_f32 v21, v21
    v_exp_f32 v22, v22
    v_exp_f32 v23, v23
    v_pk_add_f32 v[16:17], v[16:17], 1.0 op_sel_hi:[1,0]
    v_pk_add_f32 v[18:19], v[18:19], 1.0 op_sel_hi:[1,0]
    v_pk_add_f32 v[20:21], v[20:21], 1.0 op_sel_hi:[1,0]
    v_pk_add_f32 v[22:23], v[22:23], 1.0 op_sel_hi:[1,0]
    v_rcp_f32 v16, v16
    v_rcp_f32 v17, v17
    v_rcp_f32 v18, v18
    v_rcp_f32 v19, v19
    v_rcp_f32 v20, v20
    v_rcp_f32 v21, v21
    v_rcp_f32 v22, v22
    v_rcp_f32 v23, v23
    v_pk_mul_f32 v[16:17], v[16:17], v[144:145]
    v_pk_mul_f32 v[18:19], v[18:19], v[146:147]
    v_pk_mul_f32 v[20:21], v[20:21], v[160:161]
    v_pk_mul_f32 v[22:23], v[22:23], v[162:163]
    v_cvt_pk_bf16_f32 v72, v16, v17
    v_cvt_pk_bf16_f32 v73, v18, v19
    v_cvt_pk_bf16_f32 v74, v20, v21
    v_cvt_pk_bf16_f32 v75, v22, v23
    buffer_store_dwordx4 v[72:75], v10, s[12:15], s62 offen offset:0 sc1
    v_pk_mul_f32 v[24:25], v[148:149], v[148:149]
    v_pk_mul_f32 v[26:27], v[150:151], v[150:151]
    v_pk_mul_f32 v[28:29], v[164:165], v[164:165]
    v_pk_mul_f32 v[30:31], v[166:167], v[166:167]
    v_pk_fma_f32 v[24:25], v[24:25], s[44:45], v[8:9]
    v_pk_fma_f32 v[26:27], v[26:27], s[44:45], v[8:9]
    v_pk_fma_f32 v[28:29], v[28:29], s[44:45], v[8:9]
    v_pk_fma_f32 v[30:31], v[30:31], s[44:45], v[8:9]
    v_pk_mul_f32 v[24:25], v[24:25], v[148:149]
    v_pk_mul_f32 v[26:27], v[26:27], v[150:151]
    v_pk_mul_f32 v[28:29], v[28:29], v[164:165]
    v_pk_mul_f32 v[30:31], v[30:31], v[166:167]
    v_exp_f32 v24, v24
    v_exp_f32 v25, v25
    v_exp_f32 v26, v26
    v_exp_f32 v27, v27
    v_exp_f32 v28, v28
    v_exp_f32 v29, v29
    v_exp_f32 v30, v30
    v_exp_f32 v31, v31
    v_pk_add_f32 v[24:25], v[24:25], 1.0 op_sel_hi:[1,0]
    v_pk_add_f32 v[26:27], v[26:27], 1.0 op_sel_hi:[1,0]
    v_pk_add_f32 v[28:29], v[28:29], 1.0 op_sel_hi:[1,0]
    v_pk_add_f32 v[30:31], v[30:31], 1.0 op_sel_hi:[1,0]
    v_rcp_f32 v24, v24
    v_rcp_f32 v25, v25
    v_rcp_f32 v26, v26
    v_rcp_f32 v27, v27
    v_rcp_f32 v28, v28
    v_rcp_f32 v29, v29
    v_rcp_f32 v30, v30
    v_rcp_f32 v31, v31
    v_pk_mul_f32 v[24:25], v[24:25], v[148:149]
    v_pk_mul_f32 v[26:27], v[26:27], v[150:151]
    v_pk_mul_f32 v[28:29], v[28:29], v[164:165]
    v_pk_mul_f32 v[30:31], v[30:31], v[166:167]
    v_cvt_pk_bf16_f32 v76, v24, v25
    v_cvt_pk_bf16_f32 v77, v26, v27
    v_cvt_pk_bf16_f32 v78, v28, v29
    v_cvt_pk_bf16_f32 v79, v30, v31
    buffer_store_dwordx4 v[76:79], v10, s[12:15], s62 offen offset:2048 sc1
    s_add_u32 s61, s59, 32768
    s_add_u32 s62, s61, 4096
    v_pk_mul_f32 v[16:17], v[168:169], v[168:169]
    v_pk_mul_f32 v[18:19], v[170:171], v[170:171]
    v_pk_mul_f32 v[20:21], v[184:185], v[184:185]
    v_pk_mul_f32 v[22:23], v[186:187], v[186:187]
    v_pk_fma_f32 v[16:17], v[16:17], s[44:45], v[8:9]
    v_pk_fma_f32 v[18:19], v[18:19], s[44:45], v[8:9]
    v_pk_fma_f32 v[20:21], v[20:21], s[44:45], v[8:9]
    v_pk_fma_f32 v[22:23], v[22:23], s[44:45], v[8:9]
    v_pk_mul_f32 v[16:17], v[16:17], v[168:169]
    v_pk_mul_f32 v[18:19], v[18:19], v[170:171]
    v_pk_mul_f32 v[20:21], v[20:21], v[184:185]
    v_pk_mul_f32 v[22:23], v[22:23], v[186:187]
    v_exp_f32 v16, v16
    v_exp_f32 v17, v17
    v_exp_f32 v18, v18
    v_exp_f32 v19, v19
    v_exp_f32 v20, v20
    v_exp_f32 v21, v21
    v_exp_f32 v22, v22
    v_exp_f32 v23, v23
    v_pk_add_f32 v[16:17], v[16:17], 1.0 op_sel_hi:[1,0]
    v_pk_add_f32 v[18:19], v[18:19], 1.0 op_sel_hi:[1,0]
    v_pk_add_f32 v[20:21], v[20:21], 1.0 op_sel_hi:[1,0]
    v_pk_add_f32 v[22:23], v[22:23], 1.0 op_sel_hi:[1,0]
    v_rcp_f32 v16, v16
    v_rcp_f32 v17, v17
    v_rcp_f32 v18, v18
    v_rcp_f32 v19, v19
    v_rcp_f32 v20, v20
    v_rcp_f32 v21, v21
    v_rcp_f32 v22, v22
    v_rcp_f32 v23, v23
    v_pk_mul_f32 v[16:17], v[16:17], v[168:169]
    v_pk_mul_f32 v[18:19], v[18:19], v[170:171]
    v_pk_mul_f32 v[20:21], v[20:21], v[184:185]
    v_pk_mul_f32 v[22:23], v[22:23], v[186:187]
    v_cvt_pk_bf16_f32 v48, v16, v17
    v_cvt_pk_bf16_f32 v49, v18, v19
    v_cvt_pk_bf16_f32 v50, v20, v21
    v_cvt_pk_bf16_f32 v51, v22, v23
    buffer_store_dwordx4 v[48:51], v10, s[12:15], s61 offen offset:0 sc1
    v_pk_mul_f32 v[24:25], v[172:173], v[172:173]
    v_pk_mul_f32 v[26:27], v[174:175], v[174:175]
    v_pk_mul_f32 v[28:29], v[188:189], v[188:189]
    v_pk_mul_f32 v[30:31], v[190:191], v[190:191]
    v_pk_fma_f32 v[24:25], v[24:25], s[44:45], v[8:9]
    v_pk_fma_f32 v[26:27], v[26:27], s[44:45], v[8:9]
    v_pk_fma_f32 v[28:29], v[28:29], s[44:45], v[8:9]
    v_pk_fma_f32 v[30:31], v[30:31], s[44:45], v[8:9]
    v_pk_mul_f32 v[24:25], v[24:25], v[172:173]
    v_pk_mul_f32 v[26:27], v[26:27], v[174:175]
    v_pk_mul_f32 v[28:29], v[28:29], v[188:189]
    v_pk_mul_f32 v[30:31], v[30:31], v[190:191]
    v_exp_f32 v24, v24
    v_exp_f32 v25, v25
    v_exp_f32 v26, v26
    v_exp_f32 v27, v27
    v_exp_f32 v28, v28
    v_exp_f32 v29, v29
    v_exp_f32 v30, v30
    v_exp_f32 v31, v31
    v_pk_add_f32 v[24:25], v[24:25], 1.0 op_sel_hi:[1,0]
    v_pk_add_f32 v[26:27], v[26:27], 1.0 op_sel_hi:[1,0]
    v_pk_add_f32 v[28:29], v[28:29], 1.0 op_sel_hi:[1,0]
    v_pk_add_f32 v[30:31], v[30:31], 1.0 op_sel_hi:[1,0]
    v_rcp_f32 v24, v24
    v_rcp_f32 v25, v25
    v_rcp_f32 v26, v26
    v_rcp_f32 v27, v27
    v_rcp_f32 v28, v28
    v_rcp_f32 v29, v29
    v_rcp_f32 v30, v30
    v_rcp_f32 v31, v31
    v_pk_mul_f32 v[24:25], v[24:25], v[172:173]
    v_pk_mul_f32 v[26:27], v[26:27], v[174:175]
    v_pk_mul_f32 v[28:29], v[28:29], v[188:189]
    v_pk_mul_f32 v[30:31], v[30:31], v[190:191]
    v_cvt_pk_bf16_f32 v52, v24, v25
    v_cvt_pk_bf16_f32 v53, v26, v27
    v_cvt_pk_bf16_f32 v54, v28, v29
    v_cvt_pk_bf16_f32 v55, v30, v31
    buffer_store_dwordx4 v[52:55], v10, s[12:15], s61 offen offset:2048 sc1
    v_pk_mul_f32 v[16:17], v[176:177], v[176:177]
    v_pk_mul_f32 v[18:19], v[178:179], v[178:179]
    v_pk_mul_f32 v[20:21], v[192:193], v[192:193]
    v_pk_mul_f32 v[22:23], v[194:195], v[194:195]
    v_pk_fma_f32 v[16:17], v[16:17], s[44:45], v[8:9]
    v_pk_fma_f32 v[18:19], v[18:19], s[44:45], v[8:9]
    v_pk_fma_f32 v[20:21], v[20:21], s[44:45], v[8:9]
    v_pk_fma_f32 v[22:23], v[22:23], s[44:45], v[8:9]
    v_pk_mul_f32 v[16:17], v[16:17], v[176:177]
    v_pk_mul_f32 v[18:19], v[18:19], v[178:179]
    v_pk_mul_f32 v[20:21], v[20:21], v[192:193]
    v_pk_mul_f32 v[22:23], v[22:23], v[194:195]
    v_exp_f32 v16, v16
    v_exp_f32 v17, v17
    v_exp_f32 v18, v18
    v_exp_f32 v19, v19
    v_exp_f32 v20, v20
    v_exp_f32 v21, v21
    v_exp_f32 v22, v22
    v_exp_f32 v23, v23
    v_pk_add_f32 v[16:17], v[16:17], 1.0 op_sel_hi:[1,0]
    v_pk_add_f32 v[18:19], v[18:19], 1.0 op_sel_hi:[1,0]
    v_pk_add_f32 v[20:21], v[20:21], 1.0 op_sel_hi:[1,0]
    v_pk_add_f32 v[22:23], v[22:23], 1.0 op_sel_hi:[1,0]
    v_rcp_f32 v16, v16
    v_rcp_f32 v17, v17
    v_rcp_f32 v18, v18
    v_rcp_f32 v19, v19
    v_rcp_f32 v20, v20
    v_rcp_f32 v21, v21
    v_rcp_f32 v22, v22
    v_rcp_f32 v23, v23
    v_pk_mul_f32 v[16:17], v[16:17], v[176:177]
    v_pk_mul_f32 v[18:19], v[18:19], v[178:179]
    v_pk_mul_f32 v[20:21], v[20:21], v[192:193]
    v_pk_mul_f32 v[22:23], v[22:23], v[194:195]
    v_cvt_pk_bf16_f32 v56, v16, v17
    v_cvt_pk_bf16_f32 v57, v18, v19
    v_cvt_pk_bf16_f32 v58, v20, v21
    v_cvt_pk_bf16_f32 v59, v22, v23
    buffer_store_dwordx4 v[56:59], v10, s[12:15], s62 offen offset:0 sc1
    v_pk_mul_f32 v[24:25], v[180:181], v[180:181]
    v_pk_mul_f32 v[26:27], v[182:183], v[182:183]
    v_pk_mul_f32 v[28:29], v[196:197], v[196:197]
    v_pk_mul_f32 v[30:31], v[198:199], v[198:199]
    v_pk_fma_f32 v[24:25], v[24:25], s[44:45], v[8:9]
    v_pk_fma_f32 v[26:27], v[26:27], s[44:45], v[8:9]
    v_pk_fma_f32 v[28:29], v[28:29], s[44:45], v[8:9]
    v_pk_fma_f32 v[30:31], v[30:31], s[44:45], v[8:9]
    v_pk_mul_f32 v[24:25], v[24:25], v[180:181]
    v_pk_mul_f32 v[26:27], v[26:27], v[182:183]
    v_pk_mul_f32 v[28:29], v[28:29], v[196:197]
    v_pk_mul_f32 v[30:31], v[30:31], v[198:199]
    v_exp_f32 v24, v24
    v_exp_f32 v25, v25
    v_exp_f32 v26, v26
    v_exp_f32 v27, v27
    v_exp_f32 v28, v28
    v_exp_f32 v29, v29
    v_exp_f32 v30, v30
    v_exp_f32 v31, v31
    v_pk_add_f32 v[24:25], v[24:25], 1.0 op_sel_hi:[1,0]
    v_pk_add_f32 v[26:27], v[26:27], 1.0 op_sel_hi:[1,0]
    v_pk_add_f32 v[28:29], v[28:29], 1.0 op_sel_hi:[1,0]
    v_pk_add_f32 v[30:31], v[30:31], 1.0 op_sel_hi:[1,0]
    v_rcp_f32 v24, v24
    v_rcp_f32 v25, v25
    v_rcp_f32 v26, v26
    v_rcp_f32 v27, v27
    v_rcp_f32 v28, v28
    v_rcp_f32 v29, v29
    v_rcp_f32 v30, v30
    v_rcp_f32 v31, v31
    v_pk_mul_f32 v[24:25], v[24:25], v[180:181]
    v_pk_mul_f32 v[26:27], v[26:27], v[182:183]
    v_pk_mul_f32 v[28:29], v[28:29], v[196:197]
    v_pk_mul_f32 v[30:31], v[30:31], v[198:199]
    v_cvt_pk_bf16_f32 v60, v24, v25
    v_cvt_pk_bf16_f32 v61, v26, v27
    v_cvt_pk_bf16_f32 v62, v28, v29
    v_cvt_pk_bf16_f32 v63, v30, v31
    buffer_store_dwordx4 v[60:63], v10, s[12:15], s62 offen offset:2048 sc1
    s_add_u32 s62, s60, 4096
    v_pk_mul_f32 v[16:17], v[200:201], v[200:201]
    v_pk_mul_f32 v[18:19], v[202:203], v[202:203]
    v_pk_mul_f32 v[20:21], v[204:205], v[204:205]
    v_pk_mul_f32 v[22:23], v[206:207], v[206:207]
    v_pk_fma_f32 v[16:17], v[16:17], s[44:45], v[8:9]
    v_pk_fma_f32 v[18:19], v[18:19], s[44:45], v[8:9]
    v_pk_fma_f32 v[20:21], v[20:21], s[44:45], v[8:9]
    v_pk_fma_f32 v[22:23], v[22:23], s[44:45], v[8:9]
    v_pk_mul_f32 v[16:17], v[16:17], v[200:201]
    v_pk_mul_f32 v[18:19], v[18:19], v[202:203]
    v_pk_mul_f32 v[20:21], v[20:21], v[204:205]
    v_pk_mul_f32 v[22:23], v[22:23], v[206:207]
    v_exp_f32 v16, v16
    v_exp_f32 v17, v17
    v_exp_f32 v18, v18
    v_exp_f32 v19, v19
    v_exp_f32 v20, v20
    v_exp_f32 v21, v21
    v_exp_f32 v22, v22
    v_exp_f32 v23, v23
    v_pk_add_f32 v[16:17], v[16:17], 1.0 op_sel_hi:[1,0]
    v_pk_add_f32 v[18:19], v[18:19], 1.0 op_sel_hi:[1,0]
    v_pk_add_f32 v[20:21], v[20:21], 1.0 op_sel_hi:[1,0]
    v_pk_add_f32 v[22:23], v[22:23], 1.0 op_sel_hi:[1,0]
    v_rcp_f32 v16, v16
    v_rcp_f32 v17, v17
    v_rcp_f32 v18, v18
    v_rcp_f32 v19, v19
    v_rcp_f32 v20, v20
    v_rcp_f32 v21, v21
    v_rcp_f32 v22, v22
    v_rcp_f32 v23, v23
    v_pk_mul_f32 v[16:17], v[16:17], v[200:201]
    v_pk_mul_f32 v[18:19], v[18:19], v[202:203]
    v_pk_mul_f32 v[20:21], v[20:21], v[204:205]
    v_pk_mul_f32 v[22:23], v[22:23], v[206:207]
    v_cvt_pk_bf16_f32 v64, v16, v17
    v_cvt_pk_bf16_f32 v65, v18, v19
    v_cvt_pk_bf16_f32 v66, v20, v21
    v_cvt_pk_bf16_f32 v67, v22, v23
    buffer_store_dwordx2 v[64:65], v11, s[12:15], s60 offen offset:0 sc1
    buffer_store_dwordx2 v[66:67], v11, s[12:15], s60 offen offset:2048 sc1
    v_pk_mul_f32 v[24:25], v[208:209], v[208:209]
    v_pk_mul_f32 v[26:27], v[210:211], v[210:211]
    v_pk_mul_f32 v[28:29], v[212:213], v[212:213]
    v_pk_mul_f32 v[30:31], v[214:215], v[214:215]
    v_pk_fma_f32 v[24:25], v[24:25], s[44:45], v[8:9]
    v_pk_fma_f32 v[26:27], v[26:27], s[44:45], v[8:9]
    v_pk_fma_f32 v[28:29], v[28:29], s[44:45], v[8:9]
    v_pk_fma_f32 v[30:31], v[30:31], s[44:45], v[8:9]
    v_pk_mul_f32 v[24:25], v[24:25], v[208:209]
    v_pk_mul_f32 v[26:27], v[26:27], v[210:211]
    v_pk_mul_f32 v[28:29], v[28:29], v[212:213]
    v_pk_mul_f32 v[30:31], v[30:31], v[214:215]
    v_exp_f32 v24, v24
    v_exp_f32 v25, v25
    v_exp_f32 v26, v26
    v_exp_f32 v27, v27
    v_exp_f32 v28, v28
    v_exp_f32 v29, v29
    v_exp_f32 v30, v30
    v_exp_f32 v31, v31
    v_pk_add_f32 v[24:25], v[24:25], 1.0 op_sel_hi:[1,0]
    v_pk_add_f32 v[26:27], v[26:27], 1.0 op_sel_hi:[1,0]
    v_pk_add_f32 v[28:29], v[28:29], 1.0 op_sel_hi:[1,0]
    v_pk_add_f32 v[30:31], v[30:31], 1.0 op_sel_hi:[1,0]
    v_rcp_f32 v24, v24
    v_rcp_f32 v25, v25
    v_rcp_f32 v26, v26
    v_rcp_f32 v27, v27
    v_rcp_f32 v28, v28
    v_rcp_f32 v29, v29
    v_rcp_f32 v30, v30
    v_rcp_f32 v31, v31
    v_pk_mul_f32 v[24:25], v[24:25], v[208:209]
    v_pk_mul_f32 v[26:27], v[26:27], v[210:211]
    v_pk_mul_f32 v[28:29], v[28:29], v[212:213]
    v_pk_mul_f32 v[30:31], v[30:31], v[214:215]
    v_cvt_pk_bf16_f32 v68, v24, v25
    v_cvt_pk_bf16_f32 v69, v26, v27
    v_cvt_pk_bf16_f32 v70, v28, v29
    v_cvt_pk_bf16_f32 v71, v30, v31
    buffer_store_dwordx2 v[68:69], v11, s[12:15], s62 offen offset:0 sc1
    buffer_store_dwordx2 v[70:71], v11, s[12:15], s62 offen offset:2048 sc1
    s_branch gated__gdone
gated__s2slow:
    s_waitcnt vmcnt(12)
    s_mov_b64 exec, 1
    ds_add_rtn_u32 v2, v7, v3 offset:4
    s_waitcnt lgkmcnt(0)
    v_cmp_eq_u32 vcc, 3, v2
    s_and_b64 exec, exec, vcc
    s_cbranch_execz gated__nsd
    buffer_store_dword v3, v1, s[12:15], s37 offen offset:4 sc1
gated__nsd:
    s_mov_b64 exec, -1
    s_branch gated__s2done
gated__last:

.section .rodata,"a"
.p2align 8
.type fft_tab,@object
.size fft_tab, 108544
fft_tab:
.quad 0x3f803f803f803f80,0x3f803f803f803f80,0x3f553f6d3f7b3f80,0x3e483ec43f0e3f35,0x3ec43f353f6d3f80,0xbf6dbf35bec4248d,0xbe483ec43f553f80,0xbf0ebf6dbf7bbf35
.quad 0xbf35248d3f353f80,0x3f35a554bf35bf80,0xbf7bbec43f0e3f80,0x3f553f6d3e48bf35,0xbf6dbf353ec43f80,0xbec43f353f6da554,0xbf0ebf6d3e483f80,0xbf7bbec43f553f35
.quad 0xa554bf80248d3f80,0xa554bf80248d3f80,0x3f0ebf6dbe483f80,0x3f7bbec4bf553f35,0x3f6dbf35bec43f80,0x3ec43f35bf6d248d,0x3f7bbec4bf0e3f80,0xbf553f6dbe48bf35
.quad 0x3f35a554bf353f80,0xbf35248d3f35bf80,0x3e483ec4bf553f80,0x3f0ebf6d3f7bbf35,0xbec43f35bf6d3f80,0x3f6dbf353ec4a554,0xbf553f6dbf7b3f80,0xbe483ec4bf0e3f35
.quad 0x3f803f803f803f80,0x3f803f803f803f80,0xbf0ebec4be48248d,0xbf7bbf6dbf55bf35,0xbec4bf35bf6dbf80,0x3f6d3f353ec4a554,0x3f7b3f6d3f0ea554,0xbf55bec43e483f35
.quad 0xbf35248d3f353f80,0x3f35a554bf35bf80,0xbe48bf6dbf55248d,0xbf0e3ec43f7b3f35,0x3f6d3f35bec4bf80,0x3ec4bf35bf6d248d,0xbf553ec43f7ba554,0xbe483f6d3f0ebf35
.quad 0xa554bf80248d3f80,0xa554bf80248d3f80,0x3f553ec4bf7b248d,0x3e483f6dbf0ebf35,0xbf6d3f353ec4bf80,0xbec4bf353f6da554,0x3e48bf6d3f55a554,0x3f0e3ec4bf7b3f35
.quad 0x3f35a554bf353f80,0xbf35248d3f35bf80,0xbf7b3f6dbf0e248d,0x3f55bec4be483f35,0x3ec4bf353f6dbf80,0xbf6d3f35bec4248d,0x3f0ebec43e48a554,0x3f7bbf6d3f55bf35
.quad 0x3f803f803f803f80,0x3f803f803f803f80,0xbf55bf6dbf7bbf80,0xbe48bec4bf0ebf35,0x3ec43f353f6d3f80,0xbf6dbf35bec4248d,0x3e48bec4bf55bf80,0x3f0e3f6d3f7b3f35
.quad 0xbf35248d3f353f80,0x3f35a554bf35bf80,0x3f7b3ec4bf0ebf80,0xbf55bf6dbe483f35,0xbf6dbf353ec43f80,0xbec43f353f6da554,0x3f0e3f6dbe48bf80,0x3f7b3ec4bf55bf35
.quad 0xa554bf80248d3f80,0xa554bf80248d3f80,0xbf0e3f6d3e48bf80,0xbf7b3ec43f55bf35,0x3f6dbf35bec43f80,0x3ec43f35bf6d248d,0xbf7b3ec43f0ebf80,0x3f55bf6d3e483f35
.quad 0x3f35a554bf353f80,0xbf35248d3f35bf80,0xbe48bec43f55bf80,0xbf0e3f6dbf7b3f35,0xbec43f35bf6d3f80,0x3f6dbf353ec4a554,0x3f55bf6d3f7bbf80,0x3e48bec43f0ebf35
.quad 0x3f803f803f803f80,0x3f803f803f803f80,0x3f0e3ec43e48a554,0x3f7b3f6d3f553f35,0xbec4bf35bf6dbf80,0x3f6d3f353ec4a554,0xbf7bbf6dbf0e248d,0x3f553ec4be48bf35
.quad 0xbf35248d3f353f80,0x3f35a554bf35bf80,0x3e483f6d3f55a554,0x3f0ebec4bf7bbf35,0x3f6d3f35bec4bf80,0x3ec4bf35bf6d248d,0x3f55bec4bf7b248d,0x3e48bf6dbf0e3f35
.quad 0xa554bf80248d3f80,0xa554bf80248d3f80,0xbf55bec43f7ba554,0xbe48bf6d3f0e3f35,0xbf6d3f353ec4bf80,0xbec4bf353f6da554,0xbe483f6dbf55248d,0xbf0ebec43f7bbf35
.quad 0x3f35a554bf353f80,0xbf35248d3f35bf80,0x3f7bbf6d3f0ea554,0xbf553ec43e48bf35,0x3ec4bf353f6dbf80,0xbf6d3f35bec4248d,0xbf0e3ec4be48248d,0xbf7b3f6dbf553f35
.quad 0xbf803f80bf803f80,0xbf803f80bf803f80,0xbf0ebec4be488000,0xbf7bbf6dbf55bf35,0xbf6dbf35bec48000,0xbec4bf35bf6dbf80,0xbf7bbf6dbf0e8000,0x3f553ec4be48bf35
.quad 0xbf35bf80bf358000,0x3f353f803f35a50d,0xbe48bf6dbf558000,0xbf0e3ec43f7b3f35,0x3ec4bf35bf6d8000,0xbf6dbf353ec43f80,0x3f55bec4bf7b8000,0x3e48bf6dbf0e3f35
.quad 0x3f80a50dbf808000,0x3f80a50dbf808000,0x3f553ec4bf7b8000,0x3e483f6dbf0ebf35,0x3ec43f35bf6d8000,0xbf6d3f353ec4bf80,0xbe483f6dbf558000,0xbf0ebec43f7bbf35
.quad 0xbf353f80bf358000,0x3f35bf803f35a50d,0xbf7b3f6dbf0e8000,0x3f55bec4be483f35,0xbf6d3f35bec48000,0xbec43f35bf6d3f80,0xbf0e3ec4be488000,0xbf7b3f6dbf553f35
.quad 0xbf803f80bf803f80,0xbf803f80bf803f80,0xbf55bf6dbf7bbf80,0xbe48bec4bf0ebf35,0x3f6d3f353ec4a50d,0x3ec43f353f6d3f80,0xbe483ec43f553f80,0xbf0ebf6dbf7bbf35
.quad 0xbf35bf80bf358000,0x3f353f803f35a50d,0x3f7b3ec4bf0ebf80,0xbf55bf6dbe483f35,0xbec43f353f6da50d,0x3f6d3f35bec4bf80,0xbf0ebf6d3e483f80,0xbf7bbec43f553f35
.quad 0x3f80a50dbf808000,0x3f80a50dbf808000,0xbf0e3f6d3e48bf80,0xbf7b3ec43f55bf35,0xbec4bf353f6da50d,0x3f6dbf35bec43f80,0x3f7bbec4bf0e3f80,0xbf553f6dbe48bf35
.quad 0xbf353f80bf358000,0x3f35bf803f35a50d,0xbe48bec43f55bf80,0xbf0e3f6dbf7b3f35,0x3f6dbf353ec4a50d,0x3ec4bf353f6dbf80,0xbf553f6dbf7b3f80,0xbe483ec4bf0e3f35
.quad 0xbf803f80bf803f80,0xbf803f80bf803f80,0x3f0e3ec43e48a50d,0x3f7b3f6d3f553f35,0xbf6dbf35bec48000,0xbec4bf35bf6dbf80,0x3f7b3f6d3f0ea50d,0xbf55bec43e483f35
.quad 0xbf35bf80bf358000,0x3f353f803f35a50d,0x3e483f6d3f55a50d,0x3f0ebec4bf7bbf35,0x3ec4bf35bf6d8000,0xbf6dbf353ec43f80,0xbf553ec43f7ba50d,0xbe483f6d3f0ebf35
.quad 0x3f80a50dbf808000,0x3f80a50dbf808000,0xbf55bec43f7ba50d,0xbe48bf6d3f0e3f35,0x3ec43f35bf6d8000,0xbf6d3f353ec4bf80,0x3e48bf6d3f55a50d,0x3f0e3ec4bf7b3f35
.quad 0xbf353f80bf358000,0x3f35bf803f35a50d,0x3f7bbf6d3f0ea50d,0xbf553ec43e48bf35,0xbf6d3f35bec48000,0xbec43f35bf6d3f80,0x3f0ebec43e48a50d,0x3f7bbf6d3f55bf35
.quad 0xbf803f80bf803f80,0xbf803f80bf803f80,0x3f553f6d3f7b3f80,0x3e483ec43f0e3f35,0x3f6d3f353ec4a50d,0x3ec43f353f6d3f80,0x3e48bec4bf55bf80,0x3f0e3f6d3f7b3f35
.quad 0xbf35bf80bf358000,0x3f353f803f35a50d,0xbf7bbec43f0e3f80,0x3f553f6d3e48bf35,0xbec43f353f6da50d,0x3f6d3f35bec4bf80,0x3f0e3f6dbe48bf80,0x3f7b3ec4bf55bf35
.quad 0x3f80a50dbf808000,0x3f80a50dbf808000,0x3f0ebf6dbe483f80,0x3f7bbec4bf553f35,0xbec4bf353f6da50d,0x3f6dbf35bec43f80,0xbf7b3ec43f0ebf80,0x3f55bf6d3e483f35
.quad 0xbf353f80bf358000,0x3f35bf803f35a50d,0x3e483ec4bf553f80,0x3f0ebf6d3f7bbf35,0x3f6dbf353ec4a50d,0x3ec4bf353f6dbf80,0x3f55bf6d3f7bbf80,0x3e48bec43f0ebf35
.quad 0x3f8000003f800000,0x3f8000003f800000,0x3f7ffec43f800000,0x3f7ff4e63f7ffb11,0x3f7ffb113f800000,0x3f7fd3973f7fec43,0x3f7ff4e63f800000,0x3f7f9c183f7fd397
.quad 0x3f7fec433f800000,0x3f7f4e6d3f7fb10f,0x3f7fe1293f800000,0x3f7eea9d3f7f84ab,0x3f7fd3973f800000,0x3f7e70b03f7f4e6d,0x3f7fc38f3f800000,0x3f7de0b13f7f0e58
.quad 0x3f7fb10f3f800000,0x3f7d3aac3f7ec46d,0x3f7f9c183f800000,0x3f7c7eb03f7e70b0,0x3f7f84ab3f800000,0x3f7baccd3f7e1324,0x3f7f6ac73f800000,0x3f7ac5163f7dabcc
.quad 0x3f7f4e6d3f800000,0x3f79c79d3f7d3aac,0x3f7f2f9d3f800000,0x3f78b47b3f7cbfc9,0x3f7f0e583f800000,0x3f778bc53f7c3b28,0x3f7eea9d3f800000,0x3f764d973f7baccd
.quad 0x3f8000003f800000,0x3f8000003f800000,0x3f7fe1293f7fec43,0x3f7fc38f3f7fd397,0x3f7f84ab3f7fb10f,0x3f7f0e583f7f4e6d,0x3f7eea9d3f7f4e6d,0x3f7de0b13f7e70b0
.quad 0x3f7e13243f7ec46d,0x3f7c3b283f7d3aac,0x3f7cfe733f7e1324,0x3f7a1e843f7baccd,0x3f7baccd3f7d3aac,0x3f778bc53f79c79d,0x3f7a1e843f7c3b28,0x3f7484223f778bc5
.quad 0x3f7853f83f7b14be,0x3f7109083f74fa0b,0x3f764d973f79c79d,0x3f6d1c1d3f721352,0x3f740bdd3f7853f8,0x3f68bf3c3f6ed89e,0x3f718f573f76ba07,0x3f63f4733f6b4b0c
.quad 0x3f6ed89e3f74fa0b,0x3f5ebe053f676bd8,0x3f6be8583f731447,0x3f591e6a3f633c5a,0x3f68bf3c3f710908,0x3f5318493f5ebe05,0x3f655e0b3f6ed89e,0x3f4cae793f59f26a
.quad 0x3f8000003f800000,0x3f8000003f800000,0x3f7f9c183f7fb10f,0x3f7f6ac73f7f84ab,0x3f7e70b03f7ec46d,0x3f7dabcc3f7e1324,0x3f7c7eb03f7d3aac,0x3f7ac5163f7baccd
.quad 0x3f79c79d3f7b14be,0x3f76ba073f7853f8,0x3f764d973f7853f8,0x3f718f573f740bdd,0x3f7213523f74fa0b,0x3f6b4b0c3f6ed89e,0x3f6d1c1d3f710908,0x3f63f4733f68bf3c
.quad 0x3f676bd83f6c835e,0x3f5b941a3f61c598,0x3f6106f23f676bd8,0x3f5233c63f59f26a,0x3f59f26a3f61c598,0x3f47de653f514d3d,0x3f5233c63f5b941a,0x3f3ca0033f47de65
.quad 0x3f49d1123f54db31,0x3f3085bb3f3daef9,0x3f40d0da3f4d9f02,0x3f239da93f32c8c9,0x3f373a233f45e403,0x3f15f6d93f273656,0x3f2d14693f3daef9,0x3f07a1363f1b02c6
.quad 0x3f8000003f800000,0x3f8000003f800000,0x3f7f2f9d3f7f4e6d,0x3f7eea9d3f7f0e58,0x3f7cbfc93f7d3aac,0x3f7baccd3f7c3b28,0x3f78b47b3f79c79d,0x3f764d973f778bc5
.quad 0x3f7314473f74fa0b,0x3f6ed89e3f710908,0x3f6be8583f6ed89e,0x3f655e0b3f68bf3c,0x3f633c5a3f676bd8,0x3f59f26a3f5ebe05,0x3f591e6a3f5ebe05,0x3f4cae793f531849
.quad 0x3f4d9f023f54db31,0x3f3daef93f45e403,0x3f40d0da3f49d112,0x3f2d14693f373a23,0x3f32c8c93f3daef9,0x3f1b02c63f273656,0x3f239da93f3085bb,0x3f07a1363f15f6d9
.quad 0x3f13682a3f226799,0x3ee633753f039c3d,0x3f0242b13f13682a,0x3ebb31a03ee0924f,0x3ee0924f3f039c3d,0x3e8e9a223eb8442a,0x3ebb31a03ee63375,0x3e419b373e8e9a22
.quad 0x8000000080000000,0x8000000080000000,0xbbc90f8880000000,0xbc96c9b6bc490e90,0xbc490e9080000000,0xbd16c32cbcc90ab0,0xbc96c9b680000000,0xbd621469bd16c32c
.quad 0xbcc90ab080000000,0xbd96a905bd48fb30,0xbcfb49ba80000000,0xbdbc3ac3bd7b2b74,0xbd16c32c80000000,0xbde1bc2ebd96a905,0xbd2fe00780000000,0xbe039502bdafb680
.quad 0xbd48fb3080000000,0xbe164083bdc8bd36,0xbd62146980000000,0xbe28defcbde1bc2e,0xbd7b2b7480000000,0xbe3b6ecfbdfab273,0xbd8a200a80000000,0xbe4dee60be09cf86
.quad 0xbd96a90580000000,0xbe605c13be164083,0xbda3308c80000000,0xbe72b651be22abb6,0xbdafb68080000000,0xbe827dc0be2f10a2,0xbdbc3ac380000000,0xbe8b9507be3b6ecf
.quad 0x8000000080000000,0x8000000080000000,0xbcfb49babcc90ab0,0xbd2fe007bd16c32c,0xbd7b2b74bd48fb30,0xbdafb680bd96a905,0xbdbc3ac3bd96a905,0xbe039502bde1bc2e
.quad 0xbdfab273bdc8bd36,0xbe2f10a2be164083,0xbe1c76debdfab273,0xbe5a3997be3b6ecf,0xbe3b6ecfbe164083,0xbe827dc0be605c13,0xbe5a3997be2f10a2,0xbe97a117be827dc0
.quad 0xbe78cfccbe47c5c2,0xbeac7cd4be94a031,0xbe8b9507be605c13,0xbec1071ebea68f12,0xbe9aa086be78cfcc,0xbed53641beb8442a,0xbea986c4be888e93,0xbee900b7bec9b953
.quad 0xbeb8442abe94a031,0xbefc5d27bedae880,0xbec6d529bea09ae5,0xbf07a136beebcbbb,0xbed53641beac7cd4,0xbf10d3cdbefc5d27,0xbee363fabeb8442a,0xbf19c200bf064b82
.quad 0x8000000080000000,0x8000000080000000,0xbd621469bd48fb30,0xbd8a200abd7b2b74,0xbde1bc2ebdc8bd36,0xbe09cf86bdfab273,0xbe28defcbe164083,0xbe4dee60be3b6ecf
.quad 0xbe605c13be47c5c2,0xbe888e93be78cfcc,0xbe8b9507be78cfcc,0xbea986c4be9aa086,0xbea68f12be94a031,0xbec9b953beb8442a,0xbec1071ebeac7cd4,0xbee900b7bed53641
.quad 0xbedae880bec3ef15,0xbf039c3dbef15aea,0xbef41f07bedae880,0xbf121eb0bf064b82,0xbf064b82bef15aea,0xbf1ff6cbbf13682a,0xbf121eb0bf039c3d,0xbf2d1469bf1ff6cb
.quad 0xbf1d7fd1bf0e39da,0xbf396842bf2beb4a,0xbf286605bf187fc0,0xbf44e3f5bf373a23,0xbf32c8c9bf226799,0xbf4f7a1fbf41d870,0xbf3ca003bf2beb4a,0xbf591e6abf4bbbf8
.quad 0x8000000080000000,0x8000000080000000,0xbda3308cbd96a905,0xbdbc3ac3bdafb680,0xbe22abb6be164083,0xbe3b6ecfbe2f10a2,0xbe72b651be605c13,0xbe8b9507be827dc0
.quad 0xbea09ae5be94a031,0xbeb8442abeac7cd4,0xbec6d529beb8442a,0xbee363fabed53641,0xbeebcbbbbedae880,0xbf064b82befc5d27,0xbf07a136befc5d27,0xbf19c200bf10d3cd
.quad 0xbf187fc0bf0e39da,0xbf2beb4abf226799,0xbf286605bf1d7fd1,0xbf3ca003bf32c8c9,0xbf373a23bf2beb4a,0xbf4bbbf8bf41d870,0xbf44e3f5bf396842,0xbf591e6abf4f7a1f
.quad 0xbf514d3dbf45e403,0xbf64aa59bf5b941a,0xbf5c61c7bf514d3d,0xbf6e46bebf660f88,0xbf660f88bf5b941a,0xbf75dec6bf6ed89e,0xbf6e46bebf64aa59,0xbf7b61fcbf75dec6
.quad 0x3f8000003f800000,0x3f8000003f800000,0x3f7e9bc93f7ec46d,0x3f7e43233f7e70b0,0x3f7a73023f7b14be,0x3f7912983f79c79d,0x3f73913f3f74fa0b,0x3f7080663f721352
.quad 0x3f6a09a73f6c835e,0x3f64aa593f676bd8,0x3f5df6be3f61c598,0x3f55b9933f59f26a,0x3f4f7a1f3f54db31,0x3f43e2003f49d112,0x3f3ebc1b3f45e403,0x3f2f61a53f373a23
.quad 0x3f2beb4a3f3504f3,0x3f187fc03f226799,0x3f173c073f226799,0x3eff17b23f0b9a6b,0x3f00e7e43f0e39da,0x3ec9b9533ee63375,0x3ed25a093ef15aea,0x3e919ddd3eb263ef
.quad 0x3ea09ae53ec3ef15,0x3e2f10a23e78cfcc,0x3e5a39973e94a031,0x3d6214693e09cf86,0x3de1bc2e3e47c5c2,0xbd7b2b743cc90ab0,0x3bc90f883dc8bd36,0xbe354098bdafb680
.quad 0x3f8000003f800000,0x3f8000003f800000,0x3f7de0b13f7e1324,0x3f7d74743f7dabcc,0x3f778bc53f7853f8,0x3f75dec63f76ba07,0x3f6d1c1d3f6ed89e,0x3f6965913f6b4b0c
.quad 0x3f5ebe053f61c598,0x3f5848533f5b941a,0x3f4cae793f514d3d,0x3f42de293f47de65,0x3f373a233f3daef9,0x3f2994153f3085bb,0x3f1ebc123f273656,0x3f0cead03f15f6d9
.quad 0x3f039c3d3f0e39da,0x3edae8803ef15aea,0x3ecc9b8b3ee63375,0x3e97a1173eb263ef,0x3e8e9a223eac7cd4,0x3e22abb63e605c13,0x3e1c76de3e605c13,0x3c96c9b63dafb680
.quad 0x3cc90ab03dc8bd36,0xbdfab273bd48fb30,0xbdd53db9bcc90ab0,0xbe8586cebe3b6ecf,0xbe6c9a7fbe164083,0xbec9b953bea09ae5,0xbeb554ecbe888e93,0xbf04f484bee0924f
.quad 0x3f8000003f800000,0x3f8000003f800000,0x3f7cfe733f7d3aac,0x3f7c7eb03f7cbfc9,0x3f740bdd3f74fa0b,0x3f7213523f731447,0x3f655e0b3f676bd8,0x3f6106f23f633c5a
.quad 0x3f514d3d3f54db31,0x3f49d1123f4d9f02,0x3f3852163f3daef9,0x3f2d14693f32c8c9,0x3f1b02c63f226799,0x3f0b9a6b3f13682a,0x3ef41f073f039c3d,0x3ecc9b8b3ee0924f
.quad 0x3eac7cd43ec3ef15,0x3e78cfcc3e94a031,0x3e419b373e78cfcc,0x3da3308c3e09cf86,0x3d16c32c3dc8bd36,0xbdafb680bcc90ab0,0xbdee3876bd48fb30,0xbe7ee6e1be3b6ecf
.quad 0xbe888e93be47c5c2,0xbecf7bcabeac7cd4,0xbed25a09beac7cd4,0xbf0cead0bef6e0cb,0xbf0b9a6bbef15aea,0xbf2e3bdebf1d7fd1,0xbf2ac082bf187fc0,0xbf4ac77fbf3b8f3b
.quad 0x3f8000003f800000,0x3f8000003f800000,0x3f7bf5313f7c3b28,0x3f7b61fc3f7baccd,0x3f6ff5733f710908,0x3f6db2933f6ed89e,0x3f5c61c73f5ebe05,0x3f5770263f59f26a
.quad 0x3f41d8703f45e403,0x3f3968423f3daef9,0x3f212ff93f273656,0x3f14b0393f1b02c6,0x3ef6e0cb3f039c3d,0x3ed536413ee63375,0x3ea395c53eb8442a,0x3e72b6513e8e9a22
.quad 0x3e1640833e47c5c2,0x3d48fb303dc8bd36,0xbcfb49ba3cc90ab0,0xbe1008b7bdafb680,0xbe541501be164083,0xbea68f12be888e93,0xbec1071ebea09ae5,0xbeff17b2bee0924f
.quad 0xbf08f59bbef15aea,0xbf273656bf187fc0,0xbf2d1469bf1d7fd1,0xbf48d8b3bf3b8f3b,0xbf4bbbf8bf3daef9,0xbf633c5abf584853,0xbf63f473bf584853,0xbf756d97bf6db293
.quad 0x8000000080000000,0x8000000080000000,0xbdd53db9bdc8bd36,0xbdee3876bde1bc2e,0xbe541501be47c5c2,0xbe6c9a7fbe605c13,0xbe9d9e78be94a031,0xbeaf713abea68f12
.quad 0xbecf7bcabec3ef15,0xbee63375bedae880,0xbeff17b2bef15aea,0xbf0cead0bf064b82,0xbf15f6d9bf0e39da,0xbf24d225bf1d7fd1,0xbf2ac082bf226799,0xbf3a7ca4bf32c8c9
.quad 0xbf3daef9bf3504f3,0xbf4d9f02bf45e403,0xbf4e8d90bf45e403,0xbf5df6bebf5695e5,0xbf5d2d53bf54db31,0xbf6b4b0cbf64aa59,0xbf696591bf61c598,0xbf756d97bf6ff573
.quad 0xbf731447bf6c835e,0xbf7c3b28bf7853f8,0xbf7a1e84bf74fa0b,0xbf7f9c18bf7dabcc,0xbf7e70b0bf7b14be,0xbf7f84abbf7fec43,0xbf7ffec4bf7ec46d,0xbf7bf531bf7f0e58
.quad 0x8000000080000000,0x8000000080000000,0xbe039502bdfab273,0xbe1008b7be09cf86,0xbe827dc0be78cfcc,0xbe8e9a22be888e93,0xbec1071ebeb8442a,0xbed25a09bec9b953
.quad 0xbefc5d27bef15aea,0xbf08f59bbf039c3d,0xbf19c200bf13682a,0xbf26050abf1ff6cb,0xbf32c8c9bf2beb4a,0xbf3fc767bf396842,0xbf48d8b3bf41d870,0xbf55b993bf4f7a1f
.quad 0xbf5b941abf54db31,0xbf676bd8bf61c598,0xbf6aab7bbf64aa59,0xbf748422bf6ff573,0xbf75dec6bf710908,0xbf7cbfc9bf79c79d,0xbf7cfe73bf79c79d,0xbf7ff4e6bf7f0e58
.quad 0xbf7fec43bf7ec46d,0xbf7e1324bf7fb10f,0xbf7e9bc9bf7fec43,0xbf772417bf7baccd,0xbf791298bf7d3aac,0xbf6b4b0cbf731447,0xbf6f6830bf76ba07,0xbf5ac450bf660f88
.quad 0x8000000080000000,0x8000000080000000,0xbe1c76debe164083,0xbe28defcbe22abb6,0xbe9aa086be94a031,0xbea68f12bea09ae5,0xbee363fabedae880,0xbef41f07beebcbbb
.quad 0xbf13682abf0e39da,0xbf1d7fd1bf187fc0,0xbf31a81dbf2beb4a,0xbf3ca003bf373a23,0xbf4bbbf8bf45e403,0xbf5695e5bf514d3d,0xbf6106f2bf5b941a,0xbf6aab7bbf660f88
.quad 0xbf710908bf6c835e,0xbf7853f8bf74fa0b,0xbf7b61fcbf7853f8,0xbf7f2f9dbf7dabcc,0xbf7fd397bf7ec46d,0xbf7f0e58bf7fec43,0xbf7e4323bf7fb10f,0xbf77f110bf7baccd
.quad 0xbf76ba07bf7b14be,0xbf6a09a7bf710908,0xbf696591bf710908,0xbf55b993bf604621,0xbf5695e5bf61c598,0xbf3b8f3bbf49d112,0xbf3ebc1bbf4d9f02,0xbf1c420cbf2e3bde
.quad 0x8000000080000000,0x8000000080000000,0xbe354098be2f10a2,0xbe419b37be3b6ecf,0xbeb263efbeac7cd4,0xbebe1d4abeb8442a,0xbf0242b1befc5d27,0xbf0a48adbf064b82
.quad 0xbf273656bf226799,0xbf3085bbbf2beb4a,0xbf46e22abf41d870,0xbf5064afbf4bbbf8,0xbf604621bf5b941a,0xbf68bf3cbf64aa59,0xbf7294f8bf6ed89e,0xbf78b47bbf75dec6
.quad 0xbf7d3aacbf7b14be,0xbf7fb10fbf7ec46d,0xbf7fe129bf7fec43,0xbf7d7474bf7f0e58,0xbf7a7302bf7d3aac,0xbf721352bf76ba07,0xbf6d1c1dbf731447,0xbf5df6bebf660f88
.quad 0xbf584853bf61c598,0xbf41d870bf4d9f02,0xbf3ca003bf49d112,0xbf1ebc12bf2e3bde,0xbf1b02c6bf2beb4a,0xbeebcbbbbf08f59b,0xbee900b7bf08f59b,0xbe919dddbebe1d4a
.quad 0x3f803f803f803f80,0x3f803f803f803f80,0x8000800080008000,0x8000800080008000,0x3f553f6d3f7b3f80,0xbf55bf6dbf7bbf80,0xbf0ebec4be488000,0x3f0e3ec43e48a50d
.quad 0xbf35248d3f353f80,0xbf35248d3f353f80,0xbf35bf80bf358000,0xbf35bf80bf358000,0xbf7bbec43f0e3f80,0x3f7b3ec4bf0ebf80,0xbe48bf6dbf558000,0x3e483f6d3f55a50d
.quad 0xa554bf80248d3f80,0xa554bf80248d3f80,0x3f80a50dbf808000,0x3f80a50dbf808000,0x3f0ebf6dbe483f80,0xbf0e3f6d3e48bf80,0x3f553ec4bf7b8000,0xbf55bec43f7ba50d
.quad 0x3f35a554bf353f80,0x3f35a554bf353f80,0xbf353f80bf358000,0xbf353f80bf358000,0x3e483ec4bf553f80,0xbe48bec43f55bf80,0xbf7b3f6dbf0e8000,0x3f7bbf6d3f0ea50d
.quad 0x3f803f803f803f80,0x3f803f803f803f80,0x8000800080008000,0x8000800080008000,0x3e483ec43f0e3f35,0xbe48bec4bf0ebf35,0xbf7bbf6dbf55bf35,0x3f7b3f6d3f553f35
.quad 0x3f35a554bf35bf80,0x3f35a554bf35bf80,0x3f353f803f35a50d,0x3f353f803f35a50d,0x3f553f6d3e48bf35,0xbf55bf6dbe483f35,0xbf0e3ec43f7b3f35,0x3f0ebec4bf7bbf35
.quad 0xa554bf80248d3f80,0xa554bf80248d3f80,0x3f80a50dbf808000,0x3f80a50dbf808000,0x3f7bbec4bf553f35,0xbf7b3ec43f55bf35,0x3e483f6dbf0ebf35,0xbe48bf6d3f0e3f35
.quad 0xbf35248d3f35bf80,0xbf35248d3f35bf80,0x3f35bf803f35a50d,0x3f35bf803f35a50d,0x3f0ebf6d3f7bbf35,0xbf0e3f6dbf7b3f35,0x3f55bec4be483f35,0xbf553ec43e48bf35
.quad 0x3f803f803f803f80,0x3f803f803f803f80,0x8000800080008000,0x8000800080008000,0xbf0ebec4be48248d,0x3f0e3ec43e48a554,0xbf55bf6dbf7bbf80,0x3f553f6d3f7b3f80
.quad 0xbf35248d3f353f80,0xbf35248d3f353f80,0xbf35bf80bf358000,0xbf35bf80bf358000,0xbe48bf6dbf55248d,0x3e483f6d3f55a554,0x3f7b3ec4bf0ebf80,0xbf7bbec43f0e3f80
.quad 0xa554bf80248d3f80,0xa554bf80248d3f80,0x3f80a50dbf808000,0x3f80a50dbf808000,0x3f553ec4bf7b248d,0xbf55bec43f7ba554,0xbf0e3f6d3e48bf80,0x3f0ebf6dbe483f80
.quad 0x3f35a554bf353f80,0x3f35a554bf353f80,0xbf353f80bf358000,0xbf353f80bf358000,0xbf7b3f6dbf0e248d,0x3f7bbf6d3f0ea554,0xbe48bec43f55bf80,0x3e483ec4bf553f80
.quad 0x3f803f803f803f80,0x3f803f803f803f80,0x8000800080008000,0x8000800080008000,0xbf7bbf6dbf55bf35,0x3f7b3f6d3f553f35,0xbe48bec4bf0ebf35,0x3e483ec43f0e3f35
.quad 0x3f35a554bf35bf80,0x3f35a554bf35bf80,0x3f353f803f35a50d,0x3f353f803f35a50d,0xbf0e3ec43f7b3f35,0x3f0ebec4bf7bbf35,0xbf55bf6dbe483f35,0x3f553f6d3e48bf35
.quad 0xa554bf80248d3f80,0xa554bf80248d3f80,0x3f80a50dbf808000,0x3f80a50dbf808000,0x3e483f6dbf0ebf35,0xbe48bf6d3f0e3f35,0xbf7b3ec43f55bf35,0x3f7bbec4bf553f35
.quad 0xbf35248d3f35bf80,0xbf35248d3f35bf80,0x3f35bf803f35a50d,0x3f35bf803f35a50d,0x3f55bec4be483f35,0xbf553ec43e48bf35,0xbf0e3f6dbf7b3f35,0x3f0ebf6d3f7bbf35
.quad 0x0,0x0,0x3f803f803f803f80,0x3f803f803f803f80,0x3f0e3ec43e480000,0xbf0ebec4be48250d,0x3f553f6d3f7b3f80,0xbf55bf6dbf7bbf80
.quad 0x3f353f803f350000,0x3f353f803f350000,0xbf35248d3f353f80,0xbf35248d3f353f80,0x3e483f6d3f550000,0xbe48bf6dbf55250d,0xbf7bbec43f0e3f80,0x3f7b3ec4bf0ebf80
.quad 0xbf80250d3f800000,0xbf80250d3f800000,0xa554bf80248d3f80,0xa554bf80248d3f80,0xbf55bec43f7b0000,0x3f553ec4bf7b250d,0x3f0ebf6dbe483f80,0xbf0e3f6d3e48bf80
.quad 0x3f35bf803f350000,0x3f35bf803f350000,0x3f35a554bf353f80,0x3f35a554bf353f80,0x3f7bbf6d3f0e0000,0xbf7b3f6dbf0e250d,0x3e483ec4bf553f80,0xbe48bec43f55bf80
.quad 0x0,0x0,0x3f803f803f803f80,0x3f803f803f803f80,0x3f7b3f6d3f553f35,0xbf7bbf6dbf55bf35,0x3e483ec43f0e3f35,0xbe48bec4bf0ebf35
.quad 0xbf35bf80bf35250d,0xbf35bf80bf35250d,0x3f35a554bf35bf80,0x3f35a554bf35bf80,0x3f0ebec4bf7bbf35,0xbf0e3ec43f7b3f35,0x3f553f6d3e48bf35,0xbf55bf6dbe483f35
.quad 0xbf80250d3f800000,0xbf80250d3f800000,0xa554bf80248d3f80,0xa554bf80248d3f80,0xbe48bf6d3f0e3f35,0x3e483f6dbf0ebf35,0x3f7bbec4bf553f35,0xbf7b3ec43f55bf35
.quad 0xbf353f80bf35250d,0xbf353f80bf35250d,0xbf35248d3f35bf80,0xbf35248d3f35bf80,0xbf553ec43e48bf35,0x3f55bec4be483f35,0x3f0ebf6d3f7bbf35,0xbf0e3f6dbf7b3f35
.quad 0x0,0x0,0x3f803f803f803f80,0x3f803f803f803f80,0x3f553f6d3f7b3f80,0xbf55bf6dbf7bbf80,0xbf0ebec4be48248d,0x3f0e3ec43e48a554
.quad 0x3f353f803f350000,0x3f353f803f350000,0xbf35248d3f353f80,0xbf35248d3f353f80,0xbf7bbec43f0e3f80,0x3f7b3ec4bf0ebf80,0xbe48bf6dbf55248d,0x3e483f6d3f55a554
.quad 0xbf80250d3f800000,0xbf80250d3f800000,0xa554bf80248d3f80,0xa554bf80248d3f80,0x3f0ebf6dbe483f80,0xbf0e3f6d3e48bf80,0x3f553ec4bf7b248d,0xbf55bec43f7ba554
.quad 0x3f35bf803f350000,0x3f35bf803f350000,0x3f35a554bf353f80,0x3f35a554bf353f80,0x3e483ec4bf553f80,0xbe48bec43f55bf80,0xbf7b3f6dbf0e248d,0x3f7bbf6d3f0ea554
.quad 0x0,0x0,0x3f803f803f803f80,0x3f803f803f803f80,0x3e483ec43f0e3f35,0xbe48bec4bf0ebf35,0xbf7bbf6dbf55bf35,0x3f7b3f6d3f553f35
.quad 0xbf35bf80bf35250d,0xbf35bf80bf35250d,0x3f35a554bf35bf80,0x3f35a554bf35bf80,0x3f553f6d3e48bf35,0xbf55bf6dbe483f35,0xbf0e3ec43f7b3f35,0x3f0ebec4bf7bbf35
.quad 0xbf80250d3f800000,0xbf80250d3f800000,0xa554bf80248d3f80,0xa554bf80248d3f80,0x3f7bbec4bf553f35,0xbf7b3ec43f55bf35,0x3e483f6dbf0ebf35,0xbe48bf6d3f0e3f35
.quad 0xbf353f80bf35250d,0xbf353f80bf35250d,0xbf35248d3f35bf80,0xbf35248d3f35bf80,0x3f0ebf6d3f7bbf35,0xbf0e3f6dbf7b3f35,0x3f55bec4be483f35,0xbf553ec43e48bf35
.quad 0x3ec43f353f6d3f80,0x3ec43f353f6d3f80,0xbf6dbf35bec48000,0xbf6dbf35bec48000,0xbe483ec43f553f80,0x3e48bec4bf55bf80,0xbf7bbf6dbf0e8000,0x3f7b3f6d3f0ea50d
.quad 0xbf6dbf353ec43f80,0xbf6dbf353ec43f80,0x3ec4bf35bf6d8000,0x3ec4bf35bf6d8000,0xbf0ebf6d3e483f80,0x3f0e3f6dbe48bf80,0x3f55bec4bf7b8000,0xbf553ec43f7ba50d
.quad 0x3f6dbf35bec43f80,0x3f6dbf35bec43f80,0x3ec43f35bf6d8000,0x3ec43f35bf6d8000,0x3f7bbec4bf0e3f80,0xbf7b3ec43f0ebf80,0xbe483f6dbf558000,0x3e48bf6d3f55a50d
.quad 0xbec43f35bf6d3f80,0xbec43f35bf6d3f80,0xbf6d3f35bec48000,0xbf6d3f35bec48000,0xbf553f6dbf7b3f80,0x3f55bf6d3f7bbf80,0xbf0e3ec4be488000,0x3f0ebec43e48a50d
.quad 0xbf6dbf35bec4248d,0xbf6dbf35bec4248d,0xbec4bf35bf6dbf80,0xbec4bf35bf6dbf80,0xbf0ebf6dbf7bbf35,0x3f0e3f6d3f7b3f35,0x3f553ec4be48bf35,0xbf55bec43e483f35
.quad 0xbec43f353f6da554,0xbec43f353f6da554,0xbf6dbf353ec43f80,0xbf6dbf353ec43f80,0xbf7bbec43f553f35,0x3f7b3ec4bf55bf35,0x3e48bf6dbf0e3f35,0xbe483f6d3f0ebf35
.quad 0x3ec43f35bf6d248d,0x3ec43f35bf6d248d,0xbf6d3f353ec4bf80,0xbf6d3f353ec4bf80,0xbf553f6dbe48bf35,0x3f55bf6d3e483f35,0xbf0ebec43f7bbf35,0x3f0e3ec4bf7b3f35
.quad 0x3f6dbf353ec4a554,0x3f6dbf353ec4a554,0xbec43f35bf6d3f80,0xbec43f35bf6d3f80,0xbe483ec4bf0e3f35,0x3e48bec43f0ebf35,0xbf7b3f6dbf553f35,0x3f7bbf6d3f55bf35
.quad 0xbec4bf35bf6dbf80,0xbec4bf35bf6dbf80,0x3f6d3f353ec4a50d,0x3f6d3f353ec4a50d,0x3f7b3f6d3f0ea554,0xbf7bbf6dbf0e248d,0xbe483ec43f553f80,0x3e48bec4bf55bf80
.quad 0x3f6d3f35bec4bf80,0x3f6d3f35bec4bf80,0xbec43f353f6da50d,0xbec43f353f6da50d,0xbf553ec43f7ba554,0x3f55bec4bf7b248d,0xbf0ebf6d3e483f80,0x3f0e3f6dbe48bf80
.quad 0xbf6d3f353ec4bf80,0xbf6d3f353ec4bf80,0xbec4bf353f6da50d,0xbec4bf353f6da50d,0x3e48bf6d3f55a554,0xbe483f6dbf55248d,0x3f7bbec4bf0e3f80,0xbf7b3ec43f0ebf80
.quad 0x3ec4bf353f6dbf80,0x3ec4bf353f6dbf80,0x3f6dbf353ec4a50d,0x3f6dbf353ec4a50d,0x3f0ebec43e48a554,0xbf0e3ec4be48248d,0xbf553f6dbf7b3f80,0x3f55bf6d3f7bbf80
.quad 0x3f6d3f353ec4a554,0x3f6d3f353ec4a554,0x3ec43f353f6d3f80,0x3ec43f353f6d3f80,0xbf55bec43e483f35,0x3f553ec4be48bf35,0xbf0ebf6dbf7bbf35,0x3f0e3f6d3f7b3f35
.quad 0x3ec4bf35bf6d248d,0x3ec4bf35bf6d248d,0x3f6d3f35bec4bf80,0x3f6d3f35bec4bf80,0xbe483f6d3f0ebf35,0x3e48bf6dbf0e3f35,0xbf7bbec43f553f35,0x3f7b3ec4bf55bf35
.quad 0xbec4bf353f6da554,0xbec4bf353f6da554,0x3f6dbf35bec43f80,0x3f6dbf35bec43f80,0x3f0e3ec4bf7b3f35,0xbf0ebec43f7bbf35,0xbf553f6dbe48bf35,0x3f55bf6d3e483f35
.quad 0xbf6d3f35bec4248d,0xbf6d3f35bec4248d,0x3ec4bf353f6dbf80,0x3ec4bf353f6dbf80,0x3f7bbf6d3f55bf35,0xbf7b3f6dbf553f35,0xbe483ec4bf0e3f35,0x3e48bec43f0ebf35
.quad 0x3f6d3f353ec40000,0x3f6d3f353ec40000,0x3ec43f353f6d3f80,0x3ec43f353f6d3f80,0x3f7b3f6d3f0e0000,0xbf7bbf6dbf0e250d,0xbe483ec43f553f80,0x3e48bec4bf55bf80
.quad 0xbec43f353f6d0000,0xbec43f353f6d0000,0xbf6dbf353ec43f80,0xbf6dbf353ec43f80,0xbf553ec43f7b0000,0x3f55bec4bf7b250d,0xbf0ebf6d3e483f80,0x3f0e3f6dbe48bf80
.quad 0xbec4bf353f6d0000,0xbec4bf353f6d0000,0x3f6dbf35bec43f80,0x3f6dbf35bec43f80,0x3e48bf6d3f550000,0xbe483f6dbf55250d,0x3f7bbec4bf0e3f80,0xbf7b3ec43f0ebf80
.quad 0x3f6dbf353ec40000,0x3f6dbf353ec40000,0xbec43f35bf6d3f80,0xbec43f35bf6d3f80,0x3f0ebec43e480000,0xbf0e3ec4be48250d,0xbf553f6dbf7b3f80,0x3f55bf6d3f7bbf80
.quad 0x3ec43f353f6d3f80,0x3ec43f353f6d3f80,0xbf6dbf35bec4248d,0xbf6dbf35bec4248d,0xbf55bec43e483f35,0x3f553ec4be48bf35,0xbf0ebf6dbf7bbf35,0x3f0e3f6d3f7b3f35
.quad 0x3f6d3f35bec4bf80,0x3f6d3f35bec4bf80,0xbec43f353f6da554,0xbec43f353f6da554,0xbe483f6d3f0ebf35,0x3e48bf6dbf0e3f35,0xbf7bbec43f553f35,0x3f7b3ec4bf55bf35
.quad 0x3f6dbf35bec43f80,0x3f6dbf35bec43f80,0x3ec43f35bf6d248d,0x3ec43f35bf6d248d,0x3f0e3ec4bf7b3f35,0xbf0ebec43f7bbf35,0xbf553f6dbe48bf35,0x3f55bf6d3e483f35
.quad 0x3ec4bf353f6dbf80,0x3ec4bf353f6dbf80,0x3f6dbf353ec4a554,0x3f6dbf353ec4a554,0x3f7bbf6d3f55bf35,0xbf7b3f6dbf553f35,0xbe483ec4bf0e3f35,0x3e48bec43f0ebf35
.quad 0xbf6dbf35bec4250d,0xbf6dbf35bec4250d,0xbec4bf35bf6dbf80,0xbec4bf35bf6dbf80,0x3e48bec4bf55bf80,0xbe483ec43f553f80,0x3f7b3f6d3f0ea554,0xbf7bbf6dbf0e248d
.quad 0x3ec4bf35bf6d250d,0x3ec4bf35bf6d250d,0x3f6d3f35bec4bf80,0x3f6d3f35bec4bf80,0x3f0e3f6dbe48bf80,0xbf0ebf6d3e483f80,0xbf553ec43f7ba554,0x3f55bec4bf7b248d
.quad 0x3ec43f35bf6d250d,0x3ec43f35bf6d250d,0xbf6d3f353ec4bf80,0xbf6d3f353ec4bf80,0xbf7b3ec43f0ebf80,0x3f7bbec4bf0e3f80,0x3e48bf6d3f55a554,0xbe483f6dbf55248d
.quad 0xbf6d3f35bec4250d,0xbf6d3f35bec4250d,0x3ec4bf353f6dbf80,0x3ec4bf353f6dbf80,0x3f55bf6d3f7bbf80,0xbf553f6dbf7b3f80,0x3f0ebec43e48a554,0xbf0e3ec4be48248d
.quad 0xbec4bf35bf6dbf80,0xbec4bf35bf6dbf80,0x3f6d3f353ec4a554,0x3f6d3f353ec4a554,0x3f0e3f6d3f7b3f35,0xbf0ebf6dbf7bbf35,0xbf55bec43e483f35,0x3f553ec4be48bf35
.quad 0xbf6dbf353ec43f80,0xbf6dbf353ec43f80,0x3ec4bf35bf6d248d,0x3ec4bf35bf6d248d,0x3f7b3ec4bf55bf35,0xbf7bbec43f553f35,0xbe483f6d3f0ebf35,0x3e48bf6dbf0e3f35
.quad 0xbf6d3f353ec4bf80,0xbf6d3f353ec4bf80,0xbec4bf353f6da554,0xbec4bf353f6da554,0x3f55bf6d3e483f35,0xbf553f6dbe48bf35,0x3f0e3ec4bf7b3f35,0xbf0ebec43f7bbf35
.quad 0xbec43f35bf6d3f80,0xbec43f35bf6d3f80,0xbf6d3f35bec4248d,0xbf6d3f35bec4248d,0x3e48bec43f0ebf35,0xbe483ec4bf0e3f35,0x3f7bbf6d3f55bf35,0xbf7b3f6dbf553f35
.quad 0xbf803f80bf803f80,0xbf803f80bf803f80,0x250d0000250d0000,0x250d0000250d0000,0xbf553f6dbf7b3f80,0x3f55bf6d3f7bbf80,0xbf0e3ec4be480000,0x3f0ebec43e48250d
.quad 0x3f35248dbf353f80,0x3f35248dbf353f80,0xbf353f80bf350000,0xbf353f80bf350000,0x3f7bbec4bf0e3f80,0xbf7b3ec43f0ebf80,0xbe483f6dbf550000,0x3e48bf6d3f55250d
.quad 0x248dbf80a5543f80,0x248dbf80a5543f80,0x3f80250dbf800000,0x3f80250dbf800000,0xbf0ebf6d3e483f80,0x3f0e3f6dbe48bf80,0x3f55bec4bf7b0000,0xbf553ec43f7b250d
.quad 0xbf35a5543f353f80,0xbf35a5543f353f80,0xbf35bf80bf350000,0xbf35bf80bf350000,0xbe483ec43f553f80,0x3e48bec4bf55bf80,0xbf7bbf6dbf0e0000,0x3f7b3f6d3f0e250d
.quad 0xbf803f80bf803f80,0xbf803f80bf803f80,0x250d0000250d0000,0x250d0000250d0000,0xbe483ec4bf0e3f35,0x3e48bec43f0ebf35,0xbf7b3f6dbf553f35,0x3f7bbf6d3f55bf35
.quad 0xbf35a5543f35bf80,0xbf35a5543f35bf80,0x3f35bf803f35250d,0x3f35bf803f35250d,0xbf553f6dbe48bf35,0x3f55bf6d3e483f35,0xbf0ebec43f7bbf35,0x3f0e3ec4bf7b3f35
.quad 0x248dbf80a5543f80,0x248dbf80a5543f80,0x3f80250dbf800000,0x3f80250dbf800000,0xbf7bbec43f553f35,0x3f7b3ec4bf55bf35,0x3e48bf6dbf0e3f35,0xbe483f6d3f0ebf35
.quad 0x3f35248dbf35bf80,0x3f35248dbf35bf80,0x3f353f803f35250d,0x3f353f803f35250d,0xbf0ebf6dbf7bbf35,0x3f0e3f6d3f7b3f35,0x3f553ec4be48bf35,0xbf55bec43e483f35
.quad 0xbf803f80bf803f80,0xbf803f80bf803f80,0x250d0000250d0000,0x250d0000250d0000,0x3f0ebec43e48248d,0xbf0e3ec4be48a554,0xbf553f6dbf7b3f80,0x3f55bf6d3f7bbf80
.quad 0x3f35248dbf353f80,0x3f35248dbf353f80,0xbf353f80bf350000,0xbf353f80bf350000,0x3e48bf6d3f55248d,0xbe483f6dbf55a554,0x3f7bbec4bf0e3f80,0xbf7b3ec43f0ebf80
.quad 0x248dbf80a5543f80,0x248dbf80a5543f80,0x3f80250dbf800000,0x3f80250dbf800000,0xbf553ec43f7b248d,0x3f55bec4bf7ba554,0xbf0ebf6d3e483f80,0x3f0e3f6dbe48bf80
.quad 0xbf35a5543f353f80,0xbf35a5543f353f80,0xbf35bf80bf350000,0xbf35bf80bf350000,0x3f7b3f6d3f0e248d,0xbf7bbf6dbf0ea554,0xbe483ec43f553f80,0x3e48bec4bf55bf80
.quad 0xbf803f80bf803f80,0xbf803f80bf803f80,0x250d0000250d0000,0x250d0000250d0000,0x3f7bbf6d3f55bf35,0xbf7b3f6dbf553f35,0xbe483ec4bf0e3f35,0x3e48bec43f0ebf35
.quad 0xbf35a5543f35bf80,0xbf35a5543f35bf80,0x3f35bf803f35250d,0x3f35bf803f35250d,0x3f0e3ec4bf7b3f35,0xbf0ebec43f7bbf35,0xbf553f6dbe48bf35,0x3f55bf6d3e483f35
.quad 0x248dbf80a5543f80,0x248dbf80a5543f80,0x3f80250dbf800000,0x3f80250dbf800000,0xbe483f6d3f0ebf35,0x3e48bf6dbf0e3f35,0xbf7bbec43f553f35,0x3f7b3ec4bf55bf35
.quad 0x3f35248dbf35bf80,0x3f35248dbf35bf80,0x3f353f803f35250d,0x3f353f803f35250d,0xbf55bec43e483f35,0x3f553ec4be48bf35,0xbf0ebf6dbf7bbf35,0x3f0e3f6d3f7b3f35
.quad 0x250d0000250d0000,0x250d0000250d0000,0x3f80bf803f80bf80,0x3f80bf803f80bf80,0xbf0e3ec4be480000,0x3f0ebec43e48250d,0x3f55bf6d3f7bbf80,0xbf553f6dbf7b3f80
.quad 0xbf353f80bf350000,0xbf353f80bf350000,0xbf35a48d3f35bf80,0xbf35a48d3f35bf80,0xbe483f6dbf550000,0x3e48bf6d3f55250d,0xbf7b3ec43f0ebf80,0x3f7bbec4bf0e3f80
.quad 0x3f80250dbf800000,0x3f80250dbf800000,0xa48d3f802554bf80,0xa48d3f802554bf80,0x3f55bec4bf7b0000,0xbf553ec43f7b250d,0x3f0e3f6dbe48bf80,0xbf0ebf6d3e483f80
.quad 0xbf35bf80bf350000,0xbf35bf80bf350000,0x3f352554bf35bf80,0x3f352554bf35bf80,0xbf7bbf6dbf0e0000,0x3f7b3f6d3f0e250d,0x3e48bec4bf55bf80,0xbe483ec43f553f80
.quad 0x250d0000250d0000,0x250d0000250d0000,0x3f80bf803f80bf80,0x3f80bf803f80bf80,0xbf7b3f6dbf553f35,0x3f7bbf6d3f55bf35,0x3e48bec43f0ebf35,0xbe483ec4bf0e3f35
.quad 0x3f35bf803f35250d,0x3f35bf803f35250d,0x3f352554bf353f80,0x3f352554bf353f80,0xbf0ebec43f7bbf35,0x3f0e3ec4bf7b3f35,0x3f55bf6d3e483f35,0xbf553f6dbe48bf35
.quad 0x3f80250dbf800000,0x3f80250dbf800000,0xa48d3f802554bf80,0xa48d3f802554bf80,0x3e48bf6dbf0e3f35,0xbe483f6d3f0ebf35,0x3f7b3ec4bf55bf35,0xbf7bbec43f553f35
.quad 0x3f353f803f35250d,0x3f353f803f35250d,0xbf35a48d3f353f80,0xbf35a48d3f353f80,0x3f553ec4be48bf35,0xbf55bec43e483f35,0x3f0e3f6d3f7b3f35,0xbf0ebf6dbf7bbf35
.quad 0x250d0000250d0000,0x250d0000250d0000,0x3f80bf803f80bf80,0x3f80bf803f80bf80,0xbf553f6dbf7b3f80,0x3f55bf6d3f7bbf80,0xbf0e3ec4be48a48d,0x3f0ebec43e482554
.quad 0xbf353f80bf350000,0xbf353f80bf350000,0xbf35a48d3f35bf80,0xbf35a48d3f35bf80,0x3f7bbec4bf0e3f80,0xbf7b3ec43f0ebf80,0xbe483f6dbf55a48d,0x3e48bf6d3f552554
.quad 0x3f80250dbf800000,0x3f80250dbf800000,0xa48d3f802554bf80,0xa48d3f802554bf80,0xbf0ebf6d3e483f80,0x3f0e3f6dbe48bf80,0x3f55bec4bf7ba48d,0xbf553ec43f7b2554
.quad 0xbf35bf80bf350000,0xbf35bf80bf350000,0x3f352554bf35bf80,0x3f352554bf35bf80,0xbe483ec43f553f80,0x3e48bec4bf55bf80,0xbf7bbf6dbf0ea48d,0x3f7b3f6d3f0e2554
.quad 0x250d0000250d0000,0x250d0000250d0000,0x3f80bf803f80bf80,0x3f80bf803f80bf80,0xbe483ec4bf0e3f35,0x3e48bec43f0ebf35,0xbf7b3f6dbf553f35,0x3f7bbf6d3f55bf35
.quad 0x3f35bf803f35250d,0x3f35bf803f35250d,0x3f352554bf353f80,0x3f352554bf353f80,0xbf553f6dbe48bf35,0x3f55bf6d3e483f35,0xbf0ebec43f7bbf35,0x3f0e3ec4bf7b3f35
.quad 0x3f80250dbf800000,0x3f80250dbf800000,0xa48d3f802554bf80,0xa48d3f802554bf80,0xbf7bbec43f553f35,0x3f7b3ec4bf55bf35,0x3e48bf6dbf0e3f35,0xbe483f6d3f0ebf35
.quad 0x3f353f803f35250d,0x3f353f803f35250d,0xbf35a48d3f353f80,0xbf35a48d3f353f80,0xbf0ebf6dbf7bbf35,0x3f0e3f6d3f7b3f35,0x3f553ec4be48bf35,0xbf55bec43e483f35
.quad 0xbec43f35bf6d3f80,0xbec43f35bf6d3f80,0xbf6d3f35bec40000,0xbf6d3f35bec40000,0x3e483ec4bf553f80,0xbe48bec43f55bf80,0xbf7b3f6dbf0e0000,0x3f7bbf6d3f0e250d
.quad 0x3f6dbf35bec43f80,0x3f6dbf35bec43f80,0x3ec43f35bf6d0000,0x3ec43f35bf6d0000,0x3f0ebf6dbe483f80,0xbf0e3f6d3e48bf80,0x3f553ec4bf7b0000,0xbf55bec43f7b250d
.quad 0xbf6dbf353ec43f80,0xbf6dbf353ec43f80,0x3ec4bf35bf6d0000,0x3ec4bf35bf6d0000,0xbf7bbec43f0e3f80,0x3f7b3ec4bf0ebf80,0xbe48bf6dbf550000,0x3e483f6d3f55250d
.quad 0x3ec43f353f6d3f80,0x3ec43f353f6d3f80,0xbf6dbf35bec40000,0xbf6dbf35bec40000,0x3f553f6d3f7b3f80,0xbf55bf6dbf7bbf80,0xbf0ebec4be480000,0x3f0e3ec43e48250d
.quad 0x3f6dbf353ec4248d,0x3f6dbf353ec4248d,0xbec43f35bf6d3f80,0xbec43f35bf6d3f80,0x3f0ebf6d3f7bbf35,0xbf0e3f6dbf7b3f35,0x3f55bec4be483f35,0xbf553ec43e48bf35
.quad 0x3ec43f35bf6da554,0x3ec43f35bf6da554,0xbf6d3f353ec4bf80,0xbf6d3f353ec4bf80,0x3f7bbec4bf553f35,0xbf7b3ec43f55bf35,0x3e483f6dbf0ebf35,0xbe48bf6d3f0e3f35
.quad 0xbec43f353f6d248d,0xbec43f353f6d248d,0xbf6dbf353ec43f80,0xbf6dbf353ec43f80,0x3f553f6d3e48bf35,0xbf55bf6dbe483f35,0xbf0e3ec43f7b3f35,0x3f0ebec4bf7bbf35
.quad 0xbf6dbf35bec4a554,0xbf6dbf35bec4a554,0xbec4bf35bf6dbf80,0xbec4bf35bf6dbf80,0x3e483ec43f0e3f35,0xbe48bec4bf0ebf35,0xbf7bbf6dbf55bf35,0x3f7b3f6d3f553f35
.quad 0x3ec4bf353f6dbf80,0x3ec4bf353f6dbf80,0x3f6dbf353ec4250d,0x3f6dbf353ec4250d,0xbf7b3f6dbf0ea554,0x3f7bbf6d3f0e248d,0xbe48bec43f55bf80,0x3e483ec4bf553f80
.quad 0xbf6d3f353ec4bf80,0xbf6d3f353ec4bf80,0xbec4bf353f6d250d,0xbec4bf353f6d250d,0x3f553ec4bf7ba554,0xbf55bec43f7b248d,0xbf0e3f6d3e48bf80,0x3f0ebf6dbe483f80
.quad 0x3f6d3f35bec4bf80,0x3f6d3f35bec4bf80,0xbec43f353f6d250d,0xbec43f353f6d250d,0xbe48bf6dbf55a554,0x3e483f6d3f55248d,0x3f7b3ec4bf0ebf80,0xbf7bbec43f0e3f80
.quad 0xbec4bf35bf6dbf80,0xbec4bf35bf6dbf80,0x3f6d3f353ec4250d,0x3f6d3f353ec4250d,0xbf0ebec4be48a554,0x3f0e3ec43e48248d,0xbf55bf6dbf7bbf80,0x3f553f6d3f7b3f80
.quad 0xbf6d3f35bec4a554,0xbf6d3f35bec4a554,0x3ec4bf353f6dbf80,0x3ec4bf353f6dbf80,0x3f55bec4be483f35,0xbf553ec43e48bf35,0xbf0e3f6dbf7b3f35,0x3f0ebf6d3f7bbf35
.quad 0xbec4bf353f6d248d,0xbec4bf353f6d248d,0x3f6dbf35bec43f80,0x3f6dbf35bec43f80,0x3e483f6dbf0ebf35,0xbe48bf6d3f0e3f35,0xbf7b3ec43f55bf35,0x3f7bbec4bf553f35
.quad 0x3ec4bf35bf6da554,0x3ec4bf35bf6da554,0x3f6d3f35bec4bf80,0x3f6d3f35bec4bf80,0xbf0e3ec43f7b3f35,0x3f0ebec4bf7bbf35,0xbf55bf6dbe483f35,0x3f553f6d3e48bf35
.quad 0x3f6d3f353ec4248d,0x3f6d3f353ec4248d,0x3ec43f353f6d3f80,0x3ec43f353f6d3f80,0xbf7bbf6dbf55bf35,0x3f7b3f6d3f553f35,0xbe48bec4bf0ebf35,0x3e483ec43f0e3f35
.quad 0xbf6d3f35bec40000,0xbf6d3f35bec40000,0x3ec4bf353f6dbf80,0x3ec4bf353f6dbf80,0xbf7b3f6dbf0e0000,0x3f7bbf6d3f0e250d,0xbe48bec43f55bf80,0x3e483ec4bf553f80
.quad 0x3ec43f35bf6d0000,0x3ec43f35bf6d0000,0xbf6d3f353ec4bf80,0xbf6d3f353ec4bf80,0x3f553ec4bf7b0000,0xbf55bec43f7b250d,0xbf0e3f6d3e48bf80,0x3f0ebf6dbe483f80
.quad 0x3ec4bf35bf6d0000,0x3ec4bf35bf6d0000,0x3f6d3f35bec4bf80,0x3f6d3f35bec4bf80,0xbe48bf6dbf550000,0x3e483f6d3f55250d,0x3f7b3ec4bf0ebf80,0xbf7bbec43f0e3f80
.quad 0xbf6dbf35bec40000,0xbf6dbf35bec40000,0xbec4bf35bf6dbf80,0xbec4bf35bf6dbf80,0xbf0ebec4be480000,0x3f0e3ec43e48250d,0xbf55bf6dbf7bbf80,0x3f553f6d3f7b3f80
.quad 0xbec43f35bf6d3f80,0xbec43f35bf6d3f80,0xbf6d3f35bec4a48d,0xbf6d3f35bec4a48d,0x3f55bec4be483f35,0xbf553ec43e48bf35,0xbf0e3f6dbf7b3f35,0x3f0ebf6d3f7bbf35
.quad 0xbf6d3f353ec4bf80,0xbf6d3f353ec4bf80,0xbec4bf353f6d2554,0xbec4bf353f6d2554,0x3e483f6dbf0ebf35,0xbe48bf6d3f0e3f35,0xbf7b3ec43f55bf35,0x3f7bbec4bf553f35
.quad 0xbf6dbf353ec43f80,0xbf6dbf353ec43f80,0x3ec4bf35bf6da48d,0x3ec4bf35bf6da48d,0xbf0e3ec43f7b3f35,0x3f0ebec4bf7bbf35,0xbf55bf6dbe483f35,0x3f553f6d3e48bf35
.quad 0xbec4bf35bf6dbf80,0xbec4bf35bf6dbf80,0x3f6d3f353ec42554,0x3f6d3f353ec42554,0xbf7bbf6dbf55bf35,0x3f7b3f6d3f553f35,0xbe48bec4bf0ebf35,0x3e483ec43f0e3f35
.quad 0x3f6dbf353ec4250d,0x3f6dbf353ec4250d,0xbec43f35bf6d3f80,0xbec43f35bf6d3f80,0xbe48bec43f55bf80,0x3e483ec4bf553f80,0x3f7bbf6d3f0e2554,0xbf7b3f6dbf0ea48d
.quad 0xbec4bf353f6d250d,0xbec4bf353f6d250d,0x3f6dbf35bec43f80,0x3f6dbf35bec43f80,0xbf0e3f6d3e48bf80,0x3f0ebf6dbe483f80,0xbf55bec43f7b2554,0x3f553ec4bf7ba48d
.quad 0xbec43f353f6d250d,0xbec43f353f6d250d,0xbf6dbf353ec43f80,0xbf6dbf353ec43f80,0x3f7b3ec4bf0ebf80,0xbf7bbec43f0e3f80,0x3e483f6d3f552554,0xbe48bf6dbf55a48d
.quad 0x3f6d3f353ec4250d,0x3f6d3f353ec4250d,0x3ec43f353f6d3f80,0x3ec43f353f6d3f80,0xbf55bf6dbf7bbf80,0x3f553f6d3f7b3f80,0x3f0e3ec43e482554,0xbf0ebec4be48a48d
.quad 0x3ec4bf353f6dbf80,0x3ec4bf353f6dbf80,0x3f6dbf353ec42554,0x3f6dbf353ec42554,0xbf0e3f6dbf7b3f35,0x3f0ebf6d3f7bbf35,0xbf553ec43e48bf35,0x3f55bec4be483f35
.quad 0x3f6dbf35bec43f80,0x3f6dbf35bec43f80,0x3ec43f35bf6da48d,0x3ec43f35bf6da48d,0xbf7b3ec43f55bf35,0x3f7bbec4bf553f35,0xbe48bf6d3f0e3f35,0x3e483f6dbf0ebf35
.quad 0x3f6d3f35bec4bf80,0x3f6d3f35bec4bf80,0xbec43f353f6d2554,0xbec43f353f6d2554,0xbf55bf6dbe483f35,0x3f553f6d3e48bf35,0x3f0ebec4bf7bbf35,0xbf0e3ec43f7b3f35
.quad 0x3ec43f353f6d3f80,0x3ec43f353f6d3f80,0xbf6dbf35bec4a48d,0xbf6dbf35bec4a48d,0xbe48bec4bf0ebf35,0x3e483ec43f0e3f35,0x3f7b3f6d3f553f35,0xbf7bbf6dbf55bf35
.quad 0x3f803f803f803f80,0x3f803f803f803f80,0xbf803f80bf803f80,0xbf803f80bf803f80,0x3f553f6d3f7b3f80,0xbf55bf6dbf7bbf80,0xbf0ebec4be488000,0x3f0e3ec43e48a50d
.quad 0xbf35248d3f353f80,0xbf35248d3f353f80,0xbf35bf80bf358000,0xbf35bf80bf358000,0xbf7bbec43f0e3f80,0x3f7b3ec4bf0ebf80,0xbe48bf6dbf558000,0x3e483f6d3f55a50d
.quad 0xa554bf80248d3f80,0xa554bf80248d3f80,0x3f80a50dbf808000,0x3f80a50dbf808000,0x3f0ebf6dbe483f80,0xbf0e3f6d3e48bf80,0x3f553ec4bf7b8000,0xbf55bec43f7ba50d
.quad 0x3f35a554bf353f80,0x3f35a554bf353f80,0xbf353f80bf358000,0xbf353f80bf358000,0x3e483ec4bf553f80,0xbe48bec43f55bf80,0xbf7b3f6dbf0e8000,0x3f7bbf6d3f0ea50d
.quad 0x3f803f803f803f80,0x3f803f803f803f80,0xbf803f80bf803f80,0xbf803f80bf803f80,0x3e483ec43f0e3f35,0xbe48bec4bf0ebf35,0xbf7bbf6dbf55bf35,0x3f7b3f6d3f553f35
.quad 0x3f35a554bf35bf80,0x3f35a554bf35bf80,0x3f353f803f35a50d,0x3f353f803f35a50d,0x3f553f6d3e48bf35,0xbf55bf6dbe483f35,0xbf0e3ec43f7b3f35,0x3f0ebec4bf7bbf35
.quad 0xa554bf80248d3f80,0xa554bf80248d3f80,0x3f80a50dbf808000,0x3f80a50dbf808000,0x3f7bbec4bf553f35,0xbf7b3ec43f55bf35,0x3e483f6dbf0ebf35,0xbe48bf6d3f0e3f35
.quad 0xbf35248d3f35bf80,0xbf35248d3f35bf80,0x3f35bf803f35a50d,0x3f35bf803f35a50d,0x3f0ebf6d3f7bbf35,0xbf0e3f6dbf7b3f35,0x3f55bec4be483f35,0xbf553ec43e48bf35
.quad 0x3f803f803f803f80,0x3f803f803f803f80,0xbf803f80bf803f80,0xbf803f80bf803f80,0xbf0ebec4be48248d,0x3f0e3ec43e48a554,0xbf55bf6dbf7bbf80,0x3f553f6d3f7b3f80
.quad 0xbf35248d3f353f80,0xbf35248d3f353f80,0xbf35bf80bf358000,0xbf35bf80bf358000,0xbe48bf6dbf55248d,0x3e483f6d3f55a554,0x3f7b3ec4bf0ebf80,0xbf7bbec43f0e3f80
.quad 0xa554bf80248d3f80,0xa554bf80248d3f80,0x3f80a50dbf808000,0x3f80a50dbf808000,0x3f553ec4bf7b248d,0xbf55bec43f7ba554,0xbf0e3f6d3e48bf80,0x3f0ebf6dbe483f80
.quad 0x3f35a554bf353f80,0x3f35a554bf353f80,0xbf353f80bf358000,0xbf353f80bf358000,0xbf7b3f6dbf0e248d,0x3f7bbf6d3f0ea554,0xbe48bec43f55bf80,0x3e483ec4bf553f80
.quad 0x3f803f803f803f80,0x3f803f803f803f80,0xbf803f80bf803f80,0xbf803f80bf803f80,0xbf7bbf6dbf55bf35,0x3f7b3f6d3f553f35,0xbe48bec4bf0ebf35,0x3e483ec43f0e3f35
.quad 0x3f35a554bf35bf80,0x3f35a554bf35bf80,0x3f353f803f35a50d,0x3f353f803f35a50d,0xbf0e3ec43f7b3f35,0x3f0ebec4bf7bbf35,0xbf55bf6dbe483f35,0x3f553f6d3e48bf35
.quad 0xa554bf80248d3f80,0xa554bf80248d3f80,0x3f80a50dbf808000,0x3f80a50dbf808000,0x3e483f6dbf0ebf35,0xbe48bf6d3f0e3f35,0xbf7b3ec43f55bf35,0x3f7bbec4bf553f35
.quad 0xbf35248d3f35bf80,0xbf35248d3f35bf80,0x3f35bf803f35a50d,0x3f35bf803f35a50d,0x3f55bec4be483f35,0xbf553ec43e48bf35,0xbf0e3f6dbf7b3f35,0x3f0ebf6d3f7bbf35
.quad 0x3ec43f353f6d3f80,0x3ec43f353f6d3f80,0xbf6dbf35bec48000,0xbf6dbf35bec48000,0xbe483ec43f553f80,0x3e48bec4bf55bf80,0xbf7bbf6dbf0e8000,0x3f7b3f6d3f0ea50d
.quad 0xbf6dbf353ec43f80,0xbf6dbf353ec43f80,0x3ec4bf35bf6d8000,0x3ec4bf35bf6d8000,0xbf0ebf6d3e483f80,0x3f0e3f6dbe48bf80,0x3f55bec4bf7b8000,0xbf553ec43f7ba50d
.quad 0x3f6dbf35bec43f80,0x3f6dbf35bec43f80,0x3ec43f35bf6d8000,0x3ec43f35bf6d8000,0x3f7bbec4bf0e3f80,0xbf7b3ec43f0ebf80,0xbe483f6dbf558000,0x3e48bf6d3f55a50d
.quad 0xbec43f35bf6d3f80,0xbec43f35bf6d3f80,0xbf6d3f35bec48000,0xbf6d3f35bec48000,0xbf553f6dbf7b3f80,0x3f55bf6d3f7bbf80,0xbf0e3ec4be488000,0x3f0ebec43e48a50d
.quad 0xbf6dbf35bec4248d,0xbf6dbf35bec4248d,0xbec4bf35bf6dbf80,0xbec4bf35bf6dbf80,0xbf0ebf6dbf7bbf35,0x3f0e3f6d3f7b3f35,0x3f553ec4be48bf35,0xbf55bec43e483f35
.quad 0xbec43f353f6da554,0xbec43f353f6da554,0xbf6dbf353ec43f80,0xbf6dbf353ec43f80,0xbf7bbec43f553f35,0x3f7b3ec4bf55bf35,0x3e48bf6dbf0e3f35,0xbe483f6d3f0ebf35
.quad 0x3ec43f35bf6d248d,0x3ec43f35bf6d248d,0xbf6d3f353ec4bf80,0xbf6d3f353ec4bf80,0xbf553f6dbe48bf35,0x3f55bf6d3e483f35,0xbf0ebec43f7bbf35,0x3f0e3ec4bf7b3f35
.quad 0x3f6dbf353ec4a554,0x3f6dbf353ec4a554,0xbec43f35bf6d3f80,0xbec43f35bf6d3f80,0xbe483ec4bf0e3f35,0x3e48bec43f0ebf35,0xbf7b3f6dbf553f35,0x3f7bbf6d3f55bf35
.quad 0xbec4bf35bf6dbf80,0xbec4bf35bf6dbf80,0x3f6d3f353ec4a50d,0x3f6d3f353ec4a50d,0x3f7b3f6d3f0ea554,0xbf7bbf6dbf0e248d,0xbe483ec43f553f80,0x3e48bec4bf55bf80
.quad 0x3f6d3f35bec4bf80,0x3f6d3f35bec4bf80,0xbec43f353f6da50d,0xbec43f353f6da50d,0xbf553ec43f7ba554,0x3f55bec4bf7b248d,0xbf0ebf6d3e483f80,0x3f0e3f6dbe48bf80
.quad 0xbf6d3f353ec4bf80,0xbf6d3f353ec4bf80,0xbec4bf353f6da50d,0xbec4bf353f6da50d,0x3e48bf6d3f55a554,0xbe483f6dbf55248d,0x3f7bbec4bf0e3f80,0xbf7b3ec43f0ebf80
.quad 0x3ec4bf353f6dbf80,0x3ec4bf353f6dbf80,0x3f6dbf353ec4a50d,0x3f6dbf353ec4a50d,0x3f0ebec43e48a554,0xbf0e3ec4be48248d,0xbf553f6dbf7b3f80,0x3f55bf6d3f7bbf80
.quad 0x3f6d3f353ec4a554,0x3f6d3f353ec4a554,0x3ec43f353f6d3f80,0x3ec43f353f6d3f80,0xbf55bec43e483f35,0x3f553ec4be48bf35,0xbf0ebf6dbf7bbf35,0x3f0e3f6d3f7b3f35
.quad 0x3ec4bf35bf6d248d,0x3ec4bf35bf6d248d,0x3f6d3f35bec4bf80,0x3f6d3f35bec4bf80,0xbe483f6d3f0ebf35,0x3e48bf6dbf0e3f35,0xbf7bbec43f553f35,0x3f7b3ec4bf55bf35
.quad 0xbec4bf353f6da554,0xbec4bf353f6da554,0x3f6dbf35bec43f80,0x3f6dbf35bec43f80,0x3f0e3ec4bf7b3f35,0xbf0ebec43f7bbf35,0xbf553f6dbe48bf35,0x3f55bf6d3e483f35
.quad 0xbf6d3f35bec4248d,0xbf6d3f35bec4248d,0x3ec4bf353f6dbf80,0x3ec4bf353f6dbf80,0x3f7bbf6d3f55bf35,0xbf7b3f6dbf553f35,0xbe483ec4bf0e3f35,0x3e48bec43f0ebf35
.quad 0x3f753f7b3f7f3f80,0xbe95be48bdc9248d,0xbe95be48bdc98000,0xbf75bf7bbf7fbf80,0x3f223f553f753f80,0x3f463f0e3e95a554,0xbf46bf0ebe958000,0x3f223f553f753f80
.quad 0xbf62be483f223f80,0xbef1bf7bbf46248d,0xbef1bf7bbf468000,0x3f623e48bf22bf80,0xbf7fbf0e3ef13f80,0xbdc93f553f62a554,0x3dc9bf55bf628000,0xbf7fbf0e3ef13f80
.quad 0x3e95bf7bbdc93f80,0x3f753e48bf7f248d,0x3f753e48bf7f8000,0xbe953f7b3dc9bf80,0x3f46bf55be953f80,0xbf22bf0e3f75a554,0x3f223f0ebf758000,0x3f46bf55be953f80
.quad 0x3ef13e48bf463f80,0xbf623f7bbf22248d,0xbf623f7bbf228000,0xbef1be483f46bf80,0xbdc93f0ebf623f80,0x3f7fbf553ef1a554,0xbf7f3f55bef18000,0xbdc93f0ebf623f80
.quad 0x3f463f553f623f6d,0xbf22bf0ebef1bec4,0xbf22bf0ebef1bec4,0xbf46bf55bf62bf6d,0xbef1be483dc93ec4,0x3f623f7b3f7f3f6d,0xbf62bf7bbf7fbf6d,0xbef1be483dc93ec4
.quad 0x3f7f3f0ebe95bf6d,0x3dc93f553f753ec4,0x3dc93f553f753ec4,0xbf7fbf0e3e953f6d,0x3e953f7b3f22bec4,0x3f753e48bf46bf6d,0xbf75be483f463f6d,0x3e953f7b3f22bec4
.quad 0x3f22bf55bef13f6d,0x3f463f0ebf62bec4,0x3f463f0ebf62bec4,0xbf223f553ef1bf6d,0x3f623e48bf7f3ec4,0x3ef1bf7b3dc93f6d,0xbef13f7bbdc9bf6d,0x3f623e48bf7f3ec4
.quad 0xbdc9bf0e3f75bf6d,0x3f7fbf553e953ec4,0x3f7fbf553e953ec4,0x3dc93f0ebf753f6d,0x3f75bf7b3f46bec4,0xbe95be483f22bf6d,0x3e953e48bf223f6d,0x3f75bf7b3f46bec4
.quad 0x3ef13f0e3f223f35,0xbf62bf55bf46bf35,0xbf62bf55bf46bf35,0xbef1bf0ebf22bf35,0xbf7fbf7bbf62bf35,0xbdc93e483ef13f35,0x3dc9be48bef1bf35,0xbf7fbf7bbf62bf35
.quad 0xbf75bf55bdc93f35,0x3e95bf0ebf7fbf35,0x3e95bf0ebf7fbf35,0x3f753f553dc9bf35,0x3f46be48bf75bf35,0xbf22bf7bbe953f35,0x3f223f7b3e95bf35,0x3f46be48bf75bf35
.quad 0x3f62bf0ebf463f35,0x3ef13f55bf22bf35,0x3ef13f55bf22bf35,0xbf623f0e3f46bf35,0xbdc93f7bbef1bf35,0x3f7fbe48bf623f35,0xbf7f3e483f62bf35,0xbdc93f7bbef1bf35
.quad 0xbe953f55bf7f3f35,0xbf753f0e3dc9bf35,0xbf753f0e3dc9bf35,0x3e95bf553f7fbf35,0xbf223e483e95bf35,0xbf463f7bbf753f35,0x3f46bf7b3f75bf35,0xbf223e483e95bf35
.quad 0x3dc93e483e953ec4,0xbf7fbf7bbf75bf6d,0xbf7fbf7bbf75bf6d,0xbdc9be48be95bec4,0xbe95bf0ebf46bf6d,0xbf75bf55bf22bec4,0x3f753f553f223ec4,0xbe95bf0ebf46bf6d
.quad 0x3f463f7b3ef1bec4,0xbf223e483f623f6d,0xbf223e483f623f6d,0xbf46bf7bbef13ec4,0xbf62bf553dc93f6d,0xbef13f0e3f7f3ec4,0x3ef1bf0ebf7fbec4,0xbf62bf553dc93f6d
.quad 0x3f7fbe48bf753ec4,0x3dc93f7bbe95bf6d,0x3dc93f7bbe95bf6d,0xbf7f3e483f75bec4,0xbf753f0e3f22bf6d,0x3e953f55bf46bec4,0xbe95bf553f463ec4,0xbf753f0e3f22bf6d
.quad 0x3f22bf7b3f62bec4,0x3f46be48bef13f6d,0x3f46be48bef13f6d,0xbf223f7bbf623ec4,0xbef13f55bf7f3f6d,0x3f62bf0e3dc93ec4,0xbf623f0ebdc9bec4,0xbef13f55bf7f3f6d
.quad 0x3dc93f0e3f623f80,0xbf7fbf55bef1248d,0xbf7fbf55bef18000,0xbdc9bf0ebf62bf80,0xbef13e483f463f80,0x3f623f7b3f22a554,0xbf62bf7bbf228000,0xbef13e483f463f80
.quad 0xbf46bf553e953f80,0x3f22bf0ebf75248d,0x3f22bf0ebf758000,0x3f463f55be95bf80,0xbe95bf7b3dc93f80,0xbf753e483f7fa554,0x3f75be48bf7f8000,0xbe95bf7b3dc93f80
.quad 0x3f7fbf0ebef13f80,0x3dc93f55bf62248d,0x3dc93f55bf628000,0xbf7f3f0e3ef1bf80,0x3f62be48bf223f80,0x3ef1bf7b3f46a554,0xbef13f7bbf468000,0x3f62be48bf223f80
.quad 0xbf223f55bf753f80,0xbf463f0ebe95248d,0xbf463f0ebe958000,0x3f22bf553f75bf80,0xbf753f7bbf7f3f80,0x3e95be483dc9a554,0xbe953e48bdc98000,0xbf753f7bbf7f3f80
.quad 0xbf75bf7bbf46bec4,0x3e95be48bf22bf6d,0x3e95be48bf22bf6d,0x3f753f7b3f463ec4,0x3dc9bf0ebf75bf6d,0xbf7fbf55be953ec4,0x3f7f3f553e95bec4,0x3dc9bf0ebf75bf6d
.quad 0xbf623e483f7f3ec4,0xbef1bf7bbdc93f6d,0xbef1bf7bbdc93f6d,0x3f62be48bf7fbec4,0xbf22bf553ef13f6d,0xbf463f0e3f62bec4,0x3f46bf0ebf623ec4,0xbf22bf553ef13f6d
.quad 0xbe953f7bbf22bec4,0xbf753e483f46bf6d,0xbf753e483f46bf6d,0x3e95bf7b3f223ec4,0xbf7f3f0e3e95bf6d,0xbdc93f55bf753ec4,0x3dc9bf553f75bec4,0xbf7f3f0e3e95bf6d
.quad 0x3ef1be48bdc93ec4,0xbf623f7bbf7f3f6d,0xbf623f7bbf7f3f6d,0xbef13e483dc9bec4,0xbf463f55bf623f6d,0x3f22bf0e3ef1bec4,0xbf223f0ebef13ec4,0xbf463f55bf623f6d
.quad 0x3f223e48be95bf35,0x3f463f7b3f753f35,0x3f463f7b3f753f35,0xbf22be483e953f35,0x3e953f553f7f3f35,0x3f753f0ebdc9bf35,0xbf75bf0e3dc93f35,0x3e953f553f7f3f35
.quad 0x3dc93f7b3ef1bf35,0xbf7fbe483f623f35,0xbf7fbe483f623f35,0xbdc9bf7bbef13f35,0xbf62bf0e3f463f35,0xbef13f553f22bf35,0x3ef1bf55bf223f35,0xbf62bf0e3f463f35
.quad 0xbf46be483f75bf35,0x3f22bf7b3e953f35,0x3f22bf7b3e953f35,0x3f463e48bf753f35,0x3f75bf553dc93f35,0xbe95bf0e3f7fbf35,0x3e953f0ebf7f3f35,0x3f75bf553dc93f35
.quad 0x3f7fbf7b3f62bf35,0x3dc93e48bef13f35,0x3dc93e48bef13f35,0xbf7f3f7bbf623f35,0xbef13f0ebf223f35,0x3f62bf553f46bf35,0xbf623f55bf463f35,0xbef13f0ebf223f35
.quad 0x3ef13f553f7f3f6d,0xbf62bf0ebdc93ec4,0xbf62bf0ebdc93ec4,0xbef1bf55bf7fbf6d,0xbf22bf7bbf62bec4,0xbf46be483ef13f6d,0x3f463e48bef1bf6d,0xbf22bf7bbf62bec4
.quad 0x3f753f0ebf22bf6d,0xbe953f553f46bec4,0xbe953f553f46bec4,0xbf75bf0e3f223f6d,0xbf7fbe483f753ec4,0xbdc93f7b3e95bf6d,0x3dc9bf7bbe953f6d,0xbf7fbe483f753ec4
.quad 0x3f62bf55bdc93f6d,0x3ef13f0ebf7f3ec4,0x3ef13f0ebf7f3ec4,0xbf623f553dc9bf6d,0xbf463f7bbef1bec4,0x3f223e48bf623f6d,0xbf22be483f62bf6d,0xbf463f7bbef1bec4
.quad 0x3e95bf0e3f46bf6d,0x3f75bf553f22bec4,0x3f75bf553f22bec4,0xbe953f0ebf463f6d,0xbdc93e48be953ec4,0x3f7fbf7b3f75bf6d,0xbf7f3f7bbf753f6d,0xbdc93e48be953ec4
.quad 0x80003f8080003f80,0x80003f8080003f80,0xbe483f7b80003f80,0xbf0e3f55bec43f6d,0xbec43f6d80003f80,0xbf6d3ec4bf353f35,0xbf0e3f5580003f80,0xbf7bbe48bf6d3ec4
.quad 0xbf80248d80003f80,0x3f80a554a50dbf80,0xbf7bbe4880003f80,0x3f553f0e3ec4bf6d,0xbf6dbec480003f80,0x3ec43f6d3f35bf35,0xbf55bf0e80003f80,0xbe483f7b3f6dbec4
.quad 0xa50dbf8080003f80,0xa50dbf8080003f80,0x3e48bf7b80003f80,0x3f0ebf55bec43f6d,0x3ec4bf6d80003f80,0x3f6dbec4bf353f35,0x3f0ebf5580003f80,0x3f7b3e48bf6d3ec4
.quad 0x3f80a55480003f80,0xbf80248da50dbf80,0x3f7b3e4880003f80,0xbf55bf0e3ec4bf6d,0x3f6d3ec480003f80,0xbec4bf6d3f35bf35,0x3f553f0e80003f80,0x3e48bf7b3f6dbec4
.quad 0x80003f8080003f80,0x80003f8080003f80,0xbf553f0ebf353f35,0xbf7b3e48bf6d3ec4,0xbf6dbec4bf80248d,0xbec4bf6dbf35bf35,0xbe48bf7bbf35bf35,0x3f55bf0e3ec4bf6d
.quad 0xbf80248d80003f80,0x3f80a554a50dbf80,0xbf0ebf55bf353f35,0x3e483f7b3f6dbec4,0x3ec4bf6dbf80248d,0xbf6d3ec43f353f35,0x3f7bbe48bf35bf35,0xbf0ebf55bec43f6d
.quad 0xa50dbf8080003f80,0xa50dbf8080003f80,0x3f55bf0ebf353f35,0x3f7bbe48bf6d3ec4,0x3f6d3ec4bf80248d,0x3ec43f6dbf35bf35,0x3e483f7bbf35bf35,0xbf553f0e3ec4bf6d
.quad 0x3f80a55480003f80,0xbf80248da50dbf80,0x3f0e3f55bf353f35,0xbe48bf7b3f6dbec4,0xbec43f6dbf80248d,0x3f6dbec43f353f35,0xbf7b3e48bf35bf35,0x3f0e3f55bec43f6d
.quad 0x80003f8080003f80,0x80003f8080003f80,0xbf7bbe48bf80248d,0xbf55bf0ebf6dbec4,0x3ec4bf6da50dbf80,0x3f6dbec43f35bf35,0x3f553f0e3f80a554,0xbe483f7b3ec43f6d
.quad 0xbf80248d80003f80,0x3f80a554a50dbf80,0x3e48bf7bbf80248d,0xbf0e3f553f6d3ec4,0x3f6d3ec4a50dbf80,0xbec4bf6dbf353f35,0xbf0e3f553f80a554,0x3f7b3e48bec4bf6d
.quad 0xa50dbf8080003f80,0xa50dbf8080003f80,0x3f7b3e48bf80248d,0x3f553f0ebf6dbec4,0xbec43f6da50dbf80,0xbf6d3ec43f35bf35,0xbf55bf0e3f80a554,0x3e48bf7b3ec43f6d
.quad 0x3f80a55480003f80,0xbf80248da50dbf80,0xbe483f7bbf80248d,0x3f0ebf553f6d3ec4,0xbf6dbec4a50dbf80,0x3ec43f6dbf353f35,0x3f0ebf553f80a554,0xbf7bbe48bec4bf6d
.quad 0x80003f8080003f80,0x80003f8080003f80,0xbf0ebf55bf35bf35,0xbe48bf7bbec4bf6d,0x3f6d3ec43f80a554,0x3ec43f6d3f353f35,0xbf7b3e48bf353f35,0xbf0ebf55bf6dbec4
.quad 0xbf80248d80003f80,0x3f80a554a50dbf80,0x3f55bf0ebf35bf35,0xbf7b3e483ec43f6d,0xbec43f6d3f80a554,0x3f6dbec4bf35bf35,0xbe48bf7bbf353f35,0xbf553f0e3f6d3ec4
.quad 0xa50dbf8080003f80,0xa50dbf8080003f80,0x3f0e3f55bf35bf35,0x3e483f7bbec4bf6d,0xbf6dbec43f80a554,0xbec4bf6d3f353f35,0x3f7bbe48bf353f35,0x3f0e3f55bf6dbec4
.quad 0x3f80a55480003f80,0xbf80248da50dbf80,0xbf553f0ebf35bf35,0x3f7bbe483ec43f6d,0x3ec4bf6d3f80a554,0xbf6d3ec4bf35bf35,0x3e483f7bbf353f35,0x3f55bf0e3f6d3ec4
.quad 0x3f8000003f80,0x3f8000003f80,0xbe48bf7b250dbf80,0xbf0ebf55bec4bf6d,0x3ec43f6d00003f80,0x3f6d3ec43f353f35,0xbf0ebf55250dbf80,0xbf7b3e48bf6dbec4
.quad 0x3f80248d00003f80,0xbf80a554250dbf80,0xbf7b3e48250dbf80,0x3f55bf0e3ec43f6d,0x3f6dbec400003f80,0xbec43f6dbf35bf35,0xbf553f0e250dbf80,0xbe48bf7b3f6d3ec4
.quad 0x250dbf8000003f80,0x250dbf8000003f80,0x3e483f7b250dbf80,0x3f0e3f55bec4bf6d,0xbec4bf6d00003f80,0xbf6dbec43f353f35,0x3f0e3f55250dbf80,0x3f7bbe48bf6dbec4
.quad 0xbf80a55400003f80,0x3f80248d250dbf80,0x3f7bbe48250dbf80,0xbf553f0e3ec43f6d,0xbf6d3ec400003f80,0x3ec4bf6dbf35bf35,0x3f55bf0e250dbf80,0x3e483f7b3f6d3ec4
.quad 0x3f8000003f80,0x3f8000003f80,0xbf55bf0ebf35bf35,0xbf7bbe48bf6dbec4,0x3f6dbec43f80248d,0x3ec4bf6d3f35bf35,0xbe483f7bbf353f35,0x3f553f0e3ec43f6d
.quad 0x3f80248d00003f80,0xbf80a554250dbf80,0xbf0e3f55bf35bf35,0x3e48bf7b3f6d3ec4,0xbec4bf6d3f80248d,0x3f6d3ec4bf353f35,0x3f7b3e48bf353f35,0xbf0e3f55bec4bf6d
.quad 0x250dbf8000003f80,0x250dbf8000003f80,0x3f553f0ebf35bf35,0x3f7b3e48bf6dbec4,0xbf6d3ec43f80248d,0xbec43f6d3f35bf35,0x3e48bf7bbf353f35,0xbf55bf0e3ec43f6d
.quad 0xbf80a55400003f80,0x3f80248d250dbf80,0x3f0ebf55bf35bf35,0xbe483f7b3f6d3ec4,0x3ec43f6d3f80248d,0xbf6dbec4bf353f35,0xbf7bbe48bf353f35,0x3f0ebf55bec4bf6d
.quad 0x3f8000003f80,0x3f8000003f80,0xbf7b3e48bf80a554,0xbf553f0ebf6d3ec4,0xbec4bf6d250dbf80,0xbf6dbec4bf35bf35,0x3f55bf0e3f80248d,0xbe48bf7b3ec4bf6d
.quad 0x3f80248d00003f80,0xbf80a554250dbf80,0x3e483f7bbf80a554,0xbf0ebf553f6dbec4,0xbf6d3ec4250dbf80,0x3ec4bf6d3f353f35,0xbf0ebf553f80248d,0x3f7bbe48bec43f6d
.quad 0x250dbf8000003f80,0x250dbf8000003f80,0x3f7bbe48bf80a554,0x3f55bf0ebf6d3ec4,0x3ec43f6d250dbf80,0x3f6d3ec4bf35bf35,0xbf553f0e3f80248d,0x3e483f7b3ec4bf6d
.quad 0xbf80a55400003f80,0x3f80248d250dbf80,0xbe48bf7bbf80a554,0x3f0e3f553f6dbec4,0x3f6dbec4250dbf80,0xbec43f6d3f353f35,0x3f0e3f553f80248d,0xbf7b3e48bec43f6d
.quad 0x3f8000003f80,0x3f8000003f80,0xbf0e3f55bf353f35,0xbe483f7bbec43f6d,0xbf6d3ec4bf80a554,0xbec43f6dbf353f35,0xbf7bbe48bf35bf35,0xbf0e3f55bf6d3ec4
.quad 0x3f80248d00003f80,0xbf80a554250dbf80,0x3f553f0ebf353f35,0xbf7bbe483ec4bf6d,0x3ec43f6dbf80a554,0xbf6dbec43f35bf35,0xbe483f7bbf35bf35,0xbf55bf0e3f6dbec4
.quad 0x250dbf8000003f80,0x250dbf8000003f80,0x3f0ebf55bf353f35,0x3e48bf7bbec43f6d,0x3f6dbec4bf80a554,0x3ec4bf6dbf353f35,0x3f7b3e48bf35bf35,0x3f0ebf55bf6d3ec4
.quad 0xbf80a55400003f80,0x3f80248d250dbf80,0xbf55bf0ebf353f35,0x3f7b3e483ec4bf6d,0xbec4bf6dbf80a554,0x3f6d3ec43f35bf35,0x3e48bf7bbf35bf35,0x3f553f0e3f6dbec4
.quad 0xbf353f3580003f80,0xbf35bf35bf80248d,0xbf553f0e80003f80,0xbe48bf7bbf6dbec4,0xbf6d3ec480003f80,0x3ec4bf6dbf35bf35,0xbf7b3e4880003f80,0x3f55bf0ebec4bf6d
.quad 0xbf35bf3580003f80,0xbf353f353f80a554,0xbf0ebf5580003f80,0xbf7b3e483f6d3ec4,0xbec4bf6d80003f80,0xbf6dbec43f353f35,0xbe48bf7b80003f80,0xbf0ebf553ec43f6d
.quad 0x3f35bf3580003f80,0x3f353f35bf80248d,0x3f55bf0e80003f80,0x3e483f7bbf6dbec4,0x3f6dbec480003f80,0xbec43f6dbf35bf35,0x3f7bbe4880003f80,0xbf553f0ebec4bf6d
.quad 0x3f353f3580003f80,0x3f35bf353f80a554,0x3f0e3f5580003f80,0x3f7bbe483f6d3ec4,0x3ec43f6d80003f80,0x3f6d3ec43f353f35,0x3e483f7b80003f80,0x3f0e3f553ec43f6d
.quad 0x3f35bf35a50dbf80,0x3f353f353f80a554,0x3f7b3e483f35bf35,0xbf0e3f553ec43f6d,0x3ec43f6d3f80a554,0xbf6dbec4bf353f35,0xbf0e3f553f353f35,0x3e48bf7bbf6dbec4
.quad 0x3f353f35a50dbf80,0x3f35bf35bf80248d,0xbe483f7b3f35bf35,0x3f553f0ebec4bf6d,0xbf6d3ec43f80a554,0xbec43f6d3f35bf35,0xbf55bf0e3f353f35,0xbf7bbe483f6d3ec4
.quad 0xbf353f35a50dbf80,0xbf35bf353f80a554,0xbf7bbe483f35bf35,0x3f0ebf553ec43f6d,0xbec4bf6d3f80a554,0x3f6d3ec4bf353f35,0x3f0ebf553f353f35,0xbe483f7bbf6dbec4
.quad 0xbf35bf35a50dbf80,0xbf353f35bf80248d,0x3e48bf7b3f35bf35,0xbf55bf0ebec4bf6d,0x3f6dbec43f80a554,0x3ec4bf6d3f35bf35,0x3f553f0e3f353f35,0x3f7b3e483f6d3ec4
.quad 0xbf353f3580003f80,0xbf35bf35bf80248d,0xbf0ebf55bf80248d,0x3f7bbe483ec4bf6d,0x3f6dbec4a50dbf80,0xbec43f6d3f353f35,0x3e483f7b3f80a554,0xbf0ebf55bf6d3ec4
.quad 0xbf35bf3580003f80,0xbf353f353f80a554,0x3f55bf0ebf80248d,0xbe48bf7bbec43f6d,0x3ec43f6da50dbf80,0x3f6d3ec4bf35bf35,0xbf7b3e483f80a554,0xbf553f0e3f6dbec4
.quad 0x3f35bf3580003f80,0x3f353f35bf80248d,0x3f0e3f55bf80248d,0xbf7b3e483ec4bf6d,0xbf6d3ec4a50dbf80,0x3ec4bf6d3f353f35,0xbe48bf7b3f80a554,0x3f0e3f55bf6d3ec4
.quad 0x3f353f3580003f80,0x3f35bf353f80a554,0xbf553f0ebf80248d,0x3e483f7bbec43f6d,0xbec4bf6da50dbf80,0xbf6dbec4bf35bf35,0x3f7bbe483f80a554,0x3f55bf0e3f6dbec4
.quad 0x3f35bf35a50dbf80,0x3f353f353f80a554,0xbe483f7b3f353f35,0xbf55bf0ebf6d3ec4,0xbec4bf6dbf80248d,0x3f6d3ec43f35bf35,0x3f553f0e3f35bf35,0xbf7bbe48bec43f6d
.quad 0x3f353f35a50dbf80,0x3f35bf35bf80248d,0xbf7bbe483f353f35,0xbf0e3f553f6dbec4,0x3f6dbec4bf80248d,0x3ec4bf6dbf353f35,0xbf0e3f553f35bf35,0xbe483f7b3ec4bf6d
.quad 0xbf353f35a50dbf80,0xbf35bf353f80a554,0x3e48bf7b3f353f35,0x3f553f0ebf6d3ec4,0x3ec43f6dbf80248d,0xbf6dbec43f35bf35,0xbf55bf0e3f35bf35,0x3f7b3e48bec43f6d
.quad 0xbf35bf35a50dbf80,0xbf353f35bf80248d,0x3f7b3e483f353f35,0x3f0ebf553f6dbec4,0xbf6d3ec4bf80248d,0xbec43f6dbf353f35,0x3f0ebf553f35bf35,0x3e48bf7b3ec4bf6d
.quad 0x3f353f3500003f80,0x3f35bf353f80248d,0xbf55bf0e250dbf80,0xbe483f7bbf6d3ec4,0x3f6d3ec400003f80,0xbec4bf6d3f35bf35,0xbf7bbe48250dbf80,0x3f553f0ebec43f6d
.quad 0x3f35bf3500003f80,0x3f353f35bf80a554,0xbf0e3f55250dbf80,0xbf7bbe483f6dbec4,0x3ec4bf6d00003f80,0x3f6dbec4bf353f35,0xbe483f7b250dbf80,0xbf0e3f553ec4bf6d
.quad 0xbf35bf3500003f80,0xbf353f353f80248d,0x3f553f0e250dbf80,0x3e48bf7bbf6d3ec4,0xbf6dbec400003f80,0x3ec43f6d3f35bf35,0x3f7b3e48250dbf80,0xbf55bf0ebec43f6d
.quad 0xbf353f3500003f80,0xbf35bf35bf80a554,0x3f0ebf55250dbf80,0x3f7b3e483f6dbec4,0xbec43f6d00003f80,0xbf6d3ec4bf353f35,0x3e48bf7b250dbf80,0x3f0ebf553ec4bf6d
.quad 0xbf35bf35250dbf80,0xbf353f35bf80a554,0x3f7bbe483f353f35,0xbf0ebf553ec4bf6d,0xbec43f6dbf80a554,0x3f6dbec43f353f35,0xbf0ebf553f35bf35,0x3e483f7bbf6d3ec4
.quad 0xbf353f35250dbf80,0xbf35bf353f80248d,0xbe48bf7b3f353f35,0x3f55bf0ebec43f6d,0x3f6d3ec4bf80a554,0x3ec43f6dbf35bf35,0xbf553f0e3f35bf35,0xbf7b3e483f6dbec4
.quad 0x3f353f35250dbf80,0x3f35bf35bf80a554,0xbf7b3e483f353f35,0x3f0e3f553ec4bf6d,0x3ec4bf6dbf80a554,0xbf6d3ec43f353f35,0x3f0e3f553f35bf35,0xbe48bf7bbf6d3ec4
.quad 0x3f35bf35250dbf80,0x3f353f353f80248d,0x3e483f7b3f353f35,0xbf553f0ebec43f6d,0xbf6dbec4bf80a554,0xbec4bf6dbf35bf35,0x3f55bf0e3f35bf35,0x3f7bbe483f6dbec4
.quad 0x3f353f3500003f80,0x3f35bf353f80248d,0xbf0e3f55bf80a554,0x3f7b3e483ec43f6d,0xbf6dbec4250dbf80,0x3ec43f6dbf353f35,0x3e48bf7b3f80248d,0xbf0e3f55bf6dbec4
.quad 0x3f35bf3500003f80,0x3f353f35bf80a554,0x3f553f0ebf80a554,0xbe483f7bbec4bf6d,0xbec43f6d250dbf80,0xbf6d3ec43f35bf35,0xbf7bbe483f80248d,0xbf55bf0e3f6d3ec4
.quad 0xbf35bf3500003f80,0xbf353f353f80248d,0x3f0ebf55bf80a554,0xbf7bbe483ec43f6d,0x3f6d3ec4250dbf80,0xbec4bf6dbf353f35,0xbe483f7b3f80248d,0x3f0ebf55bf6dbec4
.quad 0xbf353f3500003f80,0xbf35bf35bf80a554,0xbf55bf0ebf80a554,0x3e48bf7bbec4bf6d,0x3ec4bf6d250dbf80,0x3f6dbec43f35bf35,0x3f7b3e483f80248d,0x3f553f0e3f6d3ec4
.quad 0xbf35bf35250dbf80,0xbf353f35bf80a554,0xbe48bf7b3f35bf35,0xbf553f0ebf6dbec4,0x3ec4bf6d3f80248d,0xbf6d3ec4bf35bf35,0x3f55bf0e3f353f35,0xbf7b3e48bec4bf6d
.quad 0xbf353f35250dbf80,0xbf35bf353f80248d,0xbf7b3e483f35bf35,0xbf0ebf553f6d3ec4,0xbf6dbec43f80248d,0xbec4bf6d3f353f35,0xbf0ebf553f353f35,0xbe48bf7b3ec43f6d
.quad 0x3f353f35250dbf80,0x3f35bf35bf80a554,0x3e483f7b3f35bf35,0x3f55bf0ebf6dbec4,0xbec43f6d3f80248d,0x3f6dbec4bf35bf35,0xbf553f0e3f353f35,0x3f7bbe48bec4bf6d
.quad 0x3f35bf35250dbf80,0x3f353f353f80248d,0x3f7bbe483f35bf35,0x3f0e3f553f6d3ec4,0x3f6d3ec43f80248d,0x3ec43f6d3f353f35,0x3f0e3f553f353f35,0x3e483f7b3ec43f6d
.quad 0x3f8000003f800000,0x3f8000003f800000,0x3f7b3e483f800000,0x3f553f0e3f6d3ec4,0x3f6d3ec43f800000,0x3ec43f6d3f353f35,0x3f553f0e3f800000,0xbe483f7b3ec43f6d
.quad 0x248d3f803f800000,0xa554bf80bf80250d,0xbe483f7b3f800000,0x3f0ebf55bf6dbec4,0xbec43f6d3f800000,0x3f6dbec4bf35bf35,0xbf0e3f553f800000,0x3f7b3e48bec4bf6d
.quad 0xbf80250d3f800000,0xbf80250d3f800000,0xbf7bbe483f800000,0xbf55bf0e3f6d3ec4,0xbf6dbec43f800000,0xbec4bf6d3f353f35,0xbf55bf0e3f800000,0x3e48bf7b3ec43f6d
.quad 0xa554bf803f800000,0x248d3f80bf80250d,0x3e48bf7b3f800000,0xbf0e3f55bf6dbec4,0x3ec4bf6d3f800000,0xbf6d3ec4bf35bf35,0x3f0ebf553f800000,0xbf7bbe48bec4bf6d
.quad 0x3f8000003f800000,0x3f8000003f800000,0x3f0e3f553f353f35,0x3e483f7b3ec43f6d,0xbec43f6d248d3f80,0xbf6d3ec4bf353f35,0xbf7b3e48bf353f35,0xbf0ebf55bf6dbec4
.quad 0x248d3f803f800000,0xa554bf80bf80250d,0xbf553f0e3f353f35,0x3f7bbe48bec4bf6d,0xbf6dbec4248d3f80,0x3ec43f6d3f35bf35,0xbe48bf7bbf353f35,0xbf553f0e3f6d3ec4
.quad 0xbf80250d3f800000,0xbf80250d3f800000,0xbf0ebf553f353f35,0xbe48bf7b3ec43f6d,0x3ec4bf6d248d3f80,0x3f6dbec4bf353f35,0x3f7bbe48bf353f35,0x3f0e3f55bf6dbec4
.quad 0xa554bf803f800000,0x248d3f80bf80250d,0x3f55bf0e3f353f35,0xbf7b3e48bec4bf6d,0x3f6d3ec4248d3f80,0xbec4bf6d3f35bf35,0x3e483f7bbf353f35,0x3f55bf0e3f6d3ec4
.quad 0x3f8000003f800000,0x3f8000003f800000,0xbe483f7b248d3f80,0xbf0e3f55bec43f6d,0xbf6dbec4bf80250d,0xbec4bf6dbf35bf35,0x3f0ebf55a554bf80,0x3f7b3e483f6dbec4
.quad 0x248d3f803f800000,0xa554bf80bf80250d,0xbf7bbe48248d3f80,0x3f553f0e3ec4bf6d,0x3ec4bf6dbf80250d,0xbf6d3ec43f353f35,0x3f553f0ea554bf80,0x3e48bf7bbf6d3ec4
.quad 0xbf80250d3f800000,0xbf80250d3f800000,0x3e48bf7b248d3f80,0x3f0ebf55bec43f6d,0x3f6d3ec4bf80250d,0x3ec43f6dbf35bf35,0xbf0e3f55a554bf80,0xbf7bbe483f6dbec4
.quad 0xa554bf803f800000,0x248d3f80bf80250d,0x3f7b3e48248d3f80,0xbf55bf0e3ec4bf6d,0xbec43f6dbf80250d,0x3f6dbec43f353f35,0xbf55bf0ea554bf80,0xbe483f7bbf6d3ec4
.quad 0x3f8000003f800000,0x3f8000003f800000,0xbf553f0ebf353f35,0xbf7b3e48bf6d3ec4,0x3ec4bf6da554bf80,0x3f6dbec43f35bf35,0x3e483f7b3f353f35,0xbf553f0ebec43f6d
.quad 0x248d3f803f800000,0xa554bf80bf80250d,0xbf0ebf55bf353f35,0x3e483f7b3f6dbec4,0x3f6d3ec4a554bf80,0xbec4bf6dbf353f35,0xbf7b3e483f353f35,0x3f0e3f553ec4bf6d
.quad 0xbf80250d3f800000,0xbf80250d3f800000,0x3f55bf0ebf353f35,0x3f7bbe48bf6d3ec4,0xbec43f6da554bf80,0xbf6d3ec43f35bf35,0xbe48bf7b3f353f35,0x3f55bf0ebec43f6d
.quad 0xa554bf803f800000,0x248d3f80bf80250d,0x3f0e3f55bf353f35,0xbe48bf7b3f6dbec4,0xbf6dbec4a554bf80,0x3ec43f6dbf353f35,0x3f7bbe483f353f35,0xbf0ebf553ec4bf6d
.quad 0xbf800000bf800000,0xbf800000bf800000,0x3f7bbe483f80250d,0x3f55bf0e3f6dbec4,0xbf6d3ec4bf800000,0xbec43f6dbf353f35,0x3f55bf0e3f80250d,0xbe48bf7b3ec4bf6d
.quad 0xa48d3f80bf800000,0x2554bf803f80250d,0xbe48bf7b3f80250d,0x3f0e3f55bf6d3ec4,0x3ec43f6dbf800000,0xbf6dbec43f35bf35,0xbf0ebf553f80250d,0x3f7bbe48bec43f6d
.quad 0x3f80250dbf800000,0x3f80250dbf800000,0xbf7b3e483f80250d,0xbf553f0e3f6dbec4,0x3f6dbec4bf800000,0x3ec4bf6dbf353f35,0xbf553f0e3f80250d,0x3e483f7b3ec4bf6d
.quad 0x2554bf80bf800000,0xa48d3f803f80250d,0x3e483f7b3f80250d,0xbf0ebf55bf6d3ec4,0xbec4bf6dbf800000,0x3f6d3ec43f35bf35,0x3f0e3f553f80250d,0xbf7b3e48bec43f6d
.quad 0xbf800000bf800000,0xbf800000bf800000,0x3f0ebf553f35bf35,0x3e48bf7b3ec4bf6d,0x3ec43f6da48d3f80,0x3f6d3ec43f353f35,0xbf7bbe48bf35bf35,0xbf0e3f55bf6d3ec4
.quad 0xa48d3f80bf800000,0x2554bf803f80250d,0xbf55bf0e3f35bf35,0x3f7b3e48bec43f6d,0x3f6dbec4a48d3f80,0xbec43f6dbf35bf35,0xbe483f7bbf35bf35,0xbf55bf0e3f6dbec4
.quad 0x3f80250dbf800000,0x3f80250dbf800000,0xbf0e3f553f35bf35,0xbe483f7b3ec4bf6d,0xbec4bf6da48d3f80,0xbf6dbec43f353f35,0x3f7b3e48bf35bf35,0x3f0ebf55bf6d3ec4
.quad 0x2554bf80bf800000,0xa48d3f803f80250d,0x3f553f0e3f35bf35,0xbf7bbe48bec43f6d,0xbf6d3ec4a48d3f80,0x3ec4bf6dbf35bf35,0x3e48bf7bbf35bf35,0x3f553f0e3f6dbec4
.quad 0xbf800000bf800000,0xbf800000bf800000,0xbe48bf7b2554bf80,0xbf0ebf55bec4bf6d,0x3f6dbec43f80250d,0x3ec4bf6d3f35bf35,0x3f0e3f55a48d3f80,0x3f7bbe483f6d3ec4
.quad 0xa48d3f80bf800000,0x2554bf803f80250d,0xbf7b3e482554bf80,0x3f55bf0e3ec43f6d,0xbec4bf6d3f80250d,0x3f6d3ec4bf353f35,0x3f55bf0ea48d3f80,0x3e483f7bbf6dbec4
.quad 0x3f80250dbf800000,0x3f80250dbf800000,0x3e483f7b2554bf80,0x3f0e3f55bec4bf6d,0xbf6d3ec43f80250d,0xbec43f6d3f35bf35,0xbf0ebf55a48d3f80,0xbf7b3e483f6d3ec4
.quad 0x2554bf80bf800000,0xa48d3f803f80250d,0x3f7bbe482554bf80,0xbf553f0e3ec43f6d,0x3ec43f6d3f80250d,0xbf6dbec4bf353f35,0xbf553f0ea48d3f80,0xbe48bf7bbf6dbec4
.quad 0xbf800000bf800000,0xbf800000bf800000,0xbf55bf0ebf35bf35,0xbf7bbe48bf6dbec4,0xbec4bf6d2554bf80,0xbf6dbec4bf35bf35,0x3e48bf7b3f35bf35,0xbf55bf0ebec4bf6d
.quad 0xa48d3f80bf800000,0x2554bf803f80250d,0xbf0e3f55bf35bf35,0x3e48bf7b3f6d3ec4,0xbf6d3ec42554bf80,0x3ec4bf6d3f353f35,0xbf7bbe483f35bf35,0x3f0ebf553ec43f6d
.quad 0x3f80250dbf800000,0x3f80250dbf800000,0x3f553f0ebf35bf35,0x3f7b3e48bf6dbec4,0x3ec43f6d2554bf80,0x3f6d3ec4bf35bf35,0xbe483f7b3f35bf35,0x3f553f0ebec4bf6d
.quad 0x2554bf80bf800000,0xa48d3f803f80250d,0x3f0ebf55bf35bf35,0xbe483f7b3f6d3ec4,0x3f6dbec42554bf80,0xbec43f6d3f353f35,0x3f7b3e483f35bf35,0xbf0e3f553ec43f6d
.quad 0x3f353f353f800000,0xbf353f35248d3f80,0x3f0e3f553f800000,0xbf7b3e48bec43f6d,0x3ec43f6d3f800000,0xbf6dbec4bf353f35,0x3e483f7b3f800000,0xbf0ebf55bf6d3ec4
.quad 0xbf353f353f800000,0x3f353f35a554bf80,0xbf553f0e3f800000,0x3e483f7b3ec4bf6d,0xbf6d3ec43f800000,0xbec43f6d3f35bf35,0xbf7b3e483f800000,0xbf553f0e3f6dbec4
.quad 0xbf35bf353f800000,0x3f35bf35248d3f80,0xbf0ebf553f800000,0x3f7bbe48bec43f6d,0xbec4bf6d3f800000,0x3f6d3ec4bf353f35,0xbe48bf7b3f800000,0x3f0e3f55bf6d3ec4
.quad 0x3f35bf353f800000,0xbf35bf35a554bf80,0x3f55bf0e3f800000,0xbe48bf7b3ec4bf6d,0x3f6dbec43f800000,0x3ec4bf6d3f35bf35,0x3f7bbe483f800000,0x3f55bf0e3f6dbec4
.quad 0xbf35bf35bf80250d,0x3f35bf35a554bf80,0x3e48bf7bbf35bf35,0x3f553f0e3f6dbec4,0x3f6dbec4a554bf80,0xbec43f6d3f353f35,0x3f553f0e3f35bf35,0xbf7bbe48bec43f6d
.quad 0x3f35bf35bf80250d,0xbf35bf35248d3f80,0x3f7b3e48bf35bf35,0x3f0ebf55bf6d3ec4,0x3ec43f6da554bf80,0x3f6d3ec4bf35bf35,0xbf0e3f553f35bf35,0xbe483f7b3ec4bf6d
.quad 0x3f353f35bf80250d,0xbf353f35a554bf80,0xbe483f7bbf35bf35,0xbf55bf0e3f6dbec4,0xbf6d3ec4a554bf80,0x3ec4bf6d3f353f35,0xbf55bf0e3f35bf35,0x3f7b3e48bec43f6d
.quad 0xbf353f35bf80250d,0x3f353f35248d3f80,0xbf7bbe48bf35bf35,0xbf0e3f55bf6d3ec4,0xbec4bf6da554bf80,0xbf6dbec4bf35bf35,0x3f0ebf553f35bf35,0x3e48bf7b3ec4bf6d
.quad 0x3f353f353f800000,0xbf353f35248d3f80,0xbf553f0e248d3f80,0xbe48bf7bbf6dbec4,0xbec4bf6dbf80250d,0x3f6d3ec43f35bf35,0x3f7bbe48a554bf80,0xbf553f0e3ec43f6d
.quad 0xbf353f353f800000,0x3f353f35a554bf80,0xbf0ebf55248d3f80,0xbf7b3e483f6d3ec4,0x3f6dbec4bf80250d,0x3ec4bf6dbf353f35,0x3e483f7ba554bf80,0x3f0e3f55bec4bf6d
.quad 0xbf35bf353f800000,0x3f35bf35248d3f80,0x3f55bf0e248d3f80,0x3e483f7bbf6dbec4,0x3ec43f6dbf80250d,0xbf6dbec43f35bf35,0xbf7b3e48a554bf80,0x3f55bf0e3ec43f6d
.quad 0x3f35bf353f800000,0xbf35bf35a554bf80,0x3f0e3f55248d3f80,0x3f7bbe483f6d3ec4,0xbf6d3ec4bf80250d,0xbec43f6dbf353f35,0xbe48bf7ba554bf80,0xbf0ebf55bec4bf6d
.quad 0xbf35bf35bf80250d,0x3f35bf35a554bf80,0x3f7b3e483f35bf35,0xbf0e3f553ec43f6d,0xbf6d3ec4248d3f80,0x3ec4bf6dbf35bf35,0x3f0ebf55bf35bf35,0xbe483f7b3f6d3ec4
.quad 0x3f35bf35bf80250d,0xbf35bf35248d3f80,0xbe483f7b3f35bf35,0x3f553f0ebec4bf6d,0xbec4bf6d248d3f80,0xbf6dbec43f353f35,0x3f553f0ebf35bf35,0x3f7b3e48bf6dbec4
.quad 0x3f353f35bf80250d,0xbf353f35a554bf80,0xbf7bbe483f35bf35,0x3f0ebf553ec43f6d,0x3f6dbec4248d3f80,0xbec43f6dbf35bf35,0xbf0e3f55bf35bf35,0x3e48bf7b3f6d3ec4
.quad 0xbf353f35bf80250d,0x3f353f35248d3f80,0x3e48bf7b3f35bf35,0xbf55bf0ebec4bf6d,0x3ec43f6d248d3f80,0x3f6d3ec43f353f35,0xbf55bf0ebf35bf35,0xbf7bbe48bf6dbec4
.quad 0xbf353f35bf800000,0x3f353f35a48d3f80,0x3f0ebf553f80250d,0xbf7bbe48bec4bf6d,0xbec43f6dbf800000,0x3f6dbec43f353f35,0x3e48bf7b3f80250d,0xbf0e3f55bf6dbec4
.quad 0x3f353f35bf800000,0xbf353f352554bf80,0xbf55bf0e3f80250d,0x3e48bf7b3ec43f6d,0x3f6d3ec4bf800000,0x3ec43f6dbf35bf35,0xbf7bbe483f80250d,0xbf55bf0e3f6d3ec4
.quad 0x3f35bf35bf800000,0xbf35bf35a48d3f80,0xbf0e3f553f80250d,0x3f7b3e48bec4bf6d,0x3ec4bf6dbf800000,0xbf6d3ec43f353f35,0xbe483f7b3f80250d,0x3f0ebf55bf6dbec4
.quad 0xbf35bf35bf800000,0x3f35bf352554bf80,0x3f553f0e3f80250d,0xbe483f7b3ec43f6d,0xbf6dbec4bf800000,0xbec4bf6dbf35bf35,0x3f7b3e483f80250d,0x3f553f0e3f6d3ec4
.quad 0x3f35bf353f80250d,0xbf35bf352554bf80,0x3e483f7bbf353f35,0x3f55bf0e3f6d3ec4,0xbf6dbec42554bf80,0x3ec43f6dbf353f35,0x3f55bf0e3f353f35,0xbf7b3e48bec4bf6d
.quad 0xbf35bf353f80250d,0x3f35bf35a48d3f80,0x3f7bbe48bf353f35,0x3f0e3f55bf6dbec4,0xbec43f6d2554bf80,0xbf6d3ec43f35bf35,0xbf0ebf553f353f35,0xbe48bf7b3ec43f6d
.quad 0xbf353f353f80250d,0x3f353f352554bf80,0xbe48bf7bbf353f35,0xbf553f0e3f6d3ec4,0x3f6d3ec42554bf80,0xbec4bf6dbf353f35,0xbf553f0e3f353f35,0x3f7bbe48bec4bf6d
.quad 0x3f353f353f80250d,0xbf353f35a48d3f80,0xbf7b3e48bf353f35,0xbf0ebf55bf6dbec4,0x3ec4bf6d2554bf80,0x3f6dbec43f35bf35,0x3f0e3f553f353f35,0x3e483f7b3ec43f6d
.quad 0xbf353f35bf800000,0x3f353f35a48d3f80,0xbf55bf0e2554bf80,0xbe483f7bbf6d3ec4,0x3ec4bf6d3f80250d,0xbf6d3ec4bf35bf35,0x3f7b3e48a48d3f80,0xbf55bf0e3ec4bf6d
.quad 0x3f353f35bf800000,0xbf353f352554bf80,0xbf0e3f552554bf80,0xbf7bbe483f6dbec4,0xbf6dbec43f80250d,0xbec4bf6d3f353f35,0x3e48bf7ba48d3f80,0x3f0ebf55bec43f6d
.quad 0x3f35bf35bf800000,0xbf35bf35a48d3f80,0x3f553f0e2554bf80,0x3e48bf7bbf6d3ec4,0xbec43f6d3f80250d,0x3f6dbec4bf35bf35,0xbf7bbe48a48d3f80,0x3f553f0e3ec4bf6d
.quad 0xbf35bf35bf800000,0x3f35bf352554bf80,0x3f0ebf552554bf80,0x3f7b3e483f6dbec4,0x3f6d3ec43f80250d,0x3ec43f6d3f353f35,0xbe483f7ba48d3f80,0xbf0e3f55bec43f6d
.quad 0x3f35bf353f80250d,0xbf35bf352554bf80,0x3f7bbe483f353f35,0xbf0ebf553ec4bf6d,0x3f6d3ec4a48d3f80,0xbec4bf6d3f35bf35,0x3f0e3f55bf353f35,0xbe48bf7b3f6dbec4
.quad 0xbf35bf353f80250d,0x3f35bf35a48d3f80,0xbe48bf7b3f353f35,0x3f55bf0ebec43f6d,0x3ec4bf6da48d3f80,0x3f6dbec4bf353f35,0x3f55bf0ebf353f35,0x3f7bbe48bf6d3ec4
.quad 0xbf353f353f80250d,0x3f353f352554bf80,0xbf7b3e483f353f35,0x3f0e3f553ec4bf6d,0xbf6dbec4a48d3f80,0x3ec43f6d3f35bf35,0xbf0ebf55bf353f35,0x3e483f7b3f6dbec4
.quad 0x3f353f353f80250d,0xbf353f35a48d3f80,0x3e483f7b3f353f35,0xbf553f0ebec43f6d,0xbec43f6da48d3f80,0xbf6d3ec4bf353f35,0xbf553f0ebf353f35,0xbf7b3e48bf6d3ec4
.quad 0x800040003f803f80,0x8000400080004000,0xbec83ffbbf803f80,0xbf8e3fd5bf443fed,0xbf443fed3f803f80,0xbfed3f44bfb53fb5,0xbf8e3fd5bf803f80,0xbffbbec8bfed3f44
.quad 0xc000250d3f803f80,0x4000a5d4a58dc000,0xbffbbec8bf803f80,0x3fd53f8e3f44bfed,0xbfedbf443f803f80,0x3f443fed3fb5bfb5,0xbfd5bf8ebf803f80,0xbec83ffb3fedbf44
.quad 0xa58dc0003f803f80,0xa58dc00080004000,0x3ec8bffbbf803f80,0x3f8ebfd5bf443fed,0x3f44bfed3f803f80,0x3fedbf44bfb53fb5,0x3f8ebfd5bf803f80,0x3ffb3ec8bfed3f44
.quad 0x4000a5d43f803f80,0xc000250da58dc000,0x3ffb3ec8bf803f80,0xbfd5bf8e3f44bfed,0x3fed3f443f803f80,0xbf44bfed3fb5bfb5,0x3fd53f8ebf803f80,0x3ec8bffb3fedbf44
.quad 0x8000400080004000,0x8000400080004000,0xbfd53f8ebfb53fb5,0xbffb3ec8bfed3f44,0xbfedbf44c000250d,0xbf44bfedbfb5bfb5,0xbec8bffbbfb5bfb5,0x3fd5bf8e3f44bfed
.quad 0xc000250d80004000,0x4000a5d4a58dc000,0xbf8ebfd5bfb53fb5,0x3ec83ffb3fedbf44,0x3f44bfedc000250d,0xbfed3f443fb53fb5,0x3ffbbec8bfb5bfb5,0xbf8ebfd5bf443fed
.quad 0xa58dc00080004000,0xa58dc00080004000,0x3fd5bf8ebfb53fb5,0x3ffbbec8bfed3f44,0x3fed3f44c000250d,0x3f443fedbfb5bfb5,0x3ec83ffbbfb5bfb5,0xbfd53f8e3f44bfed
.quad 0x4000a5d480004000,0xc000250da58dc000,0x3f8e3fd5bfb53fb5,0xbec8bffb3fedbf44,0xbf443fedc000250d,0x3fedbf443fb53fb5,0xbffb3ec8bfb5bfb5,0x3f8e3fd5bf443fed
.quad 0x8000400080004000,0x8000400080004000,0xbffbbec8c000250d,0xbfd5bf8ebfedbf44,0x3f44bfeda58dc000,0x3fedbf443fb5bfb5,0x3fd53f8e4000a5d4,0xbec83ffb3f443fed
.quad 0xc000250d80004000,0x4000a5d4a58dc000,0x3ec8bffbc000250d,0xbf8e3fd53fed3f44,0x3fed3f44a58dc000,0xbf44bfedbfb53fb5,0xbf8e3fd54000a5d4,0x3ffb3ec8bf44bfed
.quad 0xa58dc00080004000,0xa58dc00080004000,0x3ffb3ec8c000250d,0x3fd53f8ebfedbf44,0xbf443feda58dc000,0xbfed3f443fb5bfb5,0xbfd5bf8e4000a5d4,0x3ec8bffb3f443fed
.quad 0x4000a5d480004000,0xc000250da58dc000,0xbec83ffbc000250d,0x3f8ebfd53fed3f44,0xbfedbf44a58dc000,0x3f443fedbfb53fb5,0x3f8ebfd54000a5d4,0xbffbbec8bf44bfed
.quad 0x8000400080004000,0x8000400080004000,0xbf8ebfd5bfb5bfb5,0xbec8bffbbf44bfed,0x3fed3f444000a5d4,0x3f443fed3fb53fb5,0xbffb3ec8bfb53fb5,0xbf8ebfd5bfedbf44
.quad 0xc000250d80004000,0x4000a5d4a58dc000,0x3fd5bf8ebfb5bfb5,0xbffb3ec83f443fed,0xbf443fed4000a5d4,0x3fedbf44bfb5bfb5,0xbec8bffbbfb53fb5,0xbfd53f8e3fed3f44
.quad 0xa58dc00080004000,0xa58dc00080004000,0x3f8e3fd5bfb5bfb5,0x3ec83ffbbf44bfed,0xbfedbf444000a5d4,0xbf44bfed3fb53fb5,0x3ffbbec8bfb53fb5,0x3f8e3fd5bfedbf44
.quad 0x4000a5d480004000,0xc000250da58dc000,0xbfd53f8ebfb5bfb5,0x3ffbbec83f443fed,0x3f44bfed4000a5d4,0xbfed3f44bfb5bfb5,0x3ec83ffbbfb53fb5,0x3fd5bf8e3fed3f44
.quad 0xbfb53fb53f803f80,0xbfb5bfb5c000250d,0xbfd53f8ebf803f80,0xbec8bffbbfedbf44,0xbfed3f443f803f80,0x3f44bfedbfb5bfb5,0xbffb3ec8bf803f80,0x3fd5bf8ebf44bfed
.quad 0xbfb5bfb53f803f80,0xbfb53fb54000a5d4,0xbf8ebfd5bf803f80,0xbffb3ec83fed3f44,0xbf44bfed3f803f80,0xbfedbf443fb53fb5,0xbec8bffbbf803f80,0xbf8ebfd53f443fed
.quad 0x3fb5bfb53f803f80,0x3fb53fb5c000250d,0x3fd5bf8ebf803f80,0x3ec83ffbbfedbf44,0x3fedbf443f803f80,0xbf443fedbfb5bfb5,0x3ffbbec8bf803f80,0xbfd53f8ebf44bfed
.quad 0x3fb53fb53f803f80,0x3fb5bfb54000a5d4,0x3f8e3fd5bf803f80,0x3ffbbec83fed3f44,0x3f443fed3f803f80,0x3fed3f443fb53fb5,0x3ec83ffbbf803f80,0x3f8e3fd53f443fed
.quad 0x3fb5bfb5a58dc000,0x3fb53fb54000a5d4,0x3ffb3ec83fb5bfb5,0xbf8e3fd53f443fed,0x3f443fed4000a5d4,0xbfedbf44bfb53fb5,0xbf8e3fd53fb53fb5,0x3ec8bffbbfedbf44
.quad 0x3fb53fb5a58dc000,0x3fb5bfb5c000250d,0xbec83ffb3fb5bfb5,0x3fd53f8ebf44bfed,0xbfed3f444000a5d4,0xbf443fed3fb5bfb5,0xbfd5bf8e3fb53fb5,0xbffbbec83fed3f44
.quad 0xbfb53fb5a58dc000,0xbfb5bfb54000a5d4,0xbffbbec83fb5bfb5,0x3f8ebfd53f443fed,0xbf44bfed4000a5d4,0x3fed3f44bfb53fb5,0x3f8ebfd53fb53fb5,0xbec83ffbbfedbf44
.quad 0xbfb5bfb5a58dc000,0xbfb53fb5c000250d,0x3ec8bffb3fb5bfb5,0xbfd5bf8ebf44bfed,0x3fedbf444000a5d4,0x3f44bfed3fb5bfb5,0x3fd53f8e3fb53fb5,0x3ffb3ec83fed3f44
.quad 0xbfb53fb580004000,0xbfb5bfb5c000250d,0xbf8ebfd5c000250d,0x3ffbbec83f44bfed,0x3fedbf44a58dc000,0xbf443fed3fb53fb5,0x3ec83ffb4000a5d4,0xbf8ebfd5bfed3f44
.quad 0xbfb5bfb580004000,0xbfb53fb54000a5d4,0x3fd5bf8ec000250d,0xbec8bffbbf443fed,0x3f443feda58dc000,0x3fed3f44bfb5bfb5,0xbffb3ec84000a5d4,0xbfd53f8e3fedbf44
.quad 0x3fb5bfb580004000,0x3fb53fb5c000250d,0x3f8e3fd5c000250d,0xbffb3ec83f44bfed,0xbfed3f44a58dc000,0x3f44bfed3fb53fb5,0xbec8bffb4000a5d4,0x3f8e3fd5bfed3f44
.quad 0x3fb53fb580004000,0x3fb5bfb54000a5d4,0xbfd53f8ec000250d,0x3ec83ffbbf443fed,0xbf44bfeda58dc000,0xbfedbf44bfb5bfb5,0x3ffbbec84000a5d4,0x3fd5bf8e3fedbf44
.quad 0x3fb5bfb5a58dc000,0x3fb53fb54000a5d4,0xbec83ffb3fb53fb5,0xbfd5bf8ebfed3f44,0xbf44bfedc000250d,0x3fed3f443fb5bfb5,0x3fd53f8e3fb5bfb5,0xbffbbec8bf443fed
.quad 0x3fb53fb5a58dc000,0x3fb5bfb5c000250d,0xbffbbec83fb53fb5,0xbf8e3fd53fedbf44,0x3fedbf44c000250d,0x3f44bfedbfb53fb5,0xbf8e3fd53fb5bfb5,0xbec83ffb3f44bfed
.quad 0xbfb53fb5a58dc000,0xbfb5bfb54000a5d4,0x3ec8bffb3fb53fb5,0x3fd53f8ebfed3f44,0x3f443fedc000250d,0xbfedbf443fb5bfb5,0xbfd5bf8e3fb5bfb5,0x3ffb3ec8bf443fed
.quad 0xbfb5bfb5a58dc000,0xbfb53fb5c000250d,0x3ffb3ec83fb53fb5,0x3f8ebfd53fedbf44,0xbfed3f44c000250d,0xbf443fedbfb53fb5,0x3f8ebfd53fb5bfb5,0x3ec8bffb3f44bfed
.quad 0x8000400080004000,0x8000400080004000,0xbf153ff5be493fff,0xbfa23fc6bf713fe2,0xbf8e3fd5bec83ffb,0xbffb3ec8bfd53f8e,0xbfc63fa2bf153ff5,0xbfe2bf71bfff3e49
.quad 0xbfb5bfb5bfb53fb5,0x3fb53fb53fb5bfb5,0xbf71bfe2bfc63fa2,0x3e493fff3ff5bf15,0xbec8bffbbfd53f8e,0xbf8e3fd53ffb3ec8,0x3e49bfffbfe23f71,0xbff53f153fc63fa2
.quad 0x4000a5d4c000250d,0x4000a5d4c000250d,0x3ff53f15bfffbe49,0x3fc63fa2bfe2bf71,0x3fd53f8ebffbbec8,0x3ec83ffbbf8ebfd5,0x3fa23fc6bff5bf15,0xbf713fe2be49bfff
.quad 0xbfb53fb5bfb5bfb5,0x3fb5bfb53fb53fb5,0xbfe23f71bfa2bfc6,0x3fffbe493f153ff5,0xbffb3ec8bf8ebfd5,0x3fd53f8ebec83ffb,0xbfffbe49bf71bfe2,0x3f153ff5bfa23fc6
.quad 0x8000400080004000,0x8000400080004000,0xbfe23f71bfc63fa2,0xbfff3e49bff53f15,0xbfd5bf8ebffbbec8,0xbec8bffbbf8ebfd5,0x3e49bfffbf71bfe2,0x3ff5bf153fa2bfc6
.quad 0xbfb5bfb5bfb53fb5,0x3fb53fb53fb5bfb5,0x3f15bff5bfffbe49,0xbfa23fc63fe23f71,0x3ffbbec8bf8ebfd5,0xbfd5bf8ebec83ffb,0x3fa23fc63f15bff5,0x3f71bfe2bfff3e49
.quad 0x4000a5d4c000250d,0x4000a5d4c000250d,0x3f713fe2bfa2bfc6,0x3e493fffbf15bff5,0xbf8e3fd53ec8bffb,0xbffb3ec83fd5bf8e,0xbfffbe493fe2bf71,0xbf15bff53fc63fa2
.quad 0xbfb53fb5bfb5bfb5,0x3fb5bfb53fb53fb5,0xbff5bf153e49bfff,0x3fc63fa2bf713fe2,0xbec8bffb3fd5bf8e,0xbf8e3fd5bffbbec8,0x3fc6bfa23ff53f15,0xbfe2bf71be49bfff
.quad 0x8000400080004000,0x8000400080004000,0xbff5bf15bfffbe49,0xbfc6bfa2bfe2bf71,0x3f8ebfd53ec8bffb,0x3ffbbec83fd5bf8e,0x3fa23fc63ff53f15,0xbf713fe23e493fff
.quad 0xbfb5bfb5bfb53fb5,0x3fb53fb53fb5bfb5,0x3fe2bf71bfa2bfc6,0xbfff3e493f153ff5,0x3ec83ffb3fd5bf8e,0x3f8ebfd5bffbbec8,0xbfffbe493f713fe2,0x3f153ff53fa2bfc6
.quad 0x4000a5d4c000250d,0x4000a5d4c000250d,0xbf153ff53e49bfff,0xbfa23fc63f71bfe2,0xbfd5bf8e3ffb3ec8,0xbec8bffb3f8e3fd5,0x3fc6bfa2bf153ff5,0x3fe23f71bfff3e49
.quad 0xbfb53fb5bfb5bfb5,0x3fb5bfb53fb53fb5,0xbf71bfe23fc6bfa2,0x3e493fffbff53f15,0x3ffbbec83f8e3fd5,0xbfd5bf8e3ec8bffb,0xbe493fffbfe23f71,0x3ff5bf153fc63fa2
.quad 0x8000400080004000,0x8000400080004000,0xbf71bfe2bfa2bfc6,0xbe49bfffbf15bff5,0x3fd53f8e3ffb3ec8,0x3ec83ffb3f8e3fd5,0xbfffbe49bfe23f71,0xbf15bff5bfc6bfa2
.quad 0xbfb5bfb5bfb53fb5,0x3fb53fb53fb5bfb5,0x3ff53f153e49bfff,0xbfc6bfa2bf713fe2,0xbffb3ec83f8e3fd5,0x3fd53f8e3ec8bffb,0x3fc6bfa2bff5bf15,0xbfe2bf713e493fff
.quad 0x4000a5d4c000250d,0x4000a5d4c000250d,0xbfe23f713fc6bfa2,0xbfff3e493ff5bf15,0x3f8ebfd5bec83ffb,0x3ffbbec8bfd53f8e,0xbe493fffbf71bfe2,0xbff53f153fa2bfc6
.quad 0xbfb53fb5bfb5bfb5,0x3fb5bfb53fb53fb5,0x3f15bff53fff3e49,0xbfa23fc6bfe2bf71,0x3ec83ffbbfd53f8e,0x3f8ebfd53ffb3ec8,0xbfa2bfc63f15bff5,0xbf713fe2bfff3e49
.quad 0xbfed3f44bf443fed,0xbf44bfedbfedbf44,0xbfff3e49bf713fe2,0x3f15bff5bfa2bfc6,0xbffbbec8bf8e3fd5,0x3fd5bf8ebec8bffb,0xbfe2bf71bfa23fc6,0x3fff3e493f15bff5
.quad 0x3f44bfedbfed3f44,0xbfedbf443f443fed,0x3fa2bfc6bff53f15,0xbf71bfe2be493fff,0x3fd5bf8ebffb3ec8,0x3ec8bffbbf8e3fd5,0x3ff5bf15bfff3e49,0x3fc6bfa2bfe23f71
.quad 0x3f443fedbfedbf44,0xbfed3f443f44bfed,0x3e493fffbfe2bf71,0xbff5bf153fc6bfa2,0xbec83ffbbfd5bf8e,0xbf8ebfd53ffbbec8,0xbf713fe2bfc6bfa2,0x3e49bfff3ff53f15
.quad 0xbfedbf44bf44bfed,0xbf443fedbfed3f44,0xbfc6bfa2bf15bff5,0xbfe23f71bfffbe49,0xbf8ebfd5bec8bffb,0xbffbbec8bfd5bf8e,0xbf15bff5be49bfff,0xbfa2bfc6bf71bfe2
.quad 0x3fedbf443f44bfed,0x3f443fed3fed3f44,0x3fc63fa23ff5bf15,0xbfe23f71be493fff,0xbec83ffb3fd53f8e,0xbf8ebfd5bffb3ec8,0xbff53f153e493fff,0x3fc6bfa2bf71bfe2
.quad 0xbf443fed3fedbf44,0x3fed3f44bf44bfed,0xbfff3e493fe23f71,0xbf153ff53fc6bfa2,0xbf8ebfd53ec83ffb,0xbffbbec83fd53f8e,0x3f71bfe2bfa23fc6,0x3e49bfffbf153ff5
.quad 0xbf44bfed3fed3f44,0x3fedbf44bf443fed,0x3fa2bfc63f153ff5,0x3f713fe2bfffbe49,0x3ffb3ec8bf8e3fd5,0xbfd53f8ebec8bffb,0x3f153ff5bfff3e49,0xbfa2bfc63fe2bf71
.quad 0x3fed3f443f443fed,0x3f44bfed3fedbf44,0x3e493fffbf713fe2,0x3ff53f153fa23fc6,0xbfd53f8ebffb3ec8,0xbec83ffbbf8e3fd5,0xbfe2bf71bfc6bfa2,0xbfffbe49bff5bf15
.quad 0xbfed3f44bf443fed,0xbf44bfedbfedbf44,0xbe49bfffbfe2bf71,0x3ff53f153fc6bfa2,0x3ffb3ec83f8ebfd5,0xbfd53f8e3ec83ffb,0xbf713fe23fc63fa2,0x3e49bfffbff5bf15
.quad 0x3f44bfedbfed3f44,0xbfedbf443f443fed,0x3fc63fa2bf15bff5,0x3fe2bf71bfffbe49,0xbfd53f8e3ffbbec8,0xbec83ffb3f8ebfd5,0xbf15bff53e493fff,0xbfa2bfc63f713fe2
.quad 0x3f443fedbfedbf44,0xbfed3f443f44bfed,0xbfff3e493f71bfe2,0x3f15bff53fa23fc6,0x3ec8bffb3fd53f8e,0x3f8e3fd5bffb3ec8,0x3fe23f71bfa23fc6,0xbfffbe493f15bff5
.quad 0xbfedbf44bf44bfed,0xbf443fedbfed3f44,0x3fa2bfc63ff5bf15,0xbf71bfe23e49bfff,0x3f8e3fd53ec83ffb,0x3ffb3ec83fd53f8e,0xbff53f15bfff3e49,0xbfc63fa2bfe23f71
.quad 0x3fedbf443f44bfed,0x3f443fed3fed3f44,0xbfa23fc63f153ff5,0xbf71bfe2bfffbe49,0x3ec8bffbbfd5bf8e,0x3f8e3fd53ffbbec8,0x3f153ff53fffbe49,0xbfa2bfc6bfe23f71
.quad 0xbf443fed3fedbf44,0x3fed3f44bf44bfed,0xbe49bfffbf713fe2,0xbff5bf153fa23fc6,0x3f8e3fd5bec8bffb,0x3ffb3ec8bfd5bf8e,0xbfe2bf713fc63fa2,0xbfffbe493ff53f15
.quad 0xbf44bfed3fed3f44,0x3fedbf44bf443fed,0x3fc63fa2bff53f15,0xbfe23f713e49bfff,0xbffbbec83f8ebfd5,0x3fd5bf8e3ec83ffb,0x3ff5bf153e493fff,0xbfc63fa2bf71bfe2
.quad 0x3fed3f443f443fed,0x3f44bfed3fedbf44,0xbfff3e49bfe2bf71,0xbf153ff5bfc63fa2,0x3fd5bf8e3ffbbec8,0x3ec8bffb3f8ebfd5,0xbf713fe2bfa23fc6,0xbe493fffbf153ff5
.quad 0x3f8000003f800000,0x3f8000003f800000,0x3f7ffec43f800000,0x3f7ff4e63f7ffb11,0x3f7ffb113f800000,0x3f7fd3973f7fec43,0x3f7ff4e63f800000,0x3f7f9c183f7fd397
.quad 0x3f7fb10f3f800000,0x3f7d3aac3f7ec46d,0x3f7f9c183f800000,0x3f7c7eb03f7e70b0,0x3f7f84ab3f800000,0x3f7baccd3f7e1324,0x3f7f6ac73f800000,0x3f7ac5163f7dabcc
.quad 0x3f7ec46d3f800000,0x3f74fa0b3f7b14be,0x3f7e9bc93f800000,0x3f73913f3f7a7302,0x3f7e70b03f800000,0x3f7213523f79c79d,0x3f7e43233f800000,0x3f7080663f791298
.quad 0x3f7d3aac3f800000,0x3f676bd83f74fa0b,0x3f7cfe733f800000,0x3f655e0b3f740bdd,0x3f7cbfc93f800000,0x3f633c5a3f731447,0x3f7c7eb03f800000,0x3f6106f23f721352
.quad 0x3f8000003f800000,0x3f8000003f800000,0x3f7fe1293f7fec43,0x3f7fc38f3f7fd397,0x3f7f84ab3f7fb10f,0x3f7f0e583f7f4e6d,0x3f7eea9d3f7f4e6d,0x3f7de0b13f7e70b0
.quad 0x3f7853f83f7b14be,0x3f7109083f74fa0b,0x3f764d973f79c79d,0x3f6d1c1d3f721352,0x3f740bdd3f7853f8,0x3f68bf3c3f6ed89e,0x3f718f573f76ba07,0x3f63f4733f6b4b0c
.quad 0x3f61c5983f6c835e,0x3f45e4033f54db31,0x3f5df6be3f6a09a7,0x3f3ebc1b3f4f7a1f,0x3f59f26a3f676bd8,0x3f373a233f49d112,0x3f55b9933f64aa59,0x3f2f61a53f43e200
.quad 0x3f3daef93f54db31,0x3f039c3d3f226799,0x3f3852163f514d3d,0x3ef41f073f1b02c6,0x3f32c8c93f4d9f02,0x3ee0924f3f13682a,0x3f2d14693f49d112,0x3ecc9b8b3f0b9a6b
.quad 0x3f8000003f800000,0x3f8000003f800000,0x3f7f9c183f7fb10f,0x3f7f6ac73f7f84ab,0x3f7e70b03f7ec46d,0x3f7dabcc3f7e1324,0x3f7c7eb03f7d3aac,0x3f7ac5163f7baccd
.quad 0x3f676bd83f6c835e,0x3f5b941a3f61c598,0x3f6106f23f676bd8,0x3f5233c63f59f26a,0x3f59f26a3f61c598,0x3f47de653f514d3d,0x3f5233c63f5b941a,0x3f3ca0033f47de65
.quad 0x3f2267993f3504f3,0x3ef15aea3f0e39da,0x3f173c073f2beb4a,0x3ed25a093f00e7e4,0x3f0b9a6b3f226799,0x3eb263ef3ee63375,0x3eff17b23f187fc0,0x3e919ddd3ec9b953
.quad 0x3e78cfcc3ec3ef15,0xbd48fb303dc8bd36,0x3e419b373eac7cd4,0xbdee38763d16c32c,0x3e09cf863e94a031,0xbe3b6ecfbcc90ab0,0x3da3308c3e78cfcc,0xbe7ee6e1bdafb680
.quad 0x3f8000003f800000,0x3f8000003f800000,0x3f7f2f9d3f7f4e6d,0x3f7eea9d3f7f0e58,0x3f7cbfc93f7d3aac,0x3f7baccd3f7c3b28,0x3f78b47b3f79c79d,0x3f764d973f778bc5
.quad 0x3f4d9f023f54db31,0x3f3daef93f45e403,0x3f40d0da3f49d112,0x3f2d14693f373a23,0x3f32c8c93f3daef9,0x3f1b02c63f273656,0x3f239da93f3085bb,0x3f07a1363f15f6d9
.quad 0x3e94a0313ec3ef15,0x3dc8bd363e47c5c2,0x3e5a39973ea09ae5,0x3bc90f883de1bc2e,0x3e09cf863e78cfcc,0xbdafb6803cc90ab0,0x3d6214693e2f10a2,0xbe354098bd7b2b74
.quad 0xbeac7cd4be47c5c2,0xbf187fc0bef15aea,0xbed25a09be888e93,0xbf2ac082bf0b9a6b,0xbef6e0cbbeac7cd4,0xbf3b8f3bbf1d7fd1,0xbf0cead0becf7bca,0xbf4ac77fbf2e3bde
.quad 0x0,0x0,0x3bc90f8800000000,0x3c96c9b63c490e90,0x3c490e9000000000,0x3d16c32c3cc90ab0,0x3c96c9b600000000,0x3d6214693d16c32c
.quad 0x3d48fb3000000000,0x3e1640833dc8bd36,0x3d62146900000000,0x3e28defc3de1bc2e,0x3d7b2b7400000000,0x3e3b6ecf3dfab273,0x3d8a200a00000000,0x3e4dee603e09cf86
.quad 0x3dc8bd3600000000,0x3e94a0313e47c5c2,0x3dd53db900000000,0x3e9d9e783e541501,0x3de1bc2e00000000,0x3ea68f123e605c13,0x3dee387600000000,0x3eaf713a3e6c9a7f
.quad 0x3e16408300000000,0x3edae8803e94a031,0x3e1c76de00000000,0x3ee363fa3e9aa086,0x3e22abb600000000,0x3eebcbbb3ea09ae5,0x3e28defc00000000,0x3ef41f073ea68f12
.quad 0x0,0x0,0x3cfb49ba3cc90ab0,0x3d2fe0073d16c32c,0x3d7b2b743d48fb30,0x3dafb6803d96a905,0x3dbc3ac33d96a905,0x3e0395023de1bc2e
.quad 0x3e78cfcc3e47c5c2,0x3eac7cd43e94a031,0x3e8b95073e605c13,0x3ec1071e3ea68f12,0x3e9aa0863e78cfcc,0x3ed536413eb8442a,0x3ea986c43e888e93,0x3ee900b73ec9b953
.quad 0x3ef15aea3ec3ef15,0x3f2267993f0e39da,0x3eff17b23ecf7bca,0x3f2ac0823f15f6d9,0x3f064b823edae880,0x3f32c8c93f1d7fd1,0x3f0cead03ee63375,0x3f3a7ca43f24d225
.quad 0x3f2beb4a3f0e39da,0x3f5b941a3f45e403,0x3f31a81d3f13682a,0x3f6106f23f4bbbf8,0x3f373a233f187fc0,0x3f660f883f514d3d,0x3f3ca0033f1d7fd1,0x3f6aab7b3f5695e5
.quad 0x0,0x0,0x3d6214693d48fb30,0x3d8a200a3d7b2b74,0x3de1bc2e3dc8bd36,0x3e09cf863dfab273,0x3e28defc3e164083,0x3e4dee603e3b6ecf
.quad 0x3edae8803ec3ef15,0x3f039c3d3ef15aea,0x3ef41f073edae880,0x3f121eb03f064b82,0x3f064b823ef15aea,0x3f1ff6cb3f13682a,0x3f121eb03f039c3d,0x3f2d14693f1ff6cb
.quad 0x3f45e4033f3504f3,0x3f61c5983f54db31,0x3f4e8d903f3daef9,0x3f6965913f5d2d53,0x3f5695e53f45e403,0x3f6ff5733f64aa59,0x3f5df6be3f4d9f02,0x3f756d973f6b4b0c
.quad 0x3f7853f83f6c835e,0x3f7fb10f3f7ec46d,0x3f7b61fc3f710908,0x3f7e43233f7fd397,0x3f7dabcc3f74fa0b,0x3f7baccd3f7fec43,0x3f7f2f9d3f7853f8,0x3f77f1103f7f0e58
.quad 0x0,0x0,0x3da3308c3d96a905,0x3dbc3ac33dafb680,0x3e22abb63e164083,0x3e3b6ecf3e2f10a2,0x3e72b6513e605c13,0x3e8b95073e827dc0
.quad 0x3f187fc03f0e39da,0x3f2beb4a3f226799,0x3f2866053f1d7fd1,0x3f3ca0033f32c8c9,0x3f373a233f2beb4a,0x3f4bbbf83f41d870,0x3f44e3f53f396842,0x3f591e6a3f4f7a1f
.quad 0x3f74fa0b3f6c835e,0x3f7ec46d3f7b14be,0x3f7a1e843f731447,0x3f7ffec43f7e70b0,0x3f7dabcc3f7853f8,0x3f7f0e583f7fec43,0x3f7f9c183f7c3b28,0x3f7bf5313f7f84ab
.quad 0x3f7109083f7b14be,0x3f4d9f023f61c598,0x3f6965913f76ba07,0x3f3ebc1b3f5695e5,0x3f6046213f710908,0x3f2e3bde3f49d112,0x3f55b9933f6a09a7,0x3f1c420c3f3b8f3b
.quad 0x3f7fec433f800000,0x3f7f4e6d3f7fb10f,0x3f7fe1293f800000,0x3f7eea9d3f7f84ab,0x3f7fd3973f800000,0x3f7e70b03f7f4e6d,0x3f7fc38f3f800000,0x3f7de0b13f7f0e58
.quad 0x3f7f4e6d3f800000,0x3f79c79d3f7d3aac,0x3f7f2f9d3f800000,0x3f78b47b3f7cbfc9,0x3f7f0e583f800000,0x3f778bc53f7c3b28,0x3f7eea9d3f800000,0x3f764d973f7baccd
.quad 0x3f7e13243f800000,0x3f6ed89e3f7853f8,0x3f7de0b13f800000,0x3f6d1c1d3f778bc5,0x3f7dabcc3f800000,0x3f6b4b0c3f76ba07,0x3f7d74743f800000,0x3f6965913f75dec6
.quad 0x3f7c3b283f800000,0x3f5ebe053f710908,0x3f7bf5313f800000,0x3f5c61c73f6ff573,0x3f7baccd3f800000,0x3f59f26a3f6ed89e,0x3f7b61fc3f800000,0x3f5770263f6db293
.quad 0x3f7e13243f7ec46d,0x3f7c3b283f7d3aac,0x3f7cfe733f7e1324,0x3f7a1e843f7baccd,0x3f7baccd3f7d3aac,0x3f778bc53f79c79d,0x3f7a1e843f7c3b28,0x3f7484223f778bc5
.quad 0x3f6ed89e3f74fa0b,0x3f5ebe053f676bd8,0x3f6be8583f731447,0x3f591e6a3f633c5a,0x3f68bf3c3f710908,0x3f5318493f5ebe05,0x3f655e0b3f6ed89e,0x3f4cae793f59f26a
.quad 0x3f514d3d3f61c598,0x3f2736563f3daef9,0x3f4cae793f5ebe05,0x3f1ebc123f373a23,0x3f47de653f5b941a,0x3f15f6d93f3085bb,0x3f42de293f584853,0x3f0cead03f299415
.quad 0x3f2736563f45e403,0x3eb8442a3f039c3d,0x3f212ff93f41d870,0x3ea395c53ef6e0cb,0x3f1b02c63f3daef9,0x3e8e9a223ee63375,0x3f14b0393f396842,0x3e72b6513ed53641
.quad 0x3f79c79d3f7b14be,0x3f76ba073f7853f8,0x3f764d973f7853f8,0x3f718f573f740bdd,0x3f7213523f74fa0b,0x3f6b4b0c3f6ed89e,0x3f6d1c1d3f710908,0x3f63f4733f68bf3c
.quad 0x3f49d1123f54db31,0x3f3085bb3f3daef9,0x3f40d0da3f4d9f02,0x3f239da93f32c8c9,0x3f373a233f45e403,0x3f15f6d93f273656,0x3f2d14693f3daef9,0x3f07a1363f1b02c6
.quad 0x3ee633753f0e39da,0x3e605c133eac7cd4,0x3ecc9b8b3f039c3d,0x3e1c76de3e8e9a22,0x3eb263ef3ef15aea,0x3dafb6803e605c13,0x3e97a1173edae880,0x3c96c9b63e22abb6
.quad 0x3cc90ab03e47c5c2,0xbea09ae5be164083,0xbcfb49ba3e164083,0xbec1071ebe541501,0xbdafb6803dc8bd36,0xbee0924fbe888e93,0xbe1008b73d48fb30,0xbeff17b2bea68f12
.quad 0x3f7314473f74fa0b,0x3f6ed89e3f710908,0x3f6be8583f6ed89e,0x3f655e0b3f68bf3c,0x3f633c5a3f676bd8,0x3f59f26a3f5ebe05,0x3f591e6a3f5ebe05,0x3f4cae793f531849
.quad 0x3f13682a3f226799,0x3ee633753f039c3d,0x3f0242b13f13682a,0x3ebb31a03ee0924f,0x3ee0924f3f039c3d,0x3e8e9a223eb8442a,0x3ebb31a03ee63375,0x3e419b373e8e9a22
.quad 0xbcc90ab03dc8bd36,0xbe888e93be164083,0xbdd53db93cc90ab0,0xbeb554ecbe6c9a7f,0xbe3b6ecfbd48fb30,0xbee0924fbea09ae5,0xbe8586cebdfab273,0xbf04f484bec9b953
.quad 0xbf1d7fd1bef15aea,0xbf584853bf3daef9,0xbf2d1469bf08f59b,0xbf63f473bf4bbbf8,0xbf3b8f3bbf187fc0,0xbf6db293bf584853,0xbf48d8b3bf273656,0xbf756d97bf633c5a
.quad 0x3cc90ab000000000,0x3d96a9053d48fb30,0x3cfb49ba00000000,0x3dbc3ac33d7b2b74,0x3d16c32c00000000,0x3de1bc2e3d96a905,0x3d2fe00700000000,0x3e0395023dafb680
.quad 0x3d96a90500000000,0x3e605c133e164083,0x3da3308c00000000,0x3e72b6513e22abb6,0x3dafb68000000000,0x3e827dc03e2f10a2,0x3dbc3ac300000000,0x3e8b95073e3b6ecf
.quad 0x3dfab27300000000,0x3eb8442a3e78cfcc,0x3e03950200000000,0x3ec1071e3e827dc0,0x3e09cf8600000000,0x3ec9b9533e888e93,0x3e1008b700000000,0x3ed25a093e8e9a22
.quad 0x3e2f10a200000000,0x3efc5d273eac7cd4,0x3e35409800000000,0x3f0242b13eb263ef,0x3e3b6ecf00000000,0x3f064b823eb8442a,0x3e419b3700000000,0x3f0a48ad3ebe1d4a
.quad 0x3dfab2733dc8bd36,0x3e2f10a23e164083,0x3e1c76de3dfab273,0x3e5a39973e3b6ecf,0x3e3b6ecf3e164083,0x3e827dc03e605c13,0x3e5a39973e2f10a2,0x3e97a1173e827dc0
.quad 0x3eb8442a3e94a031,0x3efc5d273edae880,0x3ec6d5293ea09ae5,0x3f07a1363eebcbbb,0x3ed536413eac7cd4,0x3f10d3cd3efc5d27,0x3ee363fa3eb8442a,0x3f19c2003f064b82
.quad 0x3f13682a3ef15aea,0x3f41d8703f2beb4a,0x3f19c2003efc5d27,0x3f48d8b33f32c8c9,0x3f1ff6cb3f039c3d,0x3f4f7a1f3f396842,0x3f26050a3f08f59b,0x3f55b9933f3fc767
.quad 0x3f41d8703f226799,0x3f6ed89e3f5b941a,0x3f46e22a3f273656,0x3f7294f83f604621,0x3f4bbbf83f2beb4a,0x3f75dec63f64aa59,0x3f5064af3f3085bb,0x3f78b47b3f68bf3c
.quad 0x3e605c133e47c5c2,0x3e888e933e78cfcc,0x3e8b95073e78cfcc,0x3ea986c43e9aa086,0x3ea68f123e94a031,0x3ec9b9533eb8442a,0x3ec1071e3eac7cd4,0x3ee900b73ed53641
.quad 0x3f1d7fd13f0e39da,0x3f3968423f2beb4a,0x3f2866053f187fc0,0x3f44e3f53f373a23,0x3f32c8c93f226799,0x3f4f7a1f3f41d870,0x3f3ca0033f2beb4a,0x3f591e6a3f4bbbf8
.quad 0x3f64aa593f54db31,0x3f79c79d3f710908,0x3f6aab7b3f5b941a,0x3f7cfe733f75dec6,0x3f6ff5733f61c598,0x3f7f0e583f79c79d,0x3f7484223f676bd8,0x3f7ff4e63f7cbfc9
.quad 0x3f7fec433f7b14be,0x3f7314473f7d3aac,0x3f7fe1293f7d3aac,0x3f6d1c1d3f7a7302,0x3f7f0e583f7ec46d,0x3f660f883f76ba07,0x3f7d74743f7fb10f,0x3f5df6be3f721352
.quad 0x3ea09ae53e94a031,0x3eb8442a3eac7cd4,0x3ec6d5293eb8442a,0x3ee363fa3ed53641,0x3eebcbbb3edae880,0x3f064b823efc5d27,0x3f07a1363efc5d27,0x3f19c2003f10d3cd
.quad 0x3f514d3d3f45e403,0x3f64aa593f5b941a,0x3f5c61c73f514d3d,0x3f6e46be3f660f88,0x3f660f883f5b941a,0x3f75dec63f6ed89e,0x3f6e46be3f64aa59,0x3f7b61fc3f75dec6
.quad 0x3f7fec433f7ec46d,0x3f76ba073f7d3aac,0x3f7e9bc93f7fec43,0x3f6f68303f791298,0x3f7baccd3f7fb10f,0x3f660f883f731447,0x3f7724173f7e1324,0x3f5ac4503f6b4b0c
.quad 0x3f49d1123f61c598,0x3f08f59b3f2beb4a,0x3f3ca0033f584853,0x3ee900b73f1b02c6,0x3f2e3bde3f4d9f02,0x3ebe1d4a3f08f59b,0x3f1ebc123f41d870,0x3e919ddd3eebcbbb
.quad 0x8000358035003500,0x8000358080003580,0xb448357bb5003500,0xb50e3555b4c4356d,0xb4c4356d35003500,0xb56d34c4b5353535,0xb50e3555b5003500,0xb57bb448b56d34c4
.quad 0xb535353535003500,0xb535b535b5801a8d,0xb555350eb5003500,0xb448b57bb56db4c4,0xb56d34c435003500,0x34c4b56db535b535,0xb57b3448b5003500,0x3555b50eb4c4b56d
.quad 0xb5801a8d35003500,0x35809b549b0db580,0xb57bb448b5003500,0x3555350e34c4b56d,0xb56db4c435003500,0x34c4356d3535b535,0xb555b50eb5003500,0xb448357b356db4c4
.quad 0xb535b53535003500,0xb535353535809b54,0xb50eb555b5003500,0xb57b3448356d34c4,0xb4c4b56d35003500,0xb56db4c435353535,0xb448b57bb5003500,0xb50eb55534c4356d
.quad 0x8000358080003580,0x8000358080003580,0xb555350eb5353535,0xb57b3448b56d34c4,0xb56db4c4b5801a8d,0xb4c4b56db535b535,0xb448b57bb535b535,0x3555b50e34c4b56d
.quad 0x3535b5359b0db580,0x3535353535809b54,0x357b34483535b535,0xb50e355534c4356d,0x34c4356d35809b54,0xb56db4c4b5353535,0xb50e355535353535,0x3448b57bb56db4c4
.quad 0xb5801a8d80003580,0x35809b549b0db580,0xb50eb555b5353535,0x3448357b356db4c4,0x34c4b56db5801a8d,0xb56d34c435353535,0x357bb448b535b535,0xb50eb555b4c4356d
.quad 0x353535359b0db580,0x3535b535b5801a8d,0xb448357b3535b535,0x3555350eb4c4b56d,0xb56d34c435809b54,0xb4c4356d3535b535,0xb555b50e35353535,0xb57bb448356d34c4
.quad 0x8000358080003580,0x8000358080003580,0xb57bb448b5801a8d,0xb555b50eb56db4c4,0x34c4b56d9b0db580,0x356db4c43535b535,0x3555350e35809b54,0xb448357b34c4356d
.quad 0xb535353580003580,0xb535b535b5801a8d,0xb50eb555b5801a8d,0x357bb44834c4b56d,0x356db4c49b0db580,0xb4c4356d35353535,0x3448357b35809b54,0xb50eb555b56d34c4
.quad 0xb5801a8d80003580,0x35809b549b0db580,0x3448b57bb5801a8d,0xb50e3555356d34c4,0x356d34c49b0db580,0xb4c4b56db5353535,0xb50e355535809b54,0x357b3448b4c4b56d
.quad 0xb535b53580003580,0xb535353535809b54,0x3555b50eb5801a8d,0xb448b57bb4c4356d,0x34c4356d9b0db580,0x356d34c4b535b535,0xb57b344835809b54,0xb555350e356db4c4
.quad 0x8000358080003580,0x8000358080003580,0xb50eb555b535b535,0xb448b57bb4c4b56d,0x356d34c435809b54,0x34c4356d35353535,0xb57b3448b5353535,0xb50eb555b56db4c4
.quad 0x3535b5359b0db580,0x3535353535809b54,0xb448357b35353535,0xb555b50eb56d34c4,0xb4c4b56db5801a8d,0x356d34c43535b535,0x3555350e3535b535,0xb57bb448b4c4356d
.quad 0xb5801a8d80003580,0x35809b549b0db580,0x3555b50eb535b535,0xb57b344834c4356d,0xb4c4356d35809b54,0x356db4c4b535b535,0xb448b57bb5353535,0xb555350e356d34c4
.quad 0x353535359b0db580,0x3535b535b5801a8d,0xb57bb44835353535,0xb50e3555356db4c4,0x356db4c4b5801a8d,0x34c4b56db5353535,0xb50e35553535b535,0xb448357b34c4b56d
.quad 0x9b0db58035003500,0x9b0db58080003580,0x3448b57bb5003500,0x350eb555b4c4356d,0x34c4b56d35003500,0x356db4c4b5353535,0x350eb555b5003500,0x357b3448b56d34c4
.quad 0x3535b53535003500,0x35353535b5801a8d,0x3555b50eb5003500,0x3448357bb56db4c4,0x356db4c435003500,0xb4c4356db535b535,0x357bb448b5003500,0xb555350eb4c4b56d
.quad 0x35809b5435003500,0xb5801a8d9b0db580,0x357b3448b5003500,0xb555b50e34c4b56d,0x356d34c435003500,0xb4c4b56d3535b535,0x3555350eb5003500,0x3448b57b356db4c4
.quad 0x3535353535003500,0x3535b53535809b54,0x350e3555b5003500,0x357bb448356d34c4,0x34c4356d35003500,0x356d34c435353535,0x3448357bb5003500,0x350e355534c4356d
.quad 0x9b0db58080003580,0x9b0db58080003580,0x3555b50eb5353535,0x357bb448b56d34c4,0x356d34c4b5801a8d,0x34c4356db535b535,0x3448357bb535b535,0xb555350e34c4b56d
.quad 0xb53535359b0db580,0xb535b53535809b54,0xb57bb4483535b535,0x350eb55534c4356d,0xb4c4b56d35809b54,0x356d34c4b5353535,0x350eb55535353535,0xb448357bb56db4c4
.quad 0x35809b5480003580,0xb5801a8d9b0db580,0x350e3555b5353535,0xb448b57b356db4c4,0xb4c4356db5801a8d,0x356db4c435353535,0xb57b3448b535b535,0x350e3555b4c4356d
.quad 0xb535b5359b0db580,0xb5353535b5801a8d,0x3448b57b3535b535,0xb555b50eb4c4b56d,0x356db4c435809b54,0x34c4b56d3535b535,0x3555350e35353535,0x357b3448356d34c4
.quad 0x9b0db58080003580,0x9b0db58080003580,0x357b3448b5801a8d,0x3555350eb56db4c4,0xb4c4356d9b0db580,0xb56d34c43535b535,0xb555b50e35809b54,0x3448b57b34c4356d
.quad 0x3535b53580003580,0x35353535b5801a8d,0x350e3555b5801a8d,0xb57b344834c4b56d,0xb56d34c49b0db580,0x34c4b56d35353535,0xb448b57b35809b54,0x350e3555b56d34c4
.quad 0x35809b5480003580,0xb5801a8d9b0db580,0xb448357bb5801a8d,0x350eb555356d34c4,0xb56db4c49b0db580,0x34c4356db5353535,0x350eb55535809b54,0xb57bb448b4c4b56d
.quad 0x3535353580003580,0x3535b53535809b54,0xb555350eb5801a8d,0x3448357bb4c4356d,0xb4c4b56d9b0db580,0xb56db4c4b535b535,0x357bb44835809b54,0x3555b50e356db4c4
.quad 0x9b0db58080003580,0x9b0db58080003580,0x350e3555b535b535,0x3448357bb4c4b56d,0xb56db4c435809b54,0xb4c4b56d35353535,0x357bb448b5353535,0x350e3555b56db4c4
.quad 0xb53535359b0db580,0xb535b53535809b54,0x3448b57b35353535,0x3555350eb56d34c4,0x34c4356db5801a8d,0xb56db4c43535b535,0xb555b50e3535b535,0x357b3448b4c4356d
.quad 0x35809b5480003580,0xb5801a8d9b0db580,0xb555350eb535b535,0x357bb44834c4356d,0x34c4b56d35809b54,0xb56d34c4b535b535,0x3448357bb5353535,0x3555b50e356d34c4
.quad 0xb535b5359b0db580,0xb5353535b5801a8d,0x357b344835353535,0x350eb555356db4c4,0xb56d34c4b5801a8d,0xb4c4356db5353535,0x350eb5553535b535,0x3448b57b34c4b56d
.quad 0x3f803f803f803f80,0x3f803f803f803f80,0x3f553f6d3f7b3f80,0xbf55bf6dbf7bbf80,0x3ec43f353f6d3f80,0x3ec43f353f6d3f80,0xbe483ec43f553f80,0x3e48bec4bf55bf80
.quad 0xbf35248d3f353f80,0xbf35248d3f353f80,0xbf7bbec43f0e3f80,0x3f7b3ec4bf0ebf80,0xbf6dbf353ec43f80,0xbf6dbf353ec43f80,0xbf0ebf6d3e483f80,0x3f0e3f6dbe48bf80
.quad 0xa554bf80248d3f80,0xa554bf80248d3f80,0x3f0ebf6dbe483f80,0xbf0e3f6d3e48bf80,0x3f6dbf35bec43f80,0x3f6dbf35bec43f80,0x3f7bbec4bf0e3f80,0xbf7b3ec43f0ebf80
.quad 0x3f35a554bf353f80,0x3f35a554bf353f80,0x3e483ec4bf553f80,0xbe48bec43f55bf80,0xbec43f35bf6d3f80,0xbec43f35bf6d3f80,0xbf553f6dbf7b3f80,0x3f55bf6d3f7bbf80
.quad 0x3f803f803f803f80,0x3f803f803f803f80,0x3e483ec43f0e3f35,0xbe48bec4bf0ebf35,0xbf6dbf35bec4248d,0xbf6dbf35bec4248d,0xbf0ebf6dbf7bbf35,0x3f0e3f6d3f7b3f35
.quad 0x3f35a554bf35bf80,0x3f35a554bf35bf80,0x3f553f6d3e48bf35,0xbf55bf6dbe483f35,0xbec43f353f6da554,0xbec43f353f6da554,0xbf7bbec43f553f35,0x3f7b3ec4bf55bf35
.quad 0xa554bf80248d3f80,0xa554bf80248d3f80,0x3f7bbec4bf553f35,0xbf7b3ec43f55bf35,0x3ec43f35bf6d248d,0x3ec43f35bf6d248d,0xbf553f6dbe48bf35,0x3f55bf6d3e483f35
.quad 0xbf35248d3f35bf80,0xbf35248d3f35bf80,0x3f0ebf6d3f7bbf35,0xbf0e3f6dbf7b3f35,0x3f6dbf353ec4a554,0x3f6dbf353ec4a554,0xbe483ec4bf0e3f35,0x3e48bec43f0ebf35
.quad 0x3f803f803f803f80,0x3f803f803f803f80,0xbf0ebec4be48248d,0x3f0e3ec43e48a554,0xbec4bf35bf6dbf80,0xbec4bf35bf6dbf80,0x3f7b3f6d3f0ea554,0xbf7bbf6dbf0e248d
.quad 0xbf35248d3f353f80,0xbf35248d3f353f80,0xbe48bf6dbf55248d,0x3e483f6d3f55a554,0x3f6d3f35bec4bf80,0x3f6d3f35bec4bf80,0xbf553ec43f7ba554,0x3f55bec4bf7b248d
.quad 0xa554bf80248d3f80,0xa554bf80248d3f80,0x3f553ec4bf7b248d,0xbf55bec43f7ba554,0xbf6d3f353ec4bf80,0xbf6d3f353ec4bf80,0x3e48bf6d3f55a554,0xbe483f6dbf55248d
.quad 0x3f35a554bf353f80,0x3f35a554bf353f80,0xbf7b3f6dbf0e248d,0x3f7bbf6d3f0ea554,0x3ec4bf353f6dbf80,0x3ec4bf353f6dbf80,0x3f0ebec43e48a554,0xbf0e3ec4be48248d
.quad 0x3f803f803f803f80,0x3f803f803f803f80,0xbf7bbf6dbf55bf35,0x3f7b3f6d3f553f35,0x3f6d3f353ec4a554,0x3f6d3f353ec4a554,0xbf55bec43e483f35,0x3f553ec4be48bf35
.quad 0x3f35a554bf35bf80,0x3f35a554bf35bf80,0xbf0e3ec43f7b3f35,0x3f0ebec4bf7bbf35,0x3ec4bf35bf6d248d,0x3ec4bf35bf6d248d,0xbe483f6d3f0ebf35,0x3e48bf6dbf0e3f35
.quad 0xa554bf80248d3f80,0xa554bf80248d3f80,0x3e483f6dbf0ebf35,0xbe48bf6d3f0e3f35,0xbec4bf353f6da554,0xbec4bf353f6da554,0x3f0e3ec4bf7b3f35,0xbf0ebec43f7bbf35
.quad 0xbf35248d3f35bf80,0xbf35248d3f35bf80,0x3f55bec4be483f35,0xbf553ec43e48bf35,0xbf6d3f35bec4248d,0xbf6d3f35bec4248d,0x3f7bbf6d3f55bf35,0xbf7b3f6dbf553f35
.quad 0xbf803f80bf803f80,0xbf803f80bf803f80,0xbf553f6dbf7b3f80,0x3f55bf6d3f7bbf80,0xbec43f35bf6d3f80,0xbec43f35bf6d3f80,0x3e483ec4bf553f80,0xbe48bec43f55bf80
.quad 0x3f35248dbf353f80,0x3f35248dbf353f80,0x3f7bbec4bf0e3f80,0xbf7b3ec43f0ebf80,0x3f6dbf35bec43f80,0x3f6dbf35bec43f80,0x3f0ebf6dbe483f80,0xbf0e3f6d3e48bf80
.quad 0x248dbf80a5543f80,0x248dbf80a5543f80,0xbf0ebf6d3e483f80,0x3f0e3f6dbe48bf80,0xbf6dbf353ec43f80,0xbf6dbf353ec43f80,0xbf7bbec43f0e3f80,0x3f7b3ec4bf0ebf80
.quad 0xbf35a5543f353f80,0xbf35a5543f353f80,0xbe483ec43f553f80,0x3e48bec4bf55bf80,0x3ec43f353f6d3f80,0x3ec43f353f6d3f80,0x3f553f6d3f7b3f80,0xbf55bf6dbf7bbf80
.quad 0xbf803f80bf803f80,0xbf803f80bf803f80,0xbe483ec4bf0e3f35,0x3e48bec43f0ebf35,0x3f6dbf353ec4248d,0x3f6dbf353ec4248d,0x3f0ebf6d3f7bbf35,0xbf0e3f6dbf7b3f35
.quad 0xbf35a5543f35bf80,0xbf35a5543f35bf80,0xbf553f6dbe48bf35,0x3f55bf6d3e483f35,0x3ec43f35bf6da554,0x3ec43f35bf6da554,0x3f7bbec4bf553f35,0xbf7b3ec43f55bf35
.quad 0x248dbf80a5543f80,0x248dbf80a5543f80,0xbf7bbec43f553f35,0x3f7b3ec4bf55bf35,0xbec43f353f6d248d,0xbec43f353f6d248d,0x3f553f6d3e48bf35,0xbf55bf6dbe483f35
.quad 0x3f35248dbf35bf80,0x3f35248dbf35bf80,0xbf0ebf6dbf7bbf35,0x3f0e3f6d3f7b3f35,0xbf6dbf35bec4a554,0xbf6dbf35bec4a554,0x3e483ec43f0e3f35,0xbe48bec4bf0ebf35
.quad 0xbf803f80bf803f80,0xbf803f80bf803f80,0x3f0ebec43e48248d,0xbf0e3ec4be48a554,0x3ec4bf353f6dbf80,0x3ec4bf353f6dbf80,0xbf7b3f6dbf0ea554,0x3f7bbf6d3f0e248d
.quad 0x3f35248dbf353f80,0x3f35248dbf353f80,0x3e48bf6d3f55248d,0xbe483f6dbf55a554,0xbf6d3f353ec4bf80,0xbf6d3f353ec4bf80,0x3f553ec4bf7ba554,0xbf55bec43f7b248d
.quad 0x248dbf80a5543f80,0x248dbf80a5543f80,0xbf553ec43f7b248d,0x3f55bec4bf7ba554,0x3f6d3f35bec4bf80,0x3f6d3f35bec4bf80,0xbe48bf6dbf55a554,0x3e483f6d3f55248d
.quad 0xbf35a5543f353f80,0xbf35a5543f353f80,0x3f7b3f6d3f0e248d,0xbf7bbf6dbf0ea554,0xbec4bf35bf6dbf80,0xbec4bf35bf6dbf80,0xbf0ebec4be48a554,0x3f0e3ec43e48248d
.quad 0xbf803f80bf803f80,0xbf803f80bf803f80,0x3f7bbf6d3f55bf35,0xbf7b3f6dbf553f35,0xbf6d3f35bec4a554,0xbf6d3f35bec4a554,0x3f55bec4be483f35,0xbf553ec43e48bf35
.quad 0xbf35a5543f35bf80,0xbf35a5543f35bf80,0x3f0e3ec4bf7b3f35,0xbf0ebec43f7bbf35,0xbec4bf353f6d248d,0xbec4bf353f6d248d,0x3e483f6dbf0ebf35,0xbe48bf6d3f0e3f35
.quad 0x248dbf80a5543f80,0x248dbf80a5543f80,0xbe483f6d3f0ebf35,0x3e48bf6dbf0e3f35,0x3ec4bf35bf6da554,0x3ec4bf35bf6da554,0xbf0e3ec43f7b3f35,0x3f0ebec4bf7bbf35
.quad 0x3f35248dbf35bf80,0x3f35248dbf35bf80,0xbf55bec43e483f35,0x3f553ec4be48bf35,0x3f6d3f353ec4248d,0x3f6d3f353ec4248d,0xbf7bbf6dbf55bf35,0x3f7b3f6d3f553f35
.quad 0x0,0x0,0x3f0e3ec43e480000,0xbf0ebec4be48250d,0x3f6d3f353ec40000,0x3f6d3f353ec40000,0x3f7b3f6d3f0e0000,0xbf7bbf6dbf0e250d
.quad 0x3f353f803f350000,0x3f353f803f350000,0x3e483f6d3f550000,0xbe48bf6dbf55250d,0xbec43f353f6d0000,0xbec43f353f6d0000,0xbf553ec43f7b0000,0x3f55bec4bf7b250d
.quad 0xbf80250d3f800000,0xbf80250d3f800000,0xbf55bec43f7b0000,0x3f553ec4bf7b250d,0xbec4bf353f6d0000,0xbec4bf353f6d0000,0x3e48bf6d3f550000,0xbe483f6dbf55250d
.quad 0x3f35bf803f350000,0x3f35bf803f350000,0x3f7bbf6d3f0e0000,0xbf7b3f6dbf0e250d,0x3f6dbf353ec40000,0x3f6dbf353ec40000,0x3f0ebec43e480000,0xbf0e3ec4be48250d
.quad 0x0,0x0,0x3f7b3f6d3f553f35,0xbf7bbf6dbf55bf35,0x3ec43f353f6d3f80,0x3ec43f353f6d3f80,0xbf55bec43e483f35,0x3f553ec4be48bf35
.quad 0xbf35bf80bf35250d,0xbf35bf80bf35250d,0x3f0ebec4bf7bbf35,0xbf0e3ec43f7b3f35,0x3f6d3f35bec4bf80,0x3f6d3f35bec4bf80,0xbe483f6d3f0ebf35,0x3e48bf6dbf0e3f35
.quad 0xbf80250d3f800000,0xbf80250d3f800000,0xbe48bf6d3f0e3f35,0x3e483f6dbf0ebf35,0x3f6dbf35bec43f80,0x3f6dbf35bec43f80,0x3f0e3ec4bf7b3f35,0xbf0ebec43f7bbf35
.quad 0xbf353f80bf35250d,0xbf353f80bf35250d,0xbf553ec43e48bf35,0x3f55bec4be483f35,0x3ec4bf353f6dbf80,0x3ec4bf353f6dbf80,0x3f7bbf6d3f55bf35,0xbf7b3f6dbf553f35
.quad 0x0,0x0,0x3f553f6d3f7b3f80,0xbf55bf6dbf7bbf80,0xbf6dbf35bec4250d,0xbf6dbf35bec4250d,0x3e48bec4bf55bf80,0xbe483ec43f553f80
.quad 0x3f353f803f350000,0x3f353f803f350000,0xbf7bbec43f0e3f80,0x3f7b3ec4bf0ebf80,0x3ec4bf35bf6d250d,0x3ec4bf35bf6d250d,0x3f0e3f6dbe48bf80,0xbf0ebf6d3e483f80
.quad 0xbf80250d3f800000,0xbf80250d3f800000,0x3f0ebf6dbe483f80,0xbf0e3f6d3e48bf80,0x3ec43f35bf6d250d,0x3ec43f35bf6d250d,0xbf7b3ec43f0ebf80,0x3f7bbec4bf0e3f80
.quad 0x3f35bf803f350000,0x3f35bf803f350000,0x3e483ec4bf553f80,0xbe48bec43f55bf80,0xbf6d3f35bec4250d,0xbf6d3f35bec4250d,0x3f55bf6d3f7bbf80,0xbf553f6dbf7b3f80
.quad 0x0,0x0,0x3e483ec43f0e3f35,0xbe48bec4bf0ebf35,0xbec4bf35bf6dbf80,0xbec4bf35bf6dbf80,0x3f0e3f6d3f7b3f35,0xbf0ebf6dbf7bbf35
.quad 0xbf35bf80bf35250d,0xbf35bf80bf35250d,0x3f553f6d3e48bf35,0xbf55bf6dbe483f35,0xbf6dbf353ec43f80,0xbf6dbf353ec43f80,0x3f7b3ec4bf55bf35,0xbf7bbec43f553f35
.quad 0xbf80250d3f800000,0xbf80250d3f800000,0x3f7bbec4bf553f35,0xbf7b3ec43f55bf35,0xbf6d3f353ec4bf80,0xbf6d3f353ec4bf80,0x3f55bf6d3e483f35,0xbf553f6dbe48bf35
.quad 0xbf353f80bf35250d,0xbf353f80bf35250d,0x3f0ebf6d3f7bbf35,0xbf0e3f6dbf7b3f35,0xbec43f35bf6d3f80,0xbec43f35bf6d3f80,0x3e48bec43f0ebf35,0xbe483ec4bf0e3f35
.quad 0x250d0000250d0000,0x250d0000250d0000,0xbf0e3ec4be480000,0x3f0ebec43e48250d,0xbf6d3f35bec40000,0xbf6d3f35bec40000,0xbf7b3f6dbf0e0000,0x3f7bbf6d3f0e250d
.quad 0xbf353f80bf350000,0xbf353f80bf350000,0xbe483f6dbf550000,0x3e48bf6d3f55250d,0x3ec43f35bf6d0000,0x3ec43f35bf6d0000,0x3f553ec4bf7b0000,0xbf55bec43f7b250d
.quad 0x3f80250dbf800000,0x3f80250dbf800000,0x3f55bec4bf7b0000,0xbf553ec43f7b250d,0x3ec4bf35bf6d0000,0x3ec4bf35bf6d0000,0xbe48bf6dbf550000,0x3e483f6d3f55250d
.quad 0xbf35bf80bf350000,0xbf35bf80bf350000,0xbf7bbf6dbf0e0000,0x3f7b3f6d3f0e250d,0xbf6dbf35bec40000,0xbf6dbf35bec40000,0xbf0ebec4be480000,0x3f0e3ec43e48250d
.quad 0x250d0000250d0000,0x250d0000250d0000,0xbf7b3f6dbf553f35,0x3f7bbf6d3f55bf35,0xbec43f35bf6d3f80,0xbec43f35bf6d3f80,0x3f55bec4be483f35,0xbf553ec43e48bf35
.quad 0x3f35bf803f35250d,0x3f35bf803f35250d,0xbf0ebec43f7bbf35,0x3f0e3ec4bf7b3f35,0xbf6d3f353ec4bf80,0xbf6d3f353ec4bf80,0x3e483f6dbf0ebf35,0xbe48bf6d3f0e3f35
.quad 0x3f80250dbf800000,0x3f80250dbf800000,0x3e48bf6dbf0e3f35,0xbe483f6d3f0ebf35,0xbf6dbf353ec43f80,0xbf6dbf353ec43f80,0xbf0e3ec43f7b3f35,0x3f0ebec4bf7bbf35
.quad 0x3f353f803f35250d,0x3f353f803f35250d,0x3f553ec4be48bf35,0xbf55bec43e483f35,0xbec4bf35bf6dbf80,0xbec4bf35bf6dbf80,0xbf7bbf6dbf55bf35,0x3f7b3f6d3f553f35
.quad 0x250d0000250d0000,0x250d0000250d0000,0xbf553f6dbf7b3f80,0x3f55bf6d3f7bbf80,0x3f6dbf353ec4250d,0x3f6dbf353ec4250d,0xbe48bec43f55bf80,0x3e483ec4bf553f80
.quad 0xbf353f80bf350000,0xbf353f80bf350000,0x3f7bbec4bf0e3f80,0xbf7b3ec43f0ebf80,0xbec4bf353f6d250d,0xbec4bf353f6d250d,0xbf0e3f6d3e48bf80,0x3f0ebf6dbe483f80
.quad 0x3f80250dbf800000,0x3f80250dbf800000,0xbf0ebf6d3e483f80,0x3f0e3f6dbe48bf80,0xbec43f353f6d250d,0xbec43f353f6d250d,0x3f7b3ec4bf0ebf80,0xbf7bbec43f0e3f80
.quad 0xbf35bf80bf350000,0xbf35bf80bf350000,0xbe483ec43f553f80,0x3e48bec4bf55bf80,0x3f6d3f353ec4250d,0x3f6d3f353ec4250d,0xbf55bf6dbf7bbf80,0x3f553f6d3f7b3f80
.quad 0x250d0000250d0000,0x250d0000250d0000,0xbe483ec4bf0e3f35,0x3e48bec43f0ebf35,0x3ec4bf353f6dbf80,0x3ec4bf353f6dbf80,0xbf0e3f6dbf7b3f35,0x3f0ebf6d3f7bbf35
.quad 0x3f35bf803f35250d,0x3f35bf803f35250d,0xbf553f6dbe48bf35,0x3f55bf6d3e483f35,0x3f6dbf35bec43f80,0x3f6dbf35bec43f80,0xbf7b3ec43f55bf35,0x3f7bbec4bf553f35
.quad 0x3f80250dbf800000,0x3f80250dbf800000,0xbf7bbec43f553f35,0x3f7b3ec4bf55bf35,0x3f6d3f35bec4bf80,0x3f6d3f35bec4bf80,0xbf55bf6dbe483f35,0x3f553f6d3e48bf35
.quad 0x3f353f803f35250d,0x3f353f803f35250d,0xbf0ebf6dbf7bbf35,0x3f0e3f6d3f7b3f35,0x3ec43f353f6d3f80,0x3ec43f353f6d3f80,0xbe48bec4bf0ebf35,0x3e483ec43f0e3f35
.quad 0x8000800080008000,0x8000800080008000,0xbf0ebec4be488000,0x3f0e3ec43e48a50d,0xbf6dbf35bec48000,0xbf6dbf35bec48000,0xbf7bbf6dbf0e8000,0x3f7b3f6d3f0ea50d
.quad 0xbf35bf80bf358000,0xbf35bf80bf358000,0xbe48bf6dbf558000,0x3e483f6d3f55a50d,0x3ec4bf35bf6d8000,0x3ec4bf35bf6d8000,0x3f55bec4bf7b8000,0xbf553ec43f7ba50d
.quad 0x3f80a50dbf808000,0x3f80a50dbf808000,0x3f553ec4bf7b8000,0xbf55bec43f7ba50d,0x3ec43f35bf6d8000,0x3ec43f35bf6d8000,0xbe483f6dbf558000,0x3e48bf6d3f55a50d
.quad 0xbf353f80bf358000,0xbf353f80bf358000,0xbf7b3f6dbf0e8000,0x3f7bbf6d3f0ea50d,0xbf6d3f35bec48000,0xbf6d3f35bec48000,0xbf0e3ec4be488000,0x3f0ebec43e48a50d
.quad 0x8000800080008000,0x8000800080008000,0xbf7bbf6dbf55bf35,0x3f7b3f6d3f553f35,0xbec4bf35bf6dbf80,0xbec4bf35bf6dbf80,0x3f553ec4be48bf35,0xbf55bec43e483f35
.quad 0x3f353f803f35a50d,0x3f353f803f35a50d,0xbf0e3ec43f7b3f35,0x3f0ebec4bf7bbf35,0xbf6dbf353ec43f80,0xbf6dbf353ec43f80,0x3e48bf6dbf0e3f35,0xbe483f6d3f0ebf35
.quad 0x3f80a50dbf808000,0x3f80a50dbf808000,0x3e483f6dbf0ebf35,0xbe48bf6d3f0e3f35,0xbf6d3f353ec4bf80,0xbf6d3f353ec4bf80,0xbf0ebec43f7bbf35,0x3f0e3ec4bf7b3f35
.quad 0x3f35bf803f35a50d,0x3f35bf803f35a50d,0x3f55bec4be483f35,0xbf553ec43e48bf35,0xbec43f35bf6d3f80,0xbec43f35bf6d3f80,0xbf7b3f6dbf553f35,0x3f7bbf6d3f55bf35
.quad 0x8000800080008000,0x8000800080008000,0xbf55bf6dbf7bbf80,0x3f553f6d3f7b3f80,0x3f6d3f353ec4a50d,0x3f6d3f353ec4a50d,0xbe483ec43f553f80,0x3e48bec4bf55bf80
.quad 0xbf35bf80bf358000,0xbf35bf80bf358000,0x3f7b3ec4bf0ebf80,0xbf7bbec43f0e3f80,0xbec43f353f6da50d,0xbec43f353f6da50d,0xbf0ebf6d3e483f80,0x3f0e3f6dbe48bf80
.quad 0x3f80a50dbf808000,0x3f80a50dbf808000,0xbf0e3f6d3e48bf80,0x3f0ebf6dbe483f80,0xbec4bf353f6da50d,0xbec4bf353f6da50d,0x3f7bbec4bf0e3f80,0xbf7b3ec43f0ebf80
.quad 0xbf353f80bf358000,0xbf353f80bf358000,0xbe48bec43f55bf80,0x3e483ec4bf553f80,0x3f6dbf353ec4a50d,0x3f6dbf353ec4a50d,0xbf553f6dbf7b3f80,0x3f55bf6d3f7bbf80
.quad 0x8000800080008000,0x8000800080008000,0xbe48bec4bf0ebf35,0x3e483ec43f0e3f35,0x3ec43f353f6d3f80,0x3ec43f353f6d3f80,0xbf0ebf6dbf7bbf35,0x3f0e3f6d3f7b3f35
.quad 0x3f353f803f35a50d,0x3f353f803f35a50d,0xbf55bf6dbe483f35,0x3f553f6d3e48bf35,0x3f6d3f35bec4bf80,0x3f6d3f35bec4bf80,0xbf7bbec43f553f35,0x3f7b3ec4bf55bf35
.quad 0x3f80a50dbf808000,0x3f80a50dbf808000,0xbf7b3ec43f55bf35,0x3f7bbec4bf553f35,0x3f6dbf35bec43f80,0x3f6dbf35bec43f80,0xbf553f6dbe48bf35,0x3f55bf6d3e483f35
.quad 0x3f35bf803f35a50d,0x3f35bf803f35a50d,0xbf0e3f6dbf7b3f35,0x3f0ebf6d3f7bbf35,0x3ec4bf353f6dbf80,0x3ec4bf353f6dbf80,0xbe483ec4bf0e3f35,0x3e48bec43f0ebf35
.quad 0xa50d8000a50d8000,0xa50d8000a50d8000,0x3f0ebec43e488000,0xbf0e3ec4be48a50d,0x3f6dbf353ec48000,0x3f6dbf353ec48000,0x3f7bbf6d3f0e8000,0xbf7b3f6dbf0ea50d
.quad 0x3f35bf803f358000,0x3f35bf803f358000,0x3e48bf6d3f558000,0xbe483f6dbf55a50d,0xbec4bf353f6d8000,0xbec4bf353f6d8000,0xbf55bec43f7b8000,0x3f553ec4bf7ba50d
.quad 0xbf80a50d3f808000,0xbf80a50d3f808000,0xbf553ec43f7b8000,0x3f55bec4bf7ba50d,0xbec43f353f6d8000,0xbec43f353f6d8000,0x3e483f6d3f558000,0xbe48bf6dbf55a50d
.quad 0x3f353f803f358000,0x3f353f803f358000,0x3f7b3f6d3f0e8000,0xbf7bbf6dbf0ea50d,0x3f6d3f353ec48000,0x3f6d3f353ec48000,0x3f0e3ec43e488000,0xbf0ebec4be48a50d
.quad 0xa50d8000a50d8000,0xa50d8000a50d8000,0x3f7bbf6d3f55bf35,0xbf7b3f6dbf553f35,0x3ec4bf353f6dbf80,0x3ec4bf353f6dbf80,0xbf553ec43e48bf35,0x3f55bec4be483f35
.quad 0xbf353f80bf35a50d,0xbf353f80bf35a50d,0x3f0e3ec4bf7b3f35,0xbf0ebec43f7bbf35,0x3f6dbf35bec43f80,0x3f6dbf35bec43f80,0xbe48bf6d3f0e3f35,0x3e483f6dbf0ebf35
.quad 0xbf80a50d3f808000,0xbf80a50d3f808000,0xbe483f6d3f0ebf35,0x3e48bf6dbf0e3f35,0x3f6d3f35bec4bf80,0x3f6d3f35bec4bf80,0x3f0ebec4bf7bbf35,0xbf0e3ec43f7b3f35
.quad 0xbf35bf80bf35a50d,0xbf35bf80bf35a50d,0xbf55bec43e483f35,0x3f553ec4be48bf35,0x3ec43f353f6d3f80,0x3ec43f353f6d3f80,0x3f7b3f6d3f553f35,0xbf7bbf6dbf55bf35
.quad 0xa50d8000a50d8000,0xa50d8000a50d8000,0x3f55bf6d3f7bbf80,0xbf553f6dbf7b3f80,0xbf6d3f35bec4a50d,0xbf6d3f35bec4a50d,0x3e483ec4bf553f80,0xbe48bec43f55bf80
.quad 0x3f35bf803f358000,0x3f35bf803f358000,0xbf7b3ec43f0ebf80,0x3f7bbec4bf0e3f80,0x3ec43f35bf6da50d,0x3ec43f35bf6da50d,0x3f0ebf6dbe483f80,0xbf0e3f6d3e48bf80
.quad 0xbf80a50d3f808000,0xbf80a50d3f808000,0x3f0e3f6dbe48bf80,0xbf0ebf6d3e483f80,0x3ec4bf35bf6da50d,0x3ec4bf35bf6da50d,0xbf7bbec43f0e3f80,0x3f7b3ec4bf0ebf80
.quad 0x3f353f803f358000,0x3f353f803f358000,0x3e48bec4bf55bf80,0xbe483ec43f553f80,0xbf6dbf35bec4a50d,0xbf6dbf35bec4a50d,0x3f553f6d3f7b3f80,0xbf55bf6dbf7bbf80
.quad 0xa50d8000a50d8000,0xa50d8000a50d8000,0x3e48bec43f0ebf35,0xbe483ec4bf0e3f35,0xbec43f35bf6d3f80,0xbec43f35bf6d3f80,0x3f0ebf6d3f7bbf35,0xbf0e3f6dbf7b3f35
.quad 0xbf353f80bf35a50d,0xbf353f80bf35a50d,0x3f55bf6d3e483f35,0xbf553f6dbe48bf35,0xbf6d3f353ec4bf80,0xbf6d3f353ec4bf80,0x3f7bbec4bf553f35,0xbf7b3ec43f55bf35
.quad 0xbf80a50d3f808000,0xbf80a50d3f808000,0x3f7b3ec4bf55bf35,0xbf7bbec43f553f35,0xbf6dbf353ec43f80,0xbf6dbf353ec43f80,0x3f553f6d3e48bf35,0xbf55bf6dbe483f35
.quad 0xbf35bf80bf35a50d,0xbf35bf80bf35a50d,0x3f0e3f6d3f7b3f35,0xbf0ebf6dbf7bbf35,0xbec4bf35bf6dbf80,0xbec4bf35bf6dbf80,0x3e483ec43f0e3f35,0xbe48bec4bf0ebf35
.quad 0x3f8000003f80,0x3f8000003f80,0x3dc93f7f00003f80,0x3e953f753e483f7b,0x3e483f7b00003f80,0x3f0e3f553ec43f6d,0x3e953f7500003f80,0x3f463f223f0e3f55
.quad 0x3ec43f6d00003f80,0x3f6d3ec43f353f35,0x3ef13f6200003f80,0x3f7f3dc93f553f0e,0x3f0e3f5500003f80,0x3f7bbe483f6d3ec4,0x3f223f4600003f80,0x3f62bef13f7b3e48
.quad 0x3f353f3500003f80,0x3f35bf353f80248d,0x3f463f2200003f80,0x3ef1bf623f7bbe48,0x3f553f0e00003f80,0x3e48bf7b3f6dbec4,0x3f623ef100003f80,0xbdc9bf7f3f55bf0e
.quad 0x3f6d3ec400003f80,0xbec4bf6d3f35bf35,0x3f753e9500003f80,0xbf22bf463f0ebf55,0x3f7b3e4800003f80,0xbf55bf0e3ec4bf6d,0x3f7f3dc900003f80,0xbf75be953e48bf7b
.quad 0x3f8000003f80,0x3f8000003f80,0x3ef13f623ec43f6d,0x3f223f463f0e3f55,0x3f553f0e3f353f35,0x3f7b3e483f6d3ec4,0x3f7f3dc93f6d3ec4,0x3f62bef13f7bbe48
.quad 0x3f6dbec43f80248d,0x3ec4bf6d3f35bf35,0x3f22bf463f6dbec4,0xbe95bf753e48bf7b,0x3e48bf7b3f35bf35,0xbf55bf0ebec4bf6d,0xbe95bf753ec4bf6d,0xbf7f3dc9bf55bf0e
.quad 0xbf35bf35250dbf80,0xbf353f35bf80a554,0xbf75be95bec4bf6d,0xbdc93f7fbf553f0e,0xbf7b3e48bf35bf35,0x3f0e3f55bec43f6d,0xbf463f22bf6dbec4,0x3f753e953e483f7b
.quad 0xbec43f6dbf80a554,0x3f6dbec43f353f35,0x3dc93f7fbf6d3ec4,0x3ef1bf623f7b3e48,0x3f0e3f55bf353f35,0xbe48bf7b3f6dbec4,0x3f623ef1bec43f6d,0xbf46bf223f0ebf55
.quad 0x3f8000003f80,0x3f8000003f80,0x3f463f223f353f35,0x3f623ef13f553f0e,0x3f7bbe483f80248d,0x3f55bf0e3f6dbec4,0x3ef1bf623f35bf35,0xbdc9bf7f3e48bf7b
.quad 0xbec4bf6d250dbf80,0xbf6dbec4bf35bf35,0xbf75be95bf35bf35,0xbf463f22bf7b3e48,0xbf553f0ebf80a554,0x3e483f7bbec43f6d,0xbdc93f7fbf353f35,0x3f753e953f0e3f55
.quad 0x3f353f3500003f80,0x3f35bf353f80248d,0x3f7fbdc93f353f35,0xbe95bf753f0ebf55,0x3f0ebf553f80248d,0xbf7bbe48bec4bf6d,0xbe95bf753f35bf35,0xbf223f46bf7bbe48
.quad 0xbf6dbec4250dbf80,0x3ec43f6dbf353f35,0xbf623ef1bf35bf35,0x3f7f3dc93e483f7b,0xbe483f7bbf80a554,0x3f0ebf553f6d3ec4,0x3f223f46bf353f35,0xbef1bf623f55bf0e
.quad 0x3f8000003f80,0x3f8000003f80,0x3f753e953f6d3ec4,0x3f7f3dc93f7b3e48,0x3f0ebf553f35bf35,0x3e48bf7b3ec4bf6d,0xbf22bf46bec4bf6d,0xbf75be95bf55bf0e
.quad 0xbf6d3ec4bf80a554,0xbec43f6dbf353f35,0x3dc93f7fbec43f6d,0x3f623ef13f0e3f55,0x3f7b3e483f353f35,0x3f0ebf553f6dbec4,0x3ef1bf623f6dbec4,0xbf46bf22be48bf7b
.quad 0xbf35bf35250dbf80,0xbf353f35bf80a554,0xbf623ef1bf6dbec4,0x3f223f46be483f7b,0x3e483f7bbf353f35,0x3f55bf0e3f6d3ec4,0x3f7f3dc93ec43f6d,0xbef1bf623f0ebf55
.quad 0x3ec4bf6d3f80248d,0xbf6d3ec4bf35bf35,0xbf46bf223ec4bf6d,0x3e953f75bf553f0e,0xbf553f0ebf35bf35,0x3f7bbe483ec43f6d,0x3e953f75bf6d3ec4,0xbdc9bf7f3f7bbe48
.quad 0x3f8000003f80,0x3f8000003f80,0x3f7fbdc93f80248d,0x3f75be953f7bbe48,0xbe48bf7b250dbf80,0xbf0ebf55bec4bf6d,0xbf753e95bf80a554,0xbf223f46bf553f0e
.quad 0x3ec43f6d00003f80,0x3f6d3ec43f353f35,0x3f62bef13f80248d,0x3dc9bf7f3f0ebf55,0xbf0ebf55250dbf80,0xbf7b3e48bf6dbec4,0xbf463f22bf80a554,0x3ef13f62be483f7b
.quad 0x3f353f3500003f80,0x3f35bf353f80248d,0x3f22bf463f80248d,0xbf62bef1be48bf7b,0xbf55bf0e250dbf80,0xbe483f7bbf6d3ec4,0xbef13f62bf80a554,0x3f7fbdc93f0e3f55
.quad 0x3f6d3ec400003f80,0xbec4bf6d3f35bf35,0x3e95bf753f80248d,0xbf463f22bf55bf0e,0xbf7bbe48250dbf80,0x3f553f0ebec43f6d,0xbdc93f7fbf80a554,0x3e95bf753f7b3e48
.quad 0x3f8000003f80,0x3f8000003f80,0x3f62bef13f6dbec4,0x3f46bf223f55bf0e,0xbf55bf0ebf35bf35,0xbf7bbe48bf6dbec4,0xbdc93f7fbec43f6d,0x3ef13f623e483f7b
.quad 0x3f6dbec43f80248d,0x3ec4bf6d3f35bf35,0xbf46bf22bec4bf6d,0xbf753e95bf7bbe48,0xbe483f7bbf353f35,0x3f553f0e3ec43f6d,0x3f75be953f6d3ec4,0xbdc9bf7f3f0ebf55
.quad 0xbf35bf35250dbf80,0xbf353f35bf80a554,0xbe953f75bf6d3ec4,0x3f7f3dc93f0e3f55,0x3f7bbe483f353f35,0xbf0ebf553ec4bf6d,0xbf22bf463ec4bf6d,0xbe953f75bf7b3e48
.quad 0xbec43f6dbf80a554,0x3f6dbec43f353f35,0x3f7fbdc93ec43f6d,0xbf62bef13e48bf7b,0xbf0ebf553f35bf35,0x3e483f7bbf6d3ec4,0xbef13f62bf6dbec4,0x3f22bf463f553f0e
.quad 0x3f8000003f80,0x3f8000003f80,0x3f22bf463f35bf35,0x3ef1bf623f0ebf55,0xbf7b3e48bf80a554,0xbf553f0ebf6d3ec4,0x3f623ef13f353f35,0x3f7fbdc93f7b3e48
.quad 0xbec4bf6d250dbf80,0xbf6dbec4bf35bf35,0xbe953f75bf353f35,0x3f223f463e483f7b,0x3f55bf0e3f80248d,0xbe48bf7b3ec4bf6d,0xbf7fbdc9bf35bf35,0xbe953f75bf553f0e
.quad 0x3f353f3500003f80,0x3f35bf353f80248d,0xbdc9bf7f3f35bf35,0xbf753e95bf55bf0e,0xbf0e3f55bf80a554,0x3f7b3e483ec43f6d,0x3f75be953f353f35,0xbf46bf223e48bf7b
.quad 0xbf6dbec4250dbf80,0x3ec43f6dbf353f35,0x3ef13f62bf353f35,0x3dc9bf7f3f7bbe48,0x3e48bf7b3f80248d,0xbf0e3f55bf6dbec4,0xbf463f22bf35bf35,0x3f62bef13f0e3f55
.quad 0x3f8000003f80,0x3f8000003f80,0x3e95bf753ec4bf6d,0x3dc9bf7f3e48bf7b,0xbf0e3f55bf353f35,0xbe483f7bbec43f6d,0x3f46bf223f6dbec4,0x3e95bf753f0ebf55
.quad 0xbf6d3ec4bf80a554,0xbec43f6dbf353f35,0x3f7fbdc93f6d3ec4,0x3ef1bf623f55bf0e,0xbf7bbe48bf35bf35,0xbf0e3f55bf6d3ec4,0x3f623ef13ec43f6d,0x3f22bf463f7bbe48
.quad 0xbf35bf35250dbf80,0xbf353f35bf80a554,0x3ef13f62bec43f6d,0x3f46bf223f7b3e48,0xbe48bf7b3f35bf35,0xbf553f0ebf6dbec4,0xbdc93f7fbf6d3ec4,0x3f62bef13f553f0e
.quad 0x3ec4bf6d3f80248d,0xbf6d3ec4bf35bf35,0xbf223f46bf6dbec4,0x3f75be953f0e3f55,0x3f55bf0e3f353f35,0xbf7b3e48bec4bf6d,0xbf753e95bec4bf6d,0x3f7fbdc93e483f7b
.quad 0x3f8000003f80,0x3f8000003f80,0xbdc9bf7f250dbf80,0xbe95bf75be48bf7b,0x3e483f7b00003f80,0x3f0e3f553ec43f6d,0xbe95bf75250dbf80,0xbf46bf22bf0ebf55
.quad 0x3ec43f6d00003f80,0x3f6d3ec43f353f35,0xbef1bf62250dbf80,0xbf7fbdc9bf55bf0e,0x3f0e3f5500003f80,0x3f7bbe483f6d3ec4,0xbf22bf46250dbf80,0xbf623ef1bf7bbe48
.quad 0x3f353f3500003f80,0x3f35bf353f80248d,0xbf46bf22250dbf80,0xbef13f62bf7b3e48,0x3f553f0e00003f80,0x3e48bf7b3f6dbec4,0xbf62bef1250dbf80,0x3dc93f7fbf553f0e
.quad 0x3f6d3ec400003f80,0xbec4bf6d3f35bf35,0xbf75be95250dbf80,0x3f223f46bf0e3f55,0x3f7b3e4800003f80,0xbf55bf0e3ec4bf6d,0xbf7fbdc9250dbf80,0x3f753e95be483f7b
.quad 0x3f8000003f80,0x3f8000003f80,0xbef1bf62bec4bf6d,0xbf22bf46bf0ebf55,0x3f553f0e3f353f35,0x3f7b3e483f6d3ec4,0xbf7fbdc9bf6dbec4,0xbf623ef1bf7b3e48
.quad 0x3f6dbec43f80248d,0x3ec4bf6d3f35bf35,0xbf223f46bf6d3ec4,0x3e953f75be483f7b,0x3e48bf7b3f35bf35,0xbf55bf0ebec4bf6d,0x3e953f75bec43f6d,0x3f7fbdc93f553f0e
.quad 0xbf35bf35250dbf80,0xbf353f35bf80a554,0x3f753e953ec43f6d,0x3dc9bf7f3f55bf0e,0xbf7b3e48bf35bf35,0x3f0e3f55bec43f6d,0x3f46bf223f6d3ec4,0xbf75be95be48bf7b
.quad 0xbec43f6dbf80a554,0x3f6dbec43f353f35,0xbdc9bf7f3f6dbec4,0xbef13f62bf7bbe48,0x3f0e3f55bf353f35,0xbe48bf7b3f6dbec4,0xbf62bef13ec4bf6d,0x3f463f22bf0e3f55
.quad 0x3f8000003f80,0x3f8000003f80,0xbf46bf22bf35bf35,0xbf62bef1bf55bf0e,0x3f7bbe483f80248d,0x3f55bf0e3f6dbec4,0xbef13f62bf353f35,0x3dc93f7fbe483f7b
.quad 0xbec4bf6d250dbf80,0xbf6dbec4bf35bf35,0x3f753e953f353f35,0x3f46bf223f7bbe48,0xbf553f0ebf80a554,0x3e483f7bbec43f6d,0x3dc9bf7f3f35bf35,0xbf75be95bf0ebf55
.quad 0x3f353f3500003f80,0x3f35bf353f80248d,0xbf7f3dc9bf35bf35,0x3e953f75bf0e3f55,0x3f0ebf553f80248d,0xbf7bbe48bec4bf6d,0x3e953f75bf353f35,0x3f22bf463f7b3e48
.quad 0xbf6dbec4250dbf80,0x3ec43f6dbf353f35,0x3f62bef13f353f35,0xbf7fbdc9be48bf7b,0xbe483f7bbf80a554,0x3f0ebf553f6d3ec4,0xbf22bf463f35bf35,0x3ef13f62bf553f0e
.quad 0x3f8000003f80,0x3f8000003f80,0xbf75be95bf6dbec4,0xbf7fbdc9bf7bbe48,0x3f0ebf553f35bf35,0x3e48bf7b3ec4bf6d,0x3f223f463ec43f6d,0x3f753e953f553f0e
.quad 0xbf6d3ec4bf80a554,0xbec43f6dbf353f35,0xbdc9bf7f3ec4bf6d,0xbf62bef1bf0ebf55,0x3f7b3e483f353f35,0x3f0ebf553f6dbec4,0xbef13f62bf6d3ec4,0x3f463f223e483f7b
.quad 0xbf35bf35250dbf80,0xbf353f35bf80a554,0x3f62bef13f6d3ec4,0xbf22bf463e48bf7b,0x3e483f7bbf353f35,0x3f55bf0e3f6d3ec4,0xbf7fbdc9bec4bf6d,0x3ef13f62bf0e3f55
.quad 0x3ec4bf6d3f80248d,0xbf6d3ec4bf35bf35,0x3f463f22bec43f6d,0xbe95bf753f55bf0e,0xbf553f0ebf35bf35,0x3f7bbe483ec43f6d,0xbe95bf753f6dbec4,0x3dc93f7fbf7b3e48
.quad 0x3f8000003f80,0x3f8000003f80,0xbf7f3dc9bf80a554,0xbf753e95bf7b3e48,0xbe48bf7b250dbf80,0xbf0ebf55bec4bf6d,0x3f75be953f80248d,0x3f22bf463f55bf0e
.quad 0x3ec43f6d00003f80,0x3f6d3ec43f353f35,0xbf623ef1bf80a554,0xbdc93f7fbf0e3f55,0xbf0ebf55250dbf80,0xbf7b3e48bf6dbec4,0x3f46bf223f80248d,0xbef1bf623e48bf7b
.quad 0x3f353f3500003f80,0x3f35bf353f80248d,0xbf223f46bf80a554,0x3f623ef13e483f7b,0xbf55bf0e250dbf80,0xbe483f7bbf6d3ec4,0x3ef1bf623f80248d,0xbf7f3dc9bf0ebf55
.quad 0x3f6d3ec400003f80,0xbec4bf6d3f35bf35,0xbe953f75bf80a554,0x3f46bf223f553f0e,0xbf7bbe48250dbf80,0x3f553f0ebec43f6d,0x3dc9bf7f3f80248d,0xbe953f75bf7bbe48
.quad 0x3f8000003f80,0x3f8000003f80,0xbf623ef1bf6d3ec4,0xbf463f22bf553f0e,0xbf55bf0ebf35bf35,0xbf7bbe48bf6dbec4,0x3dc9bf7f3ec4bf6d,0xbef1bf62be48bf7b
.quad 0x3f6dbec43f80248d,0x3ec4bf6d3f35bf35,0x3f463f223ec43f6d,0x3f75be953f7b3e48,0xbe483f7bbf353f35,0x3f553f0e3ec43f6d,0xbf753e95bf6dbec4,0x3dc93f7fbf0e3f55
.quad 0xbf35bf35250dbf80,0xbf353f35bf80a554,0x3e95bf753f6dbec4,0xbf7fbdc9bf0ebf55,0x3f7bbe483f353f35,0xbf0ebf553ec4bf6d,0x3f223f46bec43f6d,0x3e95bf753f7bbe48
.quad 0xbec43f6dbf80a554,0x3f6dbec43f353f35,0xbf7f3dc9bec4bf6d,0x3f623ef1be483f7b,0xbf0ebf553f35bf35,0x3e483f7bbf6d3ec4,0x3ef1bf623f6d3ec4,0xbf223f46bf55bf0e
.quad 0x3f8000003f80,0x3f8000003f80,0xbf223f46bf353f35,0xbef13f62bf0e3f55,0xbf7b3e48bf80a554,0xbf553f0ebf6d3ec4,0xbf62bef1bf35bf35,0xbf7f3dc9bf7bbe48
.quad 0xbec4bf6d250dbf80,0xbf6dbec4bf35bf35,0x3e95bf753f35bf35,0xbf22bf46be48bf7b,0x3f55bf0e3f80248d,0xbe48bf7b3ec4bf6d,0x3f7f3dc93f353f35,0x3e95bf753f55bf0e
.quad 0x3f353f3500003f80,0x3f35bf353f80248d,0x3dc93f7fbf353f35,0x3f75be953f553f0e,0xbf0e3f55bf80a554,0x3f7b3e483ec43f6d,0xbf753e95bf35bf35,0x3f463f22be483f7b
.quad 0xbf6dbec4250dbf80,0x3ec43f6dbf353f35,0xbef1bf623f35bf35,0xbdc93f7fbf7b3e48,0x3e48bf7b3f80248d,0xbf0e3f55bf6dbec4,0x3f46bf223f353f35,0xbf623ef1bf0ebf55
.quad 0x3f8000003f80,0x3f8000003f80,0xbe953f75bec43f6d,0xbdc93f7fbe483f7b,0xbf0e3f55bf353f35,0xbe483f7bbec43f6d,0xbf463f22bf6d3ec4,0xbe953f75bf0e3f55
.quad 0xbf6d3ec4bf80a554,0xbec43f6dbf353f35,0xbf7f3dc9bf6dbec4,0xbef13f62bf553f0e,0xbf7bbe48bf35bf35,0xbf0e3f55bf6d3ec4,0xbf62bef1bec4bf6d,0xbf223f46bf7b3e48
.quad 0xbf35bf35250dbf80,0xbf353f35bf80a554,0xbef1bf623ec4bf6d,0xbf463f22bf7bbe48,0xbe48bf7b3f35bf35,0xbf553f0ebf6dbec4,0x3dc9bf7f3f6dbec4,0xbf623ef1bf55bf0e
.quad 0x3ec4bf6d3f80248d,0xbf6d3ec4bf35bf35,0x3f22bf463f6d3ec4,0xbf753e95bf0ebf55,0x3f55bf0e3f353f35,0xbf7b3e48bec4bf6d,0x3f75be953ec43f6d,0xbf7f3dc9be48bf7b
.quad 0x3f8080003f808000,0x3f8080003f808000,0x3f7fbdc93f808000,0x3f75be953f7bbe48,0x3f7bbe483f808000,0x3f55bf0e3f6dbec4,0x3f75be953f808000,0x3f22bf463f55bf0e
.quad 0x3f6dbec43f808000,0x3ec4bf6d3f35bf35,0x3f62bef13f808000,0x3dc9bf7f3f0ebf55,0x3f55bf0e3f808000,0xbe48bf7b3ec4bf6d,0x3f46bf223f808000,0xbef1bf623e48bf7b
.quad 0x3f35bf353f808000,0xbf35bf35248dbf80,0x3f22bf463f808000,0xbf62bef1be48bf7b,0x3f0ebf553f808000,0xbf7bbe48bec4bf6d,0x3ef1bf623f808000,0xbf7f3dc9bf0ebf55
.quad 0x3ec4bf6d3f808000,0xbf6d3ec4bf35bf35,0x3e95bf753f808000,0xbf463f22bf55bf0e,0x3e48bf7b3f808000,0xbf0e3f55bf6dbec4,0x3dc9bf7f3f808000,0xbe953f75bf7bbe48
.quad 0x3f8080003f808000,0x3f8080003f808000,0x3f62bef13f6dbec4,0x3f46bf223f55bf0e,0x3f0ebf553f35bf35,0x3e48bf7b3ec4bf6d,0x3dc9bf7f3ec4bf6d,0xbef1bf62be48bf7b
.quad 0xbec4bf6d248dbf80,0xbf6dbec4bf35bf35,0xbf46bf22bec4bf6d,0xbf753e95bf7bbe48,0xbf7bbe48bf35bf35,0xbf0e3f55bf6d3ec4,0xbf753e95bf6dbec4,0x3dc93f7fbf0e3f55
.quad 0xbf353f35bf80a50d,0x3f353f35a5543f80,0xbe953f75bf6d3ec4,0x3f7f3dc93f0e3f55,0x3e483f7bbf353f35,0x3f55bf0e3f6d3ec4,0x3f223f46bec43f6d,0x3e95bf753f7bbe48
.quad 0x3f6d3ec4a5543f80,0xbec4bf6d3f35bf35,0x3f7fbdc93ec43f6d,0xbf62bef13e48bf7b,0x3f55bf0e3f353f35,0xbf7b3e48bec4bf6d,0x3ef1bf623f6d3ec4,0xbf223f46bf55bf0e
.quad 0x3f8080003f808000,0x3f8080003f808000,0x3f22bf463f35bf35,0x3ef1bf623f0ebf55,0xbe48bf7b248dbf80,0xbf0ebf55bec4bf6d,0xbf62bef1bf35bf35,0xbf7f3dc9bf7bbe48
.quad 0xbf6d3ec4bf80a50d,0xbec43f6dbf353f35,0xbe953f75bf353f35,0x3f223f463e483f7b,0x3f0e3f55a5543f80,0x3f7bbe483f6d3ec4,0x3f7f3dc93f353f35,0x3e95bf753f55bf0e
.quad 0x3f35bf353f808000,0xbf35bf35248dbf80,0xbdc9bf7f3f35bf35,0xbf753e95bf55bf0e,0xbf55bf0e248dbf80,0xbe483f7bbf6d3ec4,0xbf753e95bf35bf35,0x3f463f22be483f7b
.quad 0xbec43f6dbf80a50d,0x3f6dbec43f353f35,0x3ef13f62bf353f35,0x3dc9bf7f3f7bbe48,0x3f7b3e48a5543f80,0xbf55bf0e3ec4bf6d,0x3f46bf223f353f35,0xbf623ef1bf0ebf55
.quad 0x3f8080003f808000,0x3f8080003f808000,0x3e95bf753ec4bf6d,0x3dc9bf7f3e48bf7b,0xbf55bf0ebf35bf35,0xbf7bbe48bf6dbec4,0xbf463f22bf6d3ec4,0xbe953f75bf0e3f55
.quad 0x3ec43f6da5543f80,0x3f6d3ec43f353f35,0x3f7fbdc93f6d3ec4,0x3ef1bf623f55bf0e,0x3e48bf7b3f35bf35,0xbf55bf0ebec4bf6d,0xbf62bef1bec4bf6d,0xbf223f46bf7b3e48
.quad 0xbf353f35bf80a50d,0x3f353f35a5543f80,0x3ef13f62bec43f6d,0x3f46bf223f7b3e48,0x3f7bbe483f353f35,0xbf0ebf553ec4bf6d,0x3dc9bf7f3f6dbec4,0xbf623ef1bf55bf0e
.quad 0xbf6dbec4248dbf80,0x3ec43f6dbf353f35,0xbf223f46bf6dbec4,0x3f75be953f0e3f55,0x3f0e3f55bf353f35,0xbe48bf7b3f6dbec4,0x3f75be953ec43f6d,0xbf7f3dc9be48bf7b
.quad 0x3f8080003f808000,0x3f8080003f808000,0xbdc9bf7f248dbf80,0xbe95bf75be48bf7b,0xbf7b3e48bf80a50d,0xbf553f0ebf6d3ec4,0x3e953f75a5543f80,0x3f463f223f0e3f55
.quad 0x3f6dbec43f808000,0x3ec4bf6d3f35bf35,0xbef1bf62248dbf80,0xbf7fbdc9bf55bf0e,0xbf553f0ebf80a50d,0x3e483f7bbec43f6d,0x3f223f46a5543f80,0x3f62bef13f7b3e48
.quad 0x3f35bf353f808000,0xbf35bf35248dbf80,0xbf46bf22248dbf80,0xbef13f62bf7b3e48,0xbf0e3f55bf80a50d,0x3f7b3e483ec43f6d,0x3f623ef1a5543f80,0xbdc9bf7f3f55bf0e
.quad 0x3ec4bf6d3f808000,0xbf6d3ec4bf35bf35,0xbf75be95248dbf80,0x3f223f46bf0e3f55,0xbe483f7bbf80a50d,0x3f0ebf553f6d3ec4,0x3f7f3dc9a5543f80,0xbf75be953e48bf7b
.quad 0x3f8080003f808000,0x3f8080003f808000,0xbef1bf62bec4bf6d,0xbf22bf46bf0ebf55,0xbf0e3f55bf353f35,0xbe483f7bbec43f6d,0x3f7f3dc93f6d3ec4,0x3f62bef13f7bbe48
.quad 0xbec4bf6d248dbf80,0xbf6dbec4bf35bf35,0xbf223f46bf6d3ec4,0x3e953f75be483f7b,0x3f7b3e483f353f35,0x3f0ebf553f6dbec4,0xbe95bf753ec4bf6d,0xbf7f3dc9bf55bf0e
.quad 0xbf353f35bf80a50d,0x3f353f35a5543f80,0x3f753e953ec43f6d,0x3dc9bf7f3f55bf0e,0xbe48bf7b3f35bf35,0xbf553f0ebf6dbec4,0xbf463f22bf6dbec4,0x3f753e953e483f7b
.quad 0x3f6d3ec4a5543f80,0xbec4bf6d3f35bf35,0xbdc9bf7f3f6dbec4,0xbef13f62bf7bbe48,0xbf553f0ebf35bf35,0x3f7bbe483ec43f6d,0x3f623ef1bec43f6d,0xbf46bf223f0ebf55
.quad 0x3f8080003f808000,0x3f8080003f808000,0xbf46bf22bf35bf35,0xbf62bef1bf55bf0e,0x3e483f7ba5543f80,0x3f0e3f553ec43f6d,0x3ef1bf623f35bf35,0xbdc9bf7f3e48bf7b
.quad 0xbf6d3ec4bf80a50d,0xbec43f6dbf353f35,0x3f753e953f353f35,0x3f46bf223f7bbe48,0xbf0ebf55248dbf80,0xbf7b3e48bf6dbec4,0xbdc93f7fbf353f35,0x3f753e953f0e3f55
.quad 0x3f35bf353f808000,0xbf35bf35248dbf80,0xbf7f3dc9bf35bf35,0x3e953f75bf0e3f55,0x3f553f0ea5543f80,0x3e48bf7b3f6dbec4,0xbe95bf753f35bf35,0xbf223f46bf7bbe48
.quad 0xbec43f6dbf80a50d,0x3f6dbec43f353f35,0x3f62bef13f353f35,0xbf7fbdc9be48bf7b,0xbf7bbe48248dbf80,0x3f553f0ebec43f6d,0x3f223f46bf353f35,0xbef1bf623f55bf0e
.quad 0x3f8080003f808000,0x3f8080003f808000,0xbf75be95bf6dbec4,0xbf7fbdc9bf7bbe48,0x3f553f0e3f353f35,0x3f7b3e483f6d3ec4,0xbf22bf46bec4bf6d,0xbf75be95bf55bf0e
.quad 0x3ec43f6da5543f80,0x3f6d3ec43f353f35,0xbdc9bf7f3ec4bf6d,0xbf62bef1bf0ebf55,0xbe483f7bbf353f35,0x3f553f0e3ec43f6d,0x3ef1bf623f6dbec4,0xbf46bf22be48bf7b
.quad 0xbf353f35bf80a50d,0x3f353f35a5543f80,0x3f62bef13f6d3ec4,0xbf22bf463e48bf7b,0xbf7b3e48bf35bf35,0x3f0e3f55bec43f6d,0x3f7f3dc93ec43f6d,0xbef1bf623f0ebf55
.quad 0xbf6dbec4248dbf80,0x3ec43f6dbf353f35,0x3f463f22bec43f6d,0xbe95bf753f55bf0e,0xbf0ebf553f35bf35,0x3e483f7bbf6d3ec4,0x3e953f75bf6d3ec4,0xbdc9bf7f3f7bbe48
.quad 0x3f8080003f808000,0x3f8080003f808000,0xbf7f3dc9bf80a50d,0xbf753e95bf7b3e48,0x3f7bbe483f808000,0x3f55bf0e3f6dbec4,0xbf753e95bf80a50d,0xbf223f46bf553f0e
.quad 0x3f6dbec43f808000,0x3ec4bf6d3f35bf35,0xbf623ef1bf80a50d,0xbdc93f7fbf0e3f55,0x3f55bf0e3f808000,0xbe48bf7b3ec4bf6d,0xbf463f22bf80a50d,0x3ef13f62be483f7b
.quad 0x3f35bf353f808000,0xbf35bf35248dbf80,0xbf223f46bf80a50d,0x3f623ef13e483f7b,0x3f0ebf553f808000,0xbf7bbe48bec4bf6d,0xbef13f62bf80a50d,0x3f7fbdc93f0e3f55
.quad 0x3ec4bf6d3f808000,0xbf6d3ec4bf35bf35,0xbe953f75bf80a50d,0x3f46bf223f553f0e,0x3e48bf7b3f808000,0xbf0e3f55bf6dbec4,0xbdc93f7fbf80a50d,0x3e95bf753f7b3e48
.quad 0x3f8080003f808000,0x3f8080003f808000,0xbf623ef1bf6d3ec4,0xbf463f22bf553f0e,0x3f0ebf553f35bf35,0x3e48bf7b3ec4bf6d,0xbdc93f7fbec43f6d,0x3ef13f623e483f7b
.quad 0xbec4bf6d248dbf80,0xbf6dbec4bf35bf35,0x3f463f223ec43f6d,0x3f75be953f7b3e48,0xbf7bbe48bf35bf35,0xbf0e3f55bf6d3ec4,0x3f75be953f6d3ec4,0xbdc9bf7f3f0ebf55
.quad 0xbf353f35bf80a50d,0x3f353f35a5543f80,0x3e95bf753f6dbec4,0xbf7fbdc9bf0ebf55,0x3e483f7bbf353f35,0x3f55bf0e3f6d3ec4,0xbf22bf463ec4bf6d,0xbe953f75bf7b3e48
.quad 0x3f6d3ec4a5543f80,0xbec4bf6d3f35bf35,0xbf7f3dc9bec4bf6d,0x3f623ef1be483f7b,0x3f55bf0e3f353f35,0xbf7b3e48bec4bf6d,0xbef13f62bf6dbec4,0x3f22bf463f553f0e
.quad 0x3f8080003f808000,0x3f8080003f808000,0xbf223f46bf353f35,0xbef13f62bf0e3f55,0xbe48bf7b248dbf80,0xbf0ebf55bec4bf6d,0x3f623ef13f353f35,0x3f7fbdc93f7b3e48
.quad 0xbf6d3ec4bf80a50d,0xbec43f6dbf353f35,0x3e95bf753f35bf35,0xbf22bf46be48bf7b,0x3f0e3f55a5543f80,0x3f7bbe483f6d3ec4,0xbf7fbdc9bf35bf35,0xbe953f75bf553f0e
.quad 0x3f35bf353f808000,0xbf35bf35248dbf80,0x3dc93f7fbf353f35,0x3f75be953f553f0e,0xbf55bf0e248dbf80,0xbe483f7bbf6d3ec4,0x3f75be953f353f35,0xbf46bf223e48bf7b
.quad 0xbec43f6dbf80a50d,0x3f6dbec43f353f35,0xbef1bf623f35bf35,0xbdc93f7fbf7b3e48,0x3f7b3e48a5543f80,0xbf55bf0e3ec4bf6d,0xbf463f22bf35bf35,0x3f62bef13f0e3f55
.quad 0x3f8080003f808000,0x3f8080003f808000,0xbe953f75bec43f6d,0xbdc93f7fbe483f7b,0xbf55bf0ebf35bf35,0xbf7bbe48bf6dbec4,0x3f46bf223f6dbec4,0x3e95bf753f0ebf55
.quad 0x3ec43f6da5543f80,0x3f6d3ec43f353f35,0xbf7f3dc9bf6dbec4,0xbef13f62bf553f0e,0x3e48bf7b3f35bf35,0xbf55bf0ebec4bf6d,0x3f623ef13ec43f6d,0x3f22bf463f7bbe48
.quad 0xbf353f35bf80a50d,0x3f353f35a5543f80,0xbef1bf623ec4bf6d,0xbf463f22bf7bbe48,0x3f7bbe483f353f35,0xbf0ebf553ec4bf6d,0xbdc93f7fbf6d3ec4,0x3f62bef13f553f0e
.quad 0xbf6dbec4248dbf80,0x3ec43f6dbf353f35,0x3f22bf463f6d3ec4,0xbf753e95bf0ebf55,0x3f0e3f55bf353f35,0xbe48bf7b3f6dbec4,0xbf753e95bec4bf6d,0x3f7fbdc93e483f7b
.quad 0x3f8080003f808000,0x3f8080003f808000,0x3dc93f7fa5543f80,0x3e953f753e483f7b,0xbf7b3e48bf80a50d,0xbf553f0ebf6d3ec4,0xbe95bf75248dbf80,0xbf46bf22bf0ebf55
.quad 0x3f6dbec43f808000,0x3ec4bf6d3f35bf35,0x3ef13f62a5543f80,0x3f7f3dc93f553f0e,0xbf553f0ebf80a50d,0x3e483f7bbec43f6d,0xbf22bf46248dbf80,0xbf623ef1bf7bbe48
.quad 0x3f35bf353f808000,0xbf35bf35248dbf80,0x3f463f22a5543f80,0x3ef1bf623f7bbe48,0xbf0e3f55bf80a50d,0x3f7b3e483ec43f6d,0xbf62bef1248dbf80,0x3dc93f7fbf553f0e
.quad 0x3ec4bf6d3f808000,0xbf6d3ec4bf35bf35,0x3f753e95a5543f80,0xbf22bf463f0ebf55,0xbe483f7bbf80a50d,0x3f0ebf553f6d3ec4,0xbf7fbdc9248dbf80,0x3f753e95be483f7b
.quad 0x3f8080003f808000,0x3f8080003f808000,0x3ef13f623ec43f6d,0x3f223f463f0e3f55,0xbf0e3f55bf353f35,0xbe483f7bbec43f6d,0xbf7fbdc9bf6dbec4,0xbf623ef1bf7b3e48
.quad 0xbec4bf6d248dbf80,0xbf6dbec4bf35bf35,0x3f22bf463f6dbec4,0xbe95bf753e48bf7b,0x3f7b3e483f353f35,0x3f0ebf553f6dbec4,0x3e953f75bec43f6d,0x3f7fbdc93f553f0e
.quad 0xbf353f35bf80a50d,0x3f353f35a5543f80,0xbf75be95bec4bf6d,0xbdc93f7fbf553f0e,0xbe48bf7b3f35bf35,0xbf553f0ebf6dbec4,0x3f46bf223f6d3ec4,0xbf75be95be48bf7b
.quad 0x3f6d3ec4a5543f80,0xbec4bf6d3f35bf35,0x3dc93f7fbf6d3ec4,0x3ef1bf623f7b3e48,0xbf553f0ebf35bf35,0x3f7bbe483ec43f6d,0xbf62bef13ec4bf6d,0x3f463f22bf0e3f55
.quad 0x3f8080003f808000,0x3f8080003f808000,0x3f463f223f353f35,0x3f623ef13f553f0e,0x3e483f7ba5543f80,0x3f0e3f553ec43f6d,0xbef13f62bf353f35,0x3dc93f7fbe483f7b
.quad 0xbf6d3ec4bf80a50d,0xbec43f6dbf353f35,0xbf75be95bf35bf35,0xbf463f22bf7b3e48,0xbf0ebf55248dbf80,0xbf7b3e48bf6dbec4,0x3dc9bf7f3f35bf35,0xbf75be95bf0ebf55
.quad 0x3f35bf353f808000,0xbf35bf35248dbf80,0x3f7fbdc93f353f35,0xbe95bf753f0ebf55,0x3f553f0ea5543f80,0x3e48bf7b3f6dbec4,0x3e953f75bf353f35,0x3f22bf463f7b3e48
.quad 0xbec43f6dbf80a50d,0x3f6dbec43f353f35,0xbf623ef1bf35bf35,0x3f7f3dc93e483f7b,0xbf7bbe48248dbf80,0x3f553f0ebec43f6d,0xbf22bf463f35bf35,0x3ef13f62bf553f0e
.quad 0x3f8080003f808000,0x3f8080003f808000,0x3f753e953f6d3ec4,0x3f7f3dc93f7b3e48,0x3f553f0e3f353f35,0x3f7b3e483f6d3ec4,0x3f223f463ec43f6d,0x3f753e953f553f0e
.quad 0x3ec43f6da5543f80,0x3f6d3ec43f353f35,0x3dc93f7fbec43f6d,0x3f623ef13f0e3f55,0xbe483f7bbf353f35,0x3f553f0e3ec43f6d,0xbef13f62bf6d3ec4,0x3f463f223e483f7b
.quad 0xbf353f35bf80a50d,0x3f353f35a5543f80,0xbf623ef1bf6dbec4,0x3f223f46be483f7b,0xbf7b3e48bf35bf35,0x3f0e3f55bec43f6d,0xbf7fbdc9bec4bf6d,0x3ef13f62bf0e3f55
.quad 0xbf6dbec4248dbf80,0x3ec43f6dbf353f35,0xbf46bf223ec4bf6d,0x3e953f75bf553f0e,0xbf0ebf553f35bf35,0x3e483f7bbf6d3ec4,0xbe95bf753f6dbec4,0x3dc93f7fbf7b3e48
.quad 0x3f8000003f800000,0x3f8000003f800000,0x3f7fffb13f800000,0x3f7ffd393f7ffec4,0x3f7ffec43f800000,0x3f7ff4e63f7ffb11,0x3f7ffd393f800000,0x3f7fe7053f7ff4e6
.quad 0x3f7ffb113f800000,0x3f7fd3973f7fec43,0x3f7ff84a3f800000,0x3f7fba9e3f7fe129,0x3f7ff4e63f800000,0x3f7f9c183f7fd397,0x3f7ff0e33f800000,0x3f7f78083f7fc38f
.quad 0x3f7fec433f800000,0x3f7f4e6d3f7fb10f,0x3f7fe7053f800000,0x3f7f1f493f7f9c18,0x3f7fe1293f800000,0x3f7eea9d3f7f84ab,0x3f7fdaaf3f800000,0x3f7eb0693f7f6ac7
.quad 0x3f7fd3973f800000,0x3f7e70b03f7f4e6d,0x3f7fcbe23f800000,0x3f7e2b723f7f2f9d,0x3f7fc38f3f800000,0x3f7de0b13f7f0e58,0x3f7fba9e3f800000,0x3f7d906e3f7eea9d
.quad 0x3f8000003f800000,0x3f8000003f800000,0x3f7ff84a3f7ffb11,0x3f7ff0e33f7ff4e6,0x3f7fe1293f7fec43,0x3f7fc38f3f7fd397,0x3f7fba9e3f7fd397,0x3f7f78083f7f9c18
.quad 0x3f7f84ab3f7fb10f,0x3f7f0e583f7f4e6d,0x3f7f3f543f7f84ab,0x3f7e868b3f7eea9d,0x3f7eea9d3f7f4e6d,0x3f7de0b13f7e70b0,0x3f7e868b3f7f0e58,0x3f7d1cdd3f7de0b1
.quad 0x3f7e13243f7ec46d,0x3f7c3b283f7d3aac,0x3f7d906e3f7e70b0,0x3f7b3bab3f7c7eb0,0x3f7cfe733f7e1324,0x3f7a1e843f7baccd,0x3f7c5d3a3f7dabcc,0x3f78e3d63f7ac516
.quad 0x3f7baccd3f7d3aac,0x3f778bc53f79c79d,0x3f7aed373f7cbfc9,0x3f76167a3f78b47b,0x3f7a1e843f7c3b28,0x3f7484223f778bc5,0x3f7940c03f7baccd,0x3f72d4eb3f764d97
.quad 0x3f8000003f800000,0x3f8000003f800000,0x3f7fe7053f7fec43,0x3f7fdaaf3f7fe129,0x3f7f9c183f7fb10f,0x3f7f6ac73f7f84ab,0x3f7f1f493f7f4e6d,0x3f7eb0693f7eea9d
.quad 0x3f7e70b03f7ec46d,0x3f7dabcc3f7e1324,0x3f7d906e3f7e1324,0x3f7c5d3a3f7cfe73,0x3f7c7eb03f7d3aac,0x3f7ac5163f7baccd,0x3f7b3bab3f7c3b28,0x3f78e3d63f7a1e84
.quad 0x3f79c79d3f7b14be,0x3f76ba073f7853f8,0x3f7822d13f79c79d,0x3f74484b3f764d97,0x3f764d973f7853f8,0x3f718f573f740bdd,0x3f74484b3f76ba07,0x3f6e8ff83f718f57
.quad 0x3f7213523f74fa0b,0x3f6b4b0c3f6ed89e,0x3f6faf1b3f731447,0x3f67c1873f6be858,0x3f6d1c1d3f710908,0x3f63f4733f68bf3c,0x3f6a5ad93f6ed89e,0x3f5fe4e93f655e0b
.quad 0x3f8000003f800000,0x3f8000003f800000,0x3f7fcbe23f7fd397,0x3f7fba9e3f7fc38f,0x3f7f2f9d3f7f4e6d,0x3f7eea9d3f7f0e58,0x3f7e2b723f7e70b0,0x3f7d906e3f7de0b1
.quad 0x3f7cbfc93f7d3aac,0x3f7baccd3f7c3b28,0x3f7aed373f7baccd,0x3f7940c03f7a1e84,0x3f78b47b3f79c79d,0x3f764d973f778bc5,0x3f76167a3f778bc5,0x3f72d4eb3f748422
.quad 0x3f7314473f74fa0b,0x3f6ed89e3f710908,0x3f6faf1b3f721352,0x3f6a5ad93f6d1c1d,0x3f6be8583f6ed89e,0x3f655e0b3f68bf3c,0x3f67c1873f6b4b0c,0x3f5fe4e93f63f473
.quad 0x3f633c5a3f676bd8,0x3f59f26a3f5ebe05,0x3f5e5aa63f633c5a,0x3f5389c73f591e6a,0x3f591e6a3f5ebe05,0x3f4cae793f531849,0x3f5389c73f59f26a,0x3f4564393f4cae79
.quad 0x8000000080000000,0x8000000080000000,0xbb490fc680000000,0xbc16cb58bbc90f88,0xbbc90f8880000000,0xbc96c9b6bc490e90,0xbc16cb5880000000,0xbce22a7abc96c9b6
.quad 0xbc490e9080000000,0xbd16c32cbcc90ab0,0xbc7b514b80000000,0xbd3c6dd5bcfb49ba,0xbc96c9b680000000,0xbd621469bd16c32c,0xbcafea6980000000,0xbd83db0abd2fe007
.quad 0xbcc90ab080000000,0xbd96a905bd48fb30,0xbce22a7a80000000,0xbda973babd621469,0xbcfb49ba80000000,0xbdbc3ac3bd7b2b74,0xbd0a342f80000000,0xbdcefdb7bd8a200a
.quad 0xbd16c32c80000000,0xbde1bc2ebd96a905,0xbd2351cb80000000,0xbdf475c0bda3308c,0xbd2fe00780000000,0xbe039502bdafb680,0xbd3c6dd580000000,0xbe0cec4abdbc3ac3
.quad 0x8000000080000000,0x8000000080000000,0xbc7b514bbc490e90,0xbcafea69bc96c9b6,0xbcfb49babcc90ab0,0xbd2fe007bd16c32c,0xbd3c6dd5bd16c32c,0xbd83db0abd621469
.quad 0xbd7b2b74bd48fb30,0xbdafb680bd96a905,0xbd9cecf9bd7b2b74,0xbddb7d37bdbc3ac3,0xbdbc3ac3bd96a905,0xbe039502bde1bc2e,0xbddb7d37bdafb680,0xbe195be0be039502
.quad 0xbdfab273bdc8bd36,0xbe2f10a2be164083,0xbe0cec4abde1bc2e,0xbe44b0b9be28defc,0xbe1c76debdfab273,0xbe5a3997be3b6ecf,0xbe2bf804be09cf86,0xbe6fa8b2be4dee60
.quad 0xbe3b6ecfbe164083,0xbe827dc0be605c13,0xbe4ada4fbe22abb6,0xbe8d17c0be72b651,0xbe5a3997be2f10a2,0xbe97a117be827dc0,0xbe698bbabe3b6ecf,0xbea21887be8b9507
.quad 0x8000000080000000,0x8000000080000000,0xbce22a7abcc90ab0,0xbd0a342fbcfb49ba,0xbd621469bd48fb30,0xbd8a200abd7b2b74,0xbda973babd96a905,0xbdcefdb7bdbc3ac3
.quad 0xbde1bc2ebdc8bd36,0xbe09cf86bdfab273,0xbe0cec4abdfab273,0xbe2bf804be1c76de,0xbe28defcbe164083,0xbe4dee60be3b6ecf,0xbe44b0b9be2f10a2,0xbe6fa8b2be5a3997
.quad 0xbe605c13be47c5c2,0xbe888e93be78cfcc,0xbe7bdba4be605c13,0xbe9920febe8b9507,0xbe8b9507be78cfcc,0xbea986c4be9aa086,0xbe9920febe888e93,0xbeb9bb1ebea986c4
.quad 0xbea68f12be94a031,0xbec9b953beb8442a,0xbeb3dca5bea09ae5,0xbed97cb9bec6d529,0xbec1071ebeac7cd4,0xbee900b7bed53641,0xbece0beabeb8442a,0xbef840c8bee363fa
.quad 0x8000000080000000,0x8000000080000000,0xbd2351cbbd16c32c,0xbd3c6dd5bd2fe007,0xbda3308cbd96a905,0xbdbc3ac3bdafb680,0xbdf475c0bde1bc2e,0xbe0cec4abe039502
.quad 0xbe22abb6be164083,0xbe3b6ecfbe2f10a2,0xbe4ada4fbe3b6ecf,0xbe698bbabe5a3997,0xbe72b651be605c13,0xbe8b9507be827dc0,0xbe8d17c0be827dc0,0xbea21887be97a117
.quad 0xbea09ae5be94a031,0xbeb8442abeac7cd4,0xbeb3dca5bea68f12,0xbece0beabec1071e,0xbec6d529beb8442a,0xbee363fabed53641,0xbed97cb9bec9b953,0xbef840c8bee900b7
.quad 0xbeebcbbbbedae880,0xbf064b82befc5d27,0xbefdbabbbeebcbbb,0xbf102dd5bf07a136,0xbf07a136befc5d27,0xbf19c200bf10d3cd,0xbf102dd5bf064b82,0xbf2302d3bf19c200
.quad 0x3f8000003f800000,0x3f8000003f800000,0x3f7fa6e33f7fb10f,0x3f7f90b13f7f9c18,0x3f7e9bc93f7ec46d,0x3f7e43233f7e70b0,0x3f7cdf6c3f7d3aac,0x3f7c187a3f7c7eb0
.quad 0x3f7a73023f7b14be,0x3f7912983f79c79d,0x3f77583a3f7853f8,0x3f75341d3f764d97,0x3f73913f3f74fa0b,0x3f7080663f721352,0x3f6f20b03f710908,0x3f6afb8c3f6d1c1d
.quad 0x3f6a09a73f6c835e,0x3f64aa593f676bd8,0x3f644fac3f676bd8,0x3f5d924d3f6106f2,0x3f5df6be3f61c598,0x3f55b9933f59f26a,0x3f5703483f5b941a,0x3f4d26fd3f5233c6
.quad 0x3f4f7a1f3f54db31,0x3f43e2003f49d112,0x3f4760853f4d9f02,0x3f39f2ac3f40d0da,0x3f3ebc1b3f45e403,0x3f2f61a53f373a23,0x3f3592e73f3daef9,0x3f24381a3f2d1469
.quad 0x3f8000003f800000,0x3f8000003f800000,0x3f7f78083f7f84ab,0x3f7f5ce93f7f6ac7,0x3f7de0b13f7e1324,0x3f7d74743f7dabcc,0x3f7b3bab3f7baccd,0x3f7a49103f7ac516
.quad 0x3f778bc53f7853f8,0x3f75dec63f76ba07,0x3f72d4eb3f740bdd,0x3f703b373f718f57,0x3f6d1c1d3f6ed89e,0x3f6965913f6b4b0c,0x3f6667713f68bf3c,0x3f61668a3f63f473
.quad 0x3f5ebe053f61c598,0x3f5848533f5b941a,0x3f5627fe3f59f26a,0x3f4e16893f5233c6,0x3f4cae793f514d3d,0x3f42de293f47de65,0x3f425b893f47de65,0x3f36ad7f3f3ca003
.quad 0x3f373a233f3daef9,0x3f2994153f3085bb,0x3f2b561b3f32c8c9,0x3f1ba2993f239da9,0x3f1ebc123f273656,0x3f0cead03f15f6d9,0x3f11796b3f1b02c6,0x3efafef73f07a136
.quad 0x3f8000003f800000,0x3f8000003f800000,0x3f7f3f543f7f4e6d,0x3f7f1f493f7f2f9d,0x3f7cfe733f7d3aac,0x3f7c7eb03f7cbfc9,0x3f7940c03f79c79d,0x3f7822d13f78b47b
.quad 0x3f740bdd3f74fa0b,0x3f7213523f731447,0x3f6d67a13f6ed89e,0x3f6a5ad93f6be858,0x3f655e0b3f676bd8,0x3f6106f23f633c5a,0x3f5bfb343f5ebe05,0x3f5627fe3f591e6a
.quad 0x3f514d3d3f54db31,0x3f49d1123f4d9f02,0x3f4564393f49d112,0x3f3c17d93f40d0da,0x3f3852163f3daef9,0x3f2d14693f32c8c9,0x3f2a2a803f3085bb,0x3f1ce11f3f239da9
.quad 0x3f1b02c63f226799,0x3f0b9a6b3f13682a,0x3f0af1b73f13682a,0x3ef2bd433f0242b1,0x3ef41f073f039c3d,0x3ecc9b8b3ee0924f,0x3ed0eb2a3ee63375,0x3ea5129f3ebb31a0
.quad 0x3f8000003f800000,0x3f8000003f800000,0x3f7efcc93f7f0e58,0x3f7ed7d43f7eea9d,0x3f7bf5313f7c3b28,0x3f7b61fc3f7baccd,0x3f76ef5b3f778bc5,0x3f75a67b3f764d97
.quad 0x3f6ff5733f710908,0x3f6db2933f6ed89e,0x3f6715993f68bf3c,0x3f6398ac3f655e0b,0x3f5c61c73f5ebe05,0x3f5770263f59f26a,0x3f4fefa83f531849,0x3f4955213f4cae79
.quad 0x3f41d8703f45e403,0x3f3968423f3daef9,0x3f3238aa3f373a23,0x3f27ce613f2d1469,0x3f212ff93f273656,0x3f14b0393f1b02c6,0x3f0ee0db3f15f6d9,0x3f003a063f07a136
.quad 0x3ef6e0cb3f039c3d,0x3ed536413ee63375,0x3ece0bea3ee0924f,0x3ea80b1f3ebb31a0,0x3ea395c53eb8442a,0x3e72b6513e8e9a22,0x3e6fa8b23e8e9a22,0x3e1324ca3e419b37
.quad 0x8000000080000000,0x8000000080000000,0xbd55880ebd48fb30,0xbd6ea038bd621469,0xbdd53db9bdc8bd36,0xbdee3876bde1bc2e,0xbe1f917bbe164083,0xbe3228d4be28defc
.quad 0xbe541501be47c5c2,0xbe6c9a7fbe605c13,0xbe840270be78cfcc,0xbe931f35be8b9507,0xbe9d9e78be94a031,0xbeaf713abea68f12,0xbeb6ccc3beac7cd4,0xbecb2aaebec1071e
.quad 0xbecf7bcabec3ef15,0xbee63375bedae880,0xbee79a5dbedae880,0xbf003a06bef41f07,0xbeff17b2bef15aea,0xbf0cead0bf064b82,0xbf0af1b7bf039c3d,0xbf19210fbf121eb0
.quad 0xbf15f6d9bf0e39da,0xbf24d225bf1d7fd1,0xbf209393bf187fc0,0xbf2ff3e6bf286605,0xbf2ac082bf226799,0xbf3a7ca4bf32c8c9,0xbf34768fbf2beb4a,0xbf446337bf3ca003
.quad 0x8000000080000000,0x8000000080000000,0xbd83db0abd7b2b74,0xbd9064b4bd8a200a,0xbe039502bdfab273,0xbe1008b7be09cf86,0xbe44b0b9be3b6ecf,0xbe57278fbe4dee60
.quad 0xbe827dc0be78cfcc,0xbe8e9a22be888e93,0xbea21887be9aa086,0xbeb0eacbbea986c4,0xbec1071ebeb8442a,0xbed25a09bec9b953,0xbedf28a9bed53641,0xbef2bd43bee900b7
.quad 0xbefc5d27bef15aea,0xbf08f59bbf039c3d,0xbf0c42c9bf064b82,0xbf17de12bf121eb0,0xbf19c200bf13682a,0xbf26050abf1ff6cb,0xbf269de3bf1ff6cb,0xbf33587abf2d1469
.quad 0xbf32c8c9bf2beb4a,0xbf3fc767bf396842,0xbf3e35c5bf373a23,0xbf4b41fabf44e3f5,0xbf48d8b3bf41d870,0xbf55b993bf4f7a1f,0xbf52a649bf4bbbf8,0xbf5f20dbbf591e6a
.quad 0x8000000080000000,0x8000000080000000,0xbd9cecf9bd96a905,0xbda973babda3308c,0xbe1c76debe164083,0xbe28defcbe22abb6,0xbe698bbabe605c13,0xbe7bdba4be72b651
.quad 0xbe9aa086be94a031,0xbea68f12bea09ae5,0xbebf926fbeb8442a,0xbece0beabec6d529,0xbee363fabedae880,0xbef41f07beebcbbb,0xbf02ef9fbefc5d27,0xbf0c42c9bf07a136
.quad 0xbf13682abf0e39da,0xbf1d7fd1bf187fc0,0xbf2302d3bf1d7fd1,0xbf2da859bf286605,0xbf31a81dbf2beb4a,0xbf3ca003bf373a23,0xbf3f41fcbf396842,0xbf4a4c87bf44e3f5
.quad 0xbf4bbbf8bf45e403,0xbf5695e5bf514d3d,0xbf570348bf514d3d,0xbf61668abf5c61c7,0xbf6106f2bf5b941a,0xbf6aab7bbf660f88,0xbf69b7e4bf64aa59,0xbf725470bf6e46be
.quad 0x8000000080000000,0x8000000080000000,0xbdb5f8dabdafb680,0xbdc27c39bdbc3ac3,0xbe354098be2f10a2,0xbe419b37be3b6ecf,0xbe870adabe827dc0,0xbe901c2cbe8b9507
.quad 0xbeb263efbeac7cd4,0xbebe1d4abeb8442a,0xbedc53c1bed53641,0xbeea6681bee363fa,0xbf0242b1befc5d27,0xbf0a48adbf064b82,0xbf1553b7bf10d3cd,0xbf1e1e22bf19c200
.quad 0xbf273656bf226799,0xbf3085bbbf2beb4a,0xbf37c655bf32c8c9,0xbf4154e1bf3ca003,0xbf46e22abf41d870,0xbf5064afbf4bbbf8,0xbf546b3bbf4f7a1f,0xbf5d924dbf591e6a
.quad 0xbf604621bf5b941a,0xbf68bf3cbf64aa59,0xbf6a5ad9bf660f88,0xbf71d19fbf6e46be,0xbf7294f8bf6ed89e,0xbf78b47bbf75dec6,0xbf78e3d6bf75dec6,0xbf7d57debf7b61fc
.quad 0x3f8000003f800000,0x3f8000003f800000,0x3f7fffb13f800000,0x3f7ffd393f7ffec4,0x3f7ffec43f800000,0x3f7ff4e63f7ffb11,0x3f7ffd393f800000,0x3f7fe7053f7ff4e6
.quad 0x3f7ffb113f800000,0x3f7fd3973f7fec43,0x3f7ff84a3f800000,0x3f7fba9e3f7fe129,0x3f7ff4e63f800000,0x3f7f9c183f7fd397,0x3f7ff0e33f800000,0x3f7f78083f7fc38f
.quad 0x3f7fec433f800000,0x3f7f4e6d3f7fb10f,0x3f7fe7053f800000,0x3f7f1f493f7f9c18,0x3f7fe1293f800000,0x3f7eea9d3f7f84ab,0x3f7fdaaf3f800000,0x3f7eb0693f7f6ac7
.quad 0x3f7fd3973f800000,0x3f7e70b03f7f4e6d,0x3f7fcbe23f800000,0x3f7e2b723f7f2f9d,0x3f7fc38f3f800000,0x3f7de0b13f7f0e58,0x3f7fba9e3f800000,0x3f7d906e3f7eea9d
.quad 0x3f8000003f800000,0x3f8000003f800000,0x3f7ff84a3f7ffb11,0x3f7ff0e33f7ff4e6,0x3f7fe1293f7fec43,0x3f7fc38f3f7fd397,0x3f7fba9e3f7fd397,0x3f7f78083f7f9c18
.quad 0x3f7f84ab3f7fb10f,0x3f7f0e583f7f4e6d,0x3f7f3f543f7f84ab,0x3f7e868b3f7eea9d,0x3f7eea9d3f7f4e6d,0x3f7de0b13f7e70b0,0x3f7e868b3f7f0e58,0x3f7d1cdd3f7de0b1
.quad 0x3f7e13243f7ec46d,0x3f7c3b283f7d3aac,0x3f7d906e3f7e70b0,0x3f7b3bab3f7c7eb0,0x3f7cfe733f7e1324,0x3f7a1e843f7baccd,0x3f7c5d3a3f7dabcc,0x3f78e3d63f7ac516
.quad 0x3f7baccd3f7d3aac,0x3f778bc53f79c79d,0x3f7aed373f7cbfc9,0x3f76167a3f78b47b,0x3f7a1e843f7c3b28,0x3f7484223f778bc5,0x3f7940c03f7baccd,0x3f72d4eb3f764d97
.quad 0x3f8000003f800000,0x3f8000003f800000,0x3f7fe7053f7fec43,0x3f7fdaaf3f7fe129,0x3f7f9c183f7fb10f,0x3f7f6ac73f7f84ab,0x3f7f1f493f7f4e6d,0x3f7eb0693f7eea9d
.quad 0x3f7e70b03f7ec46d,0x3f7dabcc3f7e1324,0x3f7d906e3f7e1324,0x3f7c5d3a3f7cfe73,0x3f7c7eb03f7d3aac,0x3f7ac5163f7baccd,0x3f7b3bab3f7c3b28,0x3f78e3d63f7a1e84
.quad 0x3f79c79d3f7b14be,0x3f76ba073f7853f8,0x3f7822d13f79c79d,0x3f74484b3f764d97,0x3f764d973f7853f8,0x3f718f573f740bdd,0x3f74484b3f76ba07,0x3f6e8ff83f718f57
.quad 0x3f7213523f74fa0b,0x3f6b4b0c3f6ed89e,0x3f6faf1b3f731447,0x3f67c1873f6be858,0x3f6d1c1d3f710908,0x3f63f4733f68bf3c,0x3f6a5ad93f6ed89e,0x3f5fe4e93f655e0b
.quad 0x3f8000003f800000,0x3f8000003f800000,0x3f7fcbe23f7fd397,0x3f7fba9e3f7fc38f,0x3f7f2f9d3f7f4e6d,0x3f7eea9d3f7f0e58,0x3f7e2b723f7e70b0,0x3f7d906e3f7de0b1
.quad 0x3f7cbfc93f7d3aac,0x3f7baccd3f7c3b28,0x3f7aed373f7baccd,0x3f7940c03f7a1e84,0x3f78b47b3f79c79d,0x3f764d973f778bc5,0x3f76167a3f778bc5,0x3f72d4eb3f748422
.quad 0x3f7314473f74fa0b,0x3f6ed89e3f710908,0x3f6faf1b3f721352,0x3f6a5ad93f6d1c1d,0x3f6be8583f6ed89e,0x3f655e0b3f68bf3c,0x3f67c1873f6b4b0c,0x3f5fe4e93f63f473
.quad 0x3f633c5a3f676bd8,0x3f59f26a3f5ebe05,0x3f5e5aa63f633c5a,0x3f5389c73f591e6a,0x3f591e6a3f5ebe05,0x3f4cae793f531849,0x3f5389c73f59f26a,0x3f4564393f4cae79
.quad 0x0,0x0,0x3b490fc600000000,0x3c16cb583bc90f88,0x3bc90f8800000000,0x3c96c9b63c490e90,0x3c16cb5800000000,0x3ce22a7a3c96c9b6
.quad 0x3c490e9000000000,0x3d16c32c3cc90ab0,0x3c7b514b00000000,0x3d3c6dd53cfb49ba,0x3c96c9b600000000,0x3d6214693d16c32c,0x3cafea6900000000,0x3d83db0a3d2fe007
.quad 0x3cc90ab000000000,0x3d96a9053d48fb30,0x3ce22a7a00000000,0x3da973ba3d621469,0x3cfb49ba00000000,0x3dbc3ac33d7b2b74,0x3d0a342f00000000,0x3dcefdb73d8a200a
.quad 0x3d16c32c00000000,0x3de1bc2e3d96a905,0x3d2351cb00000000,0x3df475c03da3308c,0x3d2fe00700000000,0x3e0395023dafb680,0x3d3c6dd500000000,0x3e0cec4a3dbc3ac3
.quad 0x0,0x0,0x3c7b514b3c490e90,0x3cafea693c96c9b6,0x3cfb49ba3cc90ab0,0x3d2fe0073d16c32c,0x3d3c6dd53d16c32c,0x3d83db0a3d621469
.quad 0x3d7b2b743d48fb30,0x3dafb6803d96a905,0x3d9cecf93d7b2b74,0x3ddb7d373dbc3ac3,0x3dbc3ac33d96a905,0x3e0395023de1bc2e,0x3ddb7d373dafb680,0x3e195be03e039502
.quad 0x3dfab2733dc8bd36,0x3e2f10a23e164083,0x3e0cec4a3de1bc2e,0x3e44b0b93e28defc,0x3e1c76de3dfab273,0x3e5a39973e3b6ecf,0x3e2bf8043e09cf86,0x3e6fa8b23e4dee60
.quad 0x3e3b6ecf3e164083,0x3e827dc03e605c13,0x3e4ada4f3e22abb6,0x3e8d17c03e72b651,0x3e5a39973e2f10a2,0x3e97a1173e827dc0,0x3e698bba3e3b6ecf,0x3ea218873e8b9507
.quad 0x0,0x0,0x3ce22a7a3cc90ab0,0x3d0a342f3cfb49ba,0x3d6214693d48fb30,0x3d8a200a3d7b2b74,0x3da973ba3d96a905,0x3dcefdb73dbc3ac3
.quad 0x3de1bc2e3dc8bd36,0x3e09cf863dfab273,0x3e0cec4a3dfab273,0x3e2bf8043e1c76de,0x3e28defc3e164083,0x3e4dee603e3b6ecf,0x3e44b0b93e2f10a2,0x3e6fa8b23e5a3997
.quad 0x3e605c133e47c5c2,0x3e888e933e78cfcc,0x3e7bdba43e605c13,0x3e9920fe3e8b9507,0x3e8b95073e78cfcc,0x3ea986c43e9aa086,0x3e9920fe3e888e93,0x3eb9bb1e3ea986c4
.quad 0x3ea68f123e94a031,0x3ec9b9533eb8442a,0x3eb3dca53ea09ae5,0x3ed97cb93ec6d529,0x3ec1071e3eac7cd4,0x3ee900b73ed53641,0x3ece0bea3eb8442a,0x3ef840c83ee363fa
.quad 0x0,0x0,0x3d2351cb3d16c32c,0x3d3c6dd53d2fe007,0x3da3308c3d96a905,0x3dbc3ac33dafb680,0x3df475c03de1bc2e,0x3e0cec4a3e039502
.quad 0x3e22abb63e164083,0x3e3b6ecf3e2f10a2,0x3e4ada4f3e3b6ecf,0x3e698bba3e5a3997,0x3e72b6513e605c13,0x3e8b95073e827dc0,0x3e8d17c03e827dc0,0x3ea218873e97a117
.quad 0x3ea09ae53e94a031,0x3eb8442a3eac7cd4,0x3eb3dca53ea68f12,0x3ece0bea3ec1071e,0x3ec6d5293eb8442a,0x3ee363fa3ed53641,0x3ed97cb93ec9b953,0x3ef840c83ee900b7
.quad 0x3eebcbbb3edae880,0x3f064b823efc5d27,0x3efdbabb3eebcbbb,0x3f102dd53f07a136,0x3f07a1363efc5d27,0x3f19c2003f10d3cd,0x3f102dd53f064b82,0x3f2302d33f19c200
.quad 0x3f7fb10f3f800000,0x3f7d3aac3f7ec46d,0x3f7fa6e33f800000,0x3f7cdf6c3f7e9bc9,0x3f7f9c183f800000,0x3f7c7eb03f7e70b0,0x3f7f90b13f800000,0x3f7c187a3f7e4323
.quad 0x3f7f84ab3f800000,0x3f7baccd3f7e1324,0x3f7f78083f800000,0x3f7b3bab3f7de0b1,0x3f7f6ac73f800000,0x3f7ac5163f7dabcc,0x3f7f5ce93f800000,0x3f7a49103f7d7474
.quad 0x3f7f4e6d3f800000,0x3f79c79d3f7d3aac,0x3f7f3f543f800000,0x3f7940c03f7cfe73,0x3f7f2f9d3f800000,0x3f78b47b3f7cbfc9,0x3f7f1f493f800000,0x3f7822d13f7c7eb0
.quad 0x3f7f0e583f800000,0x3f778bc53f7c3b28,0x3f7efcc93f800000,0x3f76ef5b3f7bf531,0x3f7eea9d3f800000,0x3f764d973f7baccd,0x3f7ed7d43f800000,0x3f75a67b3f7b61fc
.quad 0x3f7853f83f7b14be,0x3f7109083f74fa0b,0x3f77583a3f7a7302,0x3f6f20b03f73913f,0x3f764d973f79c79d,0x3f6d1c1d3f721352,0x3f75341d3f791298,0x3f6afb8c3f708066
.quad 0x3f740bdd3f7853f8,0x3f68bf3c3f6ed89e,0x3f72d4eb3f778bc5,0x3f6667713f6d1c1d,0x3f718f573f76ba07,0x3f63f4733f6b4b0c,0x3f703b373f75dec6,0x3f61668a3f696591
.quad 0x3f6ed89e3f74fa0b,0x3f5ebe053f676bd8,0x3f6d67a13f740bdd,0x3f5bfb343f655e0b,0x3f6be8583f731447,0x3f591e6a3f633c5a,0x3f6a5ad93f721352,0x3f5627fe3f6106f2
.quad 0x3f68bf3c3f710908,0x3f5318493f5ebe05,0x3f6715993f6ff573,0x3f4fefa83f5c61c7,0x3f655e0b3f6ed89e,0x3f4cae793f59f26a,0x3f6398ac3f6db293,0x3f4955213f577026
.quad 0x3f676bd83f6c835e,0x3f5b941a3f61c598,0x3f644fac3f6a09a7,0x3f5703483f5df6be,0x3f6106f23f676bd8,0x3f5233c63f59f26a,0x3f5d924d3f64aa59,0x3f4d26fd3f55b993
.quad 0x3f59f26a3f61c598,0x3f47de653f514d3d,0x3f5627fe3f5ebe05,0x3f425b893f4cae79,0x3f5233c63f5b941a,0x3f3ca0033f47de65,0x3f4e16893f584853,0x3f36ad7f3f42de29
.quad 0x3f49d1123f54db31,0x3f3085bb3f3daef9,0x3f4564393f514d3d,0x3f2a2a803f385216,0x3f40d0da3f4d9f02,0x3f239da93f32c8c9,0x3f3c17d93f49d112,0x3f1ce11f3f2d1469
.quad 0x3f373a233f45e403,0x3f15f6d93f273656,0x3f3238aa3f41d870,0x3f0ee0db3f212ff9,0x3f2d14693f3daef9,0x3f07a1363f1b02c6,0x3f27ce613f396842,0x3f003a063f14b039
.quad 0x3f4d9f023f54db31,0x3f3daef93f45e403,0x3f4760853f4f7a1f,0x3f3592e73f3ebc1b,0x3f40d0da3f49d112,0x3f2d14693f373a23,0x3f39f2ac3f43e200,0x3f24381a3f2f61a5
.quad 0x3f32c8c93f3daef9,0x3f1b02c63f273656,0x3f2b561b3f373a23,0x3f11796b3f1ebc12,0x3f239da93f3085bb,0x3f07a1363f15f6d9,0x3f1ba2993f299415,0x3efafef73f0cead0
.quad 0x3f13682a3f226799,0x3ee633753f039c3d,0x3f0af1b73f1b02c6,0x3ed0eb2a3ef41f07,0x3f0242b13f13682a,0x3ebb31a03ee0924f,0x3ef2bd433f0b9a6b,0x3ea5129f3ecc9b8b
.quad 0x3ee0924f3f039c3d,0x3e8e9a223eb8442a,0x3ece0bea3ef6e0cb,0x3e6fa8b23ea395c5,0x3ebb31a03ee63375,0x3e419b373e8e9a22,0x3ea80b1f3ed53641,0x3e1324ca3e72b651
.quad 0x3d48fb3000000000,0x3e1640833dc8bd36,0x3d55880e00000000,0x3e1f917b3dd53db9,0x3d62146900000000,0x3e28defc3de1bc2e,0x3d6ea03800000000,0x3e3228d43dee3876
.quad 0x3d7b2b7400000000,0x3e3b6ecf3dfab273,0x3d83db0a00000000,0x3e44b0b93e039502,0x3d8a200a00000000,0x3e4dee603e09cf86,0x3d9064b400000000,0x3e57278f3e1008b7
.quad 0x3d96a90500000000,0x3e605c133e164083,0x3d9cecf900000000,0x3e698bba3e1c76de,0x3da3308c00000000,0x3e72b6513e22abb6,0x3da973ba00000000,0x3e7bdba43e28defc
.quad 0x3dafb68000000000,0x3e827dc03e2f10a2,0x3db5f8da00000000,0x3e870ada3e354098,0x3dbc3ac300000000,0x3e8b95073e3b6ecf,0x3dc27c3900000000,0x3e901c2c3e419b37
.quad 0x3e78cfcc3e47c5c2,0x3eac7cd43e94a031,0x3e8402703e541501,0x3eb6ccc33e9d9e78,0x3e8b95073e605c13,0x3ec1071e3ea68f12,0x3e931f353e6c9a7f,0x3ecb2aae3eaf713a
.quad 0x3e9aa0863e78cfcc,0x3ed536413eb8442a,0x3ea218873e827dc0,0x3edf28a93ec1071e,0x3ea986c43e888e93,0x3ee900b73ec9b953,0x3eb0eacb3e8e9a22,0x3ef2bd433ed25a09
.quad 0x3eb8442a3e94a031,0x3efc5d273edae880,0x3ebf926f3e9aa086,0x3f02ef9f3ee363fa,0x3ec6d5293ea09ae5,0x3f07a1363eebcbbb,0x3ece0bea3ea68f12,0x3f0c42c93ef41f07
.quad 0x3ed536413eac7cd4,0x3f10d3cd3efc5d27,0x3edc53c13eb263ef,0x3f1553b73f0242b1,0x3ee363fa3eb8442a,0x3f19c2003f064b82,0x3eea66813ebe1d4a,0x3f1e1e223f0a48ad
.quad 0x3edae8803ec3ef15,0x3f039c3d3ef15aea,0x3ee79a5d3ecf7bca,0x3f0af1b73eff17b2,0x3ef41f073edae880,0x3f121eb03f064b82,0x3f003a063ee63375,0x3f19210f3f0cead0
.quad 0x3f064b823ef15aea,0x3f1ff6cb3f13682a,0x3f0c42c93efc5d27,0x3f269de33f19c200,0x3f121eb03f039c3d,0x3f2d14693f1ff6cb,0x3f17de123f08f59b,0x3f33587a3f26050a
.quad 0x3f1d7fd13f0e39da,0x3f3968423f2beb4a,0x3f2302d33f13682a,0x3f3f41fc3f31a81d,0x3f2866053f187fc0,0x3f44e3f53f373a23,0x3f2da8593f1d7fd1,0x3f4a4c873f3ca003
.quad 0x3f32c8c93f226799,0x3f4f7a1f3f41d870,0x3f37c6553f273656,0x3f546b3b3f46e22a,0x3f3ca0033f2beb4a,0x3f591e6a3f4bbbf8,0x3f4154e13f3085bb,0x3f5d924d3f5064af
.quad 0x3f187fc03f0e39da,0x3f2beb4a3f226799,0x3f2093933f15f6d9,0x3f34768f3f2ac082,0x3f2866053f1d7fd1,0x3f3ca0033f32c8c9,0x3f2ff3e63f24d225,0x3f4463373f3a7ca4
.quad 0x3f373a233f2beb4a,0x3f4bbbf83f41d870,0x3f3e35c53f32c8c9,0x3f52a6493f48d8b3,0x3f44e3f53f396842,0x3f591e6a3f4f7a1f,0x3f4b41fa3f3fc767,0x3f5f20db3f55b993
.quad 0x3f514d3d3f45e403,0x3f64aa593f5b941a,0x3f5703483f4bbbf8,0x3f69b7e43f6106f2,0x3f5c61c73f514d3d,0x3f6e46be3f660f88,0x3f61668a3f5695e5,0x3f7254703f6aab7b
.quad 0x3f660f883f5b941a,0x3f75dec63f6ed89e,0x3f6a5ad93f604621,0x3f78e3d63f7294f8,0x3f6e46be3f64aa59,0x3f7b61fc3f75dec6,0x3f71d19f3f68bf3c,0x3f7d57de3f78b47b
.quad 0x3f80248d00003f80,0xbf80a554250dbf80,0x3f7fbdc900003f80,0xbf753e95be48bf7b,0x3f7bbe4800003f80,0xbf553f0ebec4bf6d,0x3f75be9500003f80,0xbf223f46bf0ebf55
.quad 0x3f6dbec400003f80,0xbec43f6dbf35bf35,0x3f62bef100003f80,0xbdc93f7fbf55bf0e,0x3f55bf0e00003f80,0x3e483f7bbf6dbec4,0x3f46bf2200003f80,0x3ef13f62bf7bbe48
.quad 0x3f35bf3500003f80,0x3f353f35bf80a554,0x3f22bf4600003f80,0x3f623ef1bf7b3e48,0x3f0ebf5500003f80,0x3f7b3e48bf6d3ec4,0x3ef1bf6200003f80,0x3f7fbdc9bf553f0e
.quad 0x3ec4bf6d00003f80,0x3f6dbec4bf353f35,0x3e95bf7500003f80,0x3f46bf22bf0e3f55,0x3e48bf7b00003f80,0x3f0ebf55bec43f6d,0x3dc9bf7f00003f80,0x3e95bf75be483f7b
.quad 0x3f80248d00003f80,0xbf80a554250dbf80,0x3f62bef13ec43f6d,0xbf463f22bf0ebf55,0x3f0ebf553f353f35,0xbe483f7bbf6dbec4,0x3dc9bf7f3f6d3ec4,0x3ef13f62bf7b3e48
.quad 0xbec4bf6d3f80248d,0x3f6d3ec4bf353f35,0xbf46bf223f6dbec4,0x3f75be95be483f7b,0xbf7bbe483f35bf35,0x3f0ebf553ec43f6d,0xbf753e953ec4bf6d,0xbdc9bf7f3f553f0e
.quad 0xbf353f35250dbf80,0xbf35bf353f80248d,0xbe953f75bec4bf6d,0xbf7fbdc93f55bf0e,0x3e483f7bbf35bf35,0xbf553f0e3ec4bf6d,0x3f223f46bf6dbec4,0xbe953f75be48bf7b
.quad 0x3f6d3ec4bf80a554,0x3ec43f6dbf35bf35,0x3f7fbdc9bf6d3ec4,0x3f623ef1bf7bbe48,0x3f55bf0ebf353f35,0x3f7bbe48bf6d3ec4,0x3ef1bf62bec43f6d,0x3f22bf46bf0e3f55
.quad 0x3f80248d00003f80,0xbf80a554250dbf80,0x3f22bf463f353f35,0xbef13f62bf55bf0e,0xbe48bf7b3f80248d,0x3f0e3f55bf6d3ec4,0xbf62bef13f35bf35,0x3f7fbdc9be483f7b
.quad 0xbf6d3ec4250dbf80,0x3ec4bf6d3f353f35,0xbe953f75bf35bf35,0xbf22bf463f7bbe48,0x3f0e3f55bf80a554,0xbf7b3e483ec4bf6d,0x3f7f3dc9bf353f35,0xbe953f75bf0ebf55
.quad 0x3f35bf3500003f80,0x3f353f35bf80a554,0xbdc9bf7f3f353f35,0x3f75be95bf0e3f55,0xbf55bf0e3f80248d,0x3e48bf7b3ec43f6d,0xbf753e953f35bf35,0xbf46bf223f7b3e48
.quad 0xbec43f6d250dbf80,0xbf6d3ec43f35bf35,0x3ef13f62bf35bf35,0xbdc93f7fbe48bf7b,0x3f7b3e48bf80a554,0x3f553f0ebf6dbec4,0x3f46bf22bf353f35,0x3f62bef1bf553f0e
.quad 0x3f80248d00003f80,0xbf80a554250dbf80,0x3e95bf753f6d3ec4,0xbdc93f7fbf7bbe48,0xbf55bf0e3f35bf35,0x3f7b3e48bec43f6d,0xbf463f22bec4bf6d,0x3e95bf753f553f0e
.quad 0x3ec43f6dbf80a554,0xbf6dbec43f35bf35,0x3f7fbdc9bec43f6d,0xbef13f62bf0ebf55,0x3e48bf7b3f353f35,0x3f553f0ebf6d3ec4,0xbf62bef13f6dbec4,0x3f22bf463e483f7b
.quad 0xbf353f35250dbf80,0xbf35bf353f80248d,0x3ef13f62bf6dbec4,0xbf463f223e48bf7b,0x3f7bbe48bf353f35,0x3f0e3f55bf6dbec4,0x3dc9bf7f3ec43f6d,0x3f62bef1bf0e3f55
.quad 0xbf6dbec43f80248d,0xbec4bf6d3f353f35,0xbf223f463ec4bf6d,0xbf753e953f55bf0e,0x3f0e3f55bf35bf35,0x3e483f7bbec4bf6d,0x3f75be95bf6d3ec4,0x3f7fbdc9bf7b3e48
.quad 0x3f80248d00003f80,0xbf80a554250dbf80,0xbdc9bf7f3f80248d,0x3e953f75bf7b3e48,0xbf7b3e48250dbf80,0x3f55bf0e3ec43f6d,0x3e953f75bf80a554,0xbf46bf223f55bf0e
.quad 0x3f6dbec400003f80,0xbec43f6dbf35bf35,0xbef1bf623f80248d,0x3f7f3dc9bf0e3f55,0xbf553f0e250dbf80,0xbe48bf7b3f6d3ec4,0x3f223f46bf80a554,0xbf623ef13e48bf7b
.quad 0x3f35bf3500003f80,0x3f353f35bf80a554,0xbf46bf223f80248d,0x3ef1bf623e483f7b,0xbf0e3f55250dbf80,0xbf7bbe483f6dbec4,0x3f623ef1bf80a554,0x3dc93f7fbf0ebf55
.quad 0x3ec4bf6d00003f80,0x3f6dbec4bf353f35,0xbf75be953f80248d,0xbf22bf463f553f0e,0xbe483f7b250dbf80,0xbf0e3f553ec4bf6d,0x3f7f3dc9bf80a554,0x3f753e95bf7bbe48
.quad 0x3f80248d00003f80,0xbf80a554250dbf80,0xbef1bf623f6dbec4,0x3f223f46bf553f0e,0xbf0e3f55bf35bf35,0x3e48bf7b3f6d3ec4,0x3f7f3dc9bec43f6d,0xbf623ef1be48bf7b
.quad 0xbec4bf6d3f80248d,0x3f6d3ec4bf353f35,0xbf223f46bec4bf6d,0xbe95bf753f7b3e48,0x3f7b3e48bf353f35,0xbf0e3f55bec4bf6d,0xbe95bf753f6d3ec4,0x3f7fbdc9bf0e3f55
.quad 0xbf353f35250dbf80,0xbf35bf353f80248d,0x3f753e95bf6d3ec4,0xbdc93f7fbf0ebf55,0xbe48bf7b3f353f35,0x3f55bf0ebec43f6d,0xbf463f223ec4bf6d,0xbf75be953f7bbe48
.quad 0x3f6d3ec4bf80a554,0x3ec43f6dbf35bf35,0xbdc9bf7f3ec43f6d,0x3ef1bf62be483f7b,0xbf553f0e3f35bf35,0xbf7b3e483f6dbec4,0x3f623ef1bf6dbec4,0x3f463f22bf55bf0e
.quad 0x3f80248d00003f80,0xbf80a554250dbf80,0xbf46bf223f35bf35,0x3f623ef1bf0e3f55,0x3e483f7bbf80a554,0xbf0ebf553f6dbec4,0x3ef1bf623f353f35,0x3dc93f7fbf7bbe48
.quad 0xbf6d3ec4250dbf80,0x3ec4bf6d3f353f35,0x3f753e95bf353f35,0xbf463f22be48bf7b,0xbf0ebf553f80248d,0x3f7bbe48bec43f6d,0xbdc93f7fbf35bf35,0xbf75be953f55bf0e
.quad 0x3f35bf3500003f80,0x3f353f35bf80a554,0xbf7f3dc93f35bf35,0xbe95bf753f553f0e,0x3f553f0ebf80a554,0xbe483f7bbec4bf6d,0xbe95bf753f353f35,0x3f22bf46be483f7b
.quad 0xbec43f6d250dbf80,0xbf6d3ec43f35bf35,0x3f62bef1bf353f35,0x3f7f3dc9bf7b3e48,0xbf7bbe483f80248d,0xbf55bf0e3f6d3ec4,0x3f223f46bf35bf35,0x3ef13f62bf0ebf55
.quad 0x3f80248d00003f80,0xbf80a554250dbf80,0xbf75be953ec4bf6d,0x3f7f3dc9be483f7b,0x3f553f0ebf353f35,0xbf7bbe483ec4bf6d,0xbf22bf463f6dbec4,0x3f753e95bf0e3f55
.quad 0x3ec43f6dbf80a554,0xbf6dbec43f35bf35,0xbdc9bf7f3f6d3ec4,0x3f623ef1bf553f0e,0xbe483f7bbf35bf35,0xbf55bf0e3f6dbec4,0x3ef1bf623ec43f6d,0x3f463f22bf7b3e48
.quad 0xbf353f35250dbf80,0xbf35bf353f80248d,0x3f62bef1bec43f6d,0x3f223f46bf7bbe48,0xbf7b3e483f35bf35,0xbf0ebf553f6d3ec4,0x3f7f3dc9bf6d3ec4,0x3ef13f62bf55bf0e
.quad 0xbf6dbec43f80248d,0xbec4bf6d3f353f35,0x3f463f22bf6dbec4,0x3e953f75bf0ebf55,0xbf0ebf553f353f35,0xbe48bf7b3ec43f6d,0x3e953f75bec4bf6d,0x3dc93f7fbe48bf7b
.quad 0x3f80248d00003f80,0xbf80a554250dbf80,0xbf7f3dc9250dbf80,0x3f75be953e483f7b,0x3f7bbe4800003f80,0xbf553f0ebec4bf6d,0xbf753e95250dbf80,0x3f22bf463f0e3f55
.quad 0x3f6dbec400003f80,0xbec43f6dbf35bf35,0xbf623ef1250dbf80,0x3dc9bf7f3f553f0e,0x3f55bf0e00003f80,0x3e483f7bbf6dbec4,0xbf463f22250dbf80,0xbef1bf623f7b3e48
.quad 0x3f35bf3500003f80,0x3f353f35bf80a554,0xbf223f46250dbf80,0xbf62bef13f7bbe48,0x3f0ebf5500003f80,0x3f7b3e48bf6d3ec4,0xbef13f62250dbf80,0xbf7f3dc93f55bf0e
.quad 0x3ec4bf6d00003f80,0x3f6dbec4bf353f35,0xbe953f75250dbf80,0xbf463f223f0ebf55,0x3e48bf7b00003f80,0x3f0ebf55bec43f6d,0xbdc93f7f250dbf80,0xbe953f753e48bf7b
.quad 0x3f80248d00003f80,0xbf80a554250dbf80,0xbf623ef1bec4bf6d,0x3f46bf223f0e3f55,0x3f0ebf553f353f35,0xbe483f7bbf6dbec4,0xbdc93f7fbf6dbec4,0xbef1bf623f7bbe48
.quad 0xbec4bf6d3f80248d,0x3f6d3ec4bf353f35,0x3f463f22bf6d3ec4,0xbf753e953e48bf7b,0xbf7bbe483f35bf35,0x3f0ebf553ec43f6d,0x3f75be95bec43f6d,0x3dc93f7fbf55bf0e
.quad 0xbf353f35250dbf80,0xbf35bf353f80248d,0x3e95bf753ec43f6d,0x3f7f3dc9bf553f0e,0x3e483f7bbf35bf35,0xbf553f0e3ec4bf6d,0xbf22bf463f6d3ec4,0x3e95bf753e483f7b
.quad 0x3f6d3ec4bf80a554,0x3ec43f6dbf35bf35,0xbf7f3dc93f6dbec4,0xbf62bef13f7b3e48,0x3f55bf0ebf353f35,0x3f7bbe48bf6d3ec4,0xbef13f623ec4bf6d,0xbf223f463f0ebf55
.quad 0x3f80248d00003f80,0xbf80a554250dbf80,0xbf223f46bf35bf35,0x3ef1bf623f553f0e,0xbe48bf7b3f80248d,0x3f0e3f55bf6d3ec4,0x3f623ef1bf353f35,0xbf7f3dc93e48bf7b
.quad 0xbf6d3ec4250dbf80,0x3ec4bf6d3f353f35,0x3e95bf753f353f35,0x3f223f46bf7b3e48,0x3f0e3f55bf80a554,0xbf7b3e483ec4bf6d,0xbf7fbdc93f35bf35,0x3e95bf753f0e3f55
.quad 0x3f35bf3500003f80,0x3f353f35bf80a554,0x3dc93f7fbf35bf35,0xbf753e953f0ebf55,0xbf55bf0e3f80248d,0x3e48bf7b3ec43f6d,0x3f75be95bf353f35,0x3f463f22bf7bbe48
.quad 0xbec43f6d250dbf80,0xbf6d3ec43f35bf35,0xbef1bf623f353f35,0x3dc9bf7f3e483f7b,0x3f7b3e48bf80a554,0x3f553f0ebf6dbec4,0xbf463f223f35bf35,0xbf623ef13f55bf0e
.quad 0x3f80248d00003f80,0xbf80a554250dbf80,0xbe953f75bf6dbec4,0x3dc9bf7f3f7b3e48,0xbf55bf0e3f35bf35,0x3f7b3e48bec43f6d,0x3f46bf223ec43f6d,0xbe953f75bf55bf0e
.quad 0x3ec43f6dbf80a554,0xbf6dbec43f35bf35,0xbf7f3dc93ec4bf6d,0x3ef1bf623f0e3f55,0x3e48bf7b3f353f35,0x3f553f0ebf6d3ec4,0x3f623ef1bf6d3ec4,0xbf223f46be48bf7b
.quad 0xbf353f35250dbf80,0xbf35bf353f80248d,0xbef1bf623f6d3ec4,0x3f46bf22be483f7b,0x3f7bbe48bf353f35,0x3f0e3f55bf6dbec4,0xbdc93f7fbec4bf6d,0xbf623ef13f0ebf55
.quad 0xbf6dbec43f80248d,0xbec4bf6d3f353f35,0x3f22bf46bec43f6d,0x3f75be95bf553f0e,0x3f0e3f55bf35bf35,0x3e483f7bbec4bf6d,0xbf753e953f6dbec4,0xbf7f3dc93f7bbe48
.quad 0x3f80248d00003f80,0xbf80a554250dbf80,0x3dc93f7fbf80a554,0xbe95bf753f7bbe48,0xbf7b3e48250dbf80,0x3f55bf0e3ec43f6d,0xbe95bf753f80248d,0x3f463f22bf553f0e
.quad 0x3f6dbec400003f80,0xbec43f6dbf35bf35,0x3ef13f62bf80a554,0xbf7fbdc93f0ebf55,0xbf553f0e250dbf80,0xbe48bf7b3f6d3ec4,0xbf22bf463f80248d,0x3f62bef1be483f7b
.quad 0x3f35bf3500003f80,0x3f353f35bf80a554,0x3f463f22bf80a554,0xbef13f62be48bf7b,0xbf0e3f55250dbf80,0xbf7bbe483f6dbec4,0xbf62bef13f80248d,0xbdc9bf7f3f0e3f55
.quad 0x3ec4bf6d00003f80,0x3f6dbec4bf353f35,0x3f753e95bf80a554,0x3f223f46bf55bf0e,0xbe483f7b250dbf80,0xbf0e3f553ec4bf6d,0xbf7fbdc93f80248d,0xbf75be953f7b3e48
.quad 0x3f80248d00003f80,0xbf80a554250dbf80,0x3ef13f62bf6d3ec4,0xbf22bf463f55bf0e,0xbf0e3f55bf35bf35,0x3e48bf7b3f6d3ec4,0xbf7fbdc93ec4bf6d,0x3f62bef13e483f7b
.quad 0xbec4bf6d3f80248d,0x3f6d3ec4bf353f35,0x3f22bf463ec43f6d,0x3e953f75bf7bbe48,0x3f7b3e48bf353f35,0xbf0e3f55bec4bf6d,0x3e953f75bf6dbec4,0xbf7f3dc93f0ebf55
.quad 0xbf353f35250dbf80,0xbf35bf353f80248d,0xbf75be953f6dbec4,0x3dc9bf7f3f0e3f55,0xbe48bf7b3f353f35,0x3f55bf0ebec43f6d,0x3f46bf22bec43f6d,0x3f753e95bf7b3e48
.quad 0x3f6d3ec4bf80a554,0x3ec43f6dbf35bf35,0x3dc93f7fbec4bf6d,0xbef13f623e48bf7b,0xbf553f0e3f35bf35,0xbf7b3e483f6dbec4,0xbf62bef13f6d3ec4,0xbf46bf223f553f0e
.quad 0x3f80248d00003f80,0xbf80a554250dbf80,0x3f463f22bf353f35,0xbf62bef13f0ebf55,0x3e483f7bbf80a554,0xbf0ebf553f6dbec4,0xbef13f62bf35bf35,0xbdc9bf7f3f7b3e48
.quad 0xbf6d3ec4250dbf80,0x3ec4bf6d3f353f35,0xbf75be953f35bf35,0x3f46bf223e483f7b,0xbf0ebf553f80248d,0x3f7bbe48bec43f6d,0x3dc9bf7f3f353f35,0x3f753e95bf553f0e
.quad 0x3f35bf3500003f80,0x3f353f35bf80a554,0x3f7fbdc9bf353f35,0x3e953f75bf55bf0e,0x3f553f0ebf80a554,0xbe483f7bbec4bf6d,0x3e953f75bf35bf35,0xbf223f463e48bf7b
.quad 0xbec43f6d250dbf80,0xbf6d3ec43f35bf35,0xbf623ef13f35bf35,0xbf7fbdc93f7bbe48,0xbf7bbe483f80248d,0xbf55bf0e3f6d3ec4,0xbf22bf463f353f35,0xbef1bf623f0e3f55
.quad 0x3f80248d00003f80,0xbf80a554250dbf80,0x3f753e95bec43f6d,0xbf7fbdc93e48bf7b,0x3f553f0ebf353f35,0xbf7bbe483ec4bf6d,0x3f223f46bf6d3ec4,0xbf75be953f0ebf55
.quad 0x3ec43f6dbf80a554,0xbf6dbec43f35bf35,0x3dc93f7fbf6dbec4,0xbf62bef13f55bf0e,0xbe483f7bbf35bf35,0xbf55bf0e3f6dbec4,0xbef13f62bec4bf6d,0xbf46bf223f7bbe48
.quad 0xbf353f35250dbf80,0xbf35bf353f80248d,0xbf623ef13ec4bf6d,0xbf22bf463f7b3e48,0xbf7b3e483f35bf35,0xbf0ebf553f6d3ec4,0xbf7fbdc93f6dbec4,0xbef1bf623f553f0e
.quad 0xbf6dbec43f80248d,0xbec4bf6d3f353f35,0xbf46bf223f6d3ec4,0xbe95bf753f0e3f55,0xbf0ebf553f353f35,0xbe48bf7b3ec43f6d,0xbe95bf753ec43f6d,0xbdc9bf7f3e483f7b
.quad 0x248dbf803f808000,0xa5543f80bf80a50d,0xbdc9bf7f3f808000,0x3e953f75bf7b3e48,0xbe48bf7b3f808000,0x3f0e3f55bf6d3ec4,0xbe95bf753f808000,0x3f463f22bf553f0e
.quad 0xbec4bf6d3f808000,0x3f6d3ec4bf353f35,0xbef1bf623f808000,0x3f7f3dc9bf0e3f55,0xbf0ebf553f808000,0x3f7bbe48bec43f6d,0xbf22bf463f808000,0x3f62bef1be483f7b
.quad 0xbf35bf353f808000,0x3f35bf35a5543f80,0xbf46bf223f808000,0x3ef1bf623e483f7b,0xbf55bf0e3f808000,0x3e48bf7b3ec43f6d,0xbf62bef13f808000,0xbdc9bf7f3f0e3f55
.quad 0xbf6dbec43f808000,0xbec4bf6d3f353f35,0xbf75be953f808000,0xbf22bf463f553f0e,0xbf7bbe483f808000,0xbf55bf0e3f6d3ec4,0xbf7fbdc93f808000,0xbf75be953f7b3e48
.quad 0x248dbf803f808000,0xa5543f80bf80a50d,0xbef1bf623f6dbec4,0x3f223f46bf553f0e,0xbf55bf0e3f35bf35,0x3f7b3e48bec43f6d,0xbf7fbdc93ec4bf6d,0x3f62bef13e483f7b
.quad 0xbf6d3ec4248dbf80,0x3ec4bf6d3f353f35,0xbf223f46bec4bf6d,0xbe95bf753f7b3e48,0xbe483f7bbf35bf35,0xbf55bf0e3f6dbec4,0x3e953f75bf6dbec4,0xbf7f3dc93f0ebf55
.quad 0x3f353f35bf80a50d,0xbf353f35248dbf80,0x3f753e95bf6d3ec4,0xbdc93f7fbf0ebf55,0x3f7bbe48bf353f35,0x3f0e3f55bf6dbec4,0x3f46bf22bec43f6d,0x3f753e95bf7b3e48
.quad 0x3ec4bf6da5543f80,0x3f6dbec4bf353f35,0xbdc9bf7f3ec43f6d,0x3ef1bf62be483f7b,0xbf0ebf553f353f35,0xbe48bf7b3ec43f6d,0xbf62bef13f6d3ec4,0xbf46bf223f553f0e
.quad 0x248dbf803f808000,0xa5543f80bf80a50d,0xbf46bf223f35bf35,0x3f623ef1bf0e3f55,0xbf7b3e48248dbf80,0x3f55bf0e3ec43f6d,0xbef13f62bf35bf35,0xbdc9bf7f3f7b3e48
.quad 0x3ec43f6dbf80a50d,0xbf6dbec43f35bf35,0x3f753e95bf353f35,0xbf463f22be48bf7b,0x3f55bf0ea5543f80,0x3e483f7bbf6dbec4,0x3dc9bf7f3f353f35,0x3f753e95bf553f0e
.quad 0xbf35bf353f808000,0x3f35bf35a5543f80,0xbf7f3dc93f35bf35,0xbe95bf753f553f0e,0xbf0e3f55248dbf80,0xbf7bbe483f6dbec4,0x3e953f75bf35bf35,0xbf223f463e48bf7b
.quad 0x3f6d3ec4bf80a50d,0x3ec43f6dbf35bf35,0x3f62bef1bf353f35,0x3f7f3dc9bf7b3e48,0x3e48bf7ba5543f80,0x3f0ebf55bec43f6d,0xbf22bf463f353f35,0xbef1bf623f0e3f55
.quad 0x248dbf803f808000,0xa5543f80bf80a50d,0xbf75be953ec4bf6d,0x3f7f3dc9be483f7b,0xbf0e3f55bf35bf35,0x3e48bf7b3f6d3ec4,0x3f223f46bf6d3ec4,0xbf75be953f0ebf55
.quad 0x3f6dbec4a5543f80,0xbec43f6dbf35bf35,0xbdc9bf7f3f6d3ec4,0x3f623ef1bf553f0e,0xbf7bbe483f35bf35,0x3f0ebf553ec43f6d,0xbef13f62bec4bf6d,0xbf46bf223f7bbe48
.quad 0x3f353f35bf80a50d,0xbf353f35248dbf80,0x3f62bef1bec43f6d,0x3f223f46bf7bbe48,0xbe48bf7b3f353f35,0x3f55bf0ebec43f6d,0xbf7fbdc93f6dbec4,0xbef1bf623f553f0e
.quad 0xbec43f6d248dbf80,0xbf6d3ec43f35bf35,0x3f463f22bf6dbec4,0x3e953f75bf0ebf55,0x3f55bf0ebf353f35,0x3f7bbe48bf6d3ec4,0xbe95bf753ec43f6d,0xbdc9bf7f3e483f7b
.quad 0x248dbf803f808000,0xa5543f80bf80a50d,0xbf7f3dc9248dbf80,0x3f75be953e483f7b,0x3e483f7bbf80a50d,0xbf0ebf553f6dbec4,0x3f75be95a5543f80,0xbf223f46bf0ebf55
.quad 0xbec4bf6d3f808000,0x3f6d3ec4bf353f35,0xbf623ef1248dbf80,0x3dc9bf7f3f553f0e,0x3f0e3f55bf80a50d,0xbf7b3e483ec4bf6d,0x3f46bf22a5543f80,0x3ef13f62bf7bbe48
.quad 0xbf35bf353f808000,0x3f35bf35a5543f80,0xbf223f46248dbf80,0xbf62bef13f7bbe48,0x3f553f0ebf80a50d,0xbe483f7bbec4bf6d,0x3ef1bf62a5543f80,0x3f7fbdc9bf553f0e
.quad 0xbf6dbec43f808000,0xbec4bf6d3f353f35,0xbe953f75248dbf80,0xbf463f223f0ebf55,0x3f7b3e48bf80a50d,0x3f553f0ebf6dbec4,0x3dc9bf7fa5543f80,0x3e95bf75be483f7b
.quad 0x248dbf803f808000,0xa5543f80bf80a50d,0xbf623ef1bec4bf6d,0x3f46bf223f0e3f55,0x3f553f0ebf353f35,0xbf7bbe483ec4bf6d,0x3dc9bf7f3f6d3ec4,0x3ef13f62bf7b3e48
.quad 0xbf6d3ec4248dbf80,0x3ec4bf6d3f353f35,0x3f463f22bf6d3ec4,0xbf753e953e48bf7b,0x3e48bf7b3f353f35,0x3f553f0ebf6d3ec4,0xbf753e953ec4bf6d,0xbdc9bf7f3f553f0e
.quad 0x3f353f35bf80a50d,0xbf353f35248dbf80,0x3e95bf753ec43f6d,0x3f7f3dc9bf553f0e,0xbf7b3e483f35bf35,0xbf0ebf553f6d3ec4,0x3f223f46bf6dbec4,0xbe953f75be48bf7b
.quad 0x3ec4bf6da5543f80,0x3f6dbec4bf353f35,0xbf7f3dc93f6dbec4,0xbf62bef13f7b3e48,0x3f0e3f55bf35bf35,0x3e483f7bbec4bf6d,0x3ef1bf62bec43f6d,0x3f22bf46bf0e3f55
.quad 0x248dbf803f808000,0xa5543f80bf80a50d,0xbf223f46bf35bf35,0x3ef1bf623f553f0e,0x3f7bbe48a5543f80,0xbf553f0ebec4bf6d,0xbf62bef13f35bf35,0x3f7fbdc9be483f7b
.quad 0x3ec43f6dbf80a50d,0xbf6dbec43f35bf35,0x3e95bf753f353f35,0x3f223f46bf7b3e48,0xbf553f0e248dbf80,0xbe48bf7b3f6d3ec4,0x3f7f3dc9bf353f35,0xbe953f75bf0ebf55
.quad 0xbf35bf353f808000,0x3f35bf35a5543f80,0x3dc93f7fbf35bf35,0xbf753e953f0ebf55,0x3f0ebf55a5543f80,0x3f7b3e48bf6d3ec4,0xbf753e953f35bf35,0xbf46bf223f7b3e48
.quad 0x3f6d3ec4bf80a50d,0x3ec43f6dbf35bf35,0xbef1bf623f353f35,0x3dc9bf7f3e483f7b,0xbe483f7b248dbf80,0xbf0e3f553ec4bf6d,0x3f46bf22bf353f35,0x3f62bef1bf553f0e
.quad 0x248dbf803f808000,0xa5543f80bf80a50d,0xbe953f75bf6dbec4,0x3dc9bf7f3f7b3e48,0x3f0ebf553f353f35,0xbe483f7bbf6dbec4,0xbf463f22bec4bf6d,0x3e95bf753f553f0e
.quad 0x3f6dbec4a5543f80,0xbec43f6dbf35bf35,0xbf7f3dc93ec4bf6d,0x3ef1bf623f0e3f55,0x3f7b3e48bf353f35,0xbf0e3f55bec4bf6d,0xbf62bef13f6dbec4,0x3f22bf463e483f7b
.quad 0x3f353f35bf80a50d,0xbf353f35248dbf80,0xbef1bf623f6d3ec4,0x3f46bf22be483f7b,0x3e483f7bbf35bf35,0xbf553f0e3ec4bf6d,0x3dc9bf7f3ec43f6d,0x3f62bef1bf0e3f55
.quad 0xbec43f6d248dbf80,0xbf6d3ec43f35bf35,0x3f22bf46bec43f6d,0x3f75be95bf553f0e,0xbf553f0e3f35bf35,0xbf7b3e483f6dbec4,0x3f75be95bf6d3ec4,0x3f7fbdc9bf7b3e48
.quad 0x248dbf803f808000,0xa5543f80bf80a50d,0x3dc93f7fbf80a50d,0xbe95bf753f7bbe48,0xbe48bf7b3f808000,0x3f0e3f55bf6d3ec4,0x3e953f75bf80a50d,0xbf46bf223f55bf0e
.quad 0xbec4bf6d3f808000,0x3f6d3ec4bf353f35,0x3ef13f62bf80a50d,0xbf7fbdc93f0ebf55,0xbf0ebf553f808000,0x3f7bbe48bec43f6d,0x3f223f46bf80a50d,0xbf623ef13e48bf7b
.quad 0xbf35bf353f808000,0x3f35bf35a5543f80,0x3f463f22bf80a50d,0xbef13f62be48bf7b,0xbf55bf0e3f808000,0x3e48bf7b3ec43f6d,0x3f623ef1bf80a50d,0x3dc93f7fbf0ebf55
.quad 0xbf6dbec43f808000,0xbec4bf6d3f353f35,0x3f753e95bf80a50d,0x3f223f46bf55bf0e,0xbf7bbe483f808000,0xbf55bf0e3f6d3ec4,0x3f7f3dc9bf80a50d,0x3f753e95bf7bbe48
.quad 0x248dbf803f808000,0xa5543f80bf80a50d,0x3ef13f62bf6d3ec4,0xbf22bf463f55bf0e,0xbf55bf0e3f35bf35,0x3f7b3e48bec43f6d,0x3f7f3dc9bec43f6d,0xbf623ef1be48bf7b
.quad 0xbf6d3ec4248dbf80,0x3ec4bf6d3f353f35,0x3f22bf463ec43f6d,0x3e953f75bf7bbe48,0xbe483f7bbf35bf35,0xbf55bf0e3f6dbec4,0xbe95bf753f6d3ec4,0x3f7fbdc9bf0e3f55
.quad 0x3f353f35bf80a50d,0xbf353f35248dbf80,0xbf75be953f6dbec4,0x3dc9bf7f3f0e3f55,0x3f7bbe48bf353f35,0x3f0e3f55bf6dbec4,0xbf463f223ec4bf6d,0xbf75be953f7bbe48
.quad 0x3ec4bf6da5543f80,0x3f6dbec4bf353f35,0x3dc93f7fbec4bf6d,0xbef13f623e48bf7b,0xbf0ebf553f353f35,0xbe48bf7b3ec43f6d,0x3f623ef1bf6dbec4,0x3f463f22bf55bf0e
.quad 0x248dbf803f808000,0xa5543f80bf80a50d,0x3f463f22bf353f35,0xbf62bef13f0ebf55,0xbf7b3e48248dbf80,0x3f55bf0e3ec43f6d,0x3ef1bf623f353f35,0x3dc93f7fbf7bbe48
.quad 0x3ec43f6dbf80a50d,0xbf6dbec43f35bf35,0xbf75be953f35bf35,0x3f46bf223e483f7b,0x3f55bf0ea5543f80,0x3e483f7bbf6dbec4,0xbdc93f7fbf35bf35,0xbf75be953f55bf0e
.quad 0xbf35bf353f808000,0x3f35bf35a5543f80,0x3f7fbdc9bf353f35,0x3e953f75bf55bf0e,0xbf0e3f55248dbf80,0xbf7bbe483f6dbec4,0xbe95bf753f353f35,0x3f22bf46be483f7b
.quad 0x3f6d3ec4bf80a50d,0x3ec43f6dbf35bf35,0xbf623ef13f35bf35,0xbf7fbdc93f7bbe48,0x3e48bf7ba5543f80,0x3f0ebf55bec43f6d,0x3f223f46bf35bf35,0x3ef13f62bf0ebf55
.quad 0x248dbf803f808000,0xa5543f80bf80a50d,0x3f753e95bec43f6d,0xbf7fbdc93e48bf7b,0xbf0e3f55bf35bf35,0x3e48bf7b3f6d3ec4,0xbf22bf463f6dbec4,0x3f753e95bf0e3f55
.quad 0x3f6dbec4a5543f80,0xbec43f6dbf35bf35,0x3dc93f7fbf6dbec4,0xbf62bef13f55bf0e,0xbf7bbe483f35bf35,0x3f0ebf553ec43f6d,0x3ef1bf623ec43f6d,0x3f463f22bf7b3e48
.quad 0x3f353f35bf80a50d,0xbf353f35248dbf80,0xbf623ef13ec4bf6d,0xbf22bf463f7b3e48,0xbe48bf7b3f353f35,0x3f55bf0ebec43f6d,0x3f7f3dc9bf6d3ec4,0x3ef13f62bf55bf0e
.quad 0xbec43f6d248dbf80,0xbf6d3ec43f35bf35,0xbf46bf223f6d3ec4,0xbe95bf753f0e3f55,0x3f55bf0ebf353f35,0x3f7bbe48bf6d3ec4,0x3e953f75bec4bf6d,0x3dc93f7fbe48bf7b
.quad 0x248dbf803f808000,0xa5543f80bf80a50d,0x3f7fbdc9a5543f80,0xbf753e95be48bf7b,0x3e483f7bbf80a50d,0xbf0ebf553f6dbec4,0xbf753e95248dbf80,0x3f22bf463f0e3f55
.quad 0xbec4bf6d3f808000,0x3f6d3ec4bf353f35,0x3f62bef1a5543f80,0xbdc93f7fbf55bf0e,0x3f0e3f55bf80a50d,0xbf7b3e483ec4bf6d,0xbf463f22248dbf80,0xbef1bf623f7b3e48
.quad 0xbf35bf353f808000,0x3f35bf35a5543f80,0x3f22bf46a5543f80,0x3f623ef1bf7b3e48,0x3f553f0ebf80a50d,0xbe483f7bbec4bf6d,0xbef13f62248dbf80,0xbf7f3dc93f55bf0e
.quad 0xbf6dbec43f808000,0xbec4bf6d3f353f35,0x3e95bf75a5543f80,0x3f46bf22bf0e3f55,0x3f7b3e48bf80a50d,0x3f553f0ebf6dbec4,0xbdc93f7f248dbf80,0xbe953f753e48bf7b
.quad 0x248dbf803f808000,0xa5543f80bf80a50d,0x3f62bef13ec43f6d,0xbf463f22bf0ebf55,0x3f553f0ebf353f35,0xbf7bbe483ec4bf6d,0xbdc93f7fbf6dbec4,0xbef1bf623f7bbe48
.quad 0xbf6d3ec4248dbf80,0x3ec4bf6d3f353f35,0xbf46bf223f6dbec4,0x3f75be95be483f7b,0x3e48bf7b3f353f35,0x3f553f0ebf6d3ec4,0x3f75be95bec43f6d,0x3dc93f7fbf55bf0e
.quad 0x3f353f35bf80a50d,0xbf353f35248dbf80,0xbe953f75bec4bf6d,0xbf7fbdc93f55bf0e,0xbf7b3e483f35bf35,0xbf0ebf553f6d3ec4,0xbf22bf463f6d3ec4,0x3e95bf753e483f7b
.quad 0x3ec4bf6da5543f80,0x3f6dbec4bf353f35,0x3f7fbdc9bf6d3ec4,0x3f623ef1bf7bbe48,0x3f0e3f55bf35bf35,0x3e483f7bbec4bf6d,0xbef13f623ec4bf6d,0xbf223f463f0ebf55
.quad 0x248dbf803f808000,0xa5543f80bf80a50d,0x3f22bf463f353f35,0xbef13f62bf55bf0e,0x3f7bbe48a5543f80,0xbf553f0ebec4bf6d,0x3f623ef1bf353f35,0xbf7f3dc93e48bf7b
.quad 0x3ec43f6dbf80a50d,0xbf6dbec43f35bf35,0xbe953f75bf35bf35,0xbf22bf463f7bbe48,0xbf553f0e248dbf80,0xbe48bf7b3f6d3ec4,0xbf7fbdc93f35bf35,0x3e95bf753f0e3f55
.quad 0xbf35bf353f808000,0x3f35bf35a5543f80,0xbdc9bf7f3f353f35,0x3f75be95bf0e3f55,0x3f0ebf55a5543f80,0x3f7b3e48bf6d3ec4,0x3f75be95bf353f35,0x3f463f22bf7bbe48
.quad 0x3f6d3ec4bf80a50d,0x3ec43f6dbf35bf35,0x3ef13f62bf35bf35,0xbdc93f7fbe48bf7b,0xbe483f7b248dbf80,0xbf0e3f553ec4bf6d,0xbf463f223f35bf35,0xbf623ef13f55bf0e
.quad 0x248dbf803f808000,0xa5543f80bf80a50d,0x3e95bf753f6d3ec4,0xbdc93f7fbf7bbe48,0x3f0ebf553f353f35,0xbe483f7bbf6dbec4,0x3f46bf223ec43f6d,0xbe953f75bf55bf0e
.quad 0x3f6dbec4a5543f80,0xbec43f6dbf35bf35,0x3f7fbdc9bec43f6d,0xbef13f62bf0ebf55,0x3f7b3e48bf353f35,0xbf0e3f55bec4bf6d,0x3f623ef1bf6d3ec4,0xbf223f46be48bf7b
.quad 0x3f353f35bf80a50d,0xbf353f35248dbf80,0x3ef13f62bf6dbec4,0xbf463f223e48bf7b,0x3e483f7bbf35bf35,0xbf553f0e3ec4bf6d,0xbdc93f7fbec4bf6d,0xbf623ef13f0ebf55
.quad 0xbec43f6d248dbf80,0xbf6d3ec43f35bf35,0xbf223f463ec4bf6d,0xbf753e953f55bf0e,0xbf553f0e3f35bf35,0xbf7b3e483f6dbec4,0xbf753e953f6dbec4,0xbf7f3dc93f7bbe48
.quad 0x3f7fb10f3f800000,0x3f7d3aac3f7ec46d,0x3f7fa6e33f800000,0x3f7cdf6c3f7e9bc9,0x3f7f9c183f800000,0x3f7c7eb03f7e70b0,0x3f7f90b13f800000,0x3f7c187a3f7e4323
.quad 0x3f7f84ab3f800000,0x3f7baccd3f7e1324,0x3f7f78083f800000,0x3f7b3bab3f7de0b1,0x3f7f6ac73f800000,0x3f7ac5163f7dabcc,0x3f7f5ce93f800000,0x3f7a49103f7d7474
.quad 0x3f7f4e6d3f800000,0x3f79c79d3f7d3aac,0x3f7f3f543f800000,0x3f7940c03f7cfe73,0x3f7f2f9d3f800000,0x3f78b47b3f7cbfc9,0x3f7f1f493f800000,0x3f7822d13f7c7eb0
.quad 0x3f7f0e583f800000,0x3f778bc53f7c3b28,0x3f7efcc93f800000,0x3f76ef5b3f7bf531,0x3f7eea9d3f800000,0x3f764d973f7baccd,0x3f7ed7d43f800000,0x3f75a67b3f7b61fc
.quad 0x3f7853f83f7b14be,0x3f7109083f74fa0b,0x3f77583a3f7a7302,0x3f6f20b03f73913f,0x3f764d973f79c79d,0x3f6d1c1d3f721352,0x3f75341d3f791298,0x3f6afb8c3f708066
.quad 0x3f740bdd3f7853f8,0x3f68bf3c3f6ed89e,0x3f72d4eb3f778bc5,0x3f6667713f6d1c1d,0x3f718f573f76ba07,0x3f63f4733f6b4b0c,0x3f703b373f75dec6,0x3f61668a3f696591
.quad 0x3f6ed89e3f74fa0b,0x3f5ebe053f676bd8,0x3f6d67a13f740bdd,0x3f5bfb343f655e0b,0x3f6be8583f731447,0x3f591e6a3f633c5a,0x3f6a5ad93f721352,0x3f5627fe3f6106f2
.quad 0x3f68bf3c3f710908,0x3f5318493f5ebe05,0x3f6715993f6ff573,0x3f4fefa83f5c61c7,0x3f655e0b3f6ed89e,0x3f4cae793f59f26a,0x3f6398ac3f6db293,0x3f4955213f577026
.quad 0x3f676bd83f6c835e,0x3f5b941a3f61c598,0x3f644fac3f6a09a7,0x3f5703483f5df6be,0x3f6106f23f676bd8,0x3f5233c63f59f26a,0x3f5d924d3f64aa59,0x3f4d26fd3f55b993
.quad 0x3f59f26a3f61c598,0x3f47de653f514d3d,0x3f5627fe3f5ebe05,0x3f425b893f4cae79,0x3f5233c63f5b941a,0x3f3ca0033f47de65,0x3f4e16893f584853,0x3f36ad7f3f42de29
.quad 0x3f49d1123f54db31,0x3f3085bb3f3daef9,0x3f4564393f514d3d,0x3f2a2a803f385216,0x3f40d0da3f4d9f02,0x3f239da93f32c8c9,0x3f3c17d93f49d112,0x3f1ce11f3f2d1469
.quad 0x3f373a233f45e403,0x3f15f6d93f273656,0x3f3238aa3f41d870,0x3f0ee0db3f212ff9,0x3f2d14693f3daef9,0x3f07a1363f1b02c6,0x3f27ce613f396842,0x3f003a063f14b039
.quad 0x3f4d9f023f54db31,0x3f3daef93f45e403,0x3f4760853f4f7a1f,0x3f3592e73f3ebc1b,0x3f40d0da3f49d112,0x3f2d14693f373a23,0x3f39f2ac3f43e200,0x3f24381a3f2f61a5
.quad 0x3f32c8c93f3daef9,0x3f1b02c63f273656,0x3f2b561b3f373a23,0x3f11796b3f1ebc12,0x3f239da93f3085bb,0x3f07a1363f15f6d9,0x3f1ba2993f299415,0x3efafef73f0cead0
.quad 0x3f13682a3f226799,0x3ee633753f039c3d,0x3f0af1b73f1b02c6,0x3ed0eb2a3ef41f07,0x3f0242b13f13682a,0x3ebb31a03ee0924f,0x3ef2bd433f0b9a6b,0x3ea5129f3ecc9b8b
.quad 0x3ee0924f3f039c3d,0x3e8e9a223eb8442a,0x3ece0bea3ef6e0cb,0x3e6fa8b23ea395c5,0x3ebb31a03ee63375,0x3e419b373e8e9a22,0x3ea80b1f3ed53641,0x3e1324ca3e72b651
.quad 0xbd48fb3080000000,0xbe164083bdc8bd36,0xbd55880e80000000,0xbe1f917bbdd53db9,0xbd62146980000000,0xbe28defcbde1bc2e,0xbd6ea03880000000,0xbe3228d4bdee3876
.quad 0xbd7b2b7480000000,0xbe3b6ecfbdfab273,0xbd83db0a80000000,0xbe44b0b9be039502,0xbd8a200a80000000,0xbe4dee60be09cf86,0xbd9064b480000000,0xbe57278fbe1008b7
.quad 0xbd96a90580000000,0xbe605c13be164083,0xbd9cecf980000000,0xbe698bbabe1c76de,0xbda3308c80000000,0xbe72b651be22abb6,0xbda973ba80000000,0xbe7bdba4be28defc
.quad 0xbdafb68080000000,0xbe827dc0be2f10a2,0xbdb5f8da80000000,0xbe870adabe354098,0xbdbc3ac380000000,0xbe8b9507be3b6ecf,0xbdc27c3980000000,0xbe901c2cbe419b37
.quad 0xbe78cfccbe47c5c2,0xbeac7cd4be94a031,0xbe840270be541501,0xbeb6ccc3be9d9e78,0xbe8b9507be605c13,0xbec1071ebea68f12,0xbe931f35be6c9a7f,0xbecb2aaebeaf713a
.quad 0xbe9aa086be78cfcc,0xbed53641beb8442a,0xbea21887be827dc0,0xbedf28a9bec1071e,0xbea986c4be888e93,0xbee900b7bec9b953,0xbeb0eacbbe8e9a22,0xbef2bd43bed25a09
.quad 0xbeb8442abe94a031,0xbefc5d27bedae880,0xbebf926fbe9aa086,0xbf02ef9fbee363fa,0xbec6d529bea09ae5,0xbf07a136beebcbbb,0xbece0beabea68f12,0xbf0c42c9bef41f07
.quad 0xbed53641beac7cd4,0xbf10d3cdbefc5d27,0xbedc53c1beb263ef,0xbf1553b7bf0242b1,0xbee363fabeb8442a,0xbf19c200bf064b82,0xbeea6681bebe1d4a,0xbf1e1e22bf0a48ad
.quad 0xbedae880bec3ef15,0xbf039c3dbef15aea,0xbee79a5dbecf7bca,0xbf0af1b7beff17b2,0xbef41f07bedae880,0xbf121eb0bf064b82,0xbf003a06bee63375,0xbf19210fbf0cead0
.quad 0xbf064b82bef15aea,0xbf1ff6cbbf13682a,0xbf0c42c9befc5d27,0xbf269de3bf19c200,0xbf121eb0bf039c3d,0xbf2d1469bf1ff6cb,0xbf17de12bf08f59b,0xbf33587abf26050a
.quad 0xbf1d7fd1bf0e39da,0xbf396842bf2beb4a,0xbf2302d3bf13682a,0xbf3f41fcbf31a81d,0xbf286605bf187fc0,0xbf44e3f5bf373a23,0xbf2da859bf1d7fd1,0xbf4a4c87bf3ca003
.quad 0xbf32c8c9bf226799,0xbf4f7a1fbf41d870,0xbf37c655bf273656,0xbf546b3bbf46e22a,0xbf3ca003bf2beb4a,0xbf591e6abf4bbbf8,0xbf4154e1bf3085bb,0xbf5d924dbf5064af
.quad 0xbf187fc0bf0e39da,0xbf2beb4abf226799,0xbf209393bf15f6d9,0xbf34768fbf2ac082,0xbf286605bf1d7fd1,0xbf3ca003bf32c8c9,0xbf2ff3e6bf24d225,0xbf446337bf3a7ca4
.quad 0xbf373a23bf2beb4a,0xbf4bbbf8bf41d870,0xbf3e35c5bf32c8c9,0xbf52a649bf48d8b3,0xbf44e3f5bf396842,0xbf591e6abf4f7a1f,0xbf4b41fabf3fc767,0xbf5f20dbbf55b993
.quad 0xbf514d3dbf45e403,0xbf64aa59bf5b941a,0xbf570348bf4bbbf8,0xbf69b7e4bf6106f2,0xbf5c61c7bf514d3d,0xbf6e46bebf660f88,0xbf61668abf5695e5,0xbf725470bf6aab7b
.quad 0xbf660f88bf5b941a,0xbf75dec6bf6ed89e,0xbf6a5ad9bf604621,0xbf78e3d6bf7294f8,0xbf6e46bebf64aa59,0xbf7b61fcbf75dec6,0xbf71d19fbf68bf3c,0xbf7d57debf78b47b
.quad 0x3f2beb4a3f3504f3,0x3f187fc03f226799,0x3f21cbfb3f2beb4a,0x3f0c42c93f173c07,0x3f173c073f226799,0x3eff17b23f0b9a6b,0x3f0c42c93f187fc0,0x3ee4cbfe3eff17b2
.quad 0x3f00e7e43f0e39da,0x3ec9b9533ee63375,0x3eea66813f039c3d,0x3eadf73c3ecc9b8b,0x3ed25a093ef15aea,0x3e919ddd3eb263ef,0x3eb9bb1e3edae880,0x3e698bba3e97a117
.quad 0x3ea09ae53ec3ef15,0x3e2f10a23e78cfcc,0x3e870ada3eac7cd4,0x3de7fa9a3e419b37,0x3e5a39973e94a031,0x3d6214693e09cf86,0x3e25c58c3e78cfcc,0xbb490fc63da3308c
.quad 0x3de1bc2e3e47c5c2,0xbd7b2b743cc90ab0,0x3d6ea0383e164083,0xbdf475c0bcfb49ba,0x3bc90f883dc8bd36,0xbe354098bdafb680,0xbd3c6dd53d48fb30,0xbe6fa8b2be1008b7
.quad 0x3f039c3d3f0e39da,0x3edae8803ef15aea,0x3eea66813f00e7e4,0x3eb9bb1e3ed25a09,0x3ecc9b8b3ee63375,0x3e97a1173eb263ef,0x3eadf73c3ec9b953,0x3e698bba3e919ddd
.quad 0x3e8e9a223eac7cd4,0x3e22abb63e605c13,0x3e5d4b1a3e8e9a22,0x3db5f8da3e1c76de,0x3e1c76de3e605c13,0x3c96c9b63dafb680,0x3db5f8da3e22abb6,0xbd55880e3c96c9b6
.quad 0x3cc90ab03dc8bd36,0xbdfab273bd48fb30,0xbd2351cb3d16c32c,0xbe44b0b9bdee3876,0xbdd53db9bcc90ab0,0xbe8586cebe3b6ecf,0xbe2bf804bdafb680,0xbea80b1fbe7ee6e1
.quad 0xbe6c9a7fbe164083,0xbec9b953bea09ae5,0xbe9620d2be541501,0xbeea6681bec1071e,0xbeb554ecbe888e93,0xbf04f484bee0924f,0xbed3c867bea68f12,0xbf140c5fbeff17b2
.quad 0x3eac7cd43ec3ef15,0x3e78cfcc3e94a031,0x3e870ada3ea09ae5,0x3e25c58c3e5a3997,0x3e419b373e78cfcc,0x3da3308c3e09cf86,0x3de7fa9a3e2f10a2,0xbb490fc63d621469
.quad 0x3d16c32c3dc8bd36,0xbdafb680bcc90ab0,0xbd2351cb3cc90ab0,0xbe2bf804bdd53db9,0xbdee3876bd48fb30,0xbe7ee6e1be3b6ecf,0xbe44b0b9bdfab273,0xbea80b1fbe8586ce
.quad 0xbe888e93be47c5c2,0xbecf7bcabeac7cd4,0xbeadf73cbe888e93,0xbef58035bed25a09,0xbed25a09beac7cd4,0xbf0cead0bef6e0cb,0xbef58035becf7bca,0xbf1e1e22bf0cead0
.quad 0xbf0b9a6bbef15aea,0xbf2e3bdebf1d7fd1,0xbf1ba299bf08f59b,0xbf3d27b8bf2d1469,0xbf2ac082bf187fc0,0xbf4ac77fbf3b8f3b,0xbf38dd65bf273656,0xbf570348bf48d8b3
.quad 0x3e1640833e47c5c2,0x3d48fb303dc8bd36,0x3d6ea0383de1bc2e,0xbd3c6dd53bc90f88,0xbcfb49ba3cc90ab0,0xbe1008b7bdafb680,0xbdf475c0bd7b2b74,0xbe6fa8b2be354098
.quad 0xbe541501be164083,0xbea68f12be888e93,0xbe9620d2be6c9a7f,0xbed3c867beb554ec,0xbec1071ebea09ae5,0xbeff17b2bee0924f,0xbeea6681bec9b953,0xbf140c5fbf04f484
.quad 0xbf08f59bbef15aea,0xbf273656bf187fc0,0xbf1ba299bf0b9a6b,0xbf38dd65bf2ac082,0xbf2d1469bf1d7fd1,0xbf48d8b3bf3b8f3b,0xbf3d27b8bf2e3bde,0xbf570348bf4ac77f
.quad 0xbf4bbbf8bf3daef9,0xbf633c5abf584853,0xbf58b3a1bf4bbbf8,0xbf6d67a1bf63f473,0xbf63f473bf584853,0xbf756d97bf6db293,0xbf6d67a1bf633c5a,0xbf7b3babbf756d97
.quad 0xbf3daef9bf3504f3,0xbf4d9f02bf45e403,0xbf466354bf3daef9,0xbf5627febf4e8d90,0xbf4e8d90bf45e403,0xbf5df6bebf5695e5,0xbf5627febf4d9f02,0xbf650479bf5df6be
.quad 0xbf5d2d53bf54db31,0xbf6b4b0cbf64aa59,0xbf6398acbf5b941a,0xbf70c501bf6aab7b,0xbf696591bf61c598,0xbf756d97bf6ff573,0xbf6e8ff8bf676bd8,0xbf7940c0bf748422
.quad 0xbf731447bf6c835e,0xbf7c3b28bf7853f8,0xbf76ef5bbf710908,0xbf7e5a38bf7b61fc,0xbf7a1e84bf74fa0b,0xbf7f9c18bf7dabcc,0xbf7c9f8abf7853f8,0xbf7fffb1bf7f2f9d
.quad 0xbf7e70b0bf7b14be,0xbf7f84abbf7fec43,0xbf7f90b1bf7d3aac,0xbf7e2b72bf7fe129,0xbf7ffec4bf7ec46d,0xbf7bf531bf7f0e58,0xbf7fba9ebf7fb10f,0xbf78e3d6bf7d7474
.quad 0xbf5b941abf54db31,0xbf676bd8bf61c598,0xbf6398acbf5d2d53,0xbf6e8ff8bf696591,0xbf6aab7bbf64aa59,0xbf748422bf6ff573,0xbf70c501bf6b4b0c,0xbf7940c0bf756d97
.quad 0xbf75dec6bf710908,0xbf7cbfc9bf79c79d,0xbf79f35ebf75dec6,0xbf7efcc9bf7cfe73,0xbf7cfe73bf79c79d,0xbf7ff4e6bf7f0e58,0xbf7efcc9bf7cbfc9,0xbf7fa6e3bf7ff4e6
.quad 0xbf7fec43bf7ec46d,0xbf7e1324bf7fb10f,0xbf7fcbe2bf7fd397,0xbf7b3babbf7e4323,0xbf7e9bc9bf7fec43,0xbf772417bf7baccd,0xbf7c5d3abf7f0e58,0xbf71d19fbf77f110
.quad 0xbf791298bf7d3aac,0xbf6b4b0cbf731447,0xbf74bf62bf7a7302,0xbf6398acbf6d1c1d,0xbf6f6830bf76ba07,0xbf5ac450bf660f88,0xbf6912aebf721352,0xbf50d937bf5df6be
.quad 0xbf710908bf6c835e,0xbf7853f8bf74fa0b,0xbf76ef5bbf731447,0xbf7c9f8abf7a1e84,0xbf7b61fcbf7853f8,0xbf7f2f9dbf7dabcc,0xbf7e5a38bf7c3b28,0xbf7fffb1bf7f9c18
.quad 0xbf7fd397bf7ec46d,0xbf7f0e58bf7fec43,0xbf7fcbe2bf7fec43,0xbf7c5d3abf7e9bc9,0xbf7e4323bf7fb10f,0xbf77f110bf7baccd,0xbf7b3babbf7e1324,0xbf71d19fbf772417
.quad 0xbf76ba07bf7b14be,0xbf6a09a7bf710908,0xbf70c501bf76ba07,0xbf60a6cfbf696591,0xbf696591bf710908,0xbf55b993bf604621,0xbf60a6cfbf6a09a7,0xbf495521bf55b993
.quad 0xbf5695e5bf61c598,0xbf3b8f3bbf49d112,0xbf4b41fabf584853,0xbf2c800fbf3ca003,0xbf3ebc1bbf4d9f02,0xbf1c420cbf2e3bde,0xbf311722bf41d870,0xbf0af1b7bf1ebc12
.quad 0xbf7d3aacbf7b14be,0xbf7fb10fbf7ec46d,0xbf7f90b1bf7e70b0,0xbf7fba9ebf7ffec4,0xbf7fe129bf7fec43,0xbf7d7474bf7f0e58,0xbf7e2b72bf7f84ab,0xbf78e3d6bf7bf531
.quad 0xbf7a7302bf7d3aac,0xbf721352bf76ba07,0xbf74bf62bf791298,0xbf6912aebf6f6830,0xbf6d1c1dbf731447,0xbf5df6bebf660f88,0xbf6398acbf6b4b0c,0xbf50d937bf5ac450
.quad 0xbf584853bf61c598,0xbf41d870bf4d9f02,0xbf4b41fabf5695e5,0xbf311722bf3ebc1b,0xbf3ca003bf49d112,0xbf1ebc12bf2e3bde,0xbf2c800fbf3b8f3b,0xbf0af1b7bf1c420c
.quad 0xbf1b02c6bf2beb4a,0xbeebcbbbbf08f59b,0xbf084b92bf1b02c6,0xbebf926fbee900b7,0xbee900b7bf08f59b,0xbe919dddbebe1d4a,0xbebf926fbeebcbbb,0xbe44b0b9be919ddd
.quad 0x3f8000003f800000,0x3f8000003f800000,0x3f7fa6e33f7fb10f,0x3f7f90b13f7f9c18,0x3f7e9bc93f7ec46d,0x3f7e43233f7e70b0,0x3f7cdf6c3f7d3aac,0x3f7c187a3f7c7eb0
.quad 0x3f7a73023f7b14be,0x3f7912983f79c79d,0x3f77583a3f7853f8,0x3f75341d3f764d97,0x3f73913f3f74fa0b,0x3f7080663f721352,0x3f6f20b03f710908,0x3f6afb8c3f6d1c1d
.quad 0x3f6a09a73f6c835e,0x3f64aa593f676bd8,0x3f644fac3f676bd8,0x3f5d924d3f6106f2,0x3f5df6be3f61c598,0x3f55b9933f59f26a,0x3f5703483f5b941a,0x3f4d26fd3f5233c6
.quad 0x3f4f7a1f3f54db31,0x3f43e2003f49d112,0x3f4760853f4d9f02,0x3f39f2ac3f40d0da,0x3f3ebc1b3f45e403,0x3f2f61a53f373a23,0x3f3592e73f3daef9,0x3f24381a3f2d1469
.quad 0x3f8000003f800000,0x3f8000003f800000,0x3f7f78083f7f84ab,0x3f7f5ce93f7f6ac7,0x3f7de0b13f7e1324,0x3f7d74743f7dabcc,0x3f7b3bab3f7baccd,0x3f7a49103f7ac516
.quad 0x3f778bc53f7853f8,0x3f75dec63f76ba07,0x3f72d4eb3f740bdd,0x3f703b373f718f57,0x3f6d1c1d3f6ed89e,0x3f6965913f6b4b0c,0x3f6667713f68bf3c,0x3f61668a3f63f473
.quad 0x3f5ebe053f61c598,0x3f5848533f5b941a,0x3f5627fe3f59f26a,0x3f4e16893f5233c6,0x3f4cae793f514d3d,0x3f42de293f47de65,0x3f425b893f47de65,0x3f36ad7f3f3ca003
.quad 0x3f373a233f3daef9,0x3f2994153f3085bb,0x3f2b561b3f32c8c9,0x3f1ba2993f239da9,0x3f1ebc123f273656,0x3f0cead03f15f6d9,0x3f11796b3f1b02c6,0x3efafef73f07a136
.quad 0x3f8000003f800000,0x3f8000003f800000,0x3f7f3f543f7f4e6d,0x3f7f1f493f7f2f9d,0x3f7cfe733f7d3aac,0x3f7c7eb03f7cbfc9,0x3f7940c03f79c79d,0x3f7822d13f78b47b
.quad 0x3f740bdd3f74fa0b,0x3f7213523f731447,0x3f6d67a13f6ed89e,0x3f6a5ad93f6be858,0x3f655e0b3f676bd8,0x3f6106f23f633c5a,0x3f5bfb343f5ebe05,0x3f5627fe3f591e6a
.quad 0x3f514d3d3f54db31,0x3f49d1123f4d9f02,0x3f4564393f49d112,0x3f3c17d93f40d0da,0x3f3852163f3daef9,0x3f2d14693f32c8c9,0x3f2a2a803f3085bb,0x3f1ce11f3f239da9
.quad 0x3f1b02c63f226799,0x3f0b9a6b3f13682a,0x3f0af1b73f13682a,0x3ef2bd433f0242b1,0x3ef41f073f039c3d,0x3ecc9b8b3ee0924f,0x3ed0eb2a3ee63375,0x3ea5129f3ebb31a0
.quad 0x3f8000003f800000,0x3f8000003f800000,0x3f7efcc93f7f0e58,0x3f7ed7d43f7eea9d,0x3f7bf5313f7c3b28,0x3f7b61fc3f7baccd,0x3f76ef5b3f778bc5,0x3f75a67b3f764d97
.quad 0x3f6ff5733f710908,0x3f6db2933f6ed89e,0x3f6715993f68bf3c,0x3f6398ac3f655e0b,0x3f5c61c73f5ebe05,0x3f5770263f59f26a,0x3f4fefa83f531849,0x3f4955213f4cae79
.quad 0x3f41d8703f45e403,0x3f3968423f3daef9,0x3f3238aa3f373a23,0x3f27ce613f2d1469,0x3f212ff93f273656,0x3f14b0393f1b02c6,0x3f0ee0db3f15f6d9,0x3f003a063f07a136
.quad 0x3ef6e0cb3f039c3d,0x3ed536413ee63375,0x3ece0bea3ee0924f,0x3ea80b1f3ebb31a0,0x3ea395c53eb8442a,0x3e72b6513e8e9a22,0x3e6fa8b23e8e9a22,0x3e1324ca3e419b37
.quad 0x0,0x0,0x3d55880e3d48fb30,0x3d6ea0383d621469,0x3dd53db93dc8bd36,0x3dee38763de1bc2e,0x3e1f917b3e164083,0x3e3228d43e28defc
.quad 0x3e5415013e47c5c2,0x3e6c9a7f3e605c13,0x3e8402703e78cfcc,0x3e931f353e8b9507,0x3e9d9e783e94a031,0x3eaf713a3ea68f12,0x3eb6ccc33eac7cd4,0x3ecb2aae3ec1071e
.quad 0x3ecf7bca3ec3ef15,0x3ee633753edae880,0x3ee79a5d3edae880,0x3f003a063ef41f07,0x3eff17b23ef15aea,0x3f0cead03f064b82,0x3f0af1b73f039c3d,0x3f19210f3f121eb0
.quad 0x3f15f6d93f0e39da,0x3f24d2253f1d7fd1,0x3f2093933f187fc0,0x3f2ff3e63f286605,0x3f2ac0823f226799,0x3f3a7ca43f32c8c9,0x3f34768f3f2beb4a,0x3f4463373f3ca003
.quad 0x0,0x0,0x3d83db0a3d7b2b74,0x3d9064b43d8a200a,0x3e0395023dfab273,0x3e1008b73e09cf86,0x3e44b0b93e3b6ecf,0x3e57278f3e4dee60
.quad 0x3e827dc03e78cfcc,0x3e8e9a223e888e93,0x3ea218873e9aa086,0x3eb0eacb3ea986c4,0x3ec1071e3eb8442a,0x3ed25a093ec9b953,0x3edf28a93ed53641,0x3ef2bd433ee900b7
.quad 0x3efc5d273ef15aea,0x3f08f59b3f039c3d,0x3f0c42c93f064b82,0x3f17de123f121eb0,0x3f19c2003f13682a,0x3f26050a3f1ff6cb,0x3f269de33f1ff6cb,0x3f33587a3f2d1469
.quad 0x3f32c8c93f2beb4a,0x3f3fc7673f396842,0x3f3e35c53f373a23,0x3f4b41fa3f44e3f5,0x3f48d8b33f41d870,0x3f55b9933f4f7a1f,0x3f52a6493f4bbbf8,0x3f5f20db3f591e6a
.quad 0x0,0x0,0x3d9cecf93d96a905,0x3da973ba3da3308c,0x3e1c76de3e164083,0x3e28defc3e22abb6,0x3e698bba3e605c13,0x3e7bdba43e72b651
.quad 0x3e9aa0863e94a031,0x3ea68f123ea09ae5,0x3ebf926f3eb8442a,0x3ece0bea3ec6d529,0x3ee363fa3edae880,0x3ef41f073eebcbbb,0x3f02ef9f3efc5d27,0x3f0c42c93f07a136
.quad 0x3f13682a3f0e39da,0x3f1d7fd13f187fc0,0x3f2302d33f1d7fd1,0x3f2da8593f286605,0x3f31a81d3f2beb4a,0x3f3ca0033f373a23,0x3f3f41fc3f396842,0x3f4a4c873f44e3f5
.quad 0x3f4bbbf83f45e403,0x3f5695e53f514d3d,0x3f5703483f514d3d,0x3f61668a3f5c61c7,0x3f6106f23f5b941a,0x3f6aab7b3f660f88,0x3f69b7e43f64aa59,0x3f7254703f6e46be
.quad 0x0,0x0,0x3db5f8da3dafb680,0x3dc27c393dbc3ac3,0x3e3540983e2f10a2,0x3e419b373e3b6ecf,0x3e870ada3e827dc0,0x3e901c2c3e8b9507
.quad 0x3eb263ef3eac7cd4,0x3ebe1d4a3eb8442a,0x3edc53c13ed53641,0x3eea66813ee363fa,0x3f0242b13efc5d27,0x3f0a48ad3f064b82,0x3f1553b73f10d3cd,0x3f1e1e223f19c200
.quad 0x3f2736563f226799,0x3f3085bb3f2beb4a,0x3f37c6553f32c8c9,0x3f4154e13f3ca003,0x3f46e22a3f41d870,0x3f5064af3f4bbbf8,0x3f546b3b3f4f7a1f,0x3f5d924d3f591e6a
.quad 0x3f6046213f5b941a,0x3f68bf3c3f64aa59,0x3f6a5ad93f660f88,0x3f71d19f3f6e46be,0x3f7294f83f6ed89e,0x3f78b47b3f75dec6,0x3f78e3d63f75dec6,0x3f7d57de3f7b61fc
.quad 0x3f2beb4a3f3504f3,0x3f187fc03f226799,0x3f21cbfb3f2beb4a,0x3f0c42c93f173c07,0x3f173c073f226799,0x3eff17b23f0b9a6b,0x3f0c42c93f187fc0,0x3ee4cbfe3eff17b2
.quad 0x3f00e7e43f0e39da,0x3ec9b9533ee63375,0x3eea66813f039c3d,0x3eadf73c3ecc9b8b,0x3ed25a093ef15aea,0x3e919ddd3eb263ef,0x3eb9bb1e3edae880,0x3e698bba3e97a117
.quad 0x3ea09ae53ec3ef15,0x3e2f10a23e78cfcc,0x3e870ada3eac7cd4,0x3de7fa9a3e419b37,0x3e5a39973e94a031,0x3d6214693e09cf86,0x3e25c58c3e78cfcc,0xbb490fc63da3308c
.quad 0x3de1bc2e3e47c5c2,0xbd7b2b743cc90ab0,0x3d6ea0383e164083,0xbdf475c0bcfb49ba,0x3bc90f883dc8bd36,0xbe354098bdafb680,0xbd3c6dd53d48fb30,0xbe6fa8b2be1008b7
.quad 0x3f039c3d3f0e39da,0x3edae8803ef15aea,0x3eea66813f00e7e4,0x3eb9bb1e3ed25a09,0x3ecc9b8b3ee63375,0x3e97a1173eb263ef,0x3eadf73c3ec9b953,0x3e698bba3e919ddd
.quad 0x3e8e9a223eac7cd4,0x3e22abb63e605c13,0x3e5d4b1a3e8e9a22,0x3db5f8da3e1c76de,0x3e1c76de3e605c13,0x3c96c9b63dafb680,0x3db5f8da3e22abb6,0xbd55880e3c96c9b6
.quad 0x3cc90ab03dc8bd36,0xbdfab273bd48fb30,0xbd2351cb3d16c32c,0xbe44b0b9bdee3876,0xbdd53db9bcc90ab0,0xbe8586cebe3b6ecf,0xbe2bf804bdafb680,0xbea80b1fbe7ee6e1
.quad 0xbe6c9a7fbe164083,0xbec9b953bea09ae5,0xbe9620d2be541501,0xbeea6681bec1071e,0xbeb554ecbe888e93,0xbf04f484bee0924f,0xbed3c867bea68f12,0xbf140c5fbeff17b2
.quad 0x3eac7cd43ec3ef15,0x3e78cfcc3e94a031,0x3e870ada3ea09ae5,0x3e25c58c3e5a3997,0x3e419b373e78cfcc,0x3da3308c3e09cf86,0x3de7fa9a3e2f10a2,0xbb490fc63d621469
.quad 0x3d16c32c3dc8bd36,0xbdafb680bcc90ab0,0xbd2351cb3cc90ab0,0xbe2bf804bdd53db9,0xbdee3876bd48fb30,0xbe7ee6e1be3b6ecf,0xbe44b0b9bdfab273,0xbea80b1fbe8586ce
.quad 0xbe888e93be47c5c2,0xbecf7bcabeac7cd4,0xbeadf73cbe888e93,0xbef58035bed25a09,0xbed25a09beac7cd4,0xbf0cead0bef6e0cb,0xbef58035becf7bca,0xbf1e1e22bf0cead0
.quad 0xbf0b9a6bbef15aea,0xbf2e3bdebf1d7fd1,0xbf1ba299bf08f59b,0xbf3d27b8bf2d1469,0xbf2ac082bf187fc0,0xbf4ac77fbf3b8f3b,0xbf38dd65bf273656,0xbf570348bf48d8b3
.quad 0x3e1640833e47c5c2,0x3d48fb303dc8bd36,0x3d6ea0383de1bc2e,0xbd3c6dd53bc90f88,0xbcfb49ba3cc90ab0,0xbe1008b7bdafb680,0xbdf475c0bd7b2b74,0xbe6fa8b2be354098
.quad 0xbe541501be164083,0xbea68f12be888e93,0xbe9620d2be6c9a7f,0xbed3c867beb554ec,0xbec1071ebea09ae5,0xbeff17b2bee0924f,0xbeea6681bec9b953,0xbf140c5fbf04f484
.quad 0xbf08f59bbef15aea,0xbf273656bf187fc0,0xbf1ba299bf0b9a6b,0xbf38dd65bf2ac082,0xbf2d1469bf1d7fd1,0xbf48d8b3bf3b8f3b,0xbf3d27b8bf2e3bde,0xbf570348bf4ac77f
.quad 0xbf4bbbf8bf3daef9,0xbf633c5abf584853,0xbf58b3a1bf4bbbf8,0xbf6d67a1bf63f473,0xbf63f473bf584853,0xbf756d97bf6db293,0xbf6d67a1bf633c5a,0xbf7b3babbf756d97
.quad 0x3f3daef93f3504f3,0x3f4d9f023f45e403,0x3f4663543f3daef9,0x3f5627fe3f4e8d90,0x3f4e8d903f45e403,0x3f5df6be3f5695e5,0x3f5627fe3f4d9f02,0x3f6504793f5df6be
.quad 0x3f5d2d533f54db31,0x3f6b4b0c3f64aa59,0x3f6398ac3f5b941a,0x3f70c5013f6aab7b,0x3f6965913f61c598,0x3f756d973f6ff573,0x3f6e8ff83f676bd8,0x3f7940c03f748422
.quad 0x3f7314473f6c835e,0x3f7c3b283f7853f8,0x3f76ef5b3f710908,0x3f7e5a383f7b61fc,0x3f7a1e843f74fa0b,0x3f7f9c183f7dabcc,0x3f7c9f8a3f7853f8,0x3f7fffb13f7f2f9d
.quad 0x3f7e70b03f7b14be,0x3f7f84ab3f7fec43,0x3f7f90b13f7d3aac,0x3f7e2b723f7fe129,0x3f7ffec43f7ec46d,0x3f7bf5313f7f0e58,0x3f7fba9e3f7fb10f,0x3f78e3d63f7d7474
.quad 0x3f5b941a3f54db31,0x3f676bd83f61c598,0x3f6398ac3f5d2d53,0x3f6e8ff83f696591,0x3f6aab7b3f64aa59,0x3f7484223f6ff573,0x3f70c5013f6b4b0c,0x3f7940c03f756d97
.quad 0x3f75dec63f710908,0x3f7cbfc93f79c79d,0x3f79f35e3f75dec6,0x3f7efcc93f7cfe73,0x3f7cfe733f79c79d,0x3f7ff4e63f7f0e58,0x3f7efcc93f7cbfc9,0x3f7fa6e33f7ff4e6
.quad 0x3f7fec433f7ec46d,0x3f7e13243f7fb10f,0x3f7fcbe23f7fd397,0x3f7b3bab3f7e4323,0x3f7e9bc93f7fec43,0x3f7724173f7baccd,0x3f7c5d3a3f7f0e58,0x3f71d19f3f77f110
.quad 0x3f7912983f7d3aac,0x3f6b4b0c3f731447,0x3f74bf623f7a7302,0x3f6398ac3f6d1c1d,0x3f6f68303f76ba07,0x3f5ac4503f660f88,0x3f6912ae3f721352,0x3f50d9373f5df6be
.quad 0x3f7109083f6c835e,0x3f7853f83f74fa0b,0x3f76ef5b3f731447,0x3f7c9f8a3f7a1e84,0x3f7b61fc3f7853f8,0x3f7f2f9d3f7dabcc,0x3f7e5a383f7c3b28,0x3f7fffb13f7f9c18
.quad 0x3f7fd3973f7ec46d,0x3f7f0e583f7fec43,0x3f7fcbe23f7fec43,0x3f7c5d3a3f7e9bc9,0x3f7e43233f7fb10f,0x3f77f1103f7baccd,0x3f7b3bab3f7e1324,0x3f71d19f3f772417
.quad 0x3f76ba073f7b14be,0x3f6a09a73f710908,0x3f70c5013f76ba07,0x3f60a6cf3f696591,0x3f6965913f710908,0x3f55b9933f604621,0x3f60a6cf3f6a09a7,0x3f4955213f55b993
.quad 0x3f5695e53f61c598,0x3f3b8f3b3f49d112,0x3f4b41fa3f584853,0x3f2c800f3f3ca003,0x3f3ebc1b3f4d9f02,0x3f1c420c3f2e3bde,0x3f3117223f41d870,0x3f0af1b73f1ebc12
.quad 0x3f7d3aac3f7b14be,0x3f7fb10f3f7ec46d,0x3f7f90b13f7e70b0,0x3f7fba9e3f7ffec4,0x3f7fe1293f7fec43,0x3f7d74743f7f0e58,0x3f7e2b723f7f84ab,0x3f78e3d63f7bf531
.quad 0x3f7a73023f7d3aac,0x3f7213523f76ba07,0x3f74bf623f791298,0x3f6912ae3f6f6830,0x3f6d1c1d3f731447,0x3f5df6be3f660f88,0x3f6398ac3f6b4b0c,0x3f50d9373f5ac450
.quad 0x3f5848533f61c598,0x3f41d8703f4d9f02,0x3f4b41fa3f5695e5,0x3f3117223f3ebc1b,0x3f3ca0033f49d112,0x3f1ebc123f2e3bde,0x3f2c800f3f3b8f3b,0x3f0af1b73f1c420c
.quad 0x3f1b02c63f2beb4a,0x3eebcbbb3f08f59b,0x3f084b923f1b02c6,0x3ebf926f3ee900b7,0x3ee900b73f08f59b,0x3e919ddd3ebe1d4a,0x3ebf926f3eebcbbb,0x3e44b0b93e919ddd
.quad 0x250dbf8000003f80,0x250dbf8000003f80,0xbdc9bf7f00003f80,0xbe95bf753e483f7b,0xbe48bf7b00003f80,0xbf0ebf553ec43f6d,0xbe95bf7500003f80,0xbf46bf223f0e3f55
.quad 0xbec4bf6d00003f80,0xbf6dbec43f353f35,0xbef1bf6200003f80,0xbf7fbdc93f553f0e,0xbf0ebf5500003f80,0xbf7b3e483f6d3ec4,0xbf22bf4600003f80,0xbf623ef13f7b3e48
.quad 0xbf35bf3500003f80,0xbf353f353f80248d,0xbf46bf2200003f80,0xbef13f623f7bbe48,0xbf55bf0e00003f80,0xbe483f7b3f6dbec4,0xbf62bef100003f80,0x3dc93f7f3f55bf0e
.quad 0xbf6dbec400003f80,0x3ec43f6d3f35bf35,0xbf75be9500003f80,0x3f223f463f0ebf55,0xbf7bbe4800003f80,0x3f553f0e3ec4bf6d,0xbf7fbdc900003f80,0x3f753e953e48bf7b
.quad 0x250dbf8000003f80,0x250dbf8000003f80,0xbef1bf623ec43f6d,0xbf22bf463f0e3f55,0xbf55bf0e3f353f35,0xbf7bbe483f6d3ec4,0xbf7fbdc93f6d3ec4,0xbf623ef13f7bbe48
.quad 0xbf6d3ec43f80248d,0xbec43f6d3f35bf35,0xbf223f463f6dbec4,0x3e953f753e48bf7b,0xbe483f7b3f35bf35,0x3f553f0ebec4bf6d,0x3e953f753ec4bf6d,0x3f7fbdc9bf55bf0e
.quad 0x3f353f35250dbf80,0x3f35bf35bf80a554,0x3f753e95bec4bf6d,0x3dc9bf7fbf553f0e,0x3f7bbe48bf35bf35,0xbf0ebf55bec43f6d,0x3f46bf22bf6dbec4,0xbf75be953e483f7b
.quad 0x3ec4bf6dbf80a554,0xbf6d3ec43f353f35,0xbdc9bf7fbf6d3ec4,0xbef13f623f7b3e48,0xbf0ebf55bf353f35,0x3e483f7b3f6dbec4,0xbf62bef1bec43f6d,0x3f463f223f0ebf55
.quad 0x250dbf8000003f80,0x250dbf8000003f80,0xbf46bf223f353f35,0xbf62bef13f553f0e,0xbf7b3e483f80248d,0xbf553f0e3f6dbec4,0xbef13f623f35bf35,0x3dc93f7f3e48bf7b
.quad 0x3ec43f6d250dbf80,0x3f6d3ec4bf35bf35,0x3f753e95bf35bf35,0x3f46bf22bf7b3e48,0x3f55bf0ebf80a554,0xbe48bf7bbec43f6d,0x3dc9bf7fbf353f35,0xbf75be953f0e3f55
.quad 0xbf35bf3500003f80,0xbf353f353f80248d,0xbf7f3dc93f353f35,0x3e953f753f0ebf55,0xbf0e3f553f80248d,0x3f7b3e48bec4bf6d,0x3e953f753f35bf35,0x3f22bf46bf7bbe48
.quad 0x3f6d3ec4250dbf80,0xbec4bf6dbf353f35,0x3f62bef1bf35bf35,0xbf7fbdc93e483f7b,0x3e48bf7bbf80a554,0xbf0e3f553f6d3ec4,0xbf22bf46bf353f35,0x3ef13f623f55bf0e
.quad 0x250dbf8000003f80,0x250dbf8000003f80,0xbf75be953f6d3ec4,0xbf7fbdc93f7b3e48,0xbf0e3f553f35bf35,0xbe483f7b3ec4bf6d,0x3f223f46bec4bf6d,0x3f753e95bf55bf0e
.quad 0x3f6dbec4bf80a554,0x3ec4bf6dbf353f35,0xbdc9bf7fbec43f6d,0xbf62bef13f0e3f55,0xbf7bbe483f353f35,0xbf0e3f553f6dbec4,0xbef13f623f6dbec4,0x3f463f22be48bf7b
.quad 0x3f353f35250dbf80,0x3f35bf35bf80a554,0x3f62bef1bf6dbec4,0xbf22bf46be483f7b,0xbe48bf7bbf353f35,0xbf553f0e3f6d3ec4,0xbf7fbdc93ec43f6d,0x3ef13f623f0ebf55
.quad 0xbec43f6d3f80248d,0x3f6dbec4bf35bf35,0x3f463f223ec4bf6d,0xbe95bf75bf553f0e,0x3f55bf0ebf35bf35,0xbf7b3e483ec43f6d,0xbe95bf75bf6d3ec4,0x3dc93f7f3f7bbe48
.quad 0x250dbf8000003f80,0x250dbf8000003f80,0xbf7f3dc93f80248d,0xbf753e953f7bbe48,0x3e483f7b250dbf80,0x3f0e3f55bec4bf6d,0x3f75be95bf80a554,0x3f22bf46bf553f0e
.quad 0xbec4bf6d00003f80,0xbf6dbec43f353f35,0xbf623ef13f80248d,0xbdc93f7f3f0ebf55,0x3f0e3f55250dbf80,0x3f7bbe48bf6dbec4,0x3f46bf22bf80a554,0xbef1bf62be483f7b
.quad 0xbf35bf3500003f80,0xbf353f353f80248d,0xbf223f463f80248d,0x3f623ef1be48bf7b,0x3f553f0e250dbf80,0x3e48bf7bbf6d3ec4,0x3ef1bf62bf80a554,0xbf7f3dc93f0e3f55
.quad 0xbf6dbec400003f80,0x3ec43f6d3f35bf35,0xbe953f753f80248d,0x3f46bf22bf55bf0e,0x3f7b3e48250dbf80,0xbf55bf0ebec43f6d,0x3dc9bf7fbf80a554,0xbe953f753f7b3e48
.quad 0x250dbf8000003f80,0x250dbf8000003f80,0xbf623ef13f6dbec4,0xbf463f223f55bf0e,0x3f553f0ebf35bf35,0x3f7b3e48bf6dbec4,0x3dc9bf7fbec43f6d,0xbef1bf623e483f7b
.quad 0xbf6d3ec43f80248d,0xbec43f6d3f35bf35,0x3f463f22bec4bf6d,0x3f75be95bf7bbe48,0x3e48bf7bbf353f35,0xbf55bf0e3ec43f6d,0xbf753e953f6d3ec4,0x3dc93f7f3f0ebf55
.quad 0x3f353f35250dbf80,0x3f35bf35bf80a554,0x3e95bf75bf6d3ec4,0xbf7fbdc93f0e3f55,0xbf7b3e483f353f35,0x3f0e3f553ec4bf6d,0x3f223f463ec4bf6d,0x3e95bf75bf7b3e48
.quad 0x3ec4bf6dbf80a554,0xbf6d3ec43f353f35,0xbf7f3dc93ec43f6d,0x3f623ef13e48bf7b,0x3f0e3f553f35bf35,0xbe48bf7bbf6d3ec4,0x3ef1bf62bf6dbec4,0xbf223f463f553f0e
.quad 0x250dbf8000003f80,0x250dbf8000003f80,0xbf223f463f35bf35,0xbef13f623f0ebf55,0x3f7bbe48bf80a554,0x3f55bf0ebf6d3ec4,0xbf62bef13f353f35,0xbf7f3dc93f7b3e48
.quad 0x3ec43f6d250dbf80,0x3f6d3ec4bf35bf35,0x3e95bf75bf353f35,0xbf22bf463e483f7b,0xbf553f0e3f80248d,0x3e483f7b3ec4bf6d,0x3f7f3dc9bf35bf35,0x3e95bf75bf553f0e
.quad 0xbf35bf3500003f80,0xbf353f353f80248d,0x3dc93f7f3f35bf35,0x3f75be95bf55bf0e,0x3f0ebf55bf80a554,0xbf7bbe483ec43f6d,0xbf753e953f353f35,0x3f463f223e48bf7b
.quad 0x3f6d3ec4250dbf80,0xbec4bf6dbf353f35,0xbef1bf62bf353f35,0xbdc93f7f3f7bbe48,0xbe483f7b3f80248d,0x3f0ebf55bf6dbec4,0x3f46bf22bf35bf35,0xbf623ef13f0e3f55
.quad 0x250dbf8000003f80,0x250dbf8000003f80,0xbe953f753ec4bf6d,0xbdc93f7f3e48bf7b,0x3f0ebf55bf353f35,0x3e48bf7bbec43f6d,0xbf463f223f6dbec4,0xbe953f753f0ebf55
.quad 0x3f6dbec4bf80a554,0x3ec4bf6dbf353f35,0xbf7f3dc93f6d3ec4,0xbef13f623f55bf0e,0x3f7b3e48bf35bf35,0x3f0ebf55bf6d3ec4,0xbf62bef13ec43f6d,0xbf223f463f7bbe48
.quad 0x3f353f35250dbf80,0x3f35bf35bf80a554,0xbef1bf62bec43f6d,0xbf463f223f7b3e48,0x3e483f7b3f35bf35,0x3f55bf0ebf6dbec4,0x3dc9bf7fbf6d3ec4,0xbf623ef13f553f0e
.quad 0xbec43f6d3f80248d,0x3f6dbec4bf35bf35,0x3f22bf46bf6dbec4,0xbf753e953f0e3f55,0xbf553f0e3f353f35,0x3f7bbe48bec4bf6d,0x3f75be95bec4bf6d,0xbf7f3dc93e483f7b
.quad 0x250dbf8000003f80,0x250dbf8000003f80,0x3dc93f7f250dbf80,0x3e953f75be48bf7b,0xbe48bf7b00003f80,0xbf0ebf553ec43f6d,0x3e953f75250dbf80,0x3f463f22bf0ebf55
.quad 0xbec4bf6d00003f80,0xbf6dbec43f353f35,0x3ef13f62250dbf80,0x3f7f3dc9bf55bf0e,0xbf0ebf5500003f80,0xbf7b3e483f6d3ec4,0x3f223f46250dbf80,0x3f62bef1bf7bbe48
.quad 0xbf35bf3500003f80,0xbf353f353f80248d,0x3f463f22250dbf80,0x3ef1bf62bf7b3e48,0xbf55bf0e00003f80,0xbe483f7b3f6dbec4,0x3f623ef1250dbf80,0xbdc9bf7fbf553f0e
.quad 0xbf6dbec400003f80,0x3ec43f6d3f35bf35,0x3f753e95250dbf80,0xbf22bf46bf0e3f55,0xbf7bbe4800003f80,0x3f553f0e3ec4bf6d,0x3f7f3dc9250dbf80,0xbf75be95be483f7b
.quad 0x250dbf8000003f80,0x250dbf8000003f80,0x3ef13f62bec4bf6d,0x3f223f46bf0ebf55,0xbf55bf0e3f353f35,0xbf7bbe483f6d3ec4,0x3f7f3dc9bf6dbec4,0x3f62bef1bf7b3e48
.quad 0xbf6d3ec43f80248d,0xbec43f6d3f35bf35,0x3f22bf46bf6d3ec4,0xbe95bf75be483f7b,0xbe483f7b3f35bf35,0x3f553f0ebec4bf6d,0xbe95bf75bec43f6d,0xbf7f3dc93f553f0e
.quad 0x3f353f35250dbf80,0x3f35bf35bf80a554,0xbf75be953ec43f6d,0xbdc93f7f3f55bf0e,0x3f7bbe48bf35bf35,0xbf0ebf55bec43f6d,0xbf463f223f6d3ec4,0x3f753e95be48bf7b
.quad 0x3ec4bf6dbf80a554,0xbf6d3ec43f353f35,0x3dc93f7f3f6dbec4,0x3ef1bf62bf7bbe48,0xbf0ebf55bf353f35,0x3e483f7b3f6dbec4,0x3f623ef13ec4bf6d,0xbf46bf22bf0e3f55
.quad 0x250dbf8000003f80,0x250dbf8000003f80,0x3f463f22bf35bf35,0x3f623ef1bf55bf0e,0xbf7b3e483f80248d,0xbf553f0e3f6dbec4,0x3ef1bf62bf353f35,0xbdc9bf7fbe483f7b
.quad 0x3ec43f6d250dbf80,0x3f6d3ec4bf35bf35,0xbf75be953f353f35,0xbf463f223f7bbe48,0x3f55bf0ebf80a554,0xbe48bf7bbec43f6d,0xbdc93f7f3f35bf35,0x3f753e95bf0ebf55
.quad 0xbf35bf3500003f80,0xbf353f353f80248d,0x3f7fbdc9bf35bf35,0xbe95bf75bf0e3f55,0xbf0e3f553f80248d,0x3f7b3e48bec4bf6d,0xbe95bf75bf353f35,0xbf223f463f7b3e48
.quad 0x3f6d3ec4250dbf80,0xbec4bf6dbf353f35,0xbf623ef13f353f35,0x3f7f3dc9be48bf7b,0x3e48bf7bbf80a554,0xbf0e3f553f6d3ec4,0x3f223f463f35bf35,0xbef1bf62bf553f0e
.quad 0x250dbf8000003f80,0x250dbf8000003f80,0x3f753e95bf6dbec4,0x3f7f3dc9bf7bbe48,0xbf0e3f553f35bf35,0xbe483f7b3ec4bf6d,0xbf22bf463ec43f6d,0xbf75be953f553f0e
.quad 0x3f6dbec4bf80a554,0x3ec4bf6dbf353f35,0x3dc93f7f3ec4bf6d,0x3f623ef1bf0ebf55,0xbf7bbe483f353f35,0xbf0e3f553f6dbec4,0x3ef1bf62bf6d3ec4,0xbf46bf223e483f7b
.quad 0x3f353f35250dbf80,0x3f35bf35bf80a554,0xbf623ef13f6d3ec4,0x3f223f463e48bf7b,0xbe48bf7bbf353f35,0xbf553f0e3f6d3ec4,0x3f7f3dc9bec4bf6d,0xbef1bf62bf0e3f55
.quad 0xbec43f6d3f80248d,0x3f6dbec4bf35bf35,0xbf46bf22bec43f6d,0x3e953f753f55bf0e,0x3f55bf0ebf35bf35,0xbf7b3e483ec43f6d,0x3e953f753f6dbec4,0xbdc9bf7fbf7b3e48
.quad 0x250dbf8000003f80,0x250dbf8000003f80,0x3f7fbdc9bf80a554,0x3f75be95bf7b3e48,0x3e483f7b250dbf80,0x3f0e3f55bec4bf6d,0xbf753e953f80248d,0xbf223f463f55bf0e
.quad 0xbec4bf6d00003f80,0xbf6dbec43f353f35,0x3f62bef1bf80a554,0x3dc9bf7fbf0e3f55,0x3f0e3f55250dbf80,0x3f7bbe48bf6dbec4,0xbf463f223f80248d,0x3ef13f623e48bf7b
.quad 0xbf35bf3500003f80,0xbf353f353f80248d,0x3f22bf46bf80a554,0xbf62bef13e483f7b,0x3f553f0e250dbf80,0x3e48bf7bbf6d3ec4,0xbef13f623f80248d,0x3f7fbdc9bf0ebf55
.quad 0xbf6dbec400003f80,0x3ec43f6d3f35bf35,0x3e95bf75bf80a554,0xbf463f223f553f0e,0x3f7b3e48250dbf80,0xbf55bf0ebec43f6d,0xbdc93f7f3f80248d,0x3e95bf75bf7bbe48
.quad 0x250dbf8000003f80,0x250dbf8000003f80,0x3f62bef1bf6d3ec4,0x3f46bf22bf553f0e,0x3f553f0ebf35bf35,0x3f7b3e48bf6dbec4,0xbdc93f7f3ec4bf6d,0x3ef13f62be48bf7b
.quad 0xbf6d3ec43f80248d,0xbec43f6d3f35bf35,0xbf46bf223ec43f6d,0xbf753e953f7b3e48,0x3e48bf7bbf353f35,0xbf55bf0e3ec43f6d,0x3f75be95bf6dbec4,0xbdc9bf7fbf0e3f55
.quad 0x3f353f35250dbf80,0x3f35bf35bf80a554,0xbe953f753f6dbec4,0x3f7f3dc9bf0ebf55,0xbf7b3e483f353f35,0x3f0e3f553ec4bf6d,0xbf22bf46bec43f6d,0xbe953f753f7bbe48
.quad 0x3ec4bf6dbf80a554,0xbf6d3ec43f353f35,0x3f7fbdc9bec4bf6d,0xbf62bef1be483f7b,0x3f0e3f553f35bf35,0xbe48bf7bbf6d3ec4,0xbef13f623f6d3ec4,0x3f22bf46bf55bf0e
.quad 0x250dbf8000003f80,0x250dbf8000003f80,0x3f22bf46bf353f35,0x3ef1bf62bf0e3f55,0x3f7bbe48bf80a554,0x3f55bf0ebf6d3ec4,0x3f623ef1bf35bf35,0x3f7fbdc9bf7bbe48
.quad 0x3ec43f6d250dbf80,0x3f6d3ec4bf35bf35,0xbe953f753f35bf35,0x3f223f46be48bf7b,0xbf553f0e3f80248d,0x3e483f7b3ec4bf6d,0xbf7fbdc93f353f35,0xbe953f753f55bf0e
.quad 0xbf35bf3500003f80,0xbf353f353f80248d,0xbdc9bf7fbf353f35,0xbf753e953f553f0e,0x3f0ebf55bf80a554,0xbf7bbe483ec43f6d,0x3f75be95bf35bf35,0xbf46bf22be483f7b
.quad 0x3f6d3ec4250dbf80,0xbec4bf6dbf353f35,0x3ef13f623f35bf35,0x3dc9bf7fbf7b3e48,0xbe483f7b3f80248d,0x3f0ebf55bf6dbec4,0xbf463f223f353f35,0x3f62bef1bf0ebf55
.quad 0x250dbf8000003f80,0x250dbf8000003f80,0x3e95bf75bec43f6d,0x3dc9bf7fbe483f7b,0x3f0ebf55bf353f35,0x3e48bf7bbec43f6d,0x3f46bf22bf6d3ec4,0x3e95bf75bf0e3f55
.quad 0x3f6dbec4bf80a554,0x3ec4bf6dbf353f35,0x3f7fbdc9bf6dbec4,0x3ef1bf62bf553f0e,0x3f7b3e48bf35bf35,0x3f0ebf55bf6d3ec4,0x3f623ef1bec4bf6d,0x3f22bf46bf7b3e48
.quad 0x3f353f35250dbf80,0x3f35bf35bf80a554,0x3ef13f623ec4bf6d,0x3f46bf22bf7bbe48,0x3e483f7b3f35bf35,0x3f55bf0ebf6dbec4,0xbdc93f7f3f6dbec4,0x3f62bef1bf55bf0e
.quad 0xbec43f6d3f80248d,0x3f6dbec4bf35bf35,0xbf223f463f6d3ec4,0x3f75be95bf0ebf55,0xbf553f0e3f353f35,0x3f7bbe48bec4bf6d,0xbf753e953ec43f6d,0x3f7fbdc9be48bf7b
.quad 0xbf80a50d3f808000,0xbf80a50d3f808000,0xbf7f3dc93f808000,0xbf753e953f7bbe48,0xbf7b3e483f808000,0xbf553f0e3f6dbec4,0xbf753e953f808000,0xbf223f463f55bf0e
.quad 0xbf6d3ec43f808000,0xbec43f6d3f35bf35,0xbf623ef13f808000,0xbdc93f7f3f0ebf55,0xbf553f0e3f808000,0x3e483f7b3ec4bf6d,0xbf463f223f808000,0x3ef13f623e48bf7b
.quad 0xbf353f353f808000,0x3f353f35248dbf80,0xbf223f463f808000,0x3f623ef1be48bf7b,0xbf0e3f553f808000,0x3f7b3e48bec4bf6d,0xbef13f623f808000,0x3f7fbdc9bf0ebf55
.quad 0xbec43f6d3f808000,0x3f6dbec4bf35bf35,0xbe953f753f808000,0x3f46bf22bf55bf0e,0xbe483f7b3f808000,0x3f0ebf55bf6dbec4,0xbdc93f7f3f808000,0x3e95bf75bf7bbe48
.quad 0xbf80a50d3f808000,0xbf80a50d3f808000,0xbf623ef13f6dbec4,0xbf463f223f55bf0e,0xbf0e3f553f35bf35,0xbe483f7b3ec4bf6d,0xbdc93f7f3ec4bf6d,0x3ef13f62be48bf7b
.quad 0x3ec43f6d248dbf80,0x3f6d3ec4bf35bf35,0x3f463f22bec4bf6d,0x3f75be95bf7bbe48,0x3f7b3e48bf35bf35,0x3f0ebf55bf6d3ec4,0x3f75be95bf6dbec4,0xbdc9bf7fbf0e3f55
.quad 0x3f35bf35bf80a50d,0xbf35bf35a5543f80,0x3e95bf75bf6d3ec4,0xbf7fbdc93f0e3f55,0xbe48bf7bbf353f35,0xbf553f0e3f6d3ec4,0xbf22bf46bec43f6d,0xbe953f753f7bbe48
.quad 0xbf6dbec4a5543f80,0x3ec43f6d3f35bf35,0xbf7f3dc93ec43f6d,0x3f623ef13e48bf7b,0xbf553f0e3f353f35,0x3f7bbe48bec4bf6d,0xbef13f623f6d3ec4,0x3f22bf46bf55bf0e
.quad 0xbf80a50d3f808000,0xbf80a50d3f808000,0xbf223f463f35bf35,0xbef13f623f0ebf55,0x3e483f7b248dbf80,0x3f0e3f55bec4bf6d,0x3f623ef1bf35bf35,0x3f7fbdc9bf7bbe48
.quad 0x3f6dbec4bf80a50d,0x3ec4bf6dbf353f35,0x3e95bf75bf353f35,0xbf22bf463e483f7b,0xbf0ebf55a5543f80,0xbf7b3e483f6d3ec4,0xbf7fbdc93f353f35,0xbe953f753f55bf0e
.quad 0xbf353f353f808000,0x3f353f35248dbf80,0x3dc93f7f3f35bf35,0x3f75be95bf55bf0e,0x3f553f0e248dbf80,0x3e48bf7bbf6d3ec4,0x3f75be95bf35bf35,0xbf46bf22be483f7b
.quad 0x3ec4bf6dbf80a50d,0xbf6d3ec43f353f35,0xbef1bf62bf353f35,0xbdc93f7f3f7bbe48,0xbf7bbe48a5543f80,0x3f553f0e3ec4bf6d,0xbf463f223f353f35,0x3f62bef1bf0ebf55
.quad 0xbf80a50d3f808000,0xbf80a50d3f808000,0xbe953f753ec4bf6d,0xbdc93f7f3e48bf7b,0x3f553f0ebf35bf35,0x3f7b3e48bf6dbec4,0x3f46bf22bf6d3ec4,0x3e95bf75bf0e3f55
.quad 0xbec4bf6da5543f80,0xbf6dbec43f353f35,0xbf7f3dc93f6d3ec4,0xbef13f623f55bf0e,0xbe483f7b3f35bf35,0x3f553f0ebec4bf6d,0x3f623ef1bec4bf6d,0x3f22bf46bf7b3e48
.quad 0x3f35bf35bf80a50d,0xbf35bf35a5543f80,0xbef1bf62bec43f6d,0xbf463f223f7b3e48,0xbf7b3e483f353f35,0x3f0e3f553ec4bf6d,0xbdc93f7f3f6dbec4,0x3f62bef1bf55bf0e
.quad 0x3f6d3ec4248dbf80,0xbec4bf6dbf353f35,0x3f22bf46bf6dbec4,0xbf753e953f0e3f55,0xbf0ebf55bf353f35,0x3e483f7b3f6dbec4,0xbf753e953ec43f6d,0x3f7fbdc9be48bf7b
.quad 0xbf80a50d3f808000,0xbf80a50d3f808000,0x3dc93f7f248dbf80,0x3e953f75be48bf7b,0x3f7bbe48bf80a50d,0x3f55bf0ebf6d3ec4,0xbe95bf75a5543f80,0xbf46bf223f0e3f55
.quad 0xbf6d3ec43f808000,0xbec43f6d3f35bf35,0x3ef13f62248dbf80,0x3f7f3dc9bf55bf0e,0x3f55bf0ebf80a50d,0xbe48bf7bbec43f6d,0xbf22bf46a5543f80,0xbf623ef13f7b3e48
.quad 0xbf353f353f808000,0x3f353f35248dbf80,0x3f463f22248dbf80,0x3ef1bf62bf7b3e48,0x3f0ebf55bf80a50d,0xbf7bbe483ec43f6d,0xbf62bef1a5543f80,0x3dc93f7f3f55bf0e
.quad 0xbec43f6d3f808000,0x3f6dbec4bf35bf35,0x3f753e95248dbf80,0xbf22bf46bf0e3f55,0x3e48bf7bbf80a50d,0xbf0e3f553f6d3ec4,0xbf7fbdc9a5543f80,0x3f753e953e48bf7b
.quad 0xbf80a50d3f808000,0xbf80a50d3f808000,0x3ef13f62bec4bf6d,0x3f223f46bf0ebf55,0x3f0ebf55bf353f35,0x3e48bf7bbec43f6d,0xbf7fbdc93f6d3ec4,0xbf623ef13f7bbe48
.quad 0x3ec43f6d248dbf80,0x3f6d3ec4bf35bf35,0x3f22bf46bf6d3ec4,0xbe95bf75be483f7b,0xbf7bbe483f353f35,0xbf0e3f553f6dbec4,0x3e953f753ec4bf6d,0x3f7fbdc9bf55bf0e
.quad 0x3f35bf35bf80a50d,0xbf35bf35a5543f80,0xbf75be953ec43f6d,0xbdc93f7f3f55bf0e,0x3e483f7b3f35bf35,0x3f55bf0ebf6dbec4,0x3f46bf22bf6dbec4,0xbf75be953e483f7b
.quad 0xbf6dbec4a5543f80,0x3ec43f6d3f35bf35,0x3dc93f7f3f6dbec4,0x3ef1bf62bf7bbe48,0x3f55bf0ebf35bf35,0xbf7b3e483ec43f6d,0xbf62bef1bec43f6d,0x3f463f223f0ebf55
.quad 0xbf80a50d3f808000,0xbf80a50d3f808000,0x3f463f22bf35bf35,0x3f623ef1bf55bf0e,0xbe48bf7ba5543f80,0xbf0ebf553ec43f6d,0xbef13f623f35bf35,0x3dc93f7f3e48bf7b
.quad 0x3f6dbec4bf80a50d,0x3ec4bf6dbf353f35,0xbf75be953f353f35,0xbf463f223f7bbe48,0x3f0e3f55248dbf80,0x3f7bbe48bf6dbec4,0x3dc9bf7fbf353f35,0xbf75be953f0e3f55
.quad 0xbf353f353f808000,0x3f353f35248dbf80,0x3f7fbdc9bf35bf35,0xbe95bf75bf0e3f55,0xbf55bf0ea5543f80,0xbe483f7b3f6dbec4,0x3e953f753f35bf35,0x3f22bf46bf7bbe48
.quad 0x3ec4bf6dbf80a50d,0xbf6d3ec43f353f35,0xbf623ef13f353f35,0x3f7f3dc9be48bf7b,0x3f7b3e48248dbf80,0xbf55bf0ebec43f6d,0xbf22bf46bf353f35,0x3ef13f623f55bf0e
.quad 0xbf80a50d3f808000,0xbf80a50d3f808000,0x3f753e95bf6dbec4,0x3f7f3dc9bf7bbe48,0xbf55bf0e3f353f35,0xbf7bbe483f6d3ec4,0x3f223f46bec4bf6d,0x3f753e95bf55bf0e
.quad 0xbec4bf6da5543f80,0xbf6dbec43f353f35,0x3dc93f7f3ec4bf6d,0x3f623ef1bf0ebf55,0x3e48bf7bbf353f35,0xbf55bf0e3ec43f6d,0xbef13f623f6dbec4,0x3f463f22be48bf7b
.quad 0x3f35bf35bf80a50d,0xbf35bf35a5543f80,0xbf623ef13f6d3ec4,0x3f223f463e48bf7b,0x3f7bbe48bf35bf35,0xbf0ebf55bec43f6d,0xbf7fbdc93ec43f6d,0x3ef13f623f0ebf55
.quad 0x3f6d3ec4248dbf80,0xbec4bf6dbf353f35,0xbf46bf22bec43f6d,0x3e953f753f55bf0e,0x3f0e3f553f35bf35,0xbe48bf7bbf6d3ec4,0xbe95bf75bf6d3ec4,0x3dc93f7f3f7bbe48
.quad 0xbf80a50d3f808000,0xbf80a50d3f808000,0x3f7fbdc9bf80a50d,0x3f75be95bf7b3e48,0xbf7b3e483f808000,0xbf553f0e3f6dbec4,0x3f75be95bf80a50d,0x3f22bf46bf553f0e
.quad 0xbf6d3ec43f808000,0xbec43f6d3f35bf35,0x3f62bef1bf80a50d,0x3dc9bf7fbf0e3f55,0xbf553f0e3f808000,0x3e483f7b3ec4bf6d,0x3f46bf22bf80a50d,0xbef1bf62be483f7b
.quad 0xbf353f353f808000,0x3f353f35248dbf80,0x3f22bf46bf80a50d,0xbf62bef13e483f7b,0xbf0e3f553f808000,0x3f7b3e48bec4bf6d,0x3ef1bf62bf80a50d,0xbf7f3dc93f0e3f55
.quad 0xbec43f6d3f808000,0x3f6dbec4bf35bf35,0x3e95bf75bf80a50d,0xbf463f223f553f0e,0xbe483f7b3f808000,0x3f0ebf55bf6dbec4,0x3dc9bf7fbf80a50d,0xbe953f753f7b3e48
.quad 0xbf80a50d3f808000,0xbf80a50d3f808000,0x3f62bef1bf6d3ec4,0x3f46bf22bf553f0e,0xbf0e3f553f35bf35,0xbe483f7b3ec4bf6d,0x3dc9bf7fbec43f6d,0xbef1bf623e483f7b
.quad 0x3ec43f6d248dbf80,0x3f6d3ec4bf35bf35,0xbf46bf223ec43f6d,0xbf753e953f7b3e48,0x3f7b3e48bf35bf35,0x3f0ebf55bf6d3ec4,0xbf753e953f6d3ec4,0x3dc93f7f3f0ebf55
.quad 0x3f35bf35bf80a50d,0xbf35bf35a5543f80,0xbe953f753f6dbec4,0x3f7f3dc9bf0ebf55,0xbe48bf7bbf353f35,0xbf553f0e3f6d3ec4,0x3f223f463ec4bf6d,0x3e95bf75bf7b3e48
.quad 0xbf6dbec4a5543f80,0x3ec43f6d3f35bf35,0x3f7fbdc9bec4bf6d,0xbf62bef1be483f7b,0xbf553f0e3f353f35,0x3f7bbe48bec4bf6d,0x3ef1bf62bf6dbec4,0xbf223f463f553f0e
.quad 0xbf80a50d3f808000,0xbf80a50d3f808000,0x3f22bf46bf353f35,0x3ef1bf62bf0e3f55,0x3e483f7b248dbf80,0x3f0e3f55bec4bf6d,0xbf62bef13f353f35,0xbf7f3dc93f7b3e48
.quad 0x3f6dbec4bf80a50d,0x3ec4bf6dbf353f35,0xbe953f753f35bf35,0x3f223f46be48bf7b,0xbf0ebf55a5543f80,0xbf7b3e483f6d3ec4,0x3f7f3dc9bf35bf35,0x3e95bf75bf553f0e
.quad 0xbf353f353f808000,0x3f353f35248dbf80,0xbdc9bf7fbf353f35,0xbf753e953f553f0e,0x3f553f0e248dbf80,0x3e48bf7bbf6d3ec4,0xbf753e953f353f35,0x3f463f223e48bf7b
.quad 0x3ec4bf6dbf80a50d,0xbf6d3ec43f353f35,0x3ef13f623f35bf35,0x3dc9bf7fbf7b3e48,0xbf7bbe48a5543f80,0x3f553f0e3ec4bf6d,0x3f46bf22bf35bf35,0xbf623ef13f0e3f55
.quad 0xbf80a50d3f808000,0xbf80a50d3f808000,0x3e95bf75bec43f6d,0x3dc9bf7fbe483f7b,0x3f553f0ebf35bf35,0x3f7b3e48bf6dbec4,0xbf463f223f6dbec4,0xbe953f753f0ebf55
.quad 0xbec4bf6da5543f80,0xbf6dbec43f353f35,0x3f7fbdc9bf6dbec4,0x3ef1bf62bf553f0e,0xbe483f7b3f35bf35,0x3f553f0ebec4bf6d,0xbf62bef13ec43f6d,0xbf223f463f7bbe48
.quad 0x3f35bf35bf80a50d,0xbf35bf35a5543f80,0x3ef13f623ec4bf6d,0x3f46bf22bf7bbe48,0xbf7b3e483f353f35,0x3f0e3f553ec4bf6d,0x3dc9bf7fbf6d3ec4,0xbf623ef13f553f0e
.quad 0x3f6d3ec4248dbf80,0xbec4bf6dbf353f35,0xbf223f463f6d3ec4,0x3f75be95bf0ebf55,0xbf0ebf55bf353f35,0x3e483f7b3f6dbec4,0x3f75be95bec4bf6d,0xbf7f3dc93e483f7b
.quad 0xbf80a50d3f808000,0xbf80a50d3f808000,0xbdc9bf7fa5543f80,0xbe95bf753e483f7b,0x3f7bbe48bf80a50d,0x3f55bf0ebf6d3ec4,0x3e953f75248dbf80,0x3f463f22bf0ebf55
.quad 0xbf6d3ec43f808000,0xbec43f6d3f35bf35,0xbef1bf62a5543f80,0xbf7fbdc93f553f0e,0x3f55bf0ebf80a50d,0xbe48bf7bbec43f6d,0x3f223f46248dbf80,0x3f62bef1bf7bbe48
.quad 0xbf353f353f808000,0x3f353f35248dbf80,0xbf46bf22a5543f80,0xbef13f623f7bbe48,0x3f0ebf55bf80a50d,0xbf7bbe483ec43f6d,0x3f623ef1248dbf80,0xbdc9bf7fbf553f0e
.quad 0xbec43f6d3f808000,0x3f6dbec4bf35bf35,0xbf75be95a5543f80,0x3f223f463f0ebf55,0x3e48bf7bbf80a50d,0xbf0e3f553f6d3ec4,0x3f7f3dc9248dbf80,0xbf75be95be483f7b
.quad 0xbf80a50d3f808000,0xbf80a50d3f808000,0xbef1bf623ec43f6d,0xbf22bf463f0e3f55,0x3f0ebf55bf353f35,0x3e48bf7bbec43f6d,0x3f7f3dc9bf6dbec4,0x3f62bef1bf7b3e48
.quad 0x3ec43f6d248dbf80,0x3f6d3ec4bf35bf35,0xbf223f463f6dbec4,0x3e953f753e48bf7b,0xbf7bbe483f353f35,0xbf0e3f553f6dbec4,0xbe95bf75bec43f6d,0xbf7f3dc93f553f0e
.quad 0x3f35bf35bf80a50d,0xbf35bf35a5543f80,0x3f753e95bec4bf6d,0x3dc9bf7fbf553f0e,0x3e483f7b3f35bf35,0x3f55bf0ebf6dbec4,0xbf463f223f6d3ec4,0x3f753e95be48bf7b
.quad 0xbf6dbec4a5543f80,0x3ec43f6d3f35bf35,0xbdc9bf7fbf6d3ec4,0xbef13f623f7b3e48,0x3f55bf0ebf35bf35,0xbf7b3e483ec43f6d,0x3f623ef13ec4bf6d,0xbf46bf22bf0e3f55
.quad 0xbf80a50d3f808000,0xbf80a50d3f808000,0xbf46bf223f353f35,0xbf62bef13f553f0e,0xbe48bf7ba5543f80,0xbf0ebf553ec43f6d,0x3ef1bf62bf353f35,0xbdc9bf7fbe483f7b
.quad 0x3f6dbec4bf80a50d,0x3ec4bf6dbf353f35,0x3f753e95bf35bf35,0x3f46bf22bf7b3e48,0x3f0e3f55248dbf80,0x3f7bbe48bf6dbec4,0xbdc93f7f3f35bf35,0x3f753e95bf0ebf55
.quad 0xbf353f353f808000,0x3f353f35248dbf80,0xbf7f3dc93f353f35,0x3e953f753f0ebf55,0xbf55bf0ea5543f80,0xbe483f7b3f6dbec4,0xbe95bf75bf353f35,0xbf223f463f7b3e48
.quad 0x3ec4bf6dbf80a50d,0xbf6d3ec43f353f35,0x3f62bef1bf35bf35,0xbf7fbdc93e483f7b,0x3f7b3e48248dbf80,0xbf55bf0ebec43f6d,0x3f223f463f35bf35,0xbef1bf62bf553f0e
.quad 0xbf80a50d3f808000,0xbf80a50d3f808000,0xbf75be953f6d3ec4,0xbf7fbdc93f7b3e48,0xbf55bf0e3f353f35,0xbf7bbe483f6d3ec4,0xbf22bf463ec43f6d,0xbf75be953f553f0e
.quad 0xbec4bf6da5543f80,0xbf6dbec43f353f35,0xbdc9bf7fbec43f6d,0xbf62bef13f0e3f55,0x3e48bf7bbf353f35,0xbf55bf0e3ec43f6d,0x3ef1bf62bf6d3ec4,0xbf46bf223e483f7b
.quad 0x3f35bf35bf80a50d,0xbf35bf35a5543f80,0x3f62bef1bf6dbec4,0xbf22bf46be483f7b,0x3f7bbe48bf35bf35,0xbf0ebf55bec43f6d,0x3f7f3dc9bec4bf6d,0xbef1bf62bf0e3f55
.quad 0x3f6d3ec4248dbf80,0xbec4bf6dbf353f35,0x3f463f223ec4bf6d,0xbe95bf75bf553f0e,0x3f0e3f553f35bf35,0xbe48bf7bbf6d3ec4,0x3e953f753f6dbec4,0xbdc9bf7fbf7b3e48
.quad 0x3f7ec46d3f800000,0x3f74fa0b3f7b14be,0x3f7eb0693f800000,0x3f74484b3f7ac516,0x3f7e9bc93f800000,0x3f73913f3f7a7302,0x3f7e868b3f800000,0x3f72d4eb3f7a1e84
.quad 0x3f7e70b03f800000,0x3f7213523f79c79d,0x3f7e5a383f800000,0x3f714c7a3f796e4e,0x3f7e43233f800000,0x3f7080663f791298,0x3f7e2b723f800000,0x3f6faf1b3f78b47b
.quad 0x3f7e13243f800000,0x3f6ed89e3f7853f8,0x3f7dfa383f800000,0x3f6dfcf23f77f110,0x3f7de0b13f800000,0x3f6d1c1d3f778bc5,0x3f7dc68c3f800000,0x3f6c36243f772417
.quad 0x3f7dabcc3f800000,0x3f6b4b0c3f76ba07,0x3f7d906e3f800000,0x3f6a5ad93f764d97,0x3f7d74743f800000,0x3f6965913f75dec6,0x3f7d57de3f800000,0x3f686b393f756d97
.quad 0x3f61c5983f6c835e,0x3f45e4033f54db31,0x3f5fe4e93f6b4b0c,0x3f425b893f5233c6,0x3f5df6be3f6a09a7,0x3f3ebc1b3f4f7a1f,0x3f5bfb343f68bf3c,0x3f3b06293f4cae79
.quad 0x3f59f26a3f676bd8,0x3f373a233f49d112,0x3f57dc7f3f660f88,0x3f33587a3f46e22a,0x3f55b9933f64aa59,0x3f2f61a53f43e200,0x3f5389c73f633c5a,0x3f2b561b3f40d0da
.quad 0x3f514d3d3f61c598,0x3f2736563f3daef9,0x3f4f04173f604621,0x3f2302d33f3a7ca4,0x3f4cae793f5ebe05,0x3f1ebc123f373a23,0x3f4a4c873f5d2d53,0x3f1a62933f33e7bc
.quad 0x3f47de653f5b941a,0x3f15f6d93f3085bb,0x3f4564393f59f26a,0x3f11796b3f2d1469,0x3f42de293f584853,0x3f0cead03f299415,0x3f404c5c3f5695e5,0x3f084b923f26050a
.quad 0x3f2267993f3504f3,0x3ef15aea3f0e39da,0x3f1ce11f3f3085bb,0x3ee1fb6a3f07a136,0x3f173c073f2beb4a,0x3ed25a093f00e7e4,0x3f11796b3f273656,0x3ec27b553ef41f07
.quad 0x3f0b9a6b3f226799,0x3eb263ef3ee63375,0x3f05a02c3f1d7fd1,0x3ea218873ed8106b,0x3eff17b23f187fc0,0x3e919ddd3ec9b953,0x3ef2bd433f13682a,0x3e80f8c03ebb31a0
.quad 0x3ee633753f0e39da,0x3e605c133eac7cd4,0x3ed97cb93f08f59b,0x3e3e853e3e9d9e78,0x3ecc9b8b3f039c3d,0x3e1c76de3e8e9a22,0x3ebf926f3efc5d27,0x3df475c03e7ee6e1
.quad 0x3eb263ef3ef15aea,0x3dafb6803e605c13,0x3ea5129f3ee63375,0x3d55880e3e419b37,0x3e97a1173edae880,0x3c96c9b63e22abb6,0x3e8a11f73ecf7bca,0xbc7b514b3e039502
.quad 0x3e94a0313ec3ef15,0x3dc8bd363e47c5c2,0x3e80f8c03eb263ef,0x3d55880e3e1c76de,0x3e5a39973ea09ae5,0x3bc90f883de1bc2e,0x3e3228d43e8e9a22,0xbd2351cb3d8a200a
.quad 0x3e09cf863e78cfcc,0xbdafb6803cc90ab0,0x3dc27c393e541501,0xbe06b26ebc96c9b6,0x3d6214693e2f10a2,0xbe354098bd7b2b74,0x3c7b514b3e09cf86,0xbe636c83bdd53db9
.quad 0xbcc90ab03dc8bd36,0xbe888e93be164083,0xbd83db0a3d7b2b74,0xbe9f1cdfbe419b37,0xbdd53db93cc90ab0,0xbeb554ecbe6c9a7f,0xbe1324cabc490e90,0xbecb2aaebe8b9507
.quad 0xbe3b6ecfbd48fb30,0xbee0924fbea09ae5,0xbe636c83bdafb680,0xbef58035beb554ec,0xbe8586cebdfab273,0xbf04f484bec9b953,0xbe9920febe22abb6,0xbf0ee0dbbeddbe79
.quad 0xbdc8bd3680000000,0xbe94a031be47c5c2,0xbdcefdb780000000,0xbe9920febe4dee60,0xbdd53db980000000,0xbe9d9e78be541501,0xbddb7d3780000000,0xbea21887be5a3997
.quad 0xbde1bc2e80000000,0xbea68f12be605c13,0xbde7fa9a80000000,0xbeab0201be667c66,0xbdee387680000000,0xbeaf713abe6c9a7f,0xbdf475c080000000,0xbeb3dca5be72b651
.quad 0xbdfab27380000000,0xbeb8442abe78cfcc,0xbe00774580000000,0xbebca7afbe7ee6e1,0xbe03950280000000,0xbec1071ebe827dc0,0xbe06b26e80000000,0xbec5625cbe8586ce
.quad 0xbe09cf8680000000,0xbec9b953be888e93,0xbe0cec4a80000000,0xbece0beabe8b9507,0xbe1008b780000000,0xbed25a09be8e9a22,0xbe1324ca80000000,0xbed6a399be919ddd
.quad 0xbef15aeabec3ef15,0xbf226799bf0e39da,0xbef840c8bec9b953,0xbf269de3bf121eb0,0xbeff17b2becf7bca,0xbf2ac082bf15f6d9,0xbf02ef9fbed53641,0xbf2ecef7bf19c200
.quad 0xbf064b82bedae880,0xbf32c8c9bf1d7fd1,0xbf099f4ebee0924f,0xbf36ad7fbf212ff9,0xbf0cead0bee63375,0xbf3a7ca4bf24d225,0xbf102dd5beebcbbb,0xbf3e35c5bf286605
.quad 0xbf13682abef15aea,0xbf41d870bf2beb4a,0xbf16999fbef6e0cb,0xbf456439bf2f61a5,0xbf19c200befc5d27,0xbf48d8b3bf32c8c9,0xbf1ce11fbf00e7e4,0xbf4c3578bf36206c
.quad 0xbf1ff6cbbf039c3d,0xbf4f7a1fbf396842,0xbf2302d3bf064b82,0xbf52a649bf3ca003,0xbf26050abf08f59b,0xbf55b993bf3fc767,0xbf28fd41bf0b9a6b,0xbf58b3a1bf42de29
.quad 0xbf45e403bf3504f3,0xbf61c598bf54db31,0xbf4a4c87bf396842,0xbf65b710bf591e6a,0xbf4e8d90bf3daef9,0xbf696591bf5d2d53,0xbf52a649bf41d870,0xbf6cd007bf6106f2
.quad 0xbf5695e5bf45e403,0xbf6ff573bf64aa59,0xbf5a5ba0bf49d112,0xbf72d4ebbf6816a8,0xbf5df6bebf4d9f02,0xbf756d97bf6b4b0c,0xbf61668abf514d3d,0xbf77beb7bf6e46be
.quad 0xbf64aa59bf54db31,0xbf79c79dbf710908,0xbf67c187bf584853,0xbf7b87b2bf73913f,0xbf6aab7bbf5b941a,0xbf7cfe73bf75dec6,0xbf6d67a1bf5ebe05,0xbf7e2b72bf77f110
.quad 0xbf6ff573bf61c598,0xbf7f0e58bf79c79d,0xbf725470bf64aa59,0xbf7fa6e3bf7b61fc,0xbf748422bf676bd8,0xbf7ff4e6bf7cbfc9,0xbf76841bbf6a09a7,0xbf7ff84abf7de0b1
.quad 0xbf74fa0bbf6c835e,0xbf7ec46dbf7b14be,0xbf77beb7bf6ff573,0xbf7fa6e3bf7cfe73,0xbf7a1e84bf731447,0xbf7ffec4bf7e70b0,0xbf7c187abf75dec6,0xbf7fcbe2bf7f6ac7
.quad 0xbf7dabccbf7853f8,0xbf7f0e58bf7fec43,0xbf7ed7d4bf7a7302,0xbf7dc68cbf7ff4e6,0xbf7f9c18bf7c3b28,0xbf7bf531bf7f84ab,0xbf7ff84abf7dabcc,0xbf799b43bf7e9bc9
.quad 0xbf7fec43bf7ec46d,0xbf76ba07bf7d3aac,0xbf7f7808bf7f84ab,0xbf73530ebf7b61fc,0xbf7e9bc9bf7fec43,0xbf6f6830bf791298,0xbf7d57debf7ffb11,0xbf6afb8cbf764d97
.quad 0xbf7baccdbf7fb10f,0xbf660f88bf731447,0xbf799b43bf7f0e58,0xbf60a6cfbf6f6830,0xbf772417bf7e1324,0xbf5ac450bf6b4b0c,0xbf74484bbf7cbfc9,0xbf546b3bbf66becc
.quad 0xbdc8bd36248d3132,0xbe94a031be47c5c2,0xbe195be0bd48fb30,0xbeb0eacbbe7ee6e1,0xbe4dee60bdc8bd36,0xbecc9b8bbe9aa086,0xbe80f8c0be164083,0xbee79a5dbeb554ec
.quad 0xbe9aa086be47c5c2,0xbf00e7e4becf7bca,0xbeb3dca5be78cfcc,0xbf0d9281bee900b7,0xbecc9b8bbe94a031,0xbf19c200bf00e7e4,0xbee4cbfebeac7cd4,0xbf256bcbbf0cead0
.quad 0xbefc5d27bec3ef15,0xbf3085bbbf187fc0,0xbf099f4ebedae880,0xbf3b0629bf239da9,0xbf14b039bef15aea,0xbf44e3f5bf2e3bde,0xbf1f599fbf039c3d,0xbf4e1689bf385216
.quad 0xbf299415bf0e39da,0xbf5695e5bf41d870,0xbf33587abf187fc0,0xbf5e5aa6bf4ac77f,0xbf3ca003bf226799,0xbf655e0bbf531849,0xbf456439bf2beb4a,0xbf6b99fbbf5ac450
.quad 0xbef15aeabec3ef15,0xbf226799bf0e39da,0xbf06f686bee0924f,0xbf2ff3e6bf1c420c,0xbf14b039befc5d27,0xbf3ca003bf299415,0xbf21cbfbbf0b9a6b,0xbf485bcabf36206c
.quad 0xbf2e3bdebf187fc0,0xbf531849bf41d870,0xbf39f2acbf24d225,0xbf5cc7d1bf4cae79,0xbf44e3f5bf3085bb,0xbf655e0bbf5695e5,0xbf4f0417bf3b8f3b,0xbf6cd007bf5f8327
.quad 0xbf584853bf45e403,0xbf731447bf676bd8,0xbf60a6cfbf4f7a1f,0xbf7822d1bf6e46be,0xbf6816a8bf584853,0xbf7bf531bf740bdd,0xbf6e8ff8bf604621,0xbf7e868bbf78b47b
.quad 0xbf740bddbf676bd8,0xbf7fd397bf7c3b28,0xbf788486bf6db293,0xbf7fdaafbf7e9bc9,0xbf7bf531bf731447,0xbf7e9bc9bf7fd397,0xbf7e5a38bf778bc5,0xbf7c187abf7fe129
.quad 0xbf45e403bf3504f3,0xbf61c598bf54db31,0xbf51c0c2bf41d870,0xbf6afb8cbf5f8327,0xbf5c61c7bf4d9f02,0xbf7294f8bf68bf3c,0xbf65b710bf584853,0xbf788486bf708066
.quad 0xbf6db293bf61c598,0xbf7cbfc9bf76ba07,0xbf74484bbf6a09a7,0xbf7f3f54bf7b61fc,0xbf796e4ebf710908,0xbf7ffec4bf7e70b0,0xbf7d1cddbf76ba07,0xbf7efcc9bf7fe129
.quad 0xbf7f4e6dbf7b14be,0xbf7c3b28bf7fb10f,0xbf7fffb1bf7e1324,0xbf77beb7bf7de0b1,0xbf7f2f9dbf7fb10f,0xbf718f57bf7a7302,0xbf7cdf6cbf7fec43,0xbf69b7e4bf756d97
.quad 0xbf791298bf7ec46d,0xbf604621bf6ed89e,0xbf73ced9bf7c3b28,0xbf554aa4bf66becc,0xbf6d1c1dbf7853f8,0xbf48d8b3bf5d2d53,0xbf650479bf731447,0xbf3b0629bf5233c6
.quad 0xbf74fa0bbf6c835e,0xbf7ec46dbf7b14be,0xbf7a9c59bf740bdd,0xbf7fffb1bf7e9bc9,0xbf7e4323bf79c79d,0xbf7eea9dbf7ffb11,0xbf7fe705bf7dabcc,0xbf7b87b2bf7f2f9d
.quad 0xbf7f84abbf7fb10f,0xbf75dec6bf7c3b28,0xbf7d1cddbf7fd397,0xbf6dfcf2bf772417,0xbf78b47bbf7e1324,0xbf63f473bf6ff573,0xbf725470bf7a7302,0xbf57dc7fbf66becc
.quad 0xbf6a09a7bf74fa0b,0xbf49d112bf5b941a,0xbf5fe4e9bf6db293,0xbf39f2acbf4e8d90,0xbf53fac3bf64aa59,0xbf286605bf3fc767,0xbf466354bf59f26a,0xbf1553b7bf2f61a5
.quad 0xbf373a23bf4d9f02,0xbf00e7e4bf1d7fd1,0xbf269de3bf3fc767,0xbed6a399bf0a48ad,0xbf14b039bf3085bb,0xbea986c4beebcbbb,0xbf019573bf1ff6cb,0xbe75c35abec1071e
.quad 0xbf7ec46dbf800000,0xbf74fa0bbf7b14be,0xbf7d1cddbf7fb10f,0xbf703b37bf77f110,0xbf7ac516bf7ec46d,0xbf6aab7bbf740bdd,0xbf77beb7bf7d3aac,0xbf644facbf6f6830
.quad 0xbf740bddbf7b14be,0xbf5d2d53bf6a09a7,0xbf6faf1bbf7853f8,0xbf554aa4bf63f473,0xbf6aab7bbf74fa0b,0xbf4cae79bf5d2d53,0xbf650479bf710908,0xbf436051bf55b993
.quad 0xbf5ebe05bf6c835e,0xbf396842bf4d9f02,0xbf57dc7fbf676bd8,0xbf2ecef7bf44e3f5,0xbf5064afbf61c598,0xbf239da9bf3b8f3b,0xbf485bcabf5b941a,0xbf17de12bf31a81d
.quad 0xbf3fc767bf54db31,0xbf0b9a6bbf273656,0xbf36ad7fbf4d9f02,0xbefdbabbbf1c420c,0xbf2d1469bf45e403,0xbee363fabf10d3cd,0xbf2302d3bf3daef9,0xbec8477cbf04f484
.quad 0xbf61c598bf6c835e,0xbf45e403bf54db31,0xbf5988adbf660f88,0xbf39f2acbf4ac77f,0xbf5064afbf5ebe05,0xbf2d1469bf3fc767,0xbf466354bf5695e5,0xbf1f599fbf33e7bc
.quad 0xbf3b8f3bbf4d9f02,0xbf10d3cdbf273656,0xbf2ff3e6bf43e200,0xbf019573bf19c200,0xbf239da9bf396842,0xbee363fabf0b9a6b,0xbf16999fbf2e3bde,0xbec27b55bef9a02d
.quad 0xbf08f59bbf226799,0xbea09ae5bedae880,0xbef58035bf15f6d9,0xbe7bdba4bebb31a0,0xbed8106bbf08f59b,0xbe354098be9aa086,0xbeb9bb1ebef6e0cb,0xbddb7d37be72b651
.quad 0xbe9aa086bedae880,0xbd16c32cbe2f10a2,0xbe75c35abebe1d4a,0x3d0a342fbdd53db9,0xbe354098bea09ae5,0x3dd53db9bd16c32c,0xbde7fa9abe827dc0,0x3e3228d43cfb49ba
.quad 0xbf226799bf3504f3,0xbef15aeabf0e39da,0xbf12c39abf273656,0xbecb2aaebef9a02d,0xbf0242b1bf187fc0,0xbea395c5bed53641,0xbee1fb6abf08f59b,0xbe75c35abeaf713a
.quad 0xbebe1d4abef15aea,0xbe22abb6be888e93,0xbe9920febecf7bca,0xbd9cecf9be419b37,0xbe667c66beac7cd4,0x3bc90f88bde1bc2e,0xbe195be0be888e93,0x3db5f8dabcfb49ba
.quad 0xbd96a905be47c5c2,0x3e2f10a23d48fb30,0x3b490fc6bdfab273,0x3e80f8c03e039502,0x3da3308cbd48fb30,0x3ea986c43e541501,0x3e1f917b3cc90ab0,0x3ed0eb2a3e919ddd
.quad 0x3e6c9a7f3dc8bd36,0x3ef6e0cb3eb8442a,0x3e9c1faf3e2f10a2,0x3f0d92813eddbe79,0x3ec1071e3e78cfcc,0x3f1ebc123f00e7e4,0x3ee4cbfe3ea09ae5,0x3f2ecef73f121eb0
.quad 0xbe94a031bec3ef15,0xbdc8bd36be47c5c2,0xbe5101f1be9aa086,0xbb490fc6bdd53db9,0xbdee3876be605c13,0x3dbc3ac3bc490e90,0xbce22a7abe09cf86,0x3e3e853e3da3308c
.quad 0x3d7b2b74bd48fb30,0x3e8e9a223e2f10a2,0x3e195be03d16c32c,0x3ebca7af3e8586ce,0x3e72b6513dfab273,0x3ee900b73eb263ef,0x3ea5129f3e541501,0x3f099f4e3eddbe79
.quad 0x3ecf7bca3e94a031,0x3f1d7fd13f039c3d,0x3ef840c83ebe1d4a,0x3f2ff3e63f173c07,0x3f0f87843ee63375,0x3f40d0da3f299415,0x3f21cbfb3f064b82,0x3f4fefa83f3a7ca4
.quad 0x3f32c8c93f187fc0,0x3f5d2d533f49d112,0x3f425b893f299415,0x3f686b393f577026,0x3f5064af3f396842,0x3f718f573f633c5a,0x3f5cc7d13f47de65,0x3f7884863f6d1c1d
.quad 0x3f8000003f800000,0x3f8000003f800000,0x3f7eb0693f7ec46d,0x3f7e868b3f7e9bc9,0x3f7ac5163f7b14be,0x3f7a1e843f7a7302,0x3f74484b3f74fa0b,0x3f72d4eb3f73913f
.quad 0x3f6b4b0c3f6c835e,0x3f68bf3c3f6a09a7,0x3f5fe4e93f61c598,0x3f5bfb343f5df6be,0x3f5233c63f54db31,0x3f4cae793f4f7a1f,0x3f425b893f45e403,0x3f3b06293f3ebc1b
.quad 0x3f3085bb3f3504f3,0x3f2736563f2beb4a,0x3f1ce11f3f226799,0x3f11796b3f173c07,0x3f07a1363f0e39da,0x3ef41f073f00e7e4,0x3ee1fb6a3ef15aea,0x3ec27b553ed25a09
.quad 0x3eb263ef3ec3ef15,0x3e8e9a223ea09ae5,0x3e80f8c03e94a031,0x3e3228d43e5a3997,0x3e1c76de3e47c5c2,0x3d8a200a3de1bc2e,0x3d55880e3dc8bd36,0xbd2351cb3bc90f88
.quad 0x3f8000003f800000,0x3f8000003f800000,0x3f7e5a383f7e70b0,0x3f7e2b723f7e4323,0x3f796e4e3f79c79d,0x3f78b47b3f791298,0x3f714c7a3f721352,0x3f6faf1b3f708066
.quad 0x3f660f883f676bd8,0x3f633c5a3f64aa59,0x3f57dc7f3f59f26a,0x3f5389c73f55b993,0x3f46e22a3f49d112,0x3f40d0da3f43e200,0x3f33587a3f373a23,0x3f2b561b3f2f61a5
.quad 0x3f1d7fd13f226799,0x3f13682a3f187fc0,0x3f05a02c3f0b9a6b,0x3ef2bd433eff17b2,0x3ed8106b3ee63375,0x3ebb31a03ec9b953,0x3ea218873eb263ef,0x3e80f8c03e919ddd
.quad 0x3e5415013e78cfcc,0x3e09cf863e2f10a2,0x3dc27c393e09cf86,0x3c7b514b3d621469,0xbc96c9b63cc90ab0,0xbdd53db9bd7b2b74,0xbe06b26ebdafb680,0xbe636c83be354098
.quad 0x3f8000003f800000,0x3f8000003f800000,0x3f7dfa383f7e1324,0x3f7dc68c3f7de0b1,0x3f77f1103f7853f8,0x3f7724173f778bc5,0x3f6dfcf23f6ed89e,0x3f6c36243f6d1c1d
.quad 0x3f6046213f61c598,0x3f5d2d533f5ebe05,0x3f4f04173f514d3d,0x3f4a4c873f4cae79,0x3f3a7ca43f3daef9,0x3f33e7bc3f373a23,0x3f2302d33f273656,0x3f1a62933f1ebc12
.quad 0x3f08f59b3f0e39da,0x3efc5d273f039c3d,0x3ed97cb93ee63375,0x3ebf926f3ecc9b8b,0x3e9d9e783eac7cd4,0x3e7ee6e13e8e9a22,0x3e3e853e3e605c13,0x3df475c03e1c76de
.quad 0x3d7b2b743dc8bd36,0xbc490e903cc90ab0,0xbd83db0abcc90ab0,0xbe1324cabdd53db9,0xbe419b37be164083,0xbe8b9507be6c9a7f,0xbe9f1cdfbe888e93,0xbecb2aaebeb554ec
.quad 0x3f8000003f800000,0x3f8000003f800000,0x3f7d906e3f7dabcc,0x3f7d57de3f7d7474,0x3f764d973f76ba07,0x3f756d973f75dec6,0x3f6a5ad93f6b4b0c,0x3f686b393f696591
.quad 0x3f59f26a3f5b941a,0x3f5695e53f584853,0x3f4564393f47de65,0x3f404c5c3f42de29,0x3f2d14693f3085bb,0x3f26050a3f299415,0x3f11796b3f15f6d9,0x3f084b923f0cead0
.quad 0x3ee633753ef15aea,0x3ecf7bca3edae880,0x3ea5129f3eb263ef,0x3e8a11f73e97a117,0x3e419b373e605c13,0x3e0395023e22abb6,0x3d55880e3dafb680,0xbc7b514b3c96c9b6
.quad 0xbdafb680bd48fb30,0xbe22abb6bdfab273,0xbe636c83be3b6ecf,0xbe9920febe8586ce,0xbeb554ecbea09ae5,0xbeddbe79bec9b953,0xbef58035bee0924f,0xbf0ee0dbbf04f484
.quad 0x0,0x0,0x3dcefdb73dc8bd36,0x3ddb7d373dd53db9,0x3e4dee603e47c5c2,0x3e5a39973e541501,0x3e9920fe3e94a031,0x3ea218873e9d9e78
.quad 0x3ec9b9533ec3ef15,0x3ed536413ecf7bca,0x3ef840c83ef15aea,0x3f02ef9f3eff17b2,0x3f121eb03f0e39da,0x3f19c2003f15f6d9,0x3f269de33f226799,0x3f2ecef73f2ac082
.quad 0x3f3968423f3504f3,0x3f41d8703f3daef9,0x3f4a4c873f45e403,0x3f52a6493f4e8d90,0x3f591e6a3f54db31,0x3f6106f23f5d2d53,0x3f65b7103f61c598,0x3f6cd0073f696591
.quad 0x3f6ff5733f6c835e,0x3f75dec63f731447,0x3f77beb73f74fa0b,0x3f7c187a3f7a1e84,0x3f7cfe733f7b14be,0x3f7f6ac73f7e70b0,0x3f7fa6e33f7ec46d,0x3f7fcbe23f7ffec4
.quad 0x0,0x0,0x3de7fa9a3de1bc2e,0x3df475c03dee3876,0x3e667c663e605c13,0x3e72b6513e6c9a7f,0x3eab02013ea68f12,0x3eb3dca53eaf713a
.quad 0x3ee0924f3edae880,0x3eebcbbb3ee63375,0x3f099f4e3f064b82,0x3f102dd53f0cead0,0x3f212ff93f1d7fd1,0x3f2866053f24d225,0x3f36ad7f3f32c8c9,0x3f3e35c53f3a7ca4
.quad 0x3f49d1123f45e403,0x3f514d3d3f4d9f02,0x3f5a5ba03f5695e5,0x3f61668a3f5df6be,0x3f6816a83f64aa59,0x3f6e46be3f6b4b0c,0x3f72d4eb3f6ff573,0x3f77beb73f756d97
.quad 0x3f7a73023f7853f8,0x3f7dabcc3f7c3b28,0x3f7ed7d43f7dabcc,0x3f7ff84a3f7f9c18,0x3f7ff4e63f7fec43,0x3f7e9bc93f7f84ab,0x3f7dc68c3f7f0e58,0x3f799b433f7bf531
.quad 0x0,0x0,0x3e0077453dfab273,0x3e06b26e3e039502,0x3e7ee6e13e78cfcc,0x3e8586ce3e827dc0,0x3ebca7af3eb8442a,0x3ec5625c3ec1071e
.quad 0x3ef6e0cb3ef15aea,0x3f00e7e43efc5d27,0x3f16999f3f13682a,0x3f1ce11f3f19c200,0x3f2f61a53f2beb4a,0x3f36206c3f32c8c9,0x3f4564393f41d870,0x3f4c35783f48d8b3
.quad 0x3f5848533f54db31,0x3f5ebe053f5b941a,0x3f67c1873f64aa59,0x3f6d67a13f6aab7b,0x3f73913f3f710908,0x3f77f1103f75dec6,0x3f7b87b23f79c79d,0x3f7e2b723f7cfe73
.quad 0x3f7f84ab3f7ec46d,0x3f7ffb113f7fec43,0x3f7f78083f7fec43,0x3f7d57de3f7e9bc9,0x3f7b61fc3f7d3aac,0x3f764d973f791298,0x3f73530e3f76ba07,0x3f6afb8c3f6f6830
.quad 0x0,0x0,0x3e0cec4a3e09cf86,0x3e1324ca3e1008b7,0x3e8b95073e888e93,0x3e919ddd3e8e9a22,0x3ece0bea3ec9b953,0x3ed6a3993ed25a09
.quad 0x3f064b823f039c3d,0x3f0b9a6b3f08f59b,0x3f2302d33f1ff6cb,0x3f28fd413f26050a,0x3f3ca0033f396842,0x3f42de293f3fc767,0x3f52a6493f4f7a1f,0x3f58b3a13f55b993
.quad 0x3f64aa593f61c598,0x3f6a09a73f676bd8,0x3f7254703f6ff573,0x3f76841b3f748422,0x3f7b61fc3f79c79d,0x3f7de0b13f7cbfc9,0x3f7fa6e33f7f0e58,0x3f7ff84a3f7ff4e6
.quad 0x3f7f0e583f7fb10f,0x3f7cbfc93f7e1324,0x3f799b433f7baccd,0x3f74484b3f772417,0x3f6f68303f731447,0x3f66becc3f6b4b0c,0x3f60a6cf3f660f88,0x3f546b3b3f5ac450
.quad 0xbd48fb30248d3132,0xbe164083bdc8bd36,0xbe195be0bdc8bd36,0xbe80f8c0be4dee60,0xbe7ee6e1be47c5c2,0xbeb554ecbe9aa086,0xbeb0eacbbe94a031,0xbee79a5dbecc9b8b
.quad 0xbee0924fbec3ef15,0xbf0b9a6bbefc5d27,0xbf06f686bef15aea,0xbf21cbfbbf14b039,0xbf1c420cbf0e39da,0xbf36206cbf299415,0xbf2ff3e6bf226799,0xbf485bcabf3ca003
.quad 0xbf41d870bf3504f3,0xbf584853bf4d9f02,0xbf51c0c2bf45e403,0xbf65b710bf5c61c7,0xbf5f8327bf54db31,0xbf708066bf68bf3c,0xbf6afb8cbf61c598,0xbf788486bf7294f8
.quad 0xbf740bddbf6c835e,0xbf7dabccbf79c79d,0xbf7a9c59bf74fa0b,0xbf7fe705bf7e4323,0xbf7e9bc9bf7b14be,0xbf7f2f9dbf7ffb11,0xbf7fffb1bf7ec46d,0xbf7b87b2bf7eea9d
.quad 0xbe78cfccbe47c5c2,0xbeac7cd4be94a031,0xbeb3dca5be9aa086,0xbee4cbfebecc9b8b,0xbee900b7becf7bca,0xbf0cead0bf00e7e4,0xbf0d9281bf00e7e4,0xbf256bcbbf19c200
.quad 0xbf24d225bf187fc0,0xbf3b8f3bbf3085bb,0xbf39f2acbf2e3bde,0xbf4f0417bf44e3f5,0xbf4cae79bf41d870,0xbf5f8327bf5695e5,0xbf5cc7d1bf531849,0xbf6cd007bf655e0b
.quad 0xbf6a09a7bf61c598,0xbf76ba07bf710908,0xbf74484bbf6db293,0xbf7d1cddbf796e4e,0xbf7b61fcbf76ba07,0xbf7fe129bf7e70b0,0xbf7f3f54bf7cbfc9,0xbf7efcc9bf7ffec4
.quad 0xbf7fd397bf7fb10f,0xbf7a7302bf7e1324,0xbf7d1cddbf7f84ab,0xbf725470bf78b47b,0xbf772417bf7c3b28,0xbf66beccbf6ff573,0xbf6dfcf2bf75dec6,0xbf57dc7fbf63f473
.quad 0xbedae880bec3ef15,0xbf039c3dbef15aea,0xbf099f4ebefc5d27,0xbf1f599fbf14b039,0xbf239da9bf187fc0,0xbf385216bf2e3bde,0xbf3b0629bf3085bb,0xbf4e1689bf44e3f5
.quad 0xbf4f7a1fbf45e403,0xbf604621bf584853,0xbf60a6cfbf584853,0xbf6e8ff8bf6816a8,0xbf6e46bebf676bd8,0xbf78b47bbf740bdd,0xbf7822d1bf731447,0xbf7e868bbf7bf531
.quad 0xbf7e1324bf7b14be,0xbf7fec43bf7fb10f,0xbf7fffb1bf7f4e6d,0xbf7cdf6cbf7f2f9d,0xbf7de0b1bf7fb10f,0xbf756d97bf7a7302,0xbf77beb7bf7c3b28,0xbf69b7e4bf718f57
.quad 0xbf6db293bf74fa0b,0xbf59f26abf64aa59,0xbf5fe4e9bf6a09a7,0xbf466354bf53fac3,0xbf4e8d90bf5b941a,0xbf2f61a5bf3fc767,0xbf39f2acbf49d112,0xbf1553b7bf286605
.quad 0xbf187fc0bf0e39da,0xbf2beb4abf226799,0xbf33587abf299415,0xbf456439bf3ca003,0xbf4ac77fbf41d870,0xbf5ac450bf531849,0xbf5e5aa6bf5695e5,0xbf6b99fbbf655e0b
.quad 0xbf6db293bf676bd8,0xbf778bc5bf731447,0xbf788486bf740bdd,0xbf7e5a38bf7bf531,0xbf7e9bc9bf7c3b28,0xbf7fe129bf7fd397,0xbf7fdaafbf7fd397,0xbf7c187abf7e9bc9
.quad 0xbf7c3b28bf7ec46d,0xbf731447bf7853f8,0xbf73ced9bf791298,0xbf650479bf6d1c1d,0xbf66beccbf6ed89e,0xbf5233c6bf5d2d53,0xbf554aa4bf604621,0xbf3b0629bf48d8b3
.quad 0xbf3fc767bf4d9f02,0xbf1ff6cbbf3085bb,0xbf269de3bf373a23,0xbf019573bf14b039,0xbf0a48adbf1d7fd1,0xbec1071ebeebcbbb,0xbed6a399bf00e7e4,0xbe75c35abea986c4
.quad 0x3f7fb10f3f800000,0x3f7d3aac3f7ec46d,0x3f7d1cdd3f7ec46d,0x3f77beb73f7ac516,0x3f77f1103f7b14be,0x3f6f68303f740bdd,0x3f703b373f74fa0b,0x3f644fac3f6aab7b
.quad 0x3f660f883f6c835e,0x3f5695e53f5ebe05,0x3f5988ad3f61c598,0x3f4663543f5064af,0x3f4ac77f3f54db31,0x3f33e7bc3f3fc767,0x3f39f2ac3f45e403,0x3f1f599f3f2d1469
.quad 0x3f2736563f3504f3,0x3f08f59b3f187fc0,0x3f12c39a3f226799,0x3ee1fb6a3f0242b1,0x3ef9a02d3f0e39da,0x3eaf713a3ed53641,0x3ecb2aae3ef15aea,0x3e75c35a3ea395c5
.quad 0x3e9aa0863ec3ef15,0x3e09cf863e605c13,0x3e5101f13e94a031,0x3ce22a7a3dee3876,0x3dd53db93e47c5c2,0xbda3308c3c490e90,0x3b490fc63dc8bd36,0xbe3e853ebdbc3ac3
.quad 0x3f7853f83f7b14be,0x3f7109083f74fa0b,0x3f6faf1b3f740bdd,0x3f6504793f6aab7b,0x3f63f4733f6a09a7,0x3f55b9933f5d2d53,0x3f554aa43f5d2d53,0x3f4360513f4cae79
.quad 0x3f43e2003f4d9f02,0x3f2e3bde3f396842,0x3f2ff3e63f3b8f3b,0x3f16999f3f239da9,0x3f19c2003f273656,0x3ef9a02d3f0b9a6b,0x3f0195733f10d3cd,0x3ec27b553ee363fa
.quad 0x3ecf7bca3ef15aea,0x3e888e933eac7cd4,0x3e9920fe3ebe1d4a,0x3e195be03e667c66,0x3e419b373e888e93,0x3cfb49ba3de1bc2e,0x3d9cecf93e22abb6,0xbdb5f8dabbc90f88
.quad 0xbd16c32c3d48fb30,0xbe541501bdfab273,0xbe195be0bd7b2b74,0xbea5129fbe72b651,0xbe8586cebe2f10a2,0xbeddbe79beb263ef,0xbebca7afbe8e9a22,0xbf099f4ebee900b7
.quad 0x3f676bd83f6c835e,0x3f5b941a3f61c598,0x3f57dc7f3f5ebe05,0x3f485bca3f5064af,0x3f44e3f53f4d9f02,0x3f31a81d3f3b8f3b,0x3f2ecef73f396842,0x3f17de123f239da9
.quad 0x3f15f6d93f226799,0x3ef6e0cb3f08f59b,0x3ef580353f08f59b,0x3eb9bb1e3ed8106b,0x3ebb31a03edae880,0x3e72b6513e9aa086,0x3e7bdba43ea09ae5,0x3ddb7d373e354098
.quad 0x3dfab2733e47c5c2,0xbcc90ab03d48fb30,0xbb490fc63d96a905,0xbe1f917bbda3308c,0xbe039502bd48fb30,0xbe919dddbe541501,0xbe80f8c0be2f10a2,0xbed0eb2abea986c4
.quad 0xbebe1d4abe94a031,0xbf064b82bee63375,0xbef840c8becf7bca,0xbf21cbfbbf0f8784,0xbf173c07bf039c3d,0xbf3a7ca4bf299415,0xbf2ff3e6bf1d7fd1,0xbf4fefa8bf40d0da
.quad 0x3f4d9f023f54db31,0x3f3daef93f45e403,0x3f36ad7f3f3fc767,0x3f2302d33f2d1469,0x3f1c420c3f273656,0x3f04f4843f10d3cd,0x3efdbabb3f0b9a6b,0x3ec8477c3ee363fa
.quad 0x3ebe1d4a3edae880,0x3e827dc03ea09ae5,0x3e75c35a3e9aa086,0x3de7fa9a3e354098,0x3dd53db93e2f10a2,0xbcfb49ba3d16c32c,0xbd0a342f3d16c32c,0xbe3228d4bdd53db9
.quad 0xbe2f10a2bdc8bd36,0xbea09ae5be78cfcc,0xbe9c1fafbe6c9a7f,0xbee4cbfebec1071e,0xbeddbe79beb8442a,0xbf121eb0bf00e7e4,0xbf0d9281bef6e0cb,0xbf2ecef7bf1ebc12
.quad 0xbf299415bf187fc0,0xbf47de65bf396842,0xbf425b89bf32c8c9,0xbf5cc7d1bf5064af,0xbf577026bf49d112,0xbf6d1c1dbf633c5a,0xbf686b39bf5d2d53,0xbf788486bf718f57
.quad 0xbf80a55400003f80,0x3f80248d250dbf80,0xbf7f3dc900003f80,0x3f75be95be48bf7b,0xbf7b3e4800003f80,0x3f55bf0ebec4bf6d,0xbf753e9500003f80,0x3f22bf46bf0ebf55
.quad 0xbf6d3ec400003f80,0x3ec4bf6dbf35bf35,0xbf623ef100003f80,0x3dc9bf7fbf55bf0e,0xbf553f0e00003f80,0xbe48bf7bbf6dbec4,0xbf463f2200003f80,0xbef1bf62bf7bbe48
.quad 0xbf353f3500003f80,0xbf35bf35bf80a554,0xbf223f4600003f80,0xbf62bef1bf7b3e48,0xbf0e3f5500003f80,0xbf7bbe48bf6d3ec4,0xbef13f6200003f80,0xbf7f3dc9bf553f0e
.quad 0xbec43f6d00003f80,0xbf6d3ec4bf353f35,0xbe953f7500003f80,0xbf463f22bf0e3f55,0xbe483f7b00003f80,0xbf0e3f55bec43f6d,0xbdc93f7f00003f80,0xbe953f75be483f7b
.quad 0xbf80a55400003f80,0x3f80248d250dbf80,0xbf623ef13ec43f6d,0x3f46bf22bf0ebf55,0xbf0e3f553f353f35,0x3e48bf7bbf6dbec4,0xbdc93f7f3f6d3ec4,0xbef1bf62bf7b3e48
.quad 0x3ec43f6d3f80248d,0xbf6dbec4bf353f35,0x3f463f223f6dbec4,0xbf753e95be483f7b,0x3f7b3e483f35bf35,0xbf0e3f553ec43f6d,0x3f75be953ec4bf6d,0x3dc93f7f3f553f0e
.quad 0x3f35bf35250dbf80,0x3f353f353f80248d,0x3e95bf75bec4bf6d,0x3f7f3dc93f55bf0e,0xbe48bf7bbf35bf35,0x3f55bf0e3ec4bf6d,0xbf22bf46bf6dbec4,0x3e95bf75be48bf7b
.quad 0xbf6dbec4bf80a554,0xbec4bf6dbf35bf35,0xbf7f3dc9bf6d3ec4,0xbf62bef1bf7bbe48,0xbf553f0ebf353f35,0xbf7b3e48bf6d3ec4,0xbef13f62bec43f6d,0xbf223f46bf0e3f55
.quad 0xbf80a55400003f80,0x3f80248d250dbf80,0xbf223f463f353f35,0x3ef1bf62bf55bf0e,0x3e483f7b3f80248d,0xbf0ebf55bf6d3ec4,0x3f623ef13f35bf35,0xbf7f3dc9be483f7b
.quad 0x3f6dbec4250dbf80,0xbec43f6d3f353f35,0x3e95bf75bf35bf35,0x3f223f463f7bbe48,0xbf0ebf55bf80a554,0x3f7bbe483ec4bf6d,0xbf7fbdc9bf353f35,0x3e95bf75bf0ebf55
.quad 0xbf353f3500003f80,0xbf35bf35bf80a554,0x3dc93f7f3f353f35,0xbf753e95bf0e3f55,0x3f553f0e3f80248d,0xbe483f7b3ec43f6d,0x3f75be953f35bf35,0x3f463f223f7b3e48
.quad 0x3ec4bf6d250dbf80,0x3f6dbec43f35bf35,0xbef1bf62bf35bf35,0x3dc9bf7fbe48bf7b,0xbf7bbe48bf80a554,0xbf55bf0ebf6dbec4,0xbf463f22bf353f35,0xbf623ef1bf553f0e
.quad 0xbf80a55400003f80,0x3f80248d250dbf80,0xbe953f753f6d3ec4,0x3dc9bf7fbf7bbe48,0x3f553f0e3f35bf35,0xbf7bbe48bec43f6d,0x3f46bf22bec4bf6d,0xbe953f753f553f0e
.quad 0xbec4bf6dbf80a554,0x3f6d3ec43f35bf35,0xbf7f3dc9bec43f6d,0x3ef1bf62bf0ebf55,0xbe483f7b3f353f35,0xbf55bf0ebf6d3ec4,0x3f623ef13f6dbec4,0xbf223f463e483f7b
.quad 0x3f35bf35250dbf80,0x3f353f353f80248d,0xbef1bf62bf6dbec4,0x3f46bf223e48bf7b,0xbf7b3e48bf353f35,0xbf0ebf55bf6dbec4,0xbdc93f7f3ec43f6d,0xbf623ef1bf0e3f55
.quad 0x3f6d3ec43f80248d,0x3ec43f6d3f353f35,0x3f22bf463ec4bf6d,0x3f75be953f55bf0e,0xbf0ebf55bf35bf35,0xbe48bf7bbec4bf6d,0xbf753e95bf6d3ec4,0xbf7f3dc9bf7b3e48
.quad 0xbf80a55400003f80,0x3f80248d250dbf80,0x3dc93f7f3f80248d,0xbe95bf75bf7b3e48,0x3f7bbe48250dbf80,0xbf553f0e3ec43f6d,0xbe95bf75bf80a554,0x3f463f223f55bf0e
.quad 0xbf6d3ec400003f80,0x3ec4bf6dbf35bf35,0x3ef13f623f80248d,0xbf7fbdc9bf0e3f55,0x3f55bf0e250dbf80,0x3e483f7b3f6d3ec4,0xbf22bf46bf80a554,0x3f62bef13e48bf7b
.quad 0xbf353f3500003f80,0xbf35bf35bf80a554,0x3f463f223f80248d,0xbef13f623e483f7b,0x3f0ebf55250dbf80,0x3f7b3e483f6dbec4,0xbf62bef1bf80a554,0xbdc9bf7fbf0ebf55
.quad 0xbec43f6d00003f80,0xbf6d3ec4bf353f35,0x3f753e953f80248d,0x3f223f463f553f0e,0x3e48bf7b250dbf80,0x3f0ebf553ec4bf6d,0xbf7fbdc9bf80a554,0xbf75be95bf7bbe48
.quad 0xbf80a55400003f80,0x3f80248d250dbf80,0x3ef13f623f6dbec4,0xbf22bf46bf553f0e,0x3f0ebf55bf35bf35,0xbe483f7b3f6d3ec4,0xbf7fbdc9bec43f6d,0x3f62bef1be48bf7b
.quad 0x3ec43f6d3f80248d,0xbf6dbec4bf353f35,0x3f22bf46bec4bf6d,0x3e953f753f7b3e48,0xbf7bbe48bf353f35,0x3f0ebf55bec4bf6d,0x3e953f753f6d3ec4,0xbf7f3dc9bf0e3f55
.quad 0x3f35bf35250dbf80,0x3f353f353f80248d,0xbf75be95bf6d3ec4,0x3dc9bf7fbf0ebf55,0x3e483f7b3f353f35,0xbf553f0ebec43f6d,0x3f46bf223ec4bf6d,0x3f753e953f7bbe48
.quad 0xbf6dbec4bf80a554,0xbec4bf6dbf35bf35,0x3dc93f7f3ec43f6d,0xbef13f62be483f7b,0x3f55bf0e3f35bf35,0x3f7bbe483f6dbec4,0xbf62bef1bf6dbec4,0xbf46bf22bf55bf0e
.quad 0xbf80a55400003f80,0x3f80248d250dbf80,0x3f463f223f35bf35,0xbf62bef1bf0e3f55,0xbe48bf7bbf80a554,0x3f0e3f553f6dbec4,0xbef13f623f353f35,0xbdc9bf7fbf7bbe48
.quad 0x3f6dbec4250dbf80,0xbec43f6d3f353f35,0xbf75be95bf353f35,0x3f46bf22be48bf7b,0x3f0e3f553f80248d,0xbf7b3e48bec43f6d,0x3dc9bf7fbf35bf35,0x3f753e953f55bf0e
.quad 0xbf353f3500003f80,0xbf35bf35bf80a554,0x3f7fbdc93f35bf35,0x3e953f753f553f0e,0xbf55bf0ebf80a554,0x3e48bf7bbec4bf6d,0x3e953f753f353f35,0xbf223f46be483f7b
.quad 0x3ec4bf6d250dbf80,0x3f6dbec43f35bf35,0xbf623ef1bf353f35,0xbf7fbdc9bf7b3e48,0x3f7b3e483f80248d,0x3f553f0e3f6d3ec4,0xbf22bf46bf35bf35,0xbef1bf62bf0ebf55
.quad 0xbf80a55400003f80,0x3f80248d250dbf80,0x3f753e953ec4bf6d,0xbf7fbdc9be483f7b,0xbf55bf0ebf353f35,0x3f7b3e483ec4bf6d,0x3f223f463f6dbec4,0xbf75be95bf0e3f55
.quad 0xbec4bf6dbf80a554,0x3f6d3ec43f35bf35,0x3dc93f7f3f6d3ec4,0xbf62bef1bf553f0e,0x3e48bf7bbf35bf35,0x3f553f0e3f6dbec4,0xbef13f623ec43f6d,0xbf46bf22bf7b3e48
.quad 0x3f35bf35250dbf80,0x3f353f353f80248d,0xbf623ef1bec43f6d,0xbf22bf46bf7bbe48,0x3f7bbe483f35bf35,0x3f0e3f553f6d3ec4,0xbf7fbdc9bf6d3ec4,0xbef1bf62bf55bf0e
.quad 0x3f6d3ec43f80248d,0x3ec43f6d3f353f35,0xbf46bf22bf6dbec4,0xbe95bf75bf0ebf55,0x3f0e3f553f353f35,0x3e483f7b3ec43f6d,0xbe95bf75bec4bf6d,0xbdc9bf7fbe48bf7b
.quad 0xbf80a55400003f80,0x3f80248d250dbf80,0x3f7fbdc9250dbf80,0xbf753e953e483f7b,0xbf7b3e4800003f80,0x3f55bf0ebec4bf6d,0x3f75be95250dbf80,0xbf223f463f0e3f55
.quad 0xbf6d3ec400003f80,0x3ec4bf6dbf35bf35,0x3f62bef1250dbf80,0xbdc93f7f3f553f0e,0xbf553f0e00003f80,0xbe48bf7bbf6dbec4,0x3f46bf22250dbf80,0x3ef13f623f7b3e48
.quad 0xbf353f3500003f80,0xbf35bf35bf80a554,0x3f22bf46250dbf80,0x3f623ef13f7bbe48,0xbf0e3f5500003f80,0xbf7bbe48bf6d3ec4,0x3ef1bf62250dbf80,0x3f7fbdc93f55bf0e
.quad 0xbec43f6d00003f80,0xbf6d3ec4bf353f35,0x3e95bf75250dbf80,0x3f46bf223f0ebf55,0xbe483f7b00003f80,0xbf0e3f55bec43f6d,0x3dc9bf7f250dbf80,0x3e95bf753e48bf7b
.quad 0xbf80a55400003f80,0x3f80248d250dbf80,0x3f62bef1bec4bf6d,0xbf463f223f0e3f55,0xbf0e3f553f353f35,0x3e48bf7bbf6dbec4,0x3dc9bf7fbf6dbec4,0x3ef13f623f7bbe48
.quad 0x3ec43f6d3f80248d,0xbf6dbec4bf353f35,0xbf46bf22bf6d3ec4,0x3f75be953e48bf7b,0x3f7b3e483f35bf35,0xbf0e3f553ec43f6d,0xbf753e95bec43f6d,0xbdc9bf7fbf55bf0e
.quad 0x3f35bf35250dbf80,0x3f353f353f80248d,0xbe953f753ec43f6d,0xbf7fbdc9bf553f0e,0xbe48bf7bbf35bf35,0x3f55bf0e3ec4bf6d,0x3f223f463f6d3ec4,0xbe953f753e483f7b
.quad 0xbf6dbec4bf80a554,0xbec4bf6dbf35bf35,0x3f7fbdc93f6dbec4,0x3f623ef13f7b3e48,0xbf553f0ebf353f35,0xbf7b3e48bf6d3ec4,0x3ef1bf623ec4bf6d,0x3f22bf463f0ebf55
.quad 0xbf80a55400003f80,0x3f80248d250dbf80,0x3f22bf46bf35bf35,0xbef13f623f553f0e,0x3e483f7b3f80248d,0xbf0ebf55bf6d3ec4,0xbf62bef1bf353f35,0x3f7fbdc93e48bf7b
.quad 0x3f6dbec4250dbf80,0xbec43f6d3f353f35,0xbe953f753f353f35,0xbf22bf46bf7b3e48,0xbf0ebf55bf80a554,0x3f7bbe483ec4bf6d,0x3f7f3dc93f35bf35,0xbe953f753f0e3f55
.quad 0xbf353f3500003f80,0xbf35bf35bf80a554,0xbdc9bf7fbf35bf35,0x3f75be953f0ebf55,0x3f553f0e3f80248d,0xbe483f7b3ec43f6d,0xbf753e95bf353f35,0xbf46bf22bf7bbe48
.quad 0x3ec4bf6d250dbf80,0x3f6dbec43f35bf35,0x3ef13f623f353f35,0xbdc93f7f3e483f7b,0xbf7bbe48bf80a554,0xbf55bf0ebf6dbec4,0x3f46bf223f35bf35,0x3f62bef13f55bf0e
.quad 0xbf80a55400003f80,0x3f80248d250dbf80,0x3e95bf75bf6dbec4,0xbdc93f7f3f7b3e48,0x3f553f0e3f35bf35,0xbf7bbe48bec43f6d,0xbf463f223ec43f6d,0x3e95bf75bf55bf0e
.quad 0xbec4bf6dbf80a554,0x3f6d3ec43f35bf35,0x3f7fbdc93ec4bf6d,0xbef13f623f0e3f55,0xbe483f7b3f353f35,0xbf55bf0ebf6d3ec4,0xbf62bef1bf6d3ec4,0x3f22bf46be48bf7b
.quad 0x3f35bf35250dbf80,0x3f353f353f80248d,0x3ef13f623f6d3ec4,0xbf463f22be483f7b,0xbf7b3e48bf353f35,0xbf0ebf55bf6dbec4,0x3dc9bf7fbec4bf6d,0x3f62bef13f0ebf55
.quad 0x3f6d3ec43f80248d,0x3ec43f6d3f353f35,0xbf223f46bec43f6d,0xbf753e95bf553f0e,0xbf0ebf55bf35bf35,0xbe48bf7bbec4bf6d,0x3f75be953f6dbec4,0x3f7fbdc93f7bbe48
.quad 0xbf80a55400003f80,0x3f80248d250dbf80,0xbdc9bf7fbf80a554,0x3e953f753f7bbe48,0x3f7bbe48250dbf80,0xbf553f0e3ec43f6d,0x3e953f753f80248d,0xbf46bf22bf553f0e
.quad 0xbf6d3ec400003f80,0x3ec4bf6dbf35bf35,0xbef1bf62bf80a554,0x3f7f3dc93f0ebf55,0x3f55bf0e250dbf80,0x3e483f7b3f6d3ec4,0x3f223f463f80248d,0xbf623ef1be483f7b
.quad 0xbf353f3500003f80,0xbf35bf35bf80a554,0xbf46bf22bf80a554,0x3ef1bf62be48bf7b,0x3f0ebf55250dbf80,0x3f7b3e483f6dbec4,0x3f623ef13f80248d,0x3dc93f7f3f0e3f55
.quad 0xbec43f6d00003f80,0xbf6d3ec4bf353f35,0xbf75be95bf80a554,0xbf22bf46bf55bf0e,0x3e48bf7b250dbf80,0x3f0ebf553ec4bf6d,0x3f7f3dc93f80248d,0x3f753e953f7b3e48
.quad 0xbf80a55400003f80,0x3f80248d250dbf80,0xbef1bf62bf6d3ec4,0x3f223f463f55bf0e,0x3f0ebf55bf35bf35,0xbe483f7b3f6d3ec4,0x3f7f3dc93ec4bf6d,0xbf623ef13e483f7b
.quad 0x3ec43f6d3f80248d,0xbf6dbec4bf353f35,0xbf223f463ec43f6d,0xbe95bf75bf7bbe48,0xbf7bbe48bf353f35,0x3f0ebf55bec4bf6d,0xbe95bf75bf6dbec4,0x3f7fbdc93f0ebf55
.quad 0x3f35bf35250dbf80,0x3f353f353f80248d,0x3f753e953f6dbec4,0xbdc93f7f3f0e3f55,0x3e483f7b3f353f35,0xbf553f0ebec43f6d,0xbf463f22bec43f6d,0xbf75be95bf7b3e48
.quad 0xbf6dbec4bf80a554,0xbec4bf6dbf35bf35,0xbdc9bf7fbec4bf6d,0x3ef1bf623e48bf7b,0x3f55bf0e3f35bf35,0x3f7bbe483f6dbec4,0x3f623ef13f6d3ec4,0x3f463f223f553f0e
.quad 0xbf80a55400003f80,0x3f80248d250dbf80,0xbf46bf22bf353f35,0x3f623ef13f0ebf55,0xbe48bf7bbf80a554,0x3f0e3f553f6dbec4,0x3ef1bf62bf35bf35,0x3dc93f7f3f7b3e48
.quad 0x3f6dbec4250dbf80,0xbec43f6d3f353f35,0x3f753e953f35bf35,0xbf463f223e483f7b,0x3f0e3f553f80248d,0xbf7b3e48bec43f6d,0xbdc93f7f3f353f35,0xbf75be95bf553f0e
.quad 0xbf353f3500003f80,0xbf35bf35bf80a554,0xbf7f3dc9bf353f35,0xbe95bf75bf55bf0e,0xbf55bf0ebf80a554,0x3e48bf7bbec4bf6d,0xbe95bf75bf35bf35,0x3f22bf463e48bf7b
.quad 0x3ec4bf6d250dbf80,0x3f6dbec43f35bf35,0x3f62bef13f35bf35,0x3f7f3dc93f7bbe48,0x3f7b3e483f80248d,0x3f553f0e3f6d3ec4,0x3f223f463f353f35,0x3ef13f623f0e3f55
.quad 0xbf80a55400003f80,0x3f80248d250dbf80,0xbf75be95bec43f6d,0x3f7f3dc93e48bf7b,0xbf55bf0ebf353f35,0x3f7b3e483ec4bf6d,0xbf22bf46bf6d3ec4,0x3f753e953f0ebf55
.quad 0xbec4bf6dbf80a554,0x3f6d3ec43f35bf35,0xbdc9bf7fbf6dbec4,0x3f623ef13f55bf0e,0x3e48bf7bbf35bf35,0x3f553f0e3f6dbec4,0x3ef1bf62bec4bf6d,0x3f463f223f7bbe48
.quad 0x3f35bf35250dbf80,0x3f353f353f80248d,0x3f62bef13ec4bf6d,0x3f223f463f7b3e48,0x3f7bbe483f35bf35,0x3f0e3f553f6d3ec4,0x3f7f3dc93f6dbec4,0x3ef13f623f553f0e
.quad 0x3f6d3ec43f80248d,0x3ec43f6d3f353f35,0x3f463f223f6d3ec4,0x3e953f753f0e3f55,0x3f0e3f553f353f35,0x3e483f7b3ec43f6d,0x3e953f753ec43f6d,0x3dc93f7f3e483f7b
.quad 0xa5543f803f808000,0x248dbf80bf80a50d,0x3dc93f7f3f808000,0xbe95bf75bf7b3e48,0x3e483f7b3f808000,0xbf0ebf55bf6d3ec4,0x3e953f753f808000,0xbf46bf22bf553f0e
.quad 0x3ec43f6d3f808000,0xbf6dbec4bf353f35,0x3ef13f623f808000,0xbf7fbdc9bf0e3f55,0x3f0e3f553f808000,0xbf7b3e48bec43f6d,0x3f223f463f808000,0xbf623ef1be483f7b
.quad 0x3f353f353f808000,0xbf353f35a5543f80,0x3f463f223f808000,0xbef13f623e483f7b,0x3f553f0e3f808000,0xbe483f7b3ec43f6d,0x3f623ef13f808000,0x3dc93f7f3f0e3f55
.quad 0x3f6d3ec43f808000,0x3ec43f6d3f353f35,0x3f753e953f808000,0x3f223f463f553f0e,0x3f7b3e483f808000,0x3f553f0e3f6d3ec4,0x3f7f3dc93f808000,0x3f753e953f7b3e48
.quad 0xa5543f803f808000,0x248dbf80bf80a50d,0x3ef13f623f6dbec4,0xbf22bf46bf553f0e,0x3f553f0e3f35bf35,0xbf7bbe48bec43f6d,0x3f7f3dc93ec4bf6d,0xbf623ef13e483f7b
.quad 0x3f6dbec4248dbf80,0xbec43f6d3f353f35,0x3f22bf46bec4bf6d,0x3e953f753f7b3e48,0x3e48bf7bbf35bf35,0x3f553f0e3f6dbec4,0xbe95bf75bf6dbec4,0x3f7fbdc93f0ebf55
.quad 0xbf35bf35bf80a50d,0x3f35bf35248dbf80,0xbf75be95bf6d3ec4,0x3dc9bf7fbf0ebf55,0xbf7b3e48bf353f35,0xbf0ebf55bf6dbec4,0xbf463f22bec43f6d,0xbf75be95bf7b3e48
.quad 0xbec43f6da5543f80,0xbf6d3ec4bf353f35,0x3dc93f7f3ec43f6d,0xbef13f62be483f7b,0x3f0e3f553f353f35,0x3e483f7b3ec43f6d,0x3f623ef13f6d3ec4,0x3f463f223f553f0e
.quad 0xa5543f803f808000,0x248dbf80bf80a50d,0x3f463f223f35bf35,0xbf62bef1bf0e3f55,0x3f7bbe48248dbf80,0xbf553f0e3ec43f6d,0x3ef1bf62bf35bf35,0x3dc93f7f3f7b3e48
.quad 0xbec4bf6dbf80a50d,0x3f6d3ec43f35bf35,0xbf75be95bf353f35,0x3f46bf22be48bf7b,0xbf553f0ea5543f80,0xbe48bf7bbf6dbec4,0xbdc93f7f3f353f35,0xbf75be95bf553f0e
.quad 0x3f353f353f808000,0xbf353f35a5543f80,0x3f7fbdc93f35bf35,0x3e953f753f553f0e,0x3f0ebf55248dbf80,0x3f7b3e483f6dbec4,0xbe95bf75bf35bf35,0x3f22bf463e48bf7b
.quad 0xbf6dbec4bf80a50d,0xbec4bf6dbf35bf35,0xbf623ef1bf353f35,0xbf7fbdc9bf7b3e48,0xbe483f7ba5543f80,0xbf0e3f55bec43f6d,0x3f223f463f353f35,0x3ef13f623f0e3f55
.quad 0xa5543f803f808000,0x248dbf80bf80a50d,0x3f753e953ec4bf6d,0xbf7fbdc9be483f7b,0x3f0ebf55bf35bf35,0xbe483f7b3f6d3ec4,0xbf22bf46bf6d3ec4,0x3f753e953f0ebf55
.quad 0xbf6d3ec4a5543f80,0x3ec4bf6dbf35bf35,0x3dc93f7f3f6d3ec4,0xbf62bef1bf553f0e,0x3f7b3e483f35bf35,0xbf0e3f553ec43f6d,0x3ef1bf62bec4bf6d,0x3f463f223f7bbe48
.quad 0xbf35bf35bf80a50d,0x3f35bf35248dbf80,0xbf623ef1bec43f6d,0xbf22bf46bf7bbe48,0x3e483f7b3f353f35,0xbf553f0ebec43f6d,0x3f7f3dc93f6dbec4,0x3ef13f623f553f0e
.quad 0x3ec4bf6d248dbf80,0x3f6dbec43f35bf35,0xbf46bf22bf6dbec4,0xbe95bf75bf0ebf55,0xbf553f0ebf353f35,0xbf7b3e48bf6d3ec4,0x3e953f753ec43f6d,0x3dc93f7f3e483f7b
.quad 0xa5543f803f808000,0x248dbf80bf80a50d,0x3f7fbdc9248dbf80,0xbf753e953e483f7b,0xbe48bf7bbf80a50d,0x3f0e3f553f6dbec4,0xbf753e95a5543f80,0x3f22bf46bf0ebf55
.quad 0x3ec43f6d3f808000,0xbf6dbec4bf353f35,0x3f62bef1248dbf80,0xbdc93f7f3f553f0e,0xbf0ebf55bf80a50d,0x3f7bbe483ec4bf6d,0xbf463f22a5543f80,0xbef1bf62bf7bbe48
.quad 0x3f353f353f808000,0xbf353f35a5543f80,0x3f22bf46248dbf80,0x3f623ef13f7bbe48,0xbf55bf0ebf80a50d,0x3e48bf7bbec4bf6d,0xbef13f62a5543f80,0xbf7f3dc9bf553f0e
.quad 0x3f6d3ec43f808000,0x3ec43f6d3f353f35,0x3e95bf75248dbf80,0x3f46bf223f0ebf55,0xbf7bbe48bf80a50d,0xbf55bf0ebf6dbec4,0xbdc93f7fa5543f80,0xbe953f75be483f7b
.quad 0xa5543f803f808000,0x248dbf80bf80a50d,0x3f62bef1bec4bf6d,0xbf463f223f0e3f55,0xbf55bf0ebf353f35,0x3f7b3e483ec4bf6d,0xbdc93f7f3f6d3ec4,0xbef1bf62bf7b3e48
.quad 0x3f6dbec4248dbf80,0xbec43f6d3f353f35,0xbf46bf22bf6d3ec4,0x3f75be953e48bf7b,0xbe483f7b3f353f35,0xbf55bf0ebf6d3ec4,0x3f75be953ec4bf6d,0x3dc93f7f3f553f0e
.quad 0xbf35bf35bf80a50d,0x3f35bf35248dbf80,0xbe953f753ec43f6d,0xbf7fbdc9bf553f0e,0x3f7bbe483f35bf35,0x3f0e3f553f6d3ec4,0xbf22bf46bf6dbec4,0x3e95bf75be48bf7b
.quad 0xbec43f6da5543f80,0xbf6d3ec4bf353f35,0x3f7fbdc93f6dbec4,0x3f623ef13f7b3e48,0xbf0ebf55bf35bf35,0xbe48bf7bbec4bf6d,0xbef13f62bec43f6d,0xbf223f46bf0e3f55
.quad 0xa5543f803f808000,0x248dbf80bf80a50d,0x3f22bf46bf35bf35,0xbef13f623f553f0e,0xbf7b3e48a5543f80,0x3f55bf0ebec4bf6d,0x3f623ef13f35bf35,0xbf7f3dc9be483f7b
.quad 0xbec4bf6dbf80a50d,0x3f6d3ec43f35bf35,0xbe953f753f353f35,0xbf22bf46bf7b3e48,0x3f55bf0e248dbf80,0x3e483f7b3f6d3ec4,0xbf7fbdc9bf353f35,0x3e95bf75bf0ebf55
.quad 0x3f353f353f808000,0xbf353f35a5543f80,0xbdc9bf7fbf35bf35,0x3f75be953f0ebf55,0xbf0e3f55a5543f80,0xbf7bbe48bf6d3ec4,0x3f75be953f35bf35,0x3f463f223f7b3e48
.quad 0xbf6dbec4bf80a50d,0xbec4bf6dbf35bf35,0x3ef13f623f353f35,0xbdc93f7f3e483f7b,0x3e48bf7b248dbf80,0x3f0ebf553ec4bf6d,0xbf463f22bf353f35,0xbf623ef1bf553f0e
.quad 0xa5543f803f808000,0x248dbf80bf80a50d,0x3e95bf75bf6dbec4,0xbdc93f7f3f7b3e48,0xbf0e3f553f353f35,0x3e48bf7bbf6dbec4,0x3f46bf22bec4bf6d,0xbe953f753f553f0e
.quad 0xbf6d3ec4a5543f80,0x3ec4bf6dbf35bf35,0x3f7fbdc93ec4bf6d,0xbef13f623f0e3f55,0xbf7bbe48bf353f35,0x3f0ebf55bec4bf6d,0x3f623ef13f6dbec4,0xbf223f463e483f7b
.quad 0xbf35bf35bf80a50d,0x3f35bf35248dbf80,0x3ef13f623f6d3ec4,0xbf463f22be483f7b,0xbe48bf7bbf35bf35,0x3f55bf0e3ec4bf6d,0xbdc93f7f3ec43f6d,0xbf623ef1bf0e3f55
.quad 0x3ec4bf6d248dbf80,0x3f6dbec43f35bf35,0xbf223f46bec43f6d,0xbf753e95bf553f0e,0x3f55bf0e3f35bf35,0x3f7bbe483f6dbec4,0xbf753e95bf6d3ec4,0xbf7f3dc9bf7b3e48
.quad 0xa5543f803f808000,0x248dbf80bf80a50d,0xbdc9bf7fbf80a50d,0x3e953f753f7bbe48,0x3e483f7b3f808000,0xbf0ebf55bf6d3ec4,0xbe95bf75bf80a50d,0x3f463f223f55bf0e
.quad 0x3ec43f6d3f808000,0xbf6dbec4bf353f35,0xbef1bf62bf80a50d,0x3f7f3dc93f0ebf55,0x3f0e3f553f808000,0xbf7b3e48bec43f6d,0xbf22bf46bf80a50d,0x3f62bef13e48bf7b
.quad 0x3f353f353f808000,0xbf353f35a5543f80,0xbf46bf22bf80a50d,0x3ef1bf62be48bf7b,0x3f553f0e3f808000,0xbe483f7b3ec43f6d,0xbf62bef1bf80a50d,0xbdc9bf7fbf0ebf55
.quad 0x3f6d3ec43f808000,0x3ec43f6d3f353f35,0xbf75be95bf80a50d,0xbf22bf46bf55bf0e,0x3f7b3e483f808000,0x3f553f0e3f6d3ec4,0xbf7fbdc9bf80a50d,0xbf75be95bf7bbe48
.quad 0xa5543f803f808000,0x248dbf80bf80a50d,0xbef1bf62bf6d3ec4,0x3f223f463f55bf0e,0x3f553f0e3f35bf35,0xbf7bbe48bec43f6d,0xbf7fbdc9bec43f6d,0x3f62bef1be48bf7b
.quad 0x3f6dbec4248dbf80,0xbec43f6d3f353f35,0xbf223f463ec43f6d,0xbe95bf75bf7bbe48,0x3e48bf7bbf35bf35,0x3f553f0e3f6dbec4,0x3e953f753f6d3ec4,0xbf7f3dc9bf0e3f55
.quad 0xbf35bf35bf80a50d,0x3f35bf35248dbf80,0x3f753e953f6dbec4,0xbdc93f7f3f0e3f55,0xbf7b3e48bf353f35,0xbf0ebf55bf6dbec4,0x3f46bf223ec4bf6d,0x3f753e953f7bbe48
.quad 0xbec43f6da5543f80,0xbf6d3ec4bf353f35,0xbdc9bf7fbec4bf6d,0x3ef1bf623e48bf7b,0x3f0e3f553f353f35,0x3e483f7b3ec43f6d,0xbf62bef1bf6dbec4,0xbf46bf22bf55bf0e
.quad 0xa5543f803f808000,0x248dbf80bf80a50d,0xbf46bf22bf353f35,0x3f623ef13f0ebf55,0x3f7bbe48248dbf80,0xbf553f0e3ec43f6d,0xbef13f623f353f35,0xbdc9bf7fbf7bbe48
.quad 0xbec4bf6dbf80a50d,0x3f6d3ec43f35bf35,0x3f753e953f35bf35,0xbf463f223e483f7b,0xbf553f0ea5543f80,0xbe48bf7bbf6dbec4,0x3dc9bf7fbf35bf35,0x3f753e953f55bf0e
.quad 0x3f353f353f808000,0xbf353f35a5543f80,0xbf7f3dc9bf353f35,0xbe95bf75bf55bf0e,0x3f0ebf55248dbf80,0x3f7b3e483f6dbec4,0x3e953f753f353f35,0xbf223f46be483f7b
.quad 0xbf6dbec4bf80a50d,0xbec4bf6dbf35bf35,0x3f62bef13f35bf35,0x3f7f3dc93f7bbe48,0xbe483f7ba5543f80,0xbf0e3f55bec43f6d,0xbf22bf46bf35bf35,0xbef1bf62bf0ebf55
.quad 0xa5543f803f808000,0x248dbf80bf80a50d,0xbf75be95bec43f6d,0x3f7f3dc93e48bf7b,0x3f0ebf55bf35bf35,0xbe483f7b3f6d3ec4,0x3f223f463f6dbec4,0xbf75be95bf0e3f55
.quad 0xbf6d3ec4a5543f80,0x3ec4bf6dbf35bf35,0xbdc9bf7fbf6dbec4,0x3f623ef13f55bf0e,0x3f7b3e483f35bf35,0xbf0e3f553ec43f6d,0xbef13f623ec43f6d,0xbf46bf22bf7b3e48
.quad 0xbf35bf35bf80a50d,0x3f35bf35248dbf80,0x3f62bef13ec4bf6d,0x3f223f463f7b3e48,0x3e483f7b3f353f35,0xbf553f0ebec43f6d,0xbf7fbdc9bf6d3ec4,0xbef1bf62bf55bf0e
.quad 0x3ec4bf6d248dbf80,0x3f6dbec43f35bf35,0x3f463f223f6d3ec4,0x3e953f753f0e3f55,0xbf553f0ebf353f35,0xbf7b3e48bf6d3ec4,0xbe95bf75bec4bf6d,0xbdc9bf7fbe48bf7b
.quad 0xa5543f803f808000,0x248dbf80bf80a50d,0xbf7f3dc9a5543f80,0x3f75be95be48bf7b,0xbe48bf7bbf80a50d,0x3f0e3f553f6dbec4,0x3f75be95248dbf80,0xbf223f463f0e3f55
.quad 0x3ec43f6d3f808000,0xbf6dbec4bf353f35,0xbf623ef1a5543f80,0x3dc9bf7fbf55bf0e,0xbf0ebf55bf80a50d,0x3f7bbe483ec4bf6d,0x3f46bf22248dbf80,0x3ef13f623f7b3e48
.quad 0x3f353f353f808000,0xbf353f35a5543f80,0xbf223f46a5543f80,0xbf62bef1bf7b3e48,0xbf55bf0ebf80a50d,0x3e48bf7bbec4bf6d,0x3ef1bf62248dbf80,0x3f7fbdc93f55bf0e
.quad 0x3f6d3ec43f808000,0x3ec43f6d3f353f35,0xbe953f75a5543f80,0xbf463f22bf0e3f55,0xbf7bbe48bf80a50d,0xbf55bf0ebf6dbec4,0x3dc9bf7f248dbf80,0x3e95bf753e48bf7b
.quad 0xa5543f803f808000,0x248dbf80bf80a50d,0xbf623ef13ec43f6d,0x3f46bf22bf0ebf55,0xbf55bf0ebf353f35,0x3f7b3e483ec4bf6d,0x3dc9bf7fbf6dbec4,0x3ef13f623f7bbe48
.quad 0x3f6dbec4248dbf80,0xbec43f6d3f353f35,0x3f463f223f6dbec4,0xbf753e95be483f7b,0xbe483f7b3f353f35,0xbf55bf0ebf6d3ec4,0xbf753e95bec43f6d,0xbdc9bf7fbf55bf0e
.quad 0xbf35bf35bf80a50d,0x3f35bf35248dbf80,0x3e95bf75bec4bf6d,0x3f7f3dc93f55bf0e,0x3f7bbe483f35bf35,0x3f0e3f553f6d3ec4,0x3f223f463f6d3ec4,0xbe953f753e483f7b
.quad 0xbec43f6da5543f80,0xbf6d3ec4bf353f35,0xbf7f3dc9bf6d3ec4,0xbf62bef1bf7bbe48,0xbf0ebf55bf35bf35,0xbe48bf7bbec4bf6d,0x3ef1bf623ec4bf6d,0x3f22bf463f0ebf55
.quad 0xa5543f803f808000,0x248dbf80bf80a50d,0xbf223f463f353f35,0x3ef1bf62bf55bf0e,0xbf7b3e48a5543f80,0x3f55bf0ebec4bf6d,0xbf62bef1bf353f35,0x3f7fbdc93e48bf7b
.quad 0xbec4bf6dbf80a50d,0x3f6d3ec43f35bf35,0x3e95bf75bf35bf35,0x3f223f463f7bbe48,0x3f55bf0e248dbf80,0x3e483f7b3f6d3ec4,0x3f7f3dc93f35bf35,0xbe953f753f0e3f55
.quad 0x3f353f353f808000,0xbf353f35a5543f80,0x3dc93f7f3f353f35,0xbf753e95bf0e3f55,0xbf0e3f55a5543f80,0xbf7bbe48bf6d3ec4,0xbf753e95bf353f35,0xbf46bf22bf7bbe48
.quad 0xbf6dbec4bf80a50d,0xbec4bf6dbf35bf35,0xbef1bf62bf35bf35,0x3dc9bf7fbe48bf7b,0x3e48bf7b248dbf80,0x3f0ebf553ec4bf6d,0x3f46bf223f35bf35,0x3f62bef13f55bf0e
.quad 0xa5543f803f808000,0x248dbf80bf80a50d,0xbe953f753f6d3ec4,0x3dc9bf7fbf7bbe48,0xbf0e3f553f353f35,0x3e48bf7bbf6dbec4,0xbf463f223ec43f6d,0x3e95bf75bf55bf0e
.quad 0xbf6d3ec4a5543f80,0x3ec4bf6dbf35bf35,0xbf7f3dc9bec43f6d,0x3ef1bf62bf0ebf55,0xbf7bbe48bf353f35,0x3f0ebf55bec4bf6d,0xbf62bef1bf6d3ec4,0x3f22bf46be48bf7b
.quad 0xbf35bf35bf80a50d,0x3f35bf35248dbf80,0xbef1bf62bf6dbec4,0x3f46bf223e48bf7b,0xbe48bf7bbf35bf35,0x3f55bf0e3ec4bf6d,0x3dc9bf7fbec4bf6d,0x3f62bef13f0ebf55
.quad 0x3ec4bf6d248dbf80,0x3f6dbec43f35bf35,0x3f22bf463ec4bf6d,0x3f75be953f55bf0e,0x3f55bf0e3f35bf35,0x3f7bbe483f6dbec4,0x3f75be953f6dbec4,0x3f7fbdc93f7bbe48
.quad 0x3f7d3aac3f800000,0x3f676bd83f74fa0b,0x3f7d1cdd3f800000,0x3f6667713f748422,0x3f7cfe733f800000,0x3f655e0b3f740bdd,0x3f7cdf6c3f800000,0x3f644fac3f73913f
.quad 0x3f7cbfc93f800000,0x3f633c5a3f731447,0x3f7c9f8a3f800000,0x3f62241a3f7294f8,0x3f7c7eb03f800000,0x3f6106f23f721352,0x3f7c5d3a3f800000,0x3f5fe4e93f718f57
.quad 0x3f7c3b283f800000,0x3f5ebe053f710908,0x3f7c187a3f800000,0x3f5d924d3f708066,0x3f7bf5313f800000,0x3f5c61c73f6ff573,0x3f7bd14d3f800000,0x3f5b2c793f6f6830
.quad 0x3f7baccd3f800000,0x3f59f26a3f6ed89e,0x3f7b87b23f800000,0x3f58b3a13f6e46be,0x3f7b61fc3f800000,0x3f5770263f6db293,0x3f7b3bab3f800000,0x3f5627fe3f6d1c1d
.quad 0x3f3daef93f54db31,0x3f039c3d3f226799,0x3f3b06293f531849,0x3efdbabb3f1ebc12,0x3f3852163f514d3d,0x3ef41f073f1b02c6,0x3f3592e73f4f7a1f,0x3eea66813f173c07
.quad 0x3f32c8c93f4d9f02,0x3ee0924f3f13682a,0x3f2ff3e63f4bbbf8,0x3ed6a3993f0f8784,0x3f2d14693f49d112,0x3ecc9b8b3f0b9a6b,0x3f2a2a803f47de65,0x3ec27b553f07a136
.quad 0x3f2736563f45e403,0x3eb8442a3f039c3d,0x3f24381a3f43e200,0x3eadf73c3eff17b2,0x3f212ff93f41d870,0x3ea395c53ef6e0cb,0x3f1e1e223f3fc767,0x3e9920fe3eee9479
.quad 0x3f1b02c63f3daef9,0x3e8e9a223ee63375,0x3f17de123f3b8f3b,0x3e8402703eddbe79,0x3f14b0393f396842,0x3e72b6513ed53641,0x3f11796b3f373a23,0x3e5d4b1a3ecc9b8b
.quad 0x3e78cfcc3ec3ef15,0xbd48fb303dc8bd36,0x3e5d4b1a3eb8442a,0xbda973ba3d8a200a,0x3e419b373eac7cd4,0xbdee38763d16c32c,0x3e25c58c3ea09ae5,0xbe195be03bc90f88
.quad 0x3e09cf863e94a031,0xbe3b6ecfbcc90ab0,0x3ddb7d373e888e93,0xbe5d4b1abd621469,0x3da3308c3e78cfcc,0xbe7ee6e1bdafb680,0x3d55880e3e605c13,0xbe901c2cbdee3876
.quad 0x3cc90ab03e47c5c2,0xbea09ae5be164083,0xbb490fc63e2f10a2,0xbeb0eacbbe354098,0xbcfb49ba3e164083,0xbec1071ebe541501,0xbd6ea0383dfab273,0xbed0eb2abe72b651
.quad 0xbdafb6803dc8bd36,0xbee0924fbe888e93,0xbde7fa9a3d96a905,0xbeeff7fbbe97a117,0xbe1008b73d48fb30,0xbeff17b2bea68f12,0xbe2bf8043cc90ab0,0xbf06f686beb554ec
.quad 0xbeac7cd4be47c5c2,0xbf187fc0bef15aea,0xbebf926fbe6c9a7f,0xbf21cbfbbf0242b1,0xbed25a09be888e93,0xbf2ac082bf0b9a6b,0xbee4cbfebe9aa086,0xbf33587abf14b039
.quad 0xbef6e0cbbeac7cd4,0xbf3b8f3bbf1d7fd1,0xbf044889bebe1d4a,0xbf436051bf26050a,0xbf0cead0becf7bca,0xbf4ac77fbf2e3bde,0xbf1553b7bee0924f,0xbf51c0c2bf36206c
.quad 0xbf1d7fd1bef15aea,0xbf584853bf3daef9,0xbf256bcbbf00e7e4,0xbf5e5aa6bf44e3f5,0xbf2d1469bf08f59b,0xbf63f473bf4bbbf8,0xbf34768fbf10d3cd,0xbf6912aebf5233c6
.quad 0xbf3b8f3bbf187fc0,0xbf6db293bf584853,0xbf425b89bf1ff6cb,0xbf71d19fbf5df6be,0xbf48d8b3bf273656,0xbf756d97bf633c5a,0xbf4f0417bf2e3bde,0xbf788486bf6816a8
.quad 0xbe16408380000000,0xbedae880be94a031,0xbe195be080000000,0xbedf28a9be97a117,0xbe1c76de80000000,0xbee363fabe9aa086,0xbe1f917b80000000,0xbee79a5dbe9d9e78
.quad 0xbe22abb680000000,0xbeebcbbbbea09ae5,0xbe25c58c80000000,0xbeeff7fbbea395c5,0xbe28defc80000000,0xbef41f07bea68f12,0xbe2bf80480000000,0xbef840c8bea986c4
.quad 0xbe2f10a280000000,0xbefc5d27beac7cd4,0xbe3228d480000000,0xbf003a06beaf713a,0xbe35409880000000,0xbf0242b1beb263ef,0xbe3857ec80000000,0xbf044889beb554ec
.quad 0xbe3b6ecf80000000,0xbf064b82beb8442a,0xbe3e853e80000000,0xbf084b92bebb31a0,0xbe419b3780000000,0xbf0a48adbebe1d4a,0xbe44b0b980000000,0xbf0c42c9bec1071e
.quad 0xbf2beb4abf0e39da,0xbf5b941abf45e403,0xbf2ecef7bf10d3cd,0xbf5e5aa6bf48d8b3,0xbf31a81dbf13682a,0xbf6106f2bf4bbbf8,0xbf34768fbf15f6d9,0xbf6398acbf4e8d90
.quad 0xbf373a23bf187fc0,0xbf660f88bf514d3d,0xbf39f2acbf1b02c6,0xbf686b39bf53fac3,0xbf3ca003bf1d7fd1,0xbf6aab7bbf5695e5,0xbf3f41fcbf1ff6cb,0xbf6cd007bf591e6a
.quad 0xbf41d870bf226799,0xbf6ed89ebf5b941a,0xbf446337bf24d225,0xbf70c501bf5df6be,0xbf46e22abf273656,0xbf7294f8bf604621,0xbf495521bf299415,0xbf74484bbf628210
.quad 0xbf4bbbf8bf2beb4a,0xbf75dec6bf64aa59,0xbf4e1689bf2e3bde,0xbf77583abf66becc,0xbf5064afbf3085bb,0xbf78b47bbf68bf3c,0xbf52a649bf32c8c9,0xbf79f35ebf6aab7b
.quad 0xbf7853f8bf6c835e,0xbf7fb10fbf7ec46d,0xbf79f35ebf6ed89e,0xbf7f1f49bf7f6ac7,0xbf7b61fcbf710908,0xbf7e4323bf7fd397,0xbf7c9f8abf731447,0xbf7d1cddbf7ffec4
.quad 0xbf7dabccbf74fa0b,0xbf7baccdbf7fec43,0xbf7e868bbf76ba07,0xbf79f35ebf7f9c18,0xbf7f2f9dbf7853f8,0xbf77f110bf7f0e58,0xbf7fa6e3bf79c79d,0xbf75a67bbf7e4323
.quad 0xbf7fec43bf7b14be,0xbf731447bf7d3aac,0xbf7fffb1bf7c3b28,0xbf703b37bf7bf531,0xbf7fe129bf7d3aac,0xbf6d1c1dbf7a7302,0xbf7f90b1bf7e1324,0xbf69b7e4bf78b47b
.quad 0xbf7f0e58bf7ec46d,0xbf660f88bf76ba07,0xbf7e5a38bf7f4e6d,0xbf62241abf748422,0xbf7d7474bf7fb10f,0xbf5df6bebf721352,0xbf7c5d3abf7fec43,0xbf5988adbf6f6830
.quad 0xbf710908bf7b14be,0xbf4d9f02bf61c598,0xbf6d67a1bf791298,0xbf466354bf5c61c7,0xbf696591bf76ba07,0xbf3ebc1bbf5695e5,0xbf650479bf740bdd,0xbf36ad7fbf5064af
.quad 0xbf604621bf710908,0xbf2e3bdebf49d112,0xbf5b2c79bf6db293,0xbf256bcbbf42de29,0xbf55b993bf6a09a7,0xbf1c420cbf3b8f3b,0xbf4fefa8bf660f88,0xbf12c39abf33e7bc
.quad 0xbf49d112bf61c598,0xbf08f59bbf2beb4a,0xbf436051bf5d2d53,0xbefdbabbbf239da9,0xbf3ca003bf584853,0xbee900b7bf1b02c6,0xbf3592e7bf531849,0xbed3c867bf121eb0
.quad 0xbf2e3bdebf4d9f02,0xbebe1d4abf08f59b,0xbf269de3bf47de65,0xbea80b1fbeff17b2,0xbf1ebc12bf41d870,0xbe919dddbeebcbbb,0xbf16999fbf3b8f3b,0xbe75c35abed8106b
.quad 0xbf4d9f02bf3504f3,0xbf710908bf61c598,0xbf554aa4bf3daef9,0xbf75a67bbf6816a8,0xbf5c61c7bf45e403,0xbf796e4ebf6db293,0xbf62df7bbf4d9f02,0xbf7c5d3abf7294f8
.quad 0xbf68bf3cbf54db31,0xbf7e70b0bf76ba07,0xbf6dfcf2bf5b941a,0xbf7fa6e3bf7a1e84,0xbf7294f8bf61c598,0xbf7ffec4bf7cbfc9,0xbf76841bbf676bd8,0xbf7f7808bf7e9bc9
.quad 0xbf79c79dbf6c835e,0xbf7e1324bf7fb10f,0xbf7c5d3abf710908,0xbf7bd14dbf7ffec4,0xbf7e4323bf74fa0b,0xbf78b47bbf7f84ab,0xbf7f7808bf7853f8,0xbf74bf62bf7e4323
.quad 0xbf7ffb11bf7b14be,0xbf6ff573bf7c3b28,0xbf7fcbe2bf7d3aac,0xbf6a5ad9bf796e4e,0xbf7eea9dbf7ec46d,0xbf63f473bf75dec6,0xbf7d57debf7fb10f,0xbf5cc7d1bf718f57
.quad 0xbf7fb10fbf7b14be,0xbf7853f8bf7ec46d,0xbf7ff84abf7dabcc,0xbf73530ebf7c7eb0,0xbf7f2f9dbf7f4e6d,0xbf6d1c1dbf791298,0xbf7d57debf7ffb11,0xbf65b710bf748422
.quad 0xbf7a7302bf7fb10f,0xbf5d2d53bf6ed89e,0xbf76841bbf7e70b0,0xbf5389c7bf6816a8,0xbf718f57bf7c3b28,0xbf48d8b3bf604621,0xbf6b99fbbf791298,0xbf3d27b8bf577026
.quad 0xbf64aa59bf74fa0b,0xbf3085bbbf4d9f02,0xbf5cc7d1bf6ff573,0xbf2302d3bf42de29,0xbf53fac3bf6a09a7,0xbf14b039bf373a23,0xbf4a4c87bf633c5a,0xbf05a02cbf2ac082
.quad 0xbf3fc767bf5b941a,0xbeebcbbbbf1d7fd1,0xbf34768fbf531849,0xbecb2aaebf0f8784,0xbf286605bf49d112,0xbea986c4bf00e7e4,0xbf1ba299bf3fc767,0xbe870adabee363fa
.quad 0xbf5b941abf6c835e,0xbf2beb4abf45e403,0xbf50d937bf64aa59,0xbf1ba299bf385216,0xbf44e3f5bf5b941a,0xbf0a48adbf299415,0xbf37c655bf514d3d,0xbeeff7fbbf19c200
.quad 0xbf299415bf45e403,0xbec9b953bf08f59b,0xbf1a6293bf396842,0xbea21887beee9479,0xbf0a48adbf2beb4a,0xbe72b651bec9b953,0xbef2bd43bf1d7fd1,0xbe1f917bbea395c5
.quad 0xbecf7bcabf0e39da,0xbd96a905be78cfcc,0xbeab0201befc5d27,0x3c16cb58be28defc,0xbe8586cebedae880,0x3dbc3ac3bdafb680,0xbe3e853ebeb8442a,0x3e3228d4bbc90f88
.quad 0xbde1bc2ebe94a031,0x3e827dc03d96a905,0xbd0a342fbe605c13,0x3eab02013e1c76de,0x3d2fe007be164083,0x3ed25a093e6c9a7f,0x3df475c0bd96a905,0x3ef840c83e9d9e78
.quad 0xbedae880bf0e39da,0xbe164083be94a031,0xbeb0eacbbef6e0cb,0xbd55880ebe4dee60,0xbe8586cebecf7bca,0x3d2fe007bde1bc2e,0xbe3228d4bea68f12,0x3e0cec4abc96c9b6
.quad 0xbdafb680be78cfcc,0x3e6c9a7f3d96a905,0x3b490fc6be22abb6,0x3ea5129f3e28defc,0x3dbc3ac3bd96a905,0x3ed25a093e827dc0,0x3e3857ec3c490e90,0x3efdbabb3eaf713a
.quad 0x3e888e933dc8bd36,0x3f13682a3edae880,0x3eb3dca53e3b6ecf,0x3f269de33f0242b1,0x3eddbe793e888e93,0x3f3852163f15f6d9,0x3f02ef9f3eb263ef,0x3f485bca3f286605
.quad 0x3f15f6d93edae880,0x3f5695e53f396842,0x3f27ce613f00e7e4,0x3f62df7b3f48d8b3,0x3f3852163f13682a,0x3f6d1c1d3f5695e5,0x3f4760853f24d225,0x3f75341d3f628210
.quad 0xbf187fc0bf3504f3,0xbeac7cd4bef15aea,0xbf0d9281bf2beb4a,0xbe901c2cbed8106b,0xbf0242b1bf226799,0xbe667c66bebe1d4a,0xbeed3063bf187fc0,0xbe2bf804bea395c5
.quad 0xbed53641bf0e39da,0xbde1bc2ebe888e93,0xbebca7afbf039c3d,0xbd55880ebe5a3997,0xbea395c5bef15aea,0x3bc90f88be22abb6,0xbe8a11f7bedae880,0x3d83db0abdd53db9
.quad 0xbe605c13bec3ef15,0x3dfab273bd48fb30,0xbe2bf804beac7cd4,0x3e3857ec3bc90f88,0xbdee3876be94a031,0x3e72b6513d7b2b74,0xbd83db0abe78cfcc,0x3e9620d23dee3876
.quad 0xbc490e90be47c5c2,0x3eb263ef3e2f10a2,0x3d2351cbbe164083,0x3ece0bea3e667c66,0x3dbc3ac3bdc8bd36,0x3ee900b73e8e9a22,0x3e1324cabd48fb30,0x3f0195733ea986c4
.quad 0xbd48fb30be47c5c2,0x3e78cfcc3dc8bd36,0x3c7b514bbe09cf86,0x3e9f1cdf3e28defc,0x3da3308cbd96a905,0x3ec1071e3e6c9a7f,0x3e1324cabc490e90,0x3ee1fb6a3e97a117
.quad 0x3e5415013d48fb30,0x3f00e7e43eb8442a,0x3e8a11f73de1bc2e,0x3f102dd53ed8106b,0x3ea986c43e2f10a2,0x3f1ebc123ef6e0cb,0x3ec8477c3e6c9a7f,0x3f2c800f3f0a48ad
.quad 0x3ee633753e94a031,0x3f3968423f187fc0,0x3f0195733eb263ef,0x3f4564393f26050a,0x3f0f87843ecf7bca,0x3f5064af3f32c8c9,0x3f1ce11f3eebcbbb,0x3f5a5ba03f3ebc1b
.quad 0x3f2994153f039c3d,0x3f633c5a3f49d112,0x3f3592e73f10d3cd,0x3f6afb8c3f53fac3,0x3f40d0da3f1d7fd1,0x3f718f573f5d2d53,0x3f4b41fa3f299415,0x3f76ef5b3f655e0b
.quad 0x3f039c3d3ec3ef15,0x3f3daef93f226799,0x3f140c5f3ee63375,0x3f4b41fa3f31a81d,0x3f239da93f039c3d,0x3f5770263f3fc767,0x3f3238aa3f13682a,0x3f62241a3f4cae79
.quad 0x3f3fc7673f226799,0x3f6b4b0c3f584853,0x3f4c35783f3085bb,0x3f72d4eb3f628210,0x3f5770263f3daef9,0x3f78b47b3f6b4b0c,0x3f61668a3f49d112,0x3f7cdf6c3f7294f8
.quad 0x3f6a09a73f54db31,0x3f7f4e6d3f7853f8,0x3f714c7a3f5ebe05,0x3f7ffd393f7c7eb0,0x3f7724173f676bd8,0x3f7eea9d3f7f0e58,0x3f7b87b23f6ed89e,0x3f7c187a3f7ffec4
.quad 0x3f7e70b03f74fa0b,0x3f778bc53f7f4e6d,0x3f7fdaaf3f79c79d,0x3f714c7a3f7cfe73,0x3f7fc38f3f7d3aac,0x3f6965913f791298,0x3f7e2b723f7f4e6d,0x3f5fe4e93f73913f
.quad 0x3f676bd83f54db31,0x3f7d3aac3f74fa0b,0x3f703b373f604621,0x3f7fa6e33f7ac516,0x3f7724173f6a09a7,0x3f7fc38f3f7e70b0,0x3f7c187a3f721352,0x3f7d906e3f7ff4e6
.quad 0x3f7f0e583f7853f8,0x3f7912983f7f4e6d,0x3f7fffb13f7cbfc9,0x3f7254703f7c7eb0,0x3f7eea9d3f7f4e6d,0x3f6965913f778bc5,0x3f7bd14d3f7ffb11,0x3f5e5aa63f708066
.quad 0x3f76ba073f7ec46d,0x3f514d3d3f676bd8,0x3f6faf1b3f7baccd,0x3f425b893f5c61c7,0x3f66becc3f76ba07,0x3f31a81d3f4f7a1f,0x3f5bfb343f6ff573,0x3f1f599f3f40d0da
.quad 0x3f4f7a1f3f676bd8,0x3f0b9a6b3f3085bb,0x3f4154e13f5d2d53,0x3eed30633f1ebc12,0x3f31a81d3f514d3d,0x3ec1071e3f0b9a6b,0x3f2093933f43e200,0x3e931f353eee9479
.quad 0x3f8000003f800000,0x3f8000003f800000,0x3f7d1cdd3f7d3aac,0x3f7cdf6c3f7cfe73,0x3f7484223f74fa0b,0x3f73913f3f740bdd,0x3f6667713f676bd8,0x3f644fac3f655e0b
.quad 0x3f5318493f54db31,0x3f4f7a1f3f514d3d,0x3f3b06293f3daef9,0x3f3592e73f385216,0x3f1ebc123f226799,0x3f173c073f1b02c6,0x3efdbabb3f039c3d,0x3eea66813ef41f07
.quad 0x3eb8442a3ec3ef15,0x3ea09ae53eac7cd4,0x3e5d4b1a3e78cfcc,0x3e25c58c3e419b37,0x3d8a200a3dc8bd36,0x3bc90f883d16c32c,0xbda973babd48fb30,0xbe195be0bdee3876
.quad 0xbe6c9a7fbe47c5c2,0xbe9aa086be888e93,0xbebf926fbeac7cd4,0xbee4cbfebed25a09,0xbf0242b1bef15aea,0xbf14b039bf0b9a6b,0xbf21cbfbbf187fc0,0xbf33587abf2ac082
.quad 0x3f8000003f800000,0x3f8000003f800000,0x3f7c9f8a3f7cbfc9,0x3f7c5d3a3f7c7eb0,0x3f7294f83f731447,0x3f718f573f721352,0x3f62241a3f633c5a,0x3f5fe4e93f6106f2
.quad 0x3f4bbbf83f4d9f02,0x3f47de653f49d112,0x3f2ff3e63f32c8c9,0x3f2a2a803f2d1469,0x3f0f87843f13682a,0x3f07a1363f0b9a6b,0x3ed6a3993ee0924f,0x3ec27b553ecc9b8b
.quad 0x3e888e933e94a031,0x3e605c133e78cfcc,0x3ddb7d373e09cf86,0x3d55880e3da3308c,0xbd621469bcc90ab0,0xbdee3876bdafb680,0xbe5d4b1abe3b6ecf,0xbe901c2cbe7ee6e1
.quad 0xbebe1d4abeac7cd4,0xbee0924fbecf7bca,0xbf044889bef6e0cb,0xbf1553b7bf0cead0,0xbf26050abf1d7fd1,0xbf36206cbf2e3bde,0xbf436051bf3b8f3b,0xbf51c0c2bf4ac77f
.quad 0x3f8000003f800000,0x3f8000003f800000,0x3f7c187a3f7c3b28,0x3f7bd14d3f7bf531,0x3f7080663f710908,0x3f6f68303f6ff573,0x3f5d924d3f5ebe05,0x3f5b2c793f5c61c7
.quad 0x3f43e2003f45e403,0x3f3fc7673f41d870,0x3f24381a3f273656,0x3f1e1e223f212ff9,0x3eff17b23f039c3d,0x3eee94793ef6e0cb,0x3eadf73c3eb8442a,0x3e9920fe3ea395c5
.quad 0x3e2f10a23e47c5c2,0x3dfab2733e164083,0xbb490fc63cc90ab0,0xbd6ea038bcfb49ba,0xbe354098be164083,0xbe72b651be541501,0xbeb0eacbbea09ae5,0xbed0eb2abec1071e
.quad 0xbf00e7e4bef15aea,0xbf10d3cdbf08f59b,0xbf256bcbbf1d7fd1,0xbf34768fbf2d1469,0xbf44e3f5bf3daef9,0xbf5233c6bf4bbbf8,0xbf5e5aa6bf584853,0xbf6912aebf63f473
.quad 0x3f8000003f800000,0x3f8000003f800000,0x3f7b87b23f7baccd,0x3f7b3bab3f7b61fc,0x3f6e46be3f6ed89e,0x3f6d1c1d3f6db293,0x3f58b3a13f59f26a,0x3f5627fe3f577026
.quad 0x3f3b8f3b3f3daef9,0x3f373a233f396842,0x3f17de123f1b02c6,0x3f11796b3f14b039,0x3eddbe793ee63375,0x3ecc9b8b3ed53641,0x3e8402703e8e9a22,0x3e5d4b1a3e72b651
.quad 0x3d96a9053dc8bd36,0x3cc90ab03d48fb30,0xbde7fa9abdafb680,0xbe2bf804be1008b7,0xbe97a117be888e93,0xbeb554ecbea68f12,0xbeeff7fbbee0924f,0xbf06f686beff17b2
.quad 0xbf1ff6cbbf187fc0,0xbf2e3bdebf273656,0xbf425b89bf3b8f3b,0xbf4f0417bf48d8b3,0xbf5df6bebf584853,0xbf6816a8bf633c5a,0xbf71d19fbf6db293,0xbf788486bf756d97
.quad 0x0,0x0,0x3e195be03e164083,0x3e1f917b3e1c76de,0x3e97a1173e94a031,0x3e9d9e783e9aa086,0x3edf28a93edae880,0x3ee79a5d3ee363fa
.quad 0x3f10d3cd3f0e39da,0x3f15f6d93f13682a,0x3f2ecef73f2beb4a,0x3f34768f3f31a81d,0x3f48d8b33f45e403,0x3f4e8d903f4bbbf8,0x3f5e5aa63f5b941a,0x3f6398ac3f6106f2
.quad 0x3f6ed89e3f6c835e,0x3f7314473f710908,0x3f79f35e3f7853f8,0x3f7c9f8a3f7b61fc,0x3f7f6ac73f7ec46d,0x3f7ffec43f7fd397,0x3f7f1f493f7fb10f,0x3f7d1cdd3f7e4323
.quad 0x3f7912983f7b14be,0x3f740bdd3f76ba07,0x3f6d67a13f710908,0x3f6504793f696591,0x3f5c61c73f61c598,0x3f5064af3f5695e5,0x3f4663543f4d9f02,0x3f36ad7f3f3ebc1b
.quad 0x0,0x0,0x3e25c58c3e22abb6,0x3e2bf8043e28defc,0x3ea395c53ea09ae5,0x3ea986c43ea68f12,0x3eeff7fb3eebcbbb,0x3ef840c83ef41f07
.quad 0x3f1b02c63f187fc0,0x3f1ff6cb3f1d7fd1,0x3f39f2ac3f373a23,0x3f3f41fc3f3ca003,0x3f53fac33f514d3d,0x3f591e6a3f5695e5,0x3f686b393f660f88,0x3f6cd0073f6aab7b
.quad 0x3f76ba073f74fa0b,0x3f79c79d3f7853f8,0x3f7e868b3f7dabcc,0x3f7fa6e33f7f2f9d,0x3f7f9c183f7fec43,0x3f7e43233f7f0e58,0x3f79f35e3f7baccd,0x3f75a67b3f77f110
.quad 0x3f6db2933f710908,0x3f660f883f6a09a7,0x3f5b2c793f604621,0x3f4fefa83f55b993,0x3f42de293f49d112,0x3f33e7bc3f3b8f3b,0x3f256bcb3f2e3bde,0x3f12c39a3f1c420c
.quad 0x0,0x0,0x3e3228d43e2f10a2,0x3e3857ec3e354098,0x3eaf713a3eac7cd4,0x3eb554ec3eb263ef,0x3f003a063efc5d27,0x3f0448893f0242b1
.quad 0x3f24d2253f226799,0x3f2994153f273656,0x3f4463373f41d870,0x3f4955213f46e22a,0x3f5df6be3f5b941a,0x3f6282103f604621,0x3f70c5013f6ed89e,0x3f74484b3f7294f8
.quad 0x3f7c3b283f7b14be,0x3f7e13243f7d3aac,0x3f7fffb13f7fec43,0x3f7f90b13f7fe129,0x3f7bf5313f7d3aac,0x3f78b47b3f7a7302,0x3f703b373f731447,0x3f69b7e43f6d1c1d
.quad 0x3f5d2d533f61c598,0x3f5318493f584853,0x3f4360513f49d112,0x3f3592e73f3ca003,0x3f239da93f2beb4a,0x3f121eb03f1b02c6,0x3efdbabb3f08f59b,0x3ed3c8673ee900b7
.quad 0x0,0x0,0x3e3e853e3e3b6ecf,0x3e44b0b93e419b37,0x3ebb31a03eb8442a,0x3ec1071e3ebe1d4a,0x3f084b923f064b82,0x3f0c42c93f0a48ad
.quad 0x3f2e3bde3f2beb4a,0x3f32c8c93f3085bb,0x3f4e16893f4bbbf8,0x3f52a6493f5064af,0x3f66becc3f64aa59,0x3f6aab7b3f68bf3c,0x3f77583a3f75dec6,0x3f79f35e3f78b47b
.quad 0x3f7f4e6d3f7ec46d,0x3f7fec433f7fb10f,0x3f7e5a383f7f0e58,0x3f7c5d3a3f7d7474,0x3f7484223f76ba07,0x3f6f68303f721352,0x3f62241a3f660f88,0x3f5988ad3f5df6be
.quad 0x3f47de653f4d9f02,0x3f3b8f3b3f41d870,0x3f269de33f2e3bde,0x3f16999f3f1ebc12,0x3eff17b23f08f59b,0x3ed8106b3eebcbbb,0x3ea80b1f3ebe1d4a,0x3e75c35a3e919ddd
.quad 0xbf3daef9bf3504f3,0xbf4d9f02bf45e403,0xbf554aa4bf4d9f02,0xbf62df7bbf5c61c7,0xbf6816a8bf61c598,0xbf7294f8bf6db293,0xbf75a67bbf710908,0xbf7c5d3abf796e4e
.quad 0xbf7dabccbf7b14be,0xbf7ffb11bf7f4e6d,0xbf7ff84abf7fb10f,0xbf7d57debf7f2f9d,0xbf7c7eb0bf7ec46d,0xbf748422bf791298,0xbf73530ebf7853f8,0xbf65b710bf6d1c1d
.quad 0xbf64aa59bf6c835e,0xbf514d3dbf5b941a,0xbf50d937bf5b941a,0xbf37c655bf44e3f5,0xbf385216bf45e403,0xbf19c200bf299415,0xbf1ba299bf2beb4a,0xbeeff7fbbf0a48ad
.quad 0xbef6e0cbbf0e39da,0xbea68f12becf7bca,0xbeb0eacbbedae880,0xbe3228d4be8586ce,0xbe4dee60be94a031,0xbc96c9b6bde1bc2e,0xbd55880ebe164083,0x3e0cec4a3d2fe007
.quad 0xbf5b941abf54db31,0xbf676bd8bf61c598,0xbf6dfcf2bf68bf3c,0xbf76841bbf7294f8,0xbf7a1e84bf76ba07,0xbf7e9bc9bf7cbfc9,0xbf7fa6e3bf7e70b0,0xbf7f7808bf7ffec4
.quad 0xbf7e70b0bf7fb10f,0xbf791298bf7c3b28,0xbf76841bbf7a7302,0xbf6b99fbbf718f57,0xbf6816a8bf6ed89e,0xbf577026bf604621,0xbf5389c7bf5d2d53,0xbf3d27b8bf48d8b3
.quad 0xbf396842bf45e403,0xbf1d7fd1bf2beb4a,0xbf1a6293bf299415,0xbef2bd43bf0a48ad,0xbeee9479bf08f59b,0xbea395c5bec9b953,0xbea21887bec9b953,0xbe1f917bbe72b651
.quad 0xbe22abb6be78cfcc,0x3c490e90bd96a905,0x3b490fc6bdafb680,0x3e3857ec3dbc3ac3,0x3e28defc3d96a905,0x3eaf713a3e827dc0,0x3ea5129f3e6c9a7f,0x3efdbabb3ed25a09
.quad 0xbf710908bf6c835e,0xbf7853f8bf74fa0b,0xbf7c5d3abf79c79d,0xbf7f7808bf7e4323,0xbf7ffec4bf7fb10f,0xbf7e4323bf7f84ab,0xbf7bd14dbf7e1324,0xbf74bf62bf78b47b
.quad 0xbf6ff573bf74fa0b,0xbf633c5abf6a09a7,0xbf5cc7d1bf64aa59,0xbf4a4c87bf53fac3,0xbf42de29bf4d9f02,0xbf2ac082bf373a23,0xbf2302d3bf3085bb,0xbf05a02cbf14b039
.quad 0xbefc5d27bf0e39da,0xbeb8442abedae880,0xbeab0201becf7bca,0xbe3e853ebe8586ce,0xbe28defcbe78cfcc,0xbbc90f88bdafb680,0x3c16cb58bd96a905,0x3e3228d43dbc3ac3
.quad 0x3e3b6ecf3dc8bd36,0x3eb263ef3e888e93,0x3eb3dca53e888e93,0x3f02ef9f3eddbe79,0x3f0242b13edae880,0x3f2866053f15f6d9,0x3f269de33f13682a,0x3f485bca3f385216
.quad 0xbf7d3aacbf7b14be,0xbf7fb10fbf7ec46d,0xbf7fcbe2bf7ffb11,0xbf7d57debf7eea9d,0xbf796e4ebf7c3b28,0xbf718f57bf75dec6,0xbf6a5ad9bf6ff573,0xbf5cc7d1bf63f473
.quad 0xbf531849bf5b941a,0xbf3fc767bf49d112,0xbf34768fbf3fc767,0xbf1ba299bf286605,0xbf0f8784bf1d7fd1,0xbee363fabf00e7e4,0xbecb2aaebeebcbbb,0xbe870adabea986c4
.quad 0xbe605c13be94a031,0xbd96a905be164083,0xbd0a342fbde1bc2e,0x3df475c03d2fe007,0x3e1c76de3d96a905,0x3e9d9e783e6c9a7f,0x3eab02013e827dc0,0x3ef840c83ed25a09
.quad 0x3f00e7e43edae880,0x3f24d2253f13682a,0x3f27ce613f15f6d9,0x3f4760853f385216,0x3f48d8b33f396842,0x3f6282103f5695e5,0x3f62df7b3f5695e5,0x3f75341d3f6d1c1d
.quad 0x3f2beb4a3f3504f3,0x3f187fc03f226799,0x3f0d92813f187fc0,0x3eed30633f0242b1,0x3ed8106b3ef15aea,0x3ea395c53ebe1d4a,0x3e901c2c3eac7cd4,0x3e2bf8043e667c66
.quad 0x3e09cf863e47c5c2,0x3c490e903d96a905,0xbc7b514b3d48fb30,0xbe1324cabda3308c,0xbe28defcbdc8bd36,0xbe97a117be6c9a7f,0xbe9f1cdfbe78cfcc,0xbee1fb6abec1071e
.quad 0xbee63375bec3ef15,0xbf13682abf039c3d,0xbf140c5fbf039c3d,0xbf3238aabf239da9,0xbf31a81dbf226799,0xbf4cae79bf3fc767,0xbf4b41fabf3daef9,0xbf62241abf577026
.quad 0xbf604621bf54db31,0xbf721352bf6a09a7,0xbf703b37bf676bd8,0xbf7c187abf772417,0xbf7ac516bf74fa0b,0xbf7ff4e6bf7e70b0,0xbf7fa6e3bf7d3aac,0xbf7d906ebf7fc38f
.quad 0x3f039c3d3f0e39da,0x3edae8803ef15aea,0x3ebca7af3ed53641,0x3e8a11f73ea395c5,0x3e5a39973e888e93,0x3dd53db93e22abb6,0x3d55880e3de1bc2e,0xbd83db0abbc90f88
.quad 0xbde1bc2ebd48fb30,0xbe6c9a7fbe2f10a2,0xbe8a11f7be541501,0xbec8477cbea986c4,0xbed8106bbeb8442a,0xbf0a48adbef6e0cb,0xbf102dd5bf00e7e4,0xbf2c800fbf1ebc12
.quad 0xbf3085bbbf226799,0xbf49d112bf3daef9,0xbf4c3578bf3fc767,0xbf61668abf577026,0xbf628210bf584853,0xbf7294f8bf6b4b0c,0xbf72d4ebbf6b4b0c,0xbf7cdf6cbf78b47b
.quad 0xbf7cbfc9bf7853f8,0xbf7ffb11bf7f4e6d,0xbf7fffb1bf7f0e58,0xbf7bd14dbf7eea9d,0xbf7c7eb0bf7f4e6d,0xbf708066bf778bc5,0xbf725470bf791298,0xbf5e5aa6bf696591
.quad 0x3eac7cd43ec3ef15,0x3e78cfcc3e94a031,0x3e2bf8043e605c13,0x3d83db0a3dee3876,0xbbc90f883d48fb30,0xbdee3876bd7b2b74,0xbe3857ecbdfab273,0xbe9620d2be72b651
.quad 0xbeb263efbe94a031,0xbeebcbbbbecf7bca,0xbf019573bee63375,0xbf1ce11fbf0f8784,0xbf26050abf187fc0,0xbf3ebc1bbf32c8c9,0xbf456439bf396842,0xbf5a5ba0bf5064af
.quad 0xbf5ebe05bf54db31,0xbf6ed89ebf676bd8,0xbf714c7abf6a09a7,0xbf7b87b2bf772417,0xbf7c7eb0bf7853f8,0xbf7ffec4bf7f0e58,0xbf7ffd39bf7f4e6d,0xbf7c187abf7eea9d
.quad 0xbf7baccdbf7ec46d,0xbf6ff573bf76ba07,0xbf6faf1bbf76ba07,0xbf5bfb34bf66becc,0xbf5c61c7bf676bd8,0xbf40d0dabf4f7a1f,0xbf425b89bf514d3d,0xbf1f599fbf31a81d
.quad 0x3e1640833e47c5c2,0x3d48fb303dc8bd36,0xbd2351cb3c490e90,0xbe1324cabdbc3ac3,0xbe667c66be2f10a2,0xbea986c4be8e9a22,0xbece0beabeb263ef,0xbf019573bee900b7
.quad 0xbf10d3cdbf039c3d,0xbf299415bf1d7fd1,0xbf3592e7bf299415,0xbf4b41fabf40d0da,0xbf53fac3bf49d112,0xbf655e0bbf5d2d53,0xbf6afb8cbf633c5a,0xbf76ef5bbf718f57
.quad 0xbf79c79dbf74fa0b,0xbf7f4e6dbf7d3aac,0xbf7fdaafbf7e70b0,0xbf7e2b72bf7fc38f,0xbf7cfe73bf7f4e6d,0xbf73913fbf791298,0xbf714c7abf778bc5,0xbf5fe4e9bf696591
.quad 0xbf5d2d53bf676bd8,0xbf43e200bf514d3d,0xbf4154e1bf4f7a1f,0xbf209393bf31a81d,0xbf1ebc12bf3085bb,0xbeee9479bf0b9a6b,0xbeed3063bf0b9a6b,0xbe931f35bec1071e

.section .rodata,"a"
.p2align 6
.amdhsa_kernel gated_mix__spectral_gfnet__dense_activation_gelu__prompt_kernel
  .amdhsa_next_free_vgpr 256
  .amdhsa_next_free_sgpr 102
  .amdhsa_accum_offset 256
  .amdhsa_group_segment_fixed_size 0
  .amdhsa_kernarg_size 96
  .amdhsa_user_sgpr_count 2
  .amdhsa_user_sgpr_kernarg_segment_ptr 1
  .amdhsa_system_sgpr_workgroup_id_x 1
  .amdhsa_float_denorm_mode_32 3
.end_amdhsa_kernel
```
